```python
import torch

def _softmax(x, axis=-1):
    return torch.softmax(x, dim=axis)
def _gelu(x):
    return torch.nn.functional.gelu(x, approximate="tanh")
def _silu(x):
    return torch.nn.functional.silu(x)
def _sigmoid(x):
    return torch.sigmoid(x)
def _layernorm(x, axis=-1, eps=1e-5):
    m = x.mean(dim=axis, keepdim=True)
    v = x.var(dim=axis, keepdim=True, unbiased=False)
    return (x - m) / torch.sqrt(v + eps)
def _scatter_add(tgt, idx, src, axis=0):
    return tgt.clone().index_add_(axis, idx, src)
def _segment_sum(src, seg, n):
    out = torch.zeros((n,) + src.shape[1:], dtype=src.dtype)
    return out.index_add_(0, seg, src)
def _pad(x, pw):
    flat = tuple(v for pair in reversed(pw) for v in pair)
    return torch.nn.functional.pad(x, flat)

kernel_name = 'concat_heads__gqa_block_cached__mha_block_cached__near_ridge'

def setup_inputs():

    _w = (lambda a: (lambda t: t.to(torch.bfloat16) if t.is_floating_point() else t)(torch.as_tensor(a)))
    def _A_setup():
        B, Sq, D = 16, 112, 640
        Hq, Hkv, Sk, Dh = 32, 32, 512, 128
        assert Hq % Hkv == 0, (Hq, Hkv)
        return {
            "x": _w((lambda *s: torch.randn(*s, dtype=torch.bfloat16) * 0.8)(B, Sq, D)),
            "k_cache": _w((lambda *s: torch.randn(*s, dtype=torch.bfloat16) * 0.8)(B, Hkv, Sk, Dh)),
            "v_cache": _w((lambda *s: torch.randn(*s, dtype=torch.bfloat16) * 0.05)(B, Hkv, Sk, Dh)),
            "wq": _w((lambda *s: torch.randn(*s, dtype=torch.bfloat16) * 0.8)(D, Hq * Dh) * (D ** -0.5)),
            "wo": _w((lambda *s: torch.randn(*s, dtype=torch.bfloat16) * 0.05)(Hq * Dh, D) * ((Hq * Dh) ** -0.5)),
        }
    _A_in = _A_setup()

    def _B_setup():
        B, Sq, D = 16, 112, 640
        H, Sk, Dh = 32, 512, 128
        return {
            "x": _w((lambda *s: torch.randn(*s, dtype=torch.bfloat16) * 0.8)(B, Sq, D)),
            "k_cache": _w((lambda *s: torch.randn(*s, dtype=torch.bfloat16) * 0.8)(B, H, Sk, Dh)),
            "v_cache": _w((lambda *s: torch.randn(*s, dtype=torch.bfloat16) * 0.05)(B, H, Sk, Dh)),
            "wq": _w((lambda *s: torch.randn(*s, dtype=torch.bfloat16) * 0.8)(D, H * Dh) * (D ** -0.5)),
            "wo": _w((lambda *s: torch.randn(*s, dtype=torch.bfloat16) * 0.05)(H * Dh, D) * ((H * Dh) ** -0.5)),
        }
    _B_in = _B_setup()

    return {
        "A_x": _A_in["x"],
        "A_k_cache": _A_in["k_cache"],
        "A_v_cache": _A_in["v_cache"],
        "A_wq": _A_in["wq"],
        "A_wo": _A_in["wo"],
        "B_x": _B_in["x"],
        "B_k_cache": _B_in["k_cache"],
        "B_v_cache": _B_in["v_cache"],
        "B_wq": _B_in["wq"],
        "B_wo": _B_in["wo"],
    }

def reference(A_x, A_k_cache, A_v_cache, A_wq, A_wo, B_x, B_k_cache, B_v_cache, B_wq, B_wo):
    def _A_ref(x, k_cache, v_cache, wq, wo):
        B, Sq, D = x.shape
        Hq, Dh = 32, 128
        Hkv = k_cache.shape[1]
        rep = Hq // Hkv
        q = (lambda x, *d: x.permute(*d))((x @ wq).reshape(B, Sq, Hq, Dh), 0, 2, 1, 3)
        k = (lambda x, n, axis: torch.repeat_interleave(x, n, dim=axis))(k_cache, rep, axis=1)
        v = (lambda x, n, axis: torch.repeat_interleave(x, n, dim=axis))(v_cache, rep, axis=1)
        scores = torch.einsum("bhqd,bhkd->bhqk", q, k) * (Dh ** -0.5)
        p = _softmax(scores, axis=-1)
        o = torch.einsum("bhqk,bhkd->bhqd", p, v)
        return (lambda x, *d: x.permute(*d))(o, 0, 2, 1, 3).reshape(B, Sq, Hq * Dh) @ wo

    def _B_ref(x, k_cache, v_cache, wq, wo):
        B, Sq, D = x.shape
        H, Dh = 32, 128
        q = (lambda x, *d: x.permute(*d))((x @ wq).reshape(B, Sq, H, Dh), 0, 2, 1, 3)
        scores = torch.einsum("bhqd,bhkd->bhqk", q, k_cache) * (Dh ** -0.5)
        p = _softmax(scores, axis=-1)
        o = torch.einsum("bhqk,bhkd->bhqd", p, v_cache)
        return (lambda x, *d: x.permute(*d))(o, 0, 2, 1, 3).reshape(B, Sq, H * Dh) @ wo

    a = _A_ref(A_x, A_k_cache, A_v_cache, A_wq, A_wo)
    b = _B_ref(B_x, B_k_cache, B_v_cache, B_wq, B_wo)
    return torch.concatenate([a, b], axis=-1)
```

```asm
; @launch grid=(256,1,1) block=(256,1,1) lds=163840
.amdgcn_target "amdgcn-amd-amdhsa--gfx950"
.text
.globl concat_heads__gqa_block_cached__mha_block_cached__near_ridge_kernel
.p2align 8
.type concat_heads__gqa_block_cached__mha_block_cached__near_ridge_kernel,@function
concat_heads__gqa_block_cached__mha_block_cached__near_ridge_kernel:
A_code_start:
    s_cmp_ge_u32 s2, 256
    s_cbranch_scc1 A_end
    s_load_dwordx8 s[52:59], s[0:1], 0
    s_load_dwordx8 s[60:67], s[0:1], 40
    s_load_dwordx2 s[68:69], s[0:1], 96
    s_load_dwordx2 s[82:83], s[0:1], 32
    s_load_dwordx2 s[84:85], s[0:1], 72
    s_load_dwordx2 s[100:101], s[0:1], 80
    s_load_dwordx2 s[90:91], s[0:1], 88
    v_lshrrev_b32_e32 v1, 6, v0
    v_and_b32_e32 v0, 63, v0
    s_and_b32 s3, s2, 7
    v_readfirstlane_b32 s28, v1
    s_lshr_b32 s4, s2, 3
    s_lshr_b32 s5, s3, 2
    s_and_b32 s6, s3, 3
    s_lshl_b32 s6, s6, 1
    s_and_b32 s7, s4, 1
    s_add_u32 s6, s6, s7
    s_lshr_b32 s4, s4, 1
    v_and_b32_e32 v3, 15, v0
    v_lshrrev_b32_e32 v4, 4, v0
    s_lshl_b32 s70, s28, 13
    s_mul_i32 s71, s28, 40960
    v_mul_u32_u24_e32 v11, 1280, v4
    v_add_u32_e32 v5, 0, v4
    v_xor_b32_e32 v5, v5, v3
    v_lshlrev_b32_e32 v5, 4, v5
    v_add3_u32 v144, v5, v11, s71
    v_add_u32_e32 v5, 4, v4
    v_xor_b32_e32 v5, v5, v3
    v_lshlrev_b32_e32 v5, 4, v5
    v_add3_u32 v145, v5, v11, s71
    v_add_u32_e32 v5, 8, v4
    v_xor_b32_e32 v5, v5, v3
    v_lshlrev_b32_e32 v5, 4, v5
    v_add3_u32 v146, v5, v11, s71
    v_add_u32_e32 v5, 12, v4
    v_xor_b32_e32 v5, v5, v3
    v_lshlrev_b32_e32 v5, 4, v5
    v_add3_u32 v147, v5, v11, s71
    v_add_u32_e32 v5, 0, v4
    v_lshlrev_b32_e32 v5, 1, v5
    v_xor_b32_e32 v5, v5, v3
    v_lshlrev_b32_e32 v12, 4, v5
    v_lshl_add_u32 v12, v4, 13, v12
    v_add_u32_e32 v32, 0, v12
    v_add_u32_e32 v5, 4, v4
    v_lshlrev_b32_e32 v5, 1, v5
    v_xor_b32_e32 v5, v5, v3
    v_lshlrev_b32_e32 v12, 4, v5
    v_lshl_add_u32 v12, v4, 13, v12
    v_add_u32_e32 v33, 31744, v12
    v_add_u32_e32 v5, 0, v4
    v_lshlrev_b32_e32 v5, 1, v5
    v_xor_b32_e32 v5, v5, v3
    v_lshlrev_b32_e32 v12, 4, v5
    v_lshl_add_u32 v12, v4, 13, v12
    v_add_u32_e32 v34, 63488, v12
    v_add_u32_e32 v5, 4, v4
    v_lshlrev_b32_e32 v5, 1, v5
    v_xor_b32_e32 v5, v5, v3
    v_lshlrev_b32_e32 v12, 4, v5
    v_lshl_add_u32 v12, v4, 13, v12
    v_add_u32_e32 v35, 95232, v12
    s_waitcnt lgkmcnt(0)
    s_cmp_eq_u32 s5, 0
    s_cselect_b32 s52, s52, s60
    s_cselect_b32 s53, s53, s61
    s_cselect_b32 s54, s54, s62
    s_cselect_b32 s55, s55, s63
    s_cselect_b32 s56, s56, s64
    s_cselect_b32 s57, s57, s65
    s_cselect_b32 s58, s58, s66
    s_cselect_b32 s59, s59, s67
    s_cselect_b32 s82, s82, s84
    s_cselect_b32 s83, s83, s85
    s_mul_i32 s7, s4, 143360
    s_add_u32 s24, s52, s7
    s_addc_u32 s25, s53, 0
    s_mov_b32 s26, 143360
    s_mov_b32 s27, 0x20000
    s_lshl_b32 s86, s6, 2
    s_lshl_b32 s71, s86, 8
    s_add_u32 s16, s58, s71
    s_addc_u32 s17, s59, 0
    s_sub_u32 s18, 5242880, s71
    s_mov_b32 s19, 0x20000
    s_mov_b32 s31, 0
    s_mov_b32 s46, 256
    s_cmp_eq_u32 s28, 3
    s_cbranch_scc0 A_A_start
    s_branch A_B_start
A_A_start:
    s_add_u32 m0, s70, 0
    s_mov_b32 s7, 0
    buffer_load_dwordx4 v144, s[24:27], s7 offen  lds
    s_add_u32 m0, s70, 1024
    s_mov_b32 s7, 5120
    buffer_load_dwordx4 v145, s[24:27], s7 offen  lds
    s_add_u32 m0, s70, 2048
    s_mov_b32 s7, 10240
    buffer_load_dwordx4 v146, s[24:27], s7 offen  lds
    s_add_u32 m0, s70, 3072
    s_mov_b32 s7, 15360
    buffer_load_dwordx4 v147, s[24:27], s7 offen  lds
    s_add_u32 m0, s70, 4096
    s_mov_b32 s7, 20480
    buffer_load_dwordx4 v144, s[24:27], s7 offen  lds
    s_add_u32 m0, s70, 5120
    s_mov_b32 s7, 25600
    buffer_load_dwordx4 v145, s[24:27], s7 offen  lds
    s_add_u32 m0, s70, 6144
    s_mov_b32 s7, 30720
    buffer_load_dwordx4 v146, s[24:27], s7 offen  lds
    s_add_u32 m0, s70, 7168
    s_mov_b32 s7, 35840
    buffer_load_dwordx4 v147, s[24:27], s7 offen  lds
    s_lshl_b32 s7, s4, 5
    s_add_u32 s7, s7, s86
    s_lshl_b32 s71, s7, 17
    s_add_u32 s8, s54, s71
    s_addc_u32 s9, s55, 0
    s_mov_b32 s10, 524288
    s_mov_b32 s11, 0x20000
    s_add_u32 s12, s56, s71
    s_addc_u32 s13, s57, 0
    s_mov_b32 s14, 524288
    s_mov_b32 s15, 0x20000
    s_mul_i32 s71, s86, 163840
    s_add_u32 s82, s82, s71
    s_addc_u32 s83, s83, 0
    s_lshl_b32 s71, s5, 4
    s_add_u32 s71, s71, s4
    s_lshl_b32 s71, s71, 3
    s_add_u32 s71, s71, s6
    s_mul_i32 s71, s71, 143360
    s_add_u32 s20, s68, s71
    s_addc_u32 s21, s69, 0
    s_mov_b32 s22, 143360
    s_mov_b32 s23, 0x20000
    s_lshl_b32 s38, s28, 12
    s_mov_b32 s42, 53248
    s_mov_b32 s43, 4294860800
    s_mov_b32 s41, 0x3e0293ee
    s_mov_b32 s35, 0
    s_mov_b32 s32, 0
    s_mov_b32 s29, 49152
    s_mov_b32 s30, 32768
    v_add_u32_e32 v5, 0, v4
    v_xor_b32_e32 v5, v5, v3
    v_lshlrev_b32_e32 v5, 4, v5
    v_lshl_add_u32 v224, v3, 8, v5
    v_add_u32_e32 v5, 4, v4
    v_xor_b32_e32 v5, v5, v3
    v_lshlrev_b32_e32 v5, 4, v5
    v_lshl_add_u32 v225, v3, 8, v5
    v_add_u32_e32 v5, 8, v4
    v_xor_b32_e32 v5, v5, v3
    v_lshlrev_b32_e32 v5, 4, v5
    v_lshl_add_u32 v226, v3, 8, v5
    v_add_u32_e32 v5, 12, v4
    v_xor_b32_e32 v5, v5, v3
    v_lshlrev_b32_e32 v5, 4, v5
    v_lshl_add_u32 v227, v3, 8, v5
    v_lshrrev_b32_e32 v6, 2, v3
    v_and_b32_e32 v7, 3, v0
    v_lshl_add_u32 v9, v4, 2, v6
    v_and_b32_e32 v8, 7, v9
    v_lshlrev_b32_e32 v9, 8, v9
    v_lshl_add_u32 v9, v7, 3, v9
    v_xor_b32_e32 v11, 0, v8
    v_lshl_add_u32 v228, v11, 5, v9
    v_xor_b32_e32 v11, 1, v8
    v_lshl_add_u32 v229, v11, 5, v9
    v_xor_b32_e32 v11, 2, v8
    v_lshl_add_u32 v230, v11, 5, v9
    v_xor_b32_e32 v11, 3, v8
    v_lshl_add_u32 v231, v11, 5, v9
    v_xor_b32_e32 v11, 4, v8
    v_lshl_add_u32 v232, v11, 5, v9
    v_xor_b32_e32 v11, 5, v8
    v_lshl_add_u32 v233, v11, 5, v9
    v_xor_b32_e32 v11, 6, v8
    v_lshl_add_u32 v234, v11, 5, v9
    v_xor_b32_e32 v11, 7, v8
    v_lshl_add_u32 v235, v11, 5, v9
    v_lshrrev_b32_e32 v5, 1, v4
    v_add_u32_e32 v5, 0, v5
    v_xor_b32_e32 v5, v5, v3
    v_lshlrev_b32_e32 v5, 4, v5
    v_lshl_add_u32 v5, v3, 8, v5
    v_and_b32_e32 v11, 1, v4
    v_lshl_add_u32 v5, v11, 3, v5
    v_add_u32_e32 v128, s70, v5
    v_add_u32_e32 v136, 106496, v128
    v_lshrrev_b32_e32 v5, 1, v4
    v_add_u32_e32 v5, 2, v5
    v_xor_b32_e32 v5, v5, v3
    v_lshlrev_b32_e32 v5, 4, v5
    v_lshl_add_u32 v5, v3, 8, v5
    v_and_b32_e32 v11, 1, v4
    v_lshl_add_u32 v5, v11, 3, v5
    v_add_u32_e32 v129, s70, v5
    v_add_u32_e32 v137, 106496, v129
    v_lshrrev_b32_e32 v5, 1, v4
    v_add_u32_e32 v5, 4, v5
    v_xor_b32_e32 v5, v5, v3
    v_lshlrev_b32_e32 v5, 4, v5
    v_lshl_add_u32 v5, v3, 8, v5
    v_and_b32_e32 v11, 1, v4
    v_lshl_add_u32 v5, v11, 3, v5
    v_add_u32_e32 v130, s70, v5
    v_add_u32_e32 v138, 106496, v130
    v_lshrrev_b32_e32 v5, 1, v4
    v_add_u32_e32 v5, 6, v5
    v_xor_b32_e32 v5, v5, v3
    v_lshlrev_b32_e32 v5, 4, v5
    v_lshl_add_u32 v5, v3, 8, v5
    v_and_b32_e32 v11, 1, v4
    v_lshl_add_u32 v5, v11, 3, v5
    v_add_u32_e32 v131, s70, v5
    v_add_u32_e32 v139, 106496, v131
    v_lshrrev_b32_e32 v5, 1, v4
    v_add_u32_e32 v5, 8, v5
    v_xor_b32_e32 v5, v5, v3
    v_lshlrev_b32_e32 v5, 4, v5
    v_lshl_add_u32 v5, v3, 8, v5
    v_and_b32_e32 v11, 1, v4
    v_lshl_add_u32 v5, v11, 3, v5
    v_add_u32_e32 v132, s70, v5
    v_add_u32_e32 v140, 106496, v132
    v_lshrrev_b32_e32 v5, 1, v4
    v_add_u32_e32 v5, 10, v5
    v_xor_b32_e32 v5, v5, v3
    v_lshlrev_b32_e32 v5, 4, v5
    v_lshl_add_u32 v5, v3, 8, v5
    v_and_b32_e32 v11, 1, v4
    v_lshl_add_u32 v5, v11, 3, v5
    v_add_u32_e32 v133, s70, v5
    v_add_u32_e32 v141, 106496, v133
    v_lshrrev_b32_e32 v5, 1, v4
    v_add_u32_e32 v5, 12, v5
    v_xor_b32_e32 v5, v5, v3
    v_lshlrev_b32_e32 v5, 4, v5
    v_lshl_add_u32 v5, v3, 8, v5
    v_and_b32_e32 v11, 1, v4
    v_lshl_add_u32 v5, v11, 3, v5
    v_add_u32_e32 v134, s70, v5
    v_add_u32_e32 v142, 106496, v134
    v_lshrrev_b32_e32 v5, 1, v4
    v_add_u32_e32 v5, 14, v5
    v_xor_b32_e32 v5, v5, v3
    v_lshlrev_b32_e32 v5, 4, v5
    v_lshl_add_u32 v5, v3, 8, v5
    v_and_b32_e32 v11, 1, v4
    v_lshl_add_u32 v5, v11, 3, v5
    v_add_u32_e32 v135, s70, v5
    v_add_u32_e32 v143, 106496, v135
    v_add_u32_e32 v5, 0, v4
    v_xor_b32_e32 v5, v5, v3
    v_lshlrev_b32_e32 v5, 4, v5
    v_lshl_add_u32 v5, v4, 8, v5
    v_add_u32_e32 v236, s38, v5
    v_add_u32_e32 v5, 4, v4
    v_xor_b32_e32 v5, v5, v3
    v_lshlrev_b32_e32 v5, 4, v5
    v_lshl_add_u32 v5, v4, 8, v5
    v_add_u32_e32 v237, s38, v5
    v_add_u32_e32 v5, 8, v4
    v_xor_b32_e32 v5, v5, v3
    v_lshlrev_b32_e32 v5, 4, v5
    v_lshl_add_u32 v5, v4, 8, v5
    v_add_u32_e32 v238, s38, v5
    v_add_u32_e32 v5, 12, v4
    v_xor_b32_e32 v5, v5, v3
    v_lshlrev_b32_e32 v5, 4, v5
    v_lshl_add_u32 v5, v4, 8, v5
    v_add_u32_e32 v239, s38, v5
    v_add_u32_e32 v5, 0, v4
    v_lshlrev_b32_e32 v5, 1, v5
    v_xor_b32_e32 v5, v5, v3
    v_lshlrev_b32_e32 v12, 4, v5
    v_lshl_add_u32 v12, v4, 8, v12
    v_add_u32_e32 v240, s38, v12
    v_add_u32_e32 v5, 4, v4
    v_lshlrev_b32_e32 v5, 1, v5
    v_xor_b32_e32 v5, v5, v3
    v_lshlrev_b32_e32 v12, 4, v5
    v_lshl_add_u32 v12, v4, 8, v12
    v_add_u32_e32 v241, s38, v12
    v_mov_b32_e32 v242, 0x3f803f80
    v_mov_b32_e32 v243, 0x3f803f80
    v_mov_b32_e32 v244, 0x3f803f80
    v_mov_b32_e32 v245, 0x3f803f80
    s_waitcnt vmcnt(0)
    ds_read_b64 a[0:1], v128 offset:0
    ds_read_b64 a[2:3], v129 offset:0
    ds_read_b64 a[4:5], v128 offset:4096
    ds_read_b64 a[6:7], v129 offset:4096
    ds_read_b64 a[8:9], v130 offset:0
    ds_read_b64 a[10:11], v131 offset:0
    ds_read_b64 a[12:13], v130 offset:4096
    ds_read_b64 a[14:15], v131 offset:4096
    ds_read_b64 a[16:17], v132 offset:0
    ds_read_b64 a[18:19], v133 offset:0
    ds_read_b64 a[20:21], v132 offset:4096
    ds_read_b64 a[22:23], v133 offset:4096
    ds_read_b64 a[24:25], v134 offset:0
    ds_read_b64 a[26:27], v135 offset:0
    ds_read_b64 a[28:29], v134 offset:4096
    ds_read_b64 a[30:31], v135 offset:4096
    s_barrier
    ds_read_b64_tr_b16 a[160:161], v228 offset:32768
    ds_read_b64_tr_b16 a[162:163], v228 offset:36864
    ds_read_b64_tr_b16 a[164:165], v229 offset:32768
    ds_read_b64_tr_b16 a[166:167], v229 offset:36864
    ds_read_b64_tr_b16 a[168:169], v230 offset:32768
    ds_read_b64_tr_b16 a[170:171], v230 offset:36864
    s_waitcnt lgkmcnt(0)
    v_mfma_f32_16x16x32_bf16 v[0:3], a[160:163], a[0:3], 0
    ds_read_b64_tr_b16 a[172:173], v231 offset:32768
    ds_read_b64_tr_b16 a[174:175], v231 offset:36864
    ds_read_b64_tr_b16 a[176:177], v232 offset:32768
    ds_read_b64_tr_b16 a[178:179], v232 offset:36864
    ds_read_b64_tr_b16 a[180:181], v233 offset:32768
    ds_read_b64_tr_b16 a[182:183], v233 offset:36864
    ds_read_b64_tr_b16 a[184:185], v234 offset:32768
    ds_read_b64_tr_b16 a[186:187], v234 offset:36864
    v_mfma_f32_16x16x32_bf16 v[32:35], a[160:163], a[4:7], 0
    s_add_u32 m0, s70, 53248
    s_mov_b32 s7, 256
    buffer_load_dwordx4 v144, s[24:27], s7 offen  lds
    s_add_u32 m0, s70, 54272
    v_mfma_f32_16x16x32_bf16 v[4:7], a[164:167], a[0:3], 0
    ds_read_b64_tr_b16 a[188:189], v235 offset:32768
    ds_read_b64_tr_b16 a[190:191], v235 offset:36864
    v_mfma_f32_16x16x32_bf16 v[36:39], a[164:167], a[4:7], 0
    s_mov_b32 s7, 5376
    buffer_load_dwordx4 v145, s[24:27], s7 offen  lds
    s_add_u32 m0, s70, 55296
    s_mov_b32 s7, 10496
    v_mfma_f32_16x16x32_bf16 v[8:11], a[168:171], a[0:3], 0
    ds_read_b64_tr_b16 a[160:161], v228 offset:40960
    ds_read_b64_tr_b16 a[162:163], v228 offset:45056
    v_mfma_f32_16x16x32_bf16 v[40:43], a[168:171], a[4:7], 0
    buffer_load_dwordx4 v146, s[24:27], s7 offen  lds
    s_add_u32 m0, s70, 56320
    s_mov_b32 s7, 15616
    buffer_load_dwordx4 v147, s[24:27], s7 offen  lds
    s_waitcnt lgkmcnt(10)
    v_mfma_f32_16x16x32_bf16 v[12:15], a[172:175], a[0:3], 0
    ds_read_b64_tr_b16 a[164:165], v229 offset:40960
    ds_read_b64_tr_b16 a[166:167], v229 offset:45056
    v_mfma_f32_16x16x32_bf16 v[44:47], a[172:175], a[4:7], 0
    s_add_u32 m0, s70, 57344
    s_mov_b32 s7, 20736
    buffer_load_dwordx4 v144, s[24:27], s7 offen  lds
    s_add_u32 m0, s70, 58368
    s_waitcnt lgkmcnt(4)
    v_mfma_f32_16x16x32_bf16 v[16:19], a[176:179], a[0:3], 0
    ds_read_b64_tr_b16 a[168:169], v230 offset:40960
    ds_read_b64_tr_b16 a[170:171], v230 offset:45056
    v_mfma_f32_16x16x32_bf16 v[48:51], a[176:179], a[4:7], 0
    s_mov_b32 s7, 25856
    buffer_load_dwordx4 v145, s[24:27], s7 offen  lds
    s_add_u32 m0, s70, 59392
    s_mov_b32 s7, 30976
    v_mfma_f32_16x16x32_bf16 v[20:23], a[180:183], a[0:3], 0
    ds_read_b64_tr_b16 a[172:173], v231 offset:40960
    ds_read_b64_tr_b16 a[174:175], v231 offset:45056
    v_mfma_f32_16x16x32_bf16 v[52:55], a[180:183], a[4:7], 0
    buffer_load_dwordx4 v146, s[24:27], s7 offen  lds
    s_add_u32 m0, s70, 60416
    s_mov_b32 s7, 36096
    buffer_load_dwordx4 v147, s[24:27], s7 offen  lds
    v_mfma_f32_16x16x32_bf16 v[24:27], a[184:187], a[0:3], 0
    ds_read_b64_tr_b16 a[176:177], v232 offset:40960
    ds_read_b64_tr_b16 a[178:179], v232 offset:45056
    v_mfma_f32_16x16x32_bf16 v[56:59], a[184:187], a[4:7], 0
    s_add_u32 m0, s70, 106496
    s_mov_b32 s7, 512
    buffer_load_dwordx4 v144, s[24:27], s7 offen  lds
    s_add_u32 m0, s70, 107520
    v_mfma_f32_16x16x32_bf16 v[28:31], a[188:191], a[0:3], 0
    ds_read_b64_tr_b16 a[180:181], v233 offset:40960
    ds_read_b64_tr_b16 a[182:183], v233 offset:45056
    v_mfma_f32_16x16x32_bf16 v[60:63], a[188:191], a[4:7], 0
    s_mov_b32 s7, 5632
    buffer_load_dwordx4 v145, s[24:27], s7 offen  lds
    s_add_u32 m0, s70, 108544
    s_mov_b32 s7, 10752
    s_waitcnt lgkmcnt(4)
    v_mfma_f32_16x16x32_bf16 v[0:3], a[160:163], a[8:11], v[0:3]
    ds_read_b64_tr_b16 a[184:185], v234 offset:40960
    ds_read_b64_tr_b16 a[186:187], v234 offset:45056
    v_mfma_f32_16x16x32_bf16 v[32:35], a[160:163], a[12:15], v[32:35]
    buffer_load_dwordx4 v146, s[24:27], s7 offen  lds
    s_add_u32 m0, s70, 109568
    s_mov_b32 s7, 15872
    buffer_load_dwordx4 v147, s[24:27], s7 offen  lds
    v_mfma_f32_16x16x32_bf16 v[4:7], a[164:167], a[8:11], v[4:7]
    ds_read_b64_tr_b16 a[188:189], v235 offset:40960
    ds_read_b64_tr_b16 a[190:191], v235 offset:45056
    v_mfma_f32_16x16x32_bf16 v[36:39], a[164:167], a[12:15], v[36:39]
    s_add_u32 m0, s70, 110592
    s_mov_b32 s7, 20992
    buffer_load_dwordx4 v144, s[24:27], s7 offen  lds
    v_mfma_f32_16x16x32_bf16 v[8:11], a[168:171], a[8:11], v[8:11]
    s_add_u32 m0, s70, 111616
    s_mov_b32 s7, 26112
    v_mfma_f32_16x16x32_bf16 v[40:43], a[168:171], a[12:15], v[40:43]
    buffer_load_dwordx4 v145, s[24:27], s7 offen  lds
    s_add_u32 m0, s70, 112640
    v_mfma_f32_16x16x32_bf16 v[12:15], a[172:175], a[8:11], v[12:15]
    s_mov_b32 s7, 31232
    buffer_load_dwordx4 v146, s[24:27], s7 offen  lds
    v_mfma_f32_16x16x32_bf16 v[44:47], a[172:175], a[12:15], v[44:47]
    s_add_u32 m0, s70, 113664
    s_mov_b32 s7, 36352
    s_waitcnt lgkmcnt(0)
    v_mfma_f32_16x16x32_bf16 v[16:19], a[176:179], a[8:11], v[16:19]
    buffer_load_dwordx4 v147, s[24:27], s7 offen  lds
    v_mfma_f32_16x16x32_bf16 v[48:51], a[176:179], a[12:15], v[48:51]
    s_barrier
    s_mov_b32 s50, s32
    s_add_u32 s34, s32, s38
    s_add_u32 s32, s32, s42
    s_cmp_eq_u32 s32, 159744
    s_cselect_b32 s33, s43, s42
    s_cselect_b32 s32, 0, s32
    s_sub_u32 s39, 159744, s32
    v_add_u32_e32 v228, s33, v228
    v_add_u32_e32 v254, s39, v228
    ds_read_b64_tr_b16 a[160:161], v254 offset:0
    ds_read_b64_tr_b16 a[162:163], v228 offset:32768
    v_add_u32_e32 v229, s33, v229
    v_add_u32_e32 v254, s39, v229
    ds_read_b64_tr_b16 a[164:165], v254 offset:0
    ds_read_b64_tr_b16 a[166:167], v229 offset:32768
    v_add_u32_e32 v230, s33, v230
    v_add_u32_e32 v254, s39, v230
    ds_read_b64_tr_b16 a[168:169], v254 offset:0
    ds_read_b64_tr_b16 a[170:171], v230 offset:32768
    v_mfma_f32_16x16x32_bf16 v[20:23], a[180:183], a[8:11], v[20:23]
    v_add_u32_e32 v231, s33, v231
    v_add_u32_e32 v254, s39, v231
    ds_read_b64_tr_b16 a[172:173], v254 offset:0
    v_mfma_f32_16x16x32_bf16 v[52:55], a[180:183], a[12:15], v[52:55]
    ds_read_b64_tr_b16 a[174:175], v231 offset:32768
    v_mfma_f32_16x16x32_bf16 v[24:27], a[184:187], a[8:11], v[24:27]
    v_add_u32_e32 v232, s33, v232
    v_add_u32_e32 v254, s39, v232
    ds_read_b64_tr_b16 a[176:177], v254 offset:0
    v_mfma_f32_16x16x32_bf16 v[56:59], a[184:187], a[12:15], v[56:59]
    ds_read_b64_tr_b16 a[178:179], v232 offset:32768
    v_mfma_f32_16x16x32_bf16 v[28:31], a[188:191], a[8:11], v[28:31]
    v_add_u32_e32 v233, s33, v233
    v_add_u32_e32 v254, s39, v233
    ds_read_b64_tr_b16 a[180:181], v254 offset:0
    v_mfma_f32_16x16x32_bf16 v[60:63], a[188:191], a[12:15], v[60:63]
    ds_read_b64_tr_b16 a[182:183], v233 offset:32768
    s_waitcnt lgkmcnt(4)
    v_mfma_f32_16x16x32_bf16 v[0:3], a[160:163], a[16:19], v[0:3]
    v_add_u32_e32 v234, s33, v234
    v_add_u32_e32 v254, s39, v234
    ds_read_b64_tr_b16 a[184:185], v254 offset:0
    ds_read_b64_tr_b16 a[186:187], v234 offset:32768
    v_mfma_f32_16x16x32_bf16 v[32:35], a[160:163], a[20:23], v[32:35]
    s_waitcnt vmcnt(8)
    ds_read_b64 a[32:33], v128 offset:53248
    ds_read_b64 a[34:35], v129 offset:53248
    ds_read_b64 a[36:37], v128 offset:57344
    ds_read_b64 a[38:39], v129 offset:57344
    ds_read_b64 a[40:41], v130 offset:53248
    ds_read_b64 a[42:43], v131 offset:53248
    ds_read_b64 a[44:45], v130 offset:57344
    ds_read_b64 a[46:47], v131 offset:57344
    ds_read_b64 a[48:49], v132 offset:53248
    ds_read_b64 a[50:51], v133 offset:53248
    ds_read_b64 a[52:53], v132 offset:57344
    ds_read_b64 a[54:55], v133 offset:57344
    ds_read_b64 a[56:57], v134 offset:53248
    ds_read_b64 a[58:59], v135 offset:53248
    ds_read_b64 a[60:61], v134 offset:57344
    ds_read_b64 a[62:63], v135 offset:57344
    s_add_u32 m0, s70, 0
    s_mov_b32 s7, 768
    s_waitcnt lgkmcnt(15)
    v_mfma_f32_16x16x32_bf16 v[4:7], a[164:167], a[16:19], v[4:7]
    v_add_u32_e32 v235, s33, v235
    v_add_u32_e32 v254, s39, v235
    ds_read_b64_tr_b16 a[188:189], v254 offset:0
    ds_read_b64_tr_b16 a[190:191], v235 offset:32768
    v_mfma_f32_16x16x32_bf16 v[36:39], a[164:167], a[20:23], v[36:39]
    buffer_load_dwordx4 v144, s[24:27], s7 offen  lds
    s_waitcnt lgkmcnt(15)
    v_mfma_f32_16x16x32_bf16 v[8:11], a[168:171], a[16:19], v[8:11]
    ds_read_b64_tr_b16 a[160:161], v228 offset:36864
    ds_read_b64_tr_b16 a[162:163], v228 offset:40960
    v_mfma_f32_16x16x32_bf16 v[40:43], a[168:171], a[20:23], v[40:43]
    s_add_u32 m0, s70, 1024
    s_waitcnt lgkmcnt(15)
    v_mfma_f32_16x16x32_bf16 v[12:15], a[172:175], a[16:19], v[12:15]
    ds_read_b64_tr_b16 a[164:165], v229 offset:36864
    ds_read_b64_tr_b16 a[166:167], v229 offset:40960
    v_mfma_f32_16x16x32_bf16 v[44:47], a[172:175], a[20:23], v[44:47]
    s_mov_b32 s7, 5888
    s_waitcnt lgkmcnt(4)
    v_mfma_f32_16x16x32_bf16 v[16:19], a[176:179], a[16:19], v[16:19]
    ds_read_b64_tr_b16 a[168:169], v230 offset:36864
    ds_read_b64_tr_b16 a[170:171], v230 offset:40960
    v_mfma_f32_16x16x32_bf16 v[48:51], a[176:179], a[20:23], v[48:51]
    buffer_load_dwordx4 v145, s[24:27], s7 offen  lds
    v_mfma_f32_16x16x32_bf16 v[20:23], a[180:183], a[16:19], v[20:23]
    ds_read_b64_tr_b16 a[172:173], v231 offset:36864
    ds_read_b64_tr_b16 a[174:175], v231 offset:40960
    v_mfma_f32_16x16x32_bf16 v[52:55], a[180:183], a[20:23], v[52:55]
    s_add_u32 m0, s70, 2048
    s_mov_b32 s7, 11008
    v_mfma_f32_16x16x32_bf16 v[24:27], a[184:187], a[16:19], v[24:27]
    ds_read_b64_tr_b16 a[176:177], v232 offset:36864
    ds_read_b64_tr_b16 a[178:179], v232 offset:40960
    v_mfma_f32_16x16x32_bf16 v[56:59], a[184:187], a[20:23], v[56:59]
    buffer_load_dwordx4 v146, s[24:27], s7 offen  lds
    v_mfma_f32_16x16x32_bf16 v[28:31], a[188:191], a[16:19], v[28:31]
    ds_read_b64_tr_b16 a[180:181], v233 offset:36864
    ds_read_b64_tr_b16 a[182:183], v233 offset:40960
    v_mfma_f32_16x16x32_bf16 v[60:63], a[188:191], a[20:23], v[60:63]
    s_add_u32 m0, s70, 3072
    s_waitcnt lgkmcnt(4)
    v_mfma_f32_16x16x32_bf16 v[0:3], a[160:163], a[24:27], v[0:3]
    ds_read_b64_tr_b16 a[184:185], v234 offset:36864
    ds_read_b64_tr_b16 a[186:187], v234 offset:40960
    v_mfma_f32_16x16x32_bf16 v[32:35], a[160:163], a[28:31], v[32:35]
    s_mov_b32 s7, 16128
    v_mfma_f32_16x16x32_bf16 v[4:7], a[164:167], a[24:27], v[4:7]
    ds_read_b64_tr_b16 a[188:189], v235 offset:36864
    ds_read_b64_tr_b16 a[190:191], v235 offset:40960
    v_mfma_f32_16x16x32_bf16 v[36:39], a[164:167], a[28:31], v[36:39]
    buffer_load_dwordx4 v147, s[24:27], s7 offen  lds
    v_mfma_f32_16x16x32_bf16 v[8:11], a[168:171], a[24:27], v[8:11]
    ds_read_b64_tr_b16 a[160:161], v228 offset:45056
    ds_read_b64_tr_b16 a[162:163], v228 offset:49152
    v_mfma_f32_16x16x32_bf16 v[40:43], a[168:171], a[28:31], v[40:43]
    s_add_u32 m0, s70, 4096
    s_mov_b32 s7, 21248
    v_mfma_f32_16x16x32_bf16 v[12:15], a[172:175], a[24:27], v[12:15]
    ds_read_b64_tr_b16 a[164:165], v229 offset:45056
    ds_read_b64_tr_b16 a[166:167], v229 offset:49152
    v_mfma_f32_16x16x32_bf16 v[44:47], a[172:175], a[28:31], v[44:47]
    buffer_load_dwordx4 v144, s[24:27], s7 offen  lds
    s_waitcnt lgkmcnt(4)
    v_mfma_f32_16x16x32_bf16 v[16:19], a[176:179], a[24:27], v[16:19]
    ds_read_b64_tr_b16 a[168:169], v230 offset:45056
    ds_read_b64_tr_b16 a[170:171], v230 offset:49152
    v_mfma_f32_16x16x32_bf16 v[48:51], a[176:179], a[28:31], v[48:51]
    s_add_u32 m0, s70, 5120
    v_mfma_f32_16x16x32_bf16 v[20:23], a[180:183], a[24:27], v[20:23]
    ds_read_b64_tr_b16 a[172:173], v231 offset:45056
    ds_read_b64_tr_b16 a[174:175], v231 offset:49152
    v_mfma_f32_16x16x32_bf16 v[52:55], a[180:183], a[28:31], v[52:55]
    s_mov_b32 s7, 26368
    v_mfma_f32_16x16x32_bf16 v[24:27], a[184:187], a[24:27], v[24:27]
    ds_read_b64_tr_b16 a[176:177], v232 offset:45056
    ds_read_b64_tr_b16 a[178:179], v232 offset:49152
    v_mfma_f32_16x16x32_bf16 v[56:59], a[184:187], a[28:31], v[56:59]
    buffer_load_dwordx4 v145, s[24:27], s7 offen  lds
    v_mfma_f32_16x16x32_bf16 v[28:31], a[188:191], a[24:27], v[28:31]
    ds_read_b64_tr_b16 a[180:181], v233 offset:45056
    ds_read_b64_tr_b16 a[182:183], v233 offset:49152
    v_mfma_f32_16x16x32_bf16 v[60:63], a[188:191], a[28:31], v[60:63]
    s_add_u32 m0, s70, 6144
    s_mov_b32 s7, 31488
    s_waitcnt lgkmcnt(4)
    v_mfma_f32_16x16x32_bf16 v[0:3], a[160:163], a[32:35], v[0:3]
    ds_read_b64_tr_b16 a[184:185], v234 offset:45056
    ds_read_b64_tr_b16 a[186:187], v234 offset:49152
    v_mfma_f32_16x16x32_bf16 v[32:35], a[160:163], a[36:39], v[32:35]
    buffer_load_dwordx4 v146, s[24:27], s7 offen  lds
    v_mfma_f32_16x16x32_bf16 v[4:7], a[164:167], a[32:35], v[4:7]
    ds_read_b64_tr_b16 a[188:189], v235 offset:45056
    ds_read_b64_tr_b16 a[190:191], v235 offset:49152
    v_mfma_f32_16x16x32_bf16 v[36:39], a[164:167], a[36:39], v[36:39]
    s_add_u32 m0, s70, 7168
    v_mfma_f32_16x16x32_bf16 v[8:11], a[168:171], a[32:35], v[8:11]
    v_mfma_f32_16x16x32_bf16 v[40:43], a[168:171], a[36:39], v[40:43]
    s_mov_b32 s7, 36608
    v_mfma_f32_16x16x32_bf16 v[12:15], a[172:175], a[32:35], v[12:15]
    v_mfma_f32_16x16x32_bf16 v[44:47], a[172:175], a[36:39], v[44:47]
    buffer_load_dwordx4 v147, s[24:27], s7 offen  lds
    s_waitcnt lgkmcnt(0)
    v_mfma_f32_16x16x32_bf16 v[16:19], a[176:179], a[32:35], v[16:19]
    v_add_u32_e32 v224, s33, v224
    v_add_u32_e32 v225, s33, v225
    v_mfma_f32_16x16x32_bf16 v[48:51], a[176:179], a[36:39], v[48:51]
    v_add_u32_e32 v226, s33, v226
    v_add_u32_e32 v227, s33, v227
    s_barrier
    s_mov_b32 s50, s32
    s_add_u32 s34, s32, s38
    s_add_u32 s32, s32, s42
    s_cmp_eq_u32 s32, 159744
    s_cselect_b32 s33, s43, s42
    s_cselect_b32 s32, 0, s32
    v_add_u32_e32 v228, s33, v228
    ds_read_b64_tr_b16 a[160:161], v228 offset:32768
    ds_read_b64_tr_b16 a[162:163], v228 offset:36864
    v_add_u32_e32 v229, s33, v229
    ds_read_b64_tr_b16 a[164:165], v229 offset:32768
    ds_read_b64_tr_b16 a[166:167], v229 offset:36864
    v_add_u32_e32 v230, s33, v230
    ds_read_b64_tr_b16 a[168:169], v230 offset:32768
    ds_read_b64_tr_b16 a[170:171], v230 offset:36864
    v_mfma_f32_16x16x32_bf16 v[20:23], a[180:183], a[32:35], v[20:23]
    v_add_u32_e32 v231, s33, v231
    ds_read_b64_tr_b16 a[172:173], v231 offset:32768
    v_mfma_f32_16x16x32_bf16 v[52:55], a[180:183], a[36:39], v[52:55]
    ds_read_b64_tr_b16 a[174:175], v231 offset:36864
    v_mfma_f32_16x16x32_bf16 v[24:27], a[184:187], a[32:35], v[24:27]
    v_add_u32_e32 v232, s33, v232
    ds_read_b64_tr_b16 a[176:177], v232 offset:32768
    v_mfma_f32_16x16x32_bf16 v[56:59], a[184:187], a[36:39], v[56:59]
    ds_read_b64_tr_b16 a[178:179], v232 offset:36864
    v_mfma_f32_16x16x32_bf16 v[28:31], a[188:191], a[32:35], v[28:31]
    v_add_u32_e32 v233, s33, v233
    ds_read_b64_tr_b16 a[180:181], v233 offset:32768
    v_mfma_f32_16x16x32_bf16 v[60:63], a[188:191], a[36:39], v[60:63]
    ds_read_b64_tr_b16 a[182:183], v233 offset:36864
    s_waitcnt lgkmcnt(4)
    v_mfma_f32_16x16x32_bf16 v[0:3], a[160:163], a[40:43], v[0:3]
    v_add_u32_e32 v234, s33, v234
    ds_read_b64_tr_b16 a[184:185], v234 offset:32768
    ds_read_b64_tr_b16 a[186:187], v234 offset:36864
    v_mfma_f32_16x16x32_bf16 v[32:35], a[160:163], a[44:47], v[32:35]
    s_waitcnt vmcnt(8)
    ds_read_b64 a[64:65], v136 offset:0
    ds_read_b64 a[66:67], v137 offset:0
    ds_read_b64 a[68:69], v136 offset:4096
    ds_read_b64 a[70:71], v137 offset:4096
    ds_read_b64 a[72:73], v138 offset:0
    ds_read_b64 a[74:75], v139 offset:0
    ds_read_b64 a[76:77], v138 offset:4096
    ds_read_b64 a[78:79], v139 offset:4096
    ds_read_b64 a[80:81], v140 offset:0
    ds_read_b64 a[82:83], v141 offset:0
    ds_read_b64 a[84:85], v140 offset:4096
    ds_read_b64 a[86:87], v141 offset:4096
    ds_read_b64 a[88:89], v142 offset:0
    ds_read_b64 a[90:91], v143 offset:0
    ds_read_b64 a[92:93], v142 offset:4096
    ds_read_b64 a[94:95], v143 offset:4096
    s_waitcnt lgkmcnt(0)
    s_add_u32 m0, s70, 106496
    s_mov_b32 s7, 1024
    v_mfma_f32_16x16x32_bf16 v[4:7], a[164:167], a[40:43], v[4:7]
    v_add_u32_e32 v235, s33, v235
    ds_read_b64_tr_b16 a[188:189], v235 offset:32768
    ds_read_b64_tr_b16 a[190:191], v235 offset:36864
    v_mfma_f32_16x16x32_bf16 v[36:39], a[164:167], a[44:47], v[36:39]
    buffer_load_dwordx4 v144, s[24:27], s7 offen  lds
    s_add_u32 m0, s70, 107520
    v_mfma_f32_16x16x32_bf16 v[8:11], a[168:171], a[40:43], v[8:11]
    ds_read_b64_tr_b16 a[160:161], v228 offset:40960
    ds_read_b64_tr_b16 a[162:163], v228 offset:45056
    v_mfma_f32_16x16x32_bf16 v[40:43], a[168:171], a[44:47], v[40:43]
    s_mov_b32 s7, 6144
    buffer_load_dwordx4 v145, s[24:27], s7 offen  lds
    v_mfma_f32_16x16x32_bf16 v[12:15], a[172:175], a[40:43], v[12:15]
    ds_read_b64_tr_b16 a[164:165], v229 offset:40960
    ds_read_b64_tr_b16 a[166:167], v229 offset:45056
    v_mfma_f32_16x16x32_bf16 v[44:47], a[172:175], a[44:47], v[44:47]
    s_add_u32 m0, s70, 108544
    s_mov_b32 s7, 11264
    s_waitcnt lgkmcnt(4)
    v_mfma_f32_16x16x32_bf16 v[16:19], a[176:179], a[40:43], v[16:19]
    ds_read_b64_tr_b16 a[168:169], v230 offset:40960
    ds_read_b64_tr_b16 a[170:171], v230 offset:45056
    v_mfma_f32_16x16x32_bf16 v[48:51], a[176:179], a[44:47], v[48:51]
    buffer_load_dwordx4 v146, s[24:27], s7 offen  lds
    s_add_u32 m0, s70, 109568
    v_mfma_f32_16x16x32_bf16 v[20:23], a[180:183], a[40:43], v[20:23]
    ds_read_b64_tr_b16 a[172:173], v231 offset:40960
    ds_read_b64_tr_b16 a[174:175], v231 offset:45056
    v_mfma_f32_16x16x32_bf16 v[52:55], a[180:183], a[44:47], v[52:55]
    s_mov_b32 s7, 16384
    buffer_load_dwordx4 v147, s[24:27], s7 offen  lds
    v_mfma_f32_16x16x32_bf16 v[24:27], a[184:187], a[40:43], v[24:27]
    ds_read_b64_tr_b16 a[176:177], v232 offset:40960
    ds_read_b64_tr_b16 a[178:179], v232 offset:45056
    v_mfma_f32_16x16x32_bf16 v[56:59], a[184:187], a[44:47], v[56:59]
    s_add_u32 m0, s70, 110592
    s_mov_b32 s7, 21504
    v_mfma_f32_16x16x32_bf16 v[28:31], a[188:191], a[40:43], v[28:31]
    ds_read_b64_tr_b16 a[180:181], v233 offset:40960
    ds_read_b64_tr_b16 a[182:183], v233 offset:45056
    v_mfma_f32_16x16x32_bf16 v[60:63], a[188:191], a[44:47], v[60:63]
    buffer_load_dwordx4 v144, s[24:27], s7 offen  lds
    s_add_u32 m0, s70, 111616
    s_waitcnt lgkmcnt(4)
    v_mfma_f32_16x16x32_bf16 v[0:3], a[160:163], a[48:51], v[0:3]
    ds_read_b64_tr_b16 a[184:185], v234 offset:40960
    ds_read_b64_tr_b16 a[186:187], v234 offset:45056
    v_mfma_f32_16x16x32_bf16 v[32:35], a[160:163], a[52:55], v[32:35]
    s_mov_b32 s7, 26624
    buffer_load_dwordx4 v145, s[24:27], s7 offen  lds
    v_mfma_f32_16x16x32_bf16 v[4:7], a[164:167], a[48:51], v[4:7]
    ds_read_b64_tr_b16 a[188:189], v235 offset:40960
    ds_read_b64_tr_b16 a[190:191], v235 offset:45056
    v_mfma_f32_16x16x32_bf16 v[36:39], a[164:167], a[52:55], v[36:39]
    s_add_u32 m0, s70, 112640
    v_mfma_f32_16x16x32_bf16 v[8:11], a[168:171], a[48:51], v[8:11]
    s_mov_b32 s7, 31744
    buffer_load_dwordx4 v146, s[24:27], s7 offen  lds
    v_mfma_f32_16x16x32_bf16 v[40:43], a[168:171], a[52:55], v[40:43]
    s_add_u32 m0, s70, 113664
    v_mfma_f32_16x16x32_bf16 v[12:15], a[172:175], a[48:51], v[12:15]
    s_mov_b32 s7, 36864
    v_mfma_f32_16x16x32_bf16 v[44:47], a[172:175], a[52:55], v[44:47]
    buffer_load_dwordx4 v147, s[24:27], s7 offen  lds
    s_waitcnt lgkmcnt(0)
    v_mfma_f32_16x16x32_bf16 v[16:19], a[176:179], a[48:51], v[16:19]
    v_add_u32_e32 v224, s33, v224
    v_add_u32_e32 v225, s33, v225
    v_mfma_f32_16x16x32_bf16 v[48:51], a[176:179], a[52:55], v[48:51]
    v_add_u32_e32 v226, s33, v226
    v_add_u32_e32 v227, s33, v227
    s_barrier
    s_mov_b32 s50, s32
    s_add_u32 s34, s32, s38
    s_add_u32 s32, s32, s42
    s_cmp_eq_u32 s32, 159744
    s_cselect_b32 s33, s43, s42
    s_cselect_b32 s32, 0, s32
    s_sub_u32 s39, 159744, s32
    v_add_u32_e32 v228, s33, v228
    v_add_u32_e32 v254, s39, v228
    ds_read_b64_tr_b16 a[160:161], v254 offset:0
    ds_read_b64_tr_b16 a[162:163], v228 offset:32768
    v_add_u32_e32 v229, s33, v229
    v_add_u32_e32 v254, s39, v229
    ds_read_b64_tr_b16 a[164:165], v254 offset:0
    ds_read_b64_tr_b16 a[166:167], v229 offset:32768
    v_add_u32_e32 v230, s33, v230
    v_add_u32_e32 v254, s39, v230
    ds_read_b64_tr_b16 a[168:169], v254 offset:0
    ds_read_b64_tr_b16 a[170:171], v230 offset:32768
    v_mfma_f32_16x16x32_bf16 v[20:23], a[180:183], a[48:51], v[20:23]
    v_add_u32_e32 v231, s33, v231
    v_add_u32_e32 v254, s39, v231
    ds_read_b64_tr_b16 a[172:173], v254 offset:0
    v_mfma_f32_16x16x32_bf16 v[52:55], a[180:183], a[52:55], v[52:55]
    ds_read_b64_tr_b16 a[174:175], v231 offset:32768
    v_mfma_f32_16x16x32_bf16 v[24:27], a[184:187], a[48:51], v[24:27]
    v_add_u32_e32 v232, s33, v232
    v_add_u32_e32 v254, s39, v232
    ds_read_b64_tr_b16 a[176:177], v254 offset:0
    v_mfma_f32_16x16x32_bf16 v[56:59], a[184:187], a[52:55], v[56:59]
    ds_read_b64_tr_b16 a[178:179], v232 offset:32768
    v_mfma_f32_16x16x32_bf16 v[28:31], a[188:191], a[48:51], v[28:31]
    v_add_u32_e32 v233, s33, v233
    v_add_u32_e32 v254, s39, v233
    ds_read_b64_tr_b16 a[180:181], v254 offset:0
    v_mfma_f32_16x16x32_bf16 v[60:63], a[188:191], a[52:55], v[60:63]
    ds_read_b64_tr_b16 a[182:183], v233 offset:32768
    s_waitcnt lgkmcnt(4)
    v_mfma_f32_16x16x32_bf16 v[0:3], a[160:163], a[56:59], v[0:3]
    v_add_u32_e32 v234, s33, v234
    v_add_u32_e32 v254, s39, v234
    ds_read_b64_tr_b16 a[184:185], v254 offset:0
    v_mfma_f32_16x16x32_bf16 v[32:35], a[160:163], a[60:63], v[32:35]
    ds_read_b64_tr_b16 a[186:187], v234 offset:32768
    v_mfma_f32_16x16x32_bf16 v[4:7], a[164:167], a[56:59], v[4:7]
    v_add_u32_e32 v235, s33, v235
    v_add_u32_e32 v254, s39, v235
    ds_read_b64_tr_b16 a[188:189], v254 offset:0
    v_mfma_f32_16x16x32_bf16 v[36:39], a[164:167], a[60:63], v[36:39]
    ds_read_b64_tr_b16 a[190:191], v235 offset:32768
    v_mfma_f32_16x16x32_bf16 v[8:11], a[168:171], a[56:59], v[8:11]
    ds_read_b64_tr_b16 a[160:161], v228 offset:36864
    ds_read_b64_tr_b16 a[162:163], v228 offset:40960
    v_mfma_f32_16x16x32_bf16 v[40:43], a[168:171], a[60:63], v[40:43]
    v_mfma_f32_16x16x32_bf16 v[12:15], a[172:175], a[56:59], v[12:15]
    ds_read_b64_tr_b16 a[164:165], v229 offset:36864
    ds_read_b64_tr_b16 a[166:167], v229 offset:40960
    v_mfma_f32_16x16x32_bf16 v[44:47], a[172:175], a[60:63], v[44:47]
    s_waitcnt lgkmcnt(4)
    v_mfma_f32_16x16x32_bf16 v[16:19], a[176:179], a[56:59], v[16:19]
    ds_read_b64_tr_b16 a[168:169], v230 offset:36864
    ds_read_b64_tr_b16 a[170:171], v230 offset:40960
    v_mfma_f32_16x16x32_bf16 v[48:51], a[176:179], a[60:63], v[48:51]
    v_mfma_f32_16x16x32_bf16 v[20:23], a[180:183], a[56:59], v[20:23]
    ds_read_b64_tr_b16 a[172:173], v231 offset:36864
    ds_read_b64_tr_b16 a[174:175], v231 offset:40960
    v_mfma_f32_16x16x32_bf16 v[52:55], a[180:183], a[60:63], v[52:55]
    v_mfma_f32_16x16x32_bf16 v[24:27], a[184:187], a[56:59], v[24:27]
    ds_read_b64_tr_b16 a[176:177], v232 offset:36864
    ds_read_b64_tr_b16 a[178:179], v232 offset:40960
    v_mfma_f32_16x16x32_bf16 v[56:59], a[184:187], a[60:63], v[56:59]
    v_mfma_f32_16x16x32_bf16 v[28:31], a[188:191], a[56:59], v[28:31]
    ds_read_b64_tr_b16 a[180:181], v233 offset:36864
    ds_read_b64_tr_b16 a[182:183], v233 offset:40960
    v_mfma_f32_16x16x32_bf16 v[60:63], a[188:191], a[60:63], v[60:63]
    s_waitcnt lgkmcnt(4)
    v_mfma_f32_16x16x32_bf16 v[0:3], a[160:163], a[64:67], v[0:3]
    ds_read_b64_tr_b16 a[184:185], v234 offset:36864
    ds_read_b64_tr_b16 a[186:187], v234 offset:40960
    v_mfma_f32_16x16x32_bf16 v[32:35], a[160:163], a[68:71], v[32:35]
    s_waitcnt vmcnt(8)
    ds_read_b64 a[96:97], v128 offset:0
    ds_read_b64 a[98:99], v129 offset:0
    ds_read_b64 a[100:101], v128 offset:4096
    ds_read_b64 a[102:103], v129 offset:4096
    ds_read_b64 a[104:105], v130 offset:0
    ds_read_b64 a[106:107], v131 offset:0
    ds_read_b64 a[108:109], v130 offset:4096
    ds_read_b64 a[110:111], v131 offset:4096
    ds_read_b64 a[112:113], v132 offset:0
    ds_read_b64 a[114:115], v133 offset:0
    ds_read_b64 a[116:117], v132 offset:4096
    ds_read_b64 a[118:119], v133 offset:4096
    ds_read_b64 a[120:121], v134 offset:0
    ds_read_b64 a[122:123], v135 offset:0
    ds_read_b64 a[124:125], v134 offset:4096
    ds_read_b64 a[126:127], v135 offset:4096
    s_waitcnt lgkmcnt(15)
    v_mfma_f32_16x16x32_bf16 v[4:7], a[164:167], a[64:67], v[4:7]
    ds_read_b64_tr_b16 a[188:189], v235 offset:36864
    ds_read_b64_tr_b16 a[190:191], v235 offset:40960
    v_mfma_f32_16x16x32_bf16 v[36:39], a[164:167], a[68:71], v[36:39]
    s_waitcnt lgkmcnt(15)
    v_mfma_f32_16x16x32_bf16 v[8:11], a[168:171], a[64:67], v[8:11]
    ds_read_b64_tr_b16 a[160:161], v228 offset:45056
    ds_read_b64_tr_b16 a[162:163], v228 offset:49152
    v_mfma_f32_16x16x32_bf16 v[40:43], a[168:171], a[68:71], v[40:43]
    s_waitcnt lgkmcnt(15)
    v_mfma_f32_16x16x32_bf16 v[12:15], a[172:175], a[64:67], v[12:15]
    ds_read_b64_tr_b16 a[164:165], v229 offset:45056
    ds_read_b64_tr_b16 a[166:167], v229 offset:49152
    v_mfma_f32_16x16x32_bf16 v[44:47], a[172:175], a[68:71], v[44:47]
    s_waitcnt lgkmcnt(4)
    v_mfma_f32_16x16x32_bf16 v[16:19], a[176:179], a[64:67], v[16:19]
    ds_read_b64_tr_b16 a[168:169], v230 offset:45056
    ds_read_b64_tr_b16 a[170:171], v230 offset:49152
    v_mfma_f32_16x16x32_bf16 v[48:51], a[176:179], a[68:71], v[48:51]
    v_mfma_f32_16x16x32_bf16 v[20:23], a[180:183], a[64:67], v[20:23]
    ds_read_b64_tr_b16 a[172:173], v231 offset:45056
    ds_read_b64_tr_b16 a[174:175], v231 offset:49152
    v_mfma_f32_16x16x32_bf16 v[52:55], a[180:183], a[68:71], v[52:55]
    v_mfma_f32_16x16x32_bf16 v[24:27], a[184:187], a[64:67], v[24:27]
    ds_read_b64_tr_b16 a[176:177], v232 offset:45056
    ds_read_b64_tr_b16 a[178:179], v232 offset:49152
    v_mfma_f32_16x16x32_bf16 v[56:59], a[184:187], a[68:71], v[56:59]
    v_mfma_f32_16x16x32_bf16 v[28:31], a[188:191], a[64:67], v[28:31]
    ds_read_b64_tr_b16 a[180:181], v233 offset:45056
    ds_read_b64_tr_b16 a[182:183], v233 offset:49152
    v_mfma_f32_16x16x32_bf16 v[60:63], a[188:191], a[68:71], v[60:63]
    s_waitcnt lgkmcnt(4)
    v_mfma_f32_16x16x32_bf16 v[0:3], a[160:163], a[72:75], v[0:3]
    ds_read_b64_tr_b16 a[184:185], v234 offset:45056
    ds_read_b64_tr_b16 a[186:187], v234 offset:49152
    v_mfma_f32_16x16x32_bf16 v[32:35], a[160:163], a[76:79], v[32:35]
    v_mfma_f32_16x16x32_bf16 v[4:7], a[164:167], a[72:75], v[4:7]
    ds_read_b64_tr_b16 a[188:189], v235 offset:45056
    ds_read_b64_tr_b16 a[190:191], v235 offset:49152
    v_mfma_f32_16x16x32_bf16 v[36:39], a[164:167], a[76:79], v[36:39]
    v_mfma_f32_16x16x32_bf16 v[8:11], a[168:171], a[72:75], v[8:11]
    v_mfma_f32_16x16x32_bf16 v[40:43], a[168:171], a[76:79], v[40:43]
    v_mfma_f32_16x16x32_bf16 v[12:15], a[172:175], a[72:75], v[12:15]
    v_mfma_f32_16x16x32_bf16 v[44:47], a[172:175], a[76:79], v[44:47]
    s_waitcnt lgkmcnt(0)
    v_mfma_f32_16x16x32_bf16 v[16:19], a[176:179], a[72:75], v[16:19]
    v_add_u32_e32 v224, s33, v224
    v_add_u32_e32 v225, s33, v225
    v_mfma_f32_16x16x32_bf16 v[48:51], a[176:179], a[76:79], v[48:51]
    v_add_u32_e32 v226, s33, v226
    v_add_u32_e32 v227, s33, v227
    s_barrier
    s_mov_b32 s50, s32
    s_add_u32 s34, s32, s38
    s_add_u32 s32, s32, s42
    s_cmp_eq_u32 s32, 159744
    s_cselect_b32 s33, s43, s42
    s_cselect_b32 s32, 0, s32
    v_add_u32_e32 v228, s33, v228
    ds_read_b64_tr_b16 a[160:161], v228 offset:32768
    ds_read_b64_tr_b16 a[162:163], v228 offset:36864
    v_add_u32_e32 v229, s33, v229
    ds_read_b64_tr_b16 a[164:165], v229 offset:32768
    ds_read_b64_tr_b16 a[166:167], v229 offset:36864
    v_add_u32_e32 v230, s33, v230
    ds_read_b64_tr_b16 a[168:169], v230 offset:32768
    ds_read_b64_tr_b16 a[170:171], v230 offset:36864
    v_mfma_f32_16x16x32_bf16 v[20:23], a[180:183], a[72:75], v[20:23]
    v_add_u32_e32 v231, s33, v231
    ds_read_b64_tr_b16 a[172:173], v231 offset:32768
    v_mfma_f32_16x16x32_bf16 v[52:55], a[180:183], a[76:79], v[52:55]
    ds_read_b64_tr_b16 a[174:175], v231 offset:36864
    v_mfma_f32_16x16x32_bf16 v[24:27], a[184:187], a[72:75], v[24:27]
    v_add_u32_e32 v232, s33, v232
    ds_read_b64_tr_b16 a[176:177], v232 offset:32768
    v_mfma_f32_16x16x32_bf16 v[56:59], a[184:187], a[76:79], v[56:59]
    ds_read_b64_tr_b16 a[178:179], v232 offset:36864
    v_mfma_f32_16x16x32_bf16 v[28:31], a[188:191], a[72:75], v[28:31]
    v_add_u32_e32 v233, s33, v233
    ds_read_b64_tr_b16 a[180:181], v233 offset:32768
    v_mfma_f32_16x16x32_bf16 v[60:63], a[188:191], a[76:79], v[60:63]
    ds_read_b64_tr_b16 a[182:183], v233 offset:36864
    s_waitcnt lgkmcnt(4)
    v_mfma_f32_16x16x32_bf16 v[0:3], a[160:163], a[80:83], v[0:3]
    v_add_u32_e32 v234, s33, v234
    ds_read_b64_tr_b16 a[184:185], v234 offset:32768
    ds_read_b64_tr_b16 a[186:187], v234 offset:36864
    v_mfma_f32_16x16x32_bf16 v[32:35], a[160:163], a[84:87], v[32:35]
    s_add_u32 s36, s38, 53248
    v_mfma_f32_16x16x32_bf16 v[4:7], a[164:167], a[80:83], v[4:7]
    v_add_u32_e32 v235, s33, v235
    ds_read_b64_tr_b16 a[188:189], v235 offset:32768
    ds_read_b64_tr_b16 a[190:191], v235 offset:36864
    v_mfma_f32_16x16x32_bf16 v[36:39], a[164:167], a[84:87], v[36:39]
    s_mov_b32 s49, 0
    v_mfma_f32_16x16x32_bf16 v[8:11], a[168:171], a[80:83], v[8:11]
    ds_read_b64_tr_b16 a[160:161], v228 offset:40960
    ds_read_b64_tr_b16 a[162:163], v228 offset:45056
    v_mfma_f32_16x16x32_bf16 v[40:43], a[168:171], a[84:87], v[40:43]
    v_mfma_f32_16x16x32_bf16 v[12:15], a[172:175], a[80:83], v[12:15]
    ds_read_b64_tr_b16 a[164:165], v229 offset:40960
    ds_read_b64_tr_b16 a[166:167], v229 offset:45056
    v_mfma_f32_16x16x32_bf16 v[44:47], a[172:175], a[84:87], v[44:47]
    s_add_u32 m0, s36, 0
    s_waitcnt lgkmcnt(4)
    v_mfma_f32_16x16x32_bf16 v[16:19], a[176:179], a[80:83], v[16:19]
    ds_read_b64_tr_b16 a[168:169], v230 offset:40960
    ds_read_b64_tr_b16 a[170:171], v230 offset:45056
    v_mfma_f32_16x16x32_bf16 v[48:51], a[176:179], a[84:87], v[48:51]
    s_waitcnt vmcnt(0)
    ds_read_b64 a[128:129], v136 offset:0
    ds_read_b64 a[130:131], v137 offset:0
    ds_read_b64 a[132:133], v136 offset:4096
    ds_read_b64 a[134:135], v137 offset:4096
    ds_read_b64 a[136:137], v138 offset:0
    ds_read_b64 a[138:139], v139 offset:0
    ds_read_b64 a[140:141], v138 offset:4096
    ds_read_b64 a[142:143], v139 offset:4096
    ds_read_b64 a[144:145], v140 offset:0
    ds_read_b64 a[146:147], v141 offset:0
    ds_read_b64 a[148:149], v140 offset:4096
    ds_read_b64 a[150:151], v141 offset:4096
    ds_read_b64 a[152:153], v142 offset:0
    ds_read_b64 a[154:155], v143 offset:0
    ds_read_b64 a[156:157], v142 offset:4096
    ds_read_b64 a[158:159], v143 offset:4096
    s_waitcnt lgkmcnt(15)
    v_mfma_f32_16x16x32_bf16 v[20:23], a[180:183], a[80:83], v[20:23]
    ds_read_b64_tr_b16 a[172:173], v231 offset:40960
    ds_read_b64_tr_b16 a[174:175], v231 offset:45056
    v_mfma_f32_16x16x32_bf16 v[52:55], a[180:183], a[84:87], v[52:55]
    buffer_load_dwordx4 v236, s[8:11], s49 offen offset:0 nt lds
    s_waitcnt lgkmcnt(15)
    v_mfma_f32_16x16x32_bf16 v[24:27], a[184:187], a[80:83], v[24:27]
    ds_read_b64_tr_b16 a[176:177], v232 offset:40960
    ds_read_b64_tr_b16 a[178:179], v232 offset:45056
    v_mfma_f32_16x16x32_bf16 v[56:59], a[184:187], a[84:87], v[56:59]
    buffer_load_dwordx4 v237, s[8:11], s49 offen offset:1024 nt lds
    s_waitcnt lgkmcnt(15)
    v_mfma_f32_16x16x32_bf16 v[28:31], a[188:191], a[80:83], v[28:31]
    ds_read_b64_tr_b16 a[180:181], v233 offset:40960
    ds_read_b64_tr_b16 a[182:183], v233 offset:45056
    v_mfma_f32_16x16x32_bf16 v[60:63], a[188:191], a[84:87], v[60:63]
    s_waitcnt lgkmcnt(4)
    v_mfma_f32_16x16x32_bf16 v[0:3], a[160:163], a[88:91], v[0:3]
    ds_read_b64_tr_b16 a[184:185], v234 offset:40960
    ds_read_b64_tr_b16 a[186:187], v234 offset:45056
    v_mfma_f32_16x16x32_bf16 v[32:35], a[160:163], a[92:95], v[32:35]
    buffer_load_dwordx4 v238, s[8:11], s49 offen offset:2048 nt lds
    v_mfma_f32_16x16x32_bf16 v[4:7], a[164:167], a[88:91], v[4:7]
    ds_read_b64_tr_b16 a[188:189], v235 offset:40960
    ds_read_b64_tr_b16 a[190:191], v235 offset:45056
    v_mfma_f32_16x16x32_bf16 v[36:39], a[164:167], a[92:95], v[36:39]
    v_mfma_f32_16x16x32_bf16 v[8:11], a[168:171], a[88:91], v[8:11]
    v_mfma_f32_16x16x32_bf16 v[40:43], a[168:171], a[92:95], v[40:43]
    buffer_load_dwordx4 v239, s[8:11], s49 offen offset:3072 nt lds
    v_mfma_f32_16x16x32_bf16 v[12:15], a[172:175], a[88:91], v[12:15]
    v_mfma_f32_16x16x32_bf16 v[44:47], a[172:175], a[92:95], v[44:47]
    s_waitcnt lgkmcnt(0)
    v_mfma_f32_16x16x32_bf16 v[16:19], a[176:179], a[88:91], v[16:19]
    v_add_u32_e32 v224, s33, v224
    v_add_u32_e32 v225, s33, v225
    v_mfma_f32_16x16x32_bf16 v[48:51], a[176:179], a[92:95], v[48:51]
    v_add_u32_e32 v226, s33, v226
    v_add_u32_e32 v227, s33, v227
    s_barrier
    s_mov_b32 s50, s32
    s_add_u32 s34, s32, s38
    s_add_u32 s32, s32, s42
    s_cmp_eq_u32 s32, 159744
    s_cselect_b32 s33, s43, s42
    s_cselect_b32 s32, 0, s32
    s_sub_u32 s39, 159744, s32
    v_add_u32_e32 v228, s33, v228
    v_add_u32_e32 v254, s39, v228
    ds_read_b64_tr_b16 a[160:161], v254 offset:0
    ds_read_b64_tr_b16 a[162:163], v228 offset:32768
    v_add_u32_e32 v229, s33, v229
    v_add_u32_e32 v254, s39, v229
    ds_read_b64_tr_b16 a[164:165], v254 offset:0
    ds_read_b64_tr_b16 a[166:167], v229 offset:32768
    v_add_u32_e32 v230, s33, v230
    v_add_u32_e32 v254, s39, v230
    ds_read_b64_tr_b16 a[168:169], v254 offset:0
    ds_read_b64_tr_b16 a[170:171], v230 offset:32768
    v_mfma_f32_16x16x32_bf16 v[20:23], a[180:183], a[88:91], v[20:23]
    v_add_u32_e32 v231, s33, v231
    v_add_u32_e32 v254, s39, v231
    ds_read_b64_tr_b16 a[172:173], v254 offset:0
    v_mfma_f32_16x16x32_bf16 v[52:55], a[180:183], a[92:95], v[52:55]
    ds_read_b64_tr_b16 a[174:175], v231 offset:32768
    v_mfma_f32_16x16x32_bf16 v[24:27], a[184:187], a[88:91], v[24:27]
    v_add_u32_e32 v232, s33, v232
    v_add_u32_e32 v254, s39, v232
    ds_read_b64_tr_b16 a[176:177], v254 offset:0
    v_mfma_f32_16x16x32_bf16 v[56:59], a[184:187], a[92:95], v[56:59]
    ds_read_b64_tr_b16 a[178:179], v232 offset:32768
    v_mfma_f32_16x16x32_bf16 v[28:31], a[188:191], a[88:91], v[28:31]
    v_add_u32_e32 v233, s33, v233
    v_add_u32_e32 v254, s39, v233
    ds_read_b64_tr_b16 a[180:181], v254 offset:0
    v_mfma_f32_16x16x32_bf16 v[60:63], a[188:191], a[92:95], v[60:63]
    ds_read_b64_tr_b16 a[182:183], v233 offset:32768
    s_waitcnt lgkmcnt(4)
    v_mfma_f32_16x16x32_bf16 v[0:3], a[160:163], a[96:99], v[0:3]
    v_add_u32_e32 v234, s33, v234
    v_add_u32_e32 v254, s39, v234
    ds_read_b64_tr_b16 a[184:185], v254 offset:0
    v_mfma_f32_16x16x32_bf16 v[32:35], a[160:163], a[100:103], v[32:35]
    ds_read_b64_tr_b16 a[186:187], v234 offset:32768
    v_mfma_f32_16x16x32_bf16 v[4:7], a[164:167], a[96:99], v[4:7]
    v_add_u32_e32 v235, s33, v235
    v_add_u32_e32 v254, s39, v235
    ds_read_b64_tr_b16 a[188:189], v254 offset:0
    v_mfma_f32_16x16x32_bf16 v[36:39], a[164:167], a[100:103], v[36:39]
    ds_read_b64_tr_b16 a[190:191], v235 offset:32768
    v_mfma_f32_16x16x32_bf16 v[8:11], a[168:171], a[96:99], v[8:11]
    ds_read_b64_tr_b16 a[160:161], v228 offset:36864
    ds_read_b64_tr_b16 a[162:163], v228 offset:40960
    v_mfma_f32_16x16x32_bf16 v[40:43], a[168:171], a[100:103], v[40:43]
    v_mfma_f32_16x16x32_bf16 v[12:15], a[172:175], a[96:99], v[12:15]
    ds_read_b64_tr_b16 a[164:165], v229 offset:36864
    ds_read_b64_tr_b16 a[166:167], v229 offset:40960
    v_mfma_f32_16x16x32_bf16 v[44:47], a[172:175], a[100:103], v[44:47]
    s_waitcnt lgkmcnt(4)
    v_mfma_f32_16x16x32_bf16 v[16:19], a[176:179], a[96:99], v[16:19]
    ds_read_b64_tr_b16 a[168:169], v230 offset:36864
    ds_read_b64_tr_b16 a[170:171], v230 offset:40960
    v_mfma_f32_16x16x32_bf16 v[48:51], a[176:179], a[100:103], v[48:51]
    v_mfma_f32_16x16x32_bf16 v[20:23], a[180:183], a[96:99], v[20:23]
    ds_read_b64_tr_b16 a[172:173], v231 offset:36864
    ds_read_b64_tr_b16 a[174:175], v231 offset:40960
    v_mfma_f32_16x16x32_bf16 v[52:55], a[180:183], a[100:103], v[52:55]
    v_mfma_f32_16x16x32_bf16 v[24:27], a[184:187], a[96:99], v[24:27]
    ds_read_b64_tr_b16 a[176:177], v232 offset:36864
    ds_read_b64_tr_b16 a[178:179], v232 offset:40960
    v_mfma_f32_16x16x32_bf16 v[56:59], a[184:187], a[100:103], v[56:59]
    v_mfma_f32_16x16x32_bf16 v[28:31], a[188:191], a[96:99], v[28:31]
    ds_read_b64_tr_b16 a[180:181], v233 offset:36864
    ds_read_b64_tr_b16 a[182:183], v233 offset:40960
    v_mfma_f32_16x16x32_bf16 v[60:63], a[188:191], a[100:103], v[60:63]
    s_waitcnt lgkmcnt(4)
    v_mfma_f32_16x16x32_bf16 v[0:3], a[160:163], a[104:107], v[0:3]
    ds_read_b64_tr_b16 a[184:185], v234 offset:36864
    ds_read_b64_tr_b16 a[186:187], v234 offset:40960
    v_mfma_f32_16x16x32_bf16 v[32:35], a[160:163], a[108:111], v[32:35]
    v_mfma_f32_16x16x32_bf16 v[4:7], a[164:167], a[104:107], v[4:7]
    ds_read_b64_tr_b16 a[188:189], v235 offset:36864
    ds_read_b64_tr_b16 a[190:191], v235 offset:40960
    v_mfma_f32_16x16x32_bf16 v[36:39], a[164:167], a[108:111], v[36:39]
    v_mfma_f32_16x16x32_bf16 v[8:11], a[168:171], a[104:107], v[8:11]
    ds_read_b64_tr_b16 a[160:161], v228 offset:45056
    ds_read_b64_tr_b16 a[162:163], v228 offset:49152
    v_mfma_f32_16x16x32_bf16 v[40:43], a[168:171], a[108:111], v[40:43]
    v_mfma_f32_16x16x32_bf16 v[12:15], a[172:175], a[104:107], v[12:15]
    ds_read_b64_tr_b16 a[164:165], v229 offset:45056
    ds_read_b64_tr_b16 a[166:167], v229 offset:49152
    v_mfma_f32_16x16x32_bf16 v[44:47], a[172:175], a[108:111], v[44:47]
    s_waitcnt lgkmcnt(4)
    v_mfma_f32_16x16x32_bf16 v[16:19], a[176:179], a[104:107], v[16:19]
    ds_read_b64_tr_b16 a[168:169], v230 offset:45056
    ds_read_b64_tr_b16 a[170:171], v230 offset:49152
    v_mfma_f32_16x16x32_bf16 v[48:51], a[176:179], a[108:111], v[48:51]
    v_mfma_f32_16x16x32_bf16 v[20:23], a[180:183], a[104:107], v[20:23]
    ds_read_b64_tr_b16 a[172:173], v231 offset:45056
    ds_read_b64_tr_b16 a[174:175], v231 offset:49152
    v_mfma_f32_16x16x32_bf16 v[52:55], a[180:183], a[108:111], v[52:55]
    v_mfma_f32_16x16x32_bf16 v[24:27], a[184:187], a[104:107], v[24:27]
    ds_read_b64_tr_b16 a[176:177], v232 offset:45056
    ds_read_b64_tr_b16 a[178:179], v232 offset:49152
    v_mfma_f32_16x16x32_bf16 v[56:59], a[184:187], a[108:111], v[56:59]
    v_mfma_f32_16x16x32_bf16 v[28:31], a[188:191], a[104:107], v[28:31]
    ds_read_b64_tr_b16 a[180:181], v233 offset:45056
    ds_read_b64_tr_b16 a[182:183], v233 offset:49152
    v_mfma_f32_16x16x32_bf16 v[60:63], a[188:191], a[108:111], v[60:63]
    s_waitcnt lgkmcnt(4)
    v_mfma_f32_16x16x32_bf16 v[0:3], a[160:163], a[112:115], v[0:3]
    ds_read_b64_tr_b16 a[184:185], v234 offset:45056
    ds_read_b64_tr_b16 a[186:187], v234 offset:49152
    v_mfma_f32_16x16x32_bf16 v[32:35], a[160:163], a[116:119], v[32:35]
    v_mfma_f32_16x16x32_bf16 v[4:7], a[164:167], a[112:115], v[4:7]
    ds_read_b64_tr_b16 a[188:189], v235 offset:45056
    ds_read_b64_tr_b16 a[190:191], v235 offset:49152
    v_mfma_f32_16x16x32_bf16 v[36:39], a[164:167], a[116:119], v[36:39]
    v_mfma_f32_16x16x32_bf16 v[8:11], a[168:171], a[112:115], v[8:11]
    v_mfma_f32_16x16x32_bf16 v[40:43], a[168:171], a[116:119], v[40:43]
    v_mfma_f32_16x16x32_bf16 v[12:15], a[172:175], a[112:115], v[12:15]
    v_mfma_f32_16x16x32_bf16 v[44:47], a[172:175], a[116:119], v[44:47]
    s_waitcnt lgkmcnt(0)
    v_mfma_f32_16x16x32_bf16 v[16:19], a[176:179], a[112:115], v[16:19]
    v_add_u32_e32 v224, s33, v224
    v_add_u32_e32 v225, s33, v225
    v_mfma_f32_16x16x32_bf16 v[48:51], a[176:179], a[116:119], v[48:51]
    v_add_u32_e32 v226, s33, v226
    v_add_u32_e32 v227, s33, v227
    s_barrier
    s_mov_b32 s50, s32
    s_add_u32 s34, s32, s38
    s_add_u32 s32, s32, s42
    s_cmp_eq_u32 s32, 159744
    s_cselect_b32 s33, s43, s42
    s_cselect_b32 s32, 0, s32
    v_add_u32_e32 v228, s33, v228
    ds_read_b64_tr_b16 a[160:161], v228 offset:32768
    ds_read_b64_tr_b16 a[162:163], v228 offset:36864
    v_add_u32_e32 v229, s33, v229
    ds_read_b64_tr_b16 a[164:165], v229 offset:32768
    ds_read_b64_tr_b16 a[166:167], v229 offset:36864
    v_add_u32_e32 v230, s33, v230
    ds_read_b64_tr_b16 a[168:169], v230 offset:32768
    ds_read_b64_tr_b16 a[170:171], v230 offset:36864
    v_mfma_f32_16x16x32_bf16 v[20:23], a[180:183], a[112:115], v[20:23]
    v_add_u32_e32 v231, s33, v231
    ds_read_b64_tr_b16 a[172:173], v231 offset:32768
    v_mfma_f32_16x16x32_bf16 v[52:55], a[180:183], a[116:119], v[52:55]
    ds_read_b64_tr_b16 a[174:175], v231 offset:36864
    v_mfma_f32_16x16x32_bf16 v[24:27], a[184:187], a[112:115], v[24:27]
    v_add_u32_e32 v232, s33, v232
    ds_read_b64_tr_b16 a[176:177], v232 offset:32768
    v_mfma_f32_16x16x32_bf16 v[56:59], a[184:187], a[116:119], v[56:59]
    ds_read_b64_tr_b16 a[178:179], v232 offset:36864
    v_mfma_f32_16x16x32_bf16 v[28:31], a[188:191], a[112:115], v[28:31]
    v_add_u32_e32 v233, s33, v233
    ds_read_b64_tr_b16 a[180:181], v233 offset:32768
    v_mfma_f32_16x16x32_bf16 v[60:63], a[188:191], a[116:119], v[60:63]
    ds_read_b64_tr_b16 a[182:183], v233 offset:36864
    s_waitcnt lgkmcnt(4)
    v_mfma_f32_16x16x32_bf16 v[0:3], a[160:163], a[120:123], v[0:3]
    v_add_u32_e32 v234, s33, v234
    ds_read_b64_tr_b16 a[184:185], v234 offset:32768
    ds_read_b64_tr_b16 a[186:187], v234 offset:36864
    v_mfma_f32_16x16x32_bf16 v[32:35], a[160:163], a[124:127], v[32:35]
    s_add_u32 s36, s38, 106496
    s_mov_b32 s49, 16384
    v_mfma_f32_16x16x32_bf16 v[4:7], a[164:167], a[120:123], v[4:7]
    v_add_u32_e32 v235, s33, v235
    ds_read_b64_tr_b16 a[188:189], v235 offset:32768
    ds_read_b64_tr_b16 a[190:191], v235 offset:36864
    v_mfma_f32_16x16x32_bf16 v[36:39], a[164:167], a[124:127], v[36:39]
    s_add_u32 m0, s36, 0
    v_mfma_f32_16x16x32_bf16 v[8:11], a[168:171], a[120:123], v[8:11]
    ds_read_b64_tr_b16 a[160:161], v228 offset:40960
    ds_read_b64_tr_b16 a[162:163], v228 offset:45056
    v_mfma_f32_16x16x32_bf16 v[40:43], a[168:171], a[124:127], v[40:43]
    buffer_load_dwordx4 v236, s[8:11], s49 offen offset:0 nt lds
    v_mfma_f32_16x16x32_bf16 v[12:15], a[172:175], a[120:123], v[12:15]
    ds_read_b64_tr_b16 a[164:165], v229 offset:40960
    ds_read_b64_tr_b16 a[166:167], v229 offset:45056
    v_mfma_f32_16x16x32_bf16 v[44:47], a[172:175], a[124:127], v[44:47]
    buffer_load_dwordx4 v237, s[8:11], s49 offen offset:1024 nt lds
    s_waitcnt lgkmcnt(4)
    v_mfma_f32_16x16x32_bf16 v[16:19], a[176:179], a[120:123], v[16:19]
    ds_read_b64_tr_b16 a[168:169], v230 offset:40960
    ds_read_b64_tr_b16 a[170:171], v230 offset:45056
    v_mfma_f32_16x16x32_bf16 v[48:51], a[176:179], a[124:127], v[48:51]
    buffer_load_dwordx4 v238, s[8:11], s49 offen offset:2048 nt lds
    v_mfma_f32_16x16x32_bf16 v[20:23], a[180:183], a[120:123], v[20:23]
    ds_read_b64_tr_b16 a[172:173], v231 offset:40960
    ds_read_b64_tr_b16 a[174:175], v231 offset:45056
    v_mfma_f32_16x16x32_bf16 v[52:55], a[180:183], a[124:127], v[52:55]
    buffer_load_dwordx4 v239, s[8:11], s49 offen offset:3072 nt lds
    v_mfma_f32_16x16x32_bf16 v[24:27], a[184:187], a[120:123], v[24:27]
    ds_read_b64_tr_b16 a[176:177], v232 offset:40960
    ds_read_b64_tr_b16 a[178:179], v232 offset:45056
    v_mfma_f32_16x16x32_bf16 v[56:59], a[184:187], a[124:127], v[56:59]
    s_add_u32 s36, s38, 106496
    s_mov_b32 s49, 0
    v_mfma_f32_16x16x32_bf16 v[28:31], a[188:191], a[120:123], v[28:31]
    ds_read_b64_tr_b16 a[180:181], v233 offset:40960
    ds_read_b64_tr_b16 a[182:183], v233 offset:45056
    v_mfma_f32_16x16x32_bf16 v[60:63], a[188:191], a[124:127], v[60:63]
    s_add_u32 m0, s36, 16384
    s_waitcnt lgkmcnt(4)
    v_mfma_f32_16x16x32_bf16 v[0:3], a[160:163], a[128:131], v[0:3]
    ds_read_b64_tr_b16 a[184:185], v234 offset:40960
    ds_read_b64_tr_b16 a[186:187], v234 offset:45056
    v_mfma_f32_16x16x32_bf16 v[32:35], a[160:163], a[132:135], v[32:35]
    buffer_load_dwordx4 v240, s[12:15], s49 offen offset:0 nt lds
    v_mfma_f32_16x16x32_bf16 v[4:7], a[164:167], a[128:131], v[4:7]
    ds_read_b64_tr_b16 a[188:189], v235 offset:40960
    ds_read_b64_tr_b16 a[190:191], v235 offset:45056
    v_mfma_f32_16x16x32_bf16 v[36:39], a[164:167], a[132:135], v[36:39]
    buffer_load_dwordx4 v241, s[12:15], s49 offen offset:1024 nt lds
    v_mfma_f32_16x16x32_bf16 v[8:11], a[168:171], a[128:131], v[8:11]
    v_mfma_f32_16x16x32_bf16 v[40:43], a[168:171], a[132:135], v[40:43]
    buffer_load_dwordx4 v240, s[12:15], s49 offen offset:2048 nt lds
    v_mfma_f32_16x16x32_bf16 v[12:15], a[172:175], a[128:131], v[12:15]
    v_mfma_f32_16x16x32_bf16 v[44:47], a[172:175], a[132:135], v[44:47]
    buffer_load_dwordx4 v241, s[12:15], s49 offen offset:3072 nt lds
    s_waitcnt lgkmcnt(0)
    v_mfma_f32_16x16x32_bf16 v[16:19], a[176:179], a[128:131], v[16:19]
    v_add_u32_e32 v224, s33, v224
    v_add_u32_e32 v225, s33, v225
    v_mfma_f32_16x16x32_bf16 v[48:51], a[176:179], a[132:135], v[48:51]
    v_add_u32_e32 v226, s33, v226
    v_add_u32_e32 v227, s33, v227
    s_waitcnt vmcnt(8)
    s_barrier
    s_mov_b32 s50, s32
    s_add_u32 s34, s32, s38
    s_add_u32 s32, s32, s42
    s_cmp_eq_u32 s32, 159744
    s_cselect_b32 s33, s43, s42
    s_cselect_b32 s32, 0, s32
    s_sub_u32 s39, 159744, s32
    v_add_u32_e32 v228, s33, v228
    v_add_u32_e32 v254, s39, v228
    ds_read_b64_tr_b16 a[160:161], v254 offset:0
    ds_read_b64_tr_b16 a[162:163], v228 offset:32768
    ds_read_b64_tr_b16 a[164:165], v228 offset:36864
    ds_read_b64_tr_b16 a[166:167], v228 offset:40960
    ds_read_b64_tr_b16 a[168:169], v228 offset:45056
    ds_read_b64_tr_b16 a[170:171], v228 offset:49152
    v_mfma_f32_16x16x32_bf16 v[20:23], a[180:183], a[128:131], v[20:23]
    v_add_u32_e32 v229, s33, v229
    v_add_u32_e32 v254, s39, v229
    ds_read_b64_tr_b16 a[172:173], v254 offset:0
    v_mfma_f32_16x16x32_bf16 v[52:55], a[180:183], a[132:135], v[52:55]
    ds_read_b64_tr_b16 a[174:175], v229 offset:32768
    v_mfma_f32_16x16x32_bf16 v[24:27], a[184:187], a[128:131], v[24:27]
    ds_read_b64_tr_b16 a[176:177], v229 offset:36864
    ds_read_b64_tr_b16 a[178:179], v229 offset:40960
    v_mfma_f32_16x16x32_bf16 v[56:59], a[184:187], a[132:135], v[56:59]
    v_mfma_f32_16x16x32_bf16 v[28:31], a[188:191], a[128:131], v[28:31]
    ds_read_b64_tr_b16 a[180:181], v229 offset:45056
    ds_read_b64_tr_b16 a[182:183], v229 offset:49152
    v_mfma_f32_16x16x32_bf16 v[60:63], a[188:191], a[132:135], v[60:63]
    v_add_u32_e32 v230, s33, v230
    s_waitcnt lgkmcnt(4)
    v_mfma_f32_16x16x32_bf16 v[0:3], a[160:163], a[136:139], v[0:3]
    v_add_u32_e32 v254, s39, v230
    ds_read_b64_tr_b16 a[184:185], v254 offset:0
    ds_read_b64_tr_b16 a[186:187], v230 offset:32768
    v_mfma_f32_16x16x32_bf16 v[32:35], a[160:163], a[140:143], v[32:35]
    s_add_u32 s36, s38, 0
    v_mfma_f32_16x16x32_bf16 v[0:3], a[164:167], a[144:147], v[0:3]
    ds_read_b64_tr_b16 a[188:189], v230 offset:36864
    ds_read_b64_tr_b16 a[190:191], v230 offset:40960
    v_mfma_f32_16x16x32_bf16 v[32:35], a[164:167], a[148:151], v[32:35]
    v_mfma_f32_16x16x32_bf16 v[0:3], a[168:171], a[152:155], v[0:3]
    ds_read_b64_tr_b16 a[160:161], v230 offset:45056
    ds_read_b64_tr_b16 a[162:163], v230 offset:49152
    v_mfma_f32_16x16x32_bf16 v[32:35], a[168:171], a[156:159], v[32:35]
    s_mov_b32 s49, 32768
    v_mfma_f32_16x16x32_bf16 v[4:7], a[172:175], a[136:139], v[4:7]
    v_add_u32_e32 v231, s33, v231
    v_add_u32_e32 v254, s39, v231
    ds_read_b64_tr_b16 a[164:165], v254 offset:0
    v_mfma_f32_16x16x32_bf16 v[36:39], a[172:175], a[140:143], v[36:39]
    ds_read_b64_tr_b16 a[166:167], v231 offset:32768
    s_waitcnt lgkmcnt(4)
    v_mfma_f32_16x16x32_bf16 v[4:7], a[176:179], a[144:147], v[4:7]
    ds_read_b64_tr_b16 a[168:169], v231 offset:36864
    ds_read_b64_tr_b16 a[170:171], v231 offset:40960
    v_mfma_f32_16x16x32_bf16 v[36:39], a[176:179], a[148:151], v[36:39]
    v_mfma_f32_16x16x32_bf16 v[4:7], a[180:183], a[152:155], v[4:7]
    ds_read_b64_tr_b16 a[172:173], v231 offset:45056
    ds_read_b64_tr_b16 a[174:175], v231 offset:49152
    v_mfma_f32_16x16x32_bf16 v[36:39], a[180:183], a[156:159], v[36:39]
    s_add_u32 m0, s36, 0
    v_mfma_f32_16x16x32_bf16 v[8:11], a[184:187], a[136:139], v[8:11]
    v_add_u32_e32 v232, s33, v232
    v_add_u32_e32 v254, s39, v232
    ds_read_b64_tr_b16 a[176:177], v254 offset:0
    v_mfma_f32_16x16x32_bf16 v[40:43], a[184:187], a[140:143], v[40:43]
    ds_read_b64_tr_b16 a[178:179], v232 offset:32768
    v_mfma_f32_16x16x32_bf16 v[8:11], a[188:191], a[144:147], v[8:11]
    ds_read_b64_tr_b16 a[180:181], v232 offset:36864
    ds_read_b64_tr_b16 a[182:183], v232 offset:40960
    v_mul_f32_e32 v0, s41, v0
    v_mfma_f32_16x16x32_bf16 v[40:43], a[188:191], a[148:151], v[40:43]
    buffer_load_dwordx4 v236, s[8:11], s49 offen offset:0 nt lds
    s_waitcnt lgkmcnt(4)
    v_mfma_f32_16x16x32_bf16 v[8:11], a[160:163], a[152:155], v[8:11]
    ds_read_b64_tr_b16 a[184:185], v232 offset:45056
    ds_read_b64_tr_b16 a[186:187], v232 offset:49152
    v_mfma_f32_16x16x32_bf16 v[40:43], a[160:163], a[156:159], v[40:43]
    v_mul_f32_e32 v1, s41, v1
    v_mul_f32_e32 v2, s41, v2
    v_mul_f32_e32 v3, s41, v3
    v_mfma_f32_16x16x32_bf16 v[12:15], a[164:167], a[136:139], v[12:15]
    v_add_u32_e32 v233, s33, v233
    v_add_u32_e32 v254, s39, v233
    ds_read_b64_tr_b16 a[188:189], v254 offset:0
    ds_read_b64_tr_b16 a[190:191], v233 offset:32768
    v_mfma_f32_16x16x32_bf16 v[44:47], a[164:167], a[140:143], v[44:47]
    v_mul_f32_e32 v4, s41, v4
    v_mul_f32_e32 v5, s41, v5
    v_mul_f32_e32 v6, s41, v6
    v_mfma_f32_16x16x32_bf16 v[12:15], a[168:171], a[144:147], v[12:15]
    ds_read_b64_tr_b16 a[160:161], v233 offset:36864
    ds_read_b64_tr_b16 a[162:163], v233 offset:40960
    v_mul_f32_e32 v7, s41, v7
    v_mfma_f32_16x16x32_bf16 v[44:47], a[168:171], a[148:151], v[44:47]
    buffer_load_dwordx4 v237, s[8:11], s49 offen offset:1024 nt lds
    v_mfma_f32_16x16x32_bf16 v[12:15], a[172:175], a[152:155], v[12:15]
    ds_read_b64_tr_b16 a[164:165], v233 offset:45056
    ds_read_b64_tr_b16 a[166:167], v233 offset:49152
    v_mul_f32_e32 v32, s41, v32
    v_mfma_f32_16x16x32_bf16 v[44:47], a[172:175], a[156:159], v[44:47]
    v_mul_f32_e32 v33, s41, v33
    v_mul_f32_e32 v34, s41, v34
    v_mul_f32_e32 v35, s41, v35
    s_waitcnt lgkmcnt(4)
    v_mfma_f32_16x16x32_bf16 v[16:19], a[176:179], a[136:139], v[16:19]
    v_add_u32_e32 v234, s33, v234
    v_add_u32_e32 v254, s39, v234
    ds_read_b64_tr_b16 a[168:169], v254 offset:0
    ds_read_b64_tr_b16 a[170:171], v234 offset:32768
    v_mfma_f32_16x16x32_bf16 v[48:51], a[176:179], a[140:143], v[48:51]
    buffer_load_dwordx4 v238, s[8:11], s49 offen offset:2048 nt lds
    v_mfma_f32_16x16x32_bf16 v[16:19], a[180:183], a[144:147], v[16:19]
    ds_read_b64_tr_b16 a[172:173], v234 offset:36864
    ds_read_b64_tr_b16 a[174:175], v234 offset:40960
    v_mul_f32_e32 v36, s41, v36
    v_mfma_f32_16x16x32_bf16 v[48:51], a[180:183], a[148:151], v[48:51]
    v_mul_f32_e32 v37, s41, v37
    v_mul_f32_e32 v38, s41, v38
    v_mul_f32_e32 v39, s41, v39
    v_mfma_f32_16x16x32_bf16 v[16:19], a[184:187], a[152:155], v[16:19]
    ds_read_b64_tr_b16 a[176:177], v234 offset:45056
    ds_read_b64_tr_b16 a[178:179], v234 offset:49152
    v_cvt_pk_bf16_f32 v192, v0, v1
    v_mfma_f32_16x16x32_bf16 v[48:51], a[184:187], a[156:159], v[48:51]
    v_cvt_pk_bf16_f32 v193, v2, v3
    v_cvt_pk_bf16_f32 v194, v4, v5
    v_cvt_pk_bf16_f32 v195, v6, v7
    v_mfma_f32_16x16x32_bf16 v[20:23], a[188:191], a[136:139], v[20:23]
    v_add_u32_e32 v235, s33, v235
    v_add_u32_e32 v254, s39, v235
    ds_read_b64_tr_b16 a[180:181], v254 offset:0
    ds_read_b64_tr_b16 a[182:183], v235 offset:32768
    v_mfma_f32_16x16x32_bf16 v[52:55], a[188:191], a[140:143], v[52:55]
    buffer_load_dwordx4 v239, s[8:11], s49 offen offset:3072 nt lds
    s_waitcnt lgkmcnt(4)
    v_mfma_f32_16x16x32_bf16 v[20:23], a[160:163], a[144:147], v[20:23]
    ds_read_b64_tr_b16 a[184:185], v235 offset:36864
    ds_read_b64_tr_b16 a[186:187], v235 offset:40960
    v_mfma_f32_16x16x32_bf16 v[52:55], a[160:163], a[148:151], v[52:55]
    v_cvt_pk_bf16_f32 v208, v32, v33
    v_cvt_pk_bf16_f32 v209, v34, v35
    v_cvt_pk_bf16_f32 v210, v36, v37
    v_mfma_f32_16x16x32_bf16 v[20:23], a[164:167], a[152:155], v[20:23]
    ds_read_b64_tr_b16 a[188:189], v235 offset:45056
    ds_read_b64_tr_b16 a[190:191], v235 offset:49152
    v_cvt_pk_bf16_f32 v211, v38, v39
    v_mfma_f32_16x16x32_bf16 v[52:55], a[164:167], a[156:159], v[52:55]
    v_permlane32_swap_b32_e32 v192, v194
    v_permlane32_swap_b32_e32 v193, v195
    v_permlane32_swap_b32_e32 v208, v210
    v_mfma_f32_16x16x32_bf16 v[24:27], a[168:171], a[136:139], v[24:27]
    v_add_u32_e32 v224, s33, v224
    ds_read_b128 a[160:163], v224 offset:0
    v_permlane32_swap_b32_e32 v209, v211
    v_mfma_f32_16x16x32_bf16 v[56:59], a[168:171], a[140:143], v[56:59]
    s_add_u32 s36, s38, 0
    v_permlane16_swap_b32_e32 v192, v194
    v_permlane16_swap_b32_e32 v193, v195
    v_mfma_f32_16x16x32_bf16 v[24:27], a[172:175], a[144:147], v[24:27]
    v_add_u32_e32 v225, s33, v225
    ds_read_b128 a[164:167], v225 offset:0
    v_permlane16_swap_b32_e32 v208, v210
    v_mfma_f32_16x16x32_bf16 v[56:59], a[172:175], a[148:151], v[56:59]
    v_permlane16_swap_b32_e32 v209, v211
    v_mul_f32_e32 v8, s41, v8
    v_mul_f32_e32 v9, s41, v9
    s_waitcnt lgkmcnt(2)
    v_mfma_f32_16x16x32_bf16 v[24:27], a[176:179], a[152:155], v[24:27]
    v_add_u32_e32 v226, s33, v226
    ds_read_b128 a[168:171], v226 offset:0
    v_mfma_f32_16x16x32_bf16 v[56:59], a[176:179], a[156:159], v[56:59]
    s_mov_b32 s49, 16384
    v_mul_f32_e32 v10, s41, v10
    v_mul_f32_e32 v11, s41, v11
    v_mfma_f32_16x16x32_bf16 v[28:31], a[180:183], a[136:139], v[28:31]
    v_add_u32_e32 v227, s33, v227
    ds_read_b128 a[172:175], v227 offset:0
    v_mul_f32_e32 v12, s41, v12
    v_mfma_f32_16x16x32_bf16 v[60:63], a[180:183], a[140:143], v[60:63]
    v_mul_f32_e32 v13, s41, v13
    v_mul_f32_e32 v14, s41, v14
    v_mul_f32_e32 v15, s41, v15
    v_mfma_f32_16x16x32_bf16 v[28:31], a[184:187], a[144:147], v[28:31]
    ds_read_b128 a[176:179], v224 offset:4096
    v_mul_f32_e32 v40, s41, v40
    v_mul_f32_e32 v41, s41, v41
    v_mfma_f32_16x16x32_bf16 v[60:63], a[184:187], a[148:151], v[60:63]
    v_mul_f32_e32 v42, s41, v42
    v_mul_f32_e32 v43, s41, v43
    v_mul_f32_e32 v44, s41, v44
    v_mfma_f32_16x16x32_bf16 v[28:31], a[188:191], a[152:155], v[28:31]
    ds_read_b128 a[180:183], v225 offset:4096
    v_mul_f32_e32 v45, s41, v45
    v_mul_f32_e32 v46, s41, v46
    v_mfma_f32_16x16x32_bf16 v[60:63], a[188:191], a[156:159], v[60:63]
    s_add_u32 m0, s36, 16384
    v_mul_f32_e32 v47, s41, v47
    v_cvt_pk_bf16_f32 v196, v8, v9
    v_cvt_pk_bf16_f32 v197, v10, v11
    v_cvt_pk_bf16_f32 v198, v12, v13
    v_cvt_pk_bf16_f32 v199, v14, v15
    v_cvt_pk_bf16_f32 v212, v40, v41
    v_cvt_pk_bf16_f32 v213, v42, v43
    v_cvt_pk_bf16_f32 v214, v44, v45
    v_cvt_pk_bf16_f32 v215, v46, v47
    v_permlane32_swap_b32_e32 v196, v198
    v_permlane32_swap_b32_e32 v197, v199
    v_permlane32_swap_b32_e32 v212, v214
    v_permlane32_swap_b32_e32 v213, v215
    v_permlane16_swap_b32_e32 v196, v198
    v_permlane16_swap_b32_e32 v197, v199
    v_permlane16_swap_b32_e32 v212, v214
    v_permlane16_swap_b32_e32 v213, v215
    v_mul_f32_e32 v16, s41, v16
    v_mul_f32_e32 v17, s41, v17
    v_mul_f32_e32 v18, s41, v18
    v_mul_f32_e32 v19, s41, v19
    v_mul_f32_e32 v20, s41, v20
    v_mul_f32_e32 v21, s41, v21
    v_mul_f32_e32 v22, s41, v22
    v_mul_f32_e32 v23, s41, v23
    v_mul_f32_e32 v48, s41, v48
    v_mul_f32_e32 v49, s41, v49
    v_mul_f32_e32 v50, s41, v50
    v_mul_f32_e32 v51, s41, v51
    v_mul_f32_e32 v52, s41, v52
    v_mul_f32_e32 v53, s41, v53
    v_mul_f32_e32 v54, s41, v54
    v_mul_f32_e32 v55, s41, v55
    v_cvt_pk_bf16_f32 v200, v16, v17
    v_cvt_pk_bf16_f32 v201, v18, v19
    v_cvt_pk_bf16_f32 v202, v20, v21
    v_cvt_pk_bf16_f32 v203, v22, v23
    v_cvt_pk_bf16_f32 v216, v48, v49
    v_cvt_pk_bf16_f32 v217, v50, v51
    v_cvt_pk_bf16_f32 v218, v52, v53
    v_cvt_pk_bf16_f32 v219, v54, v55
    v_permlane32_swap_b32_e32 v200, v202
    v_permlane32_swap_b32_e32 v201, v203
    v_permlane32_swap_b32_e32 v216, v218
    v_permlane32_swap_b32_e32 v217, v219
    v_permlane16_swap_b32_e32 v200, v202
    v_permlane16_swap_b32_e32 v201, v203
    v_permlane16_swap_b32_e32 v216, v218
    v_permlane16_swap_b32_e32 v217, v219
    v_mul_f32_e32 v24, s41, v24
    v_mul_f32_e32 v25, s41, v25
    v_mul_f32_e32 v26, s41, v26
    v_mul_f32_e32 v27, s41, v27
    v_mul_f32_e32 v28, s41, v28
    v_mul_f32_e32 v29, s41, v29
    v_mul_f32_e32 v30, s41, v30
    v_mul_f32_e32 v31, s41, v31
    v_mul_f32_e32 v56, s41, v56
    v_mul_f32_e32 v57, s41, v57
    v_mul_f32_e32 v58, s41, v58
    v_mul_f32_e32 v59, s41, v59
    v_mul_f32_e32 v60, s41, v60
    v_mul_f32_e32 v61, s41, v61
    v_mul_f32_e32 v62, s41, v62
    v_mul_f32_e32 v63, s41, v63
    v_cvt_pk_bf16_f32 v204, v24, v25
    v_cvt_pk_bf16_f32 v205, v26, v27
    v_cvt_pk_bf16_f32 v206, v28, v29
    v_cvt_pk_bf16_f32 v207, v30, v31
    v_cvt_pk_bf16_f32 v220, v56, v57
    v_cvt_pk_bf16_f32 v221, v58, v59
    v_cvt_pk_bf16_f32 v222, v60, v61
    v_cvt_pk_bf16_f32 v223, v62, v63
    v_permlane32_swap_b32_e32 v204, v206
    v_permlane32_swap_b32_e32 v205, v207
    v_permlane32_swap_b32_e32 v220, v222
    v_permlane32_swap_b32_e32 v221, v223
    v_permlane16_swap_b32_e32 v204, v206
    v_permlane16_swap_b32_e32 v205, v207
    v_permlane16_swap_b32_e32 v220, v222
    s_waitcnt lgkmcnt(2)
    v_mfma_f32_16x16x32_bf16 v[128:131], a[160:163], v[192:195], 0
    v_permlane16_swap_b32_e32 v221, v223
    ds_read_b128 a[184:187], v226 offset:4096
    v_mfma_f32_16x16x32_bf16 v[144:147], a[160:163], v[208:211], 0
    v_mfma_f32_16x16x32_bf16 v[128:131], a[164:167], v[196:199], v[128:131]
    ds_read_b128 a[188:191], v227 offset:4096
    v_mfma_f32_16x16x32_bf16 v[144:147], a[164:167], v[212:215], v[144:147]
    buffer_load_dwordx4 v240, s[12:15], s49 offen offset:0 nt lds
    v_mfma_f32_16x16x32_bf16 v[128:131], a[168:171], v[200:203], v[128:131]
    ds_read_b128 a[160:163], v224 offset:8192
    v_mfma_f32_16x16x32_bf16 v[144:147], a[168:171], v[216:219], v[144:147]
    v_mfma_f32_16x16x32_bf16 v[128:131], a[172:175], v[204:207], v[128:131]
    ds_read_b128 a[164:167], v225 offset:8192
    v_mfma_f32_16x16x32_bf16 v[144:147], a[172:175], v[220:223], v[144:147]
    s_waitcnt lgkmcnt(2)
    v_mfma_f32_16x16x32_bf16 v[132:135], a[176:179], v[192:195], 0
    ds_read_b128 a[168:171], v226 offset:8192
    v_mfma_f32_16x16x32_bf16 v[148:151], a[176:179], v[208:211], 0
    buffer_load_dwordx4 v241, s[12:15], s49 offen offset:1024 nt lds
    v_mfma_f32_16x16x32_bf16 v[132:135], a[180:183], v[196:199], v[132:135]
    ds_read_b128 a[172:175], v227 offset:8192
    v_mfma_f32_16x16x32_bf16 v[148:151], a[180:183], v[212:215], v[148:151]
    v_mfma_f32_16x16x32_bf16 v[132:135], a[184:187], v[200:203], v[132:135]
    ds_read_b128 a[176:179], v224 offset:12288
    v_mfma_f32_16x16x32_bf16 v[148:151], a[184:187], v[216:219], v[148:151]
    buffer_load_dwordx4 v240, s[12:15], s49 offen offset:2048 nt lds
    v_mfma_f32_16x16x32_bf16 v[132:135], a[188:191], v[204:207], v[132:135]
    ds_read_b128 a[180:183], v225 offset:12288
    v_mfma_f32_16x16x32_bf16 v[148:151], a[188:191], v[220:223], v[148:151]
    s_waitcnt lgkmcnt(2)
    v_mfma_f32_16x16x32_bf16 v[136:139], a[160:163], v[192:195], 0
    ds_read_b128 a[184:187], v226 offset:12288
    v_mfma_f32_16x16x32_bf16 v[152:155], a[160:163], v[208:211], 0
    v_mfma_f32_16x16x32_bf16 v[136:139], a[164:167], v[196:199], v[136:139]
    ds_read_b128 a[188:191], v227 offset:12288
    v_mfma_f32_16x16x32_bf16 v[152:155], a[164:167], v[212:215], v[152:155]
    buffer_load_dwordx4 v241, s[12:15], s49 offen offset:3072 nt lds
    v_mfma_f32_16x16x32_bf16 v[136:139], a[168:171], v[200:203], v[136:139]
    v_mfma_f32_16x16x32_bf16 v[152:155], a[168:171], v[216:219], v[152:155]
    v_mfma_f32_16x16x32_bf16 v[136:139], a[172:175], v[204:207], v[136:139]
    v_mfma_f32_16x16x32_bf16 v[152:155], a[172:175], v[220:223], v[152:155]
    s_waitcnt lgkmcnt(0)
    v_mfma_f32_16x16x32_bf16 v[140:143], a[176:179], v[192:195], 0
    v_mfma_f32_16x16x32_bf16 v[156:159], a[176:179], v[208:211], 0
    s_waitcnt vmcnt(8)
    s_barrier
    s_mov_b32 s50, s32
    s_add_u32 s34, s32, s38
    s_add_u32 s32, s32, s42
    s_cmp_eq_u32 s32, 159744
    s_cselect_b32 s33, s43, s42
    s_cselect_b32 s32, 0, s32
    v_add_u32_e32 v224, s33, v224
    ds_read_b128 a[160:163], v224 offset:0
    v_add_u32_e32 v225, s33, v225
    ds_read_b128 a[164:167], v225 offset:0
    v_add_u32_e32 v226, s33, v226
    ds_read_b128 a[168:171], v226 offset:0
    v_mfma_f32_16x16x32_bf16 v[140:143], a[180:183], v[196:199], v[140:143]
    v_mfma_f32_16x16x32_bf16 v[156:159], a[180:183], v[212:215], v[156:159]
    v_mfma_f32_16x16x32_bf16 v[140:143], a[184:187], v[200:203], v[140:143]
    v_mfma_f32_16x16x32_bf16 v[156:159], a[184:187], v[216:219], v[156:159]
    v_mfma_f32_16x16x32_bf16 v[140:143], a[188:191], v[204:207], v[140:143]
    v_mfma_f32_16x16x32_bf16 v[156:159], a[188:191], v[220:223], v[156:159]
A_A_head:
    s_waitcnt lgkmcnt(0)
    v_mfma_f32_16x16x32_bf16 v[160:163], a[160:163], v[192:195], 0
    v_add_u32_e32 v227, s33, v227
    ds_read_b128 a[172:175], v227 offset:0
    ds_read_b128 a[176:179], v224 offset:4096
    ds_read_b128 a[180:183], v225 offset:4096
    ds_read_b128 a[184:187], v226 offset:4096
    v_mfma_f32_16x16x32_bf16 v[176:179], a[160:163], v[208:211], 0
    s_add_u32 m0, s34, 0
    v_exp_f32_e32 v128, v128
    v_mfma_f32_16x16x32_bf16 v[160:163], a[164:167], v[196:199], v[160:163]
    ds_read_b128 a[188:191], v227 offset:4096
    v_exp_f32_e32 v129, v129
    v_mfma_f32_16x16x32_bf16 v[176:179], a[164:167], v[212:215], v[176:179]
    buffer_load_dwordx4 v236, s[8:11], s29 offen offset:0 nt lds
    v_mfma_f32_16x16x32_bf16 v[160:163], a[168:171], v[200:203], v[160:163]
    ds_read_b128 a[160:163], v224 offset:8192
    v_exp_f32_e32 v130, v130
    v_mfma_f32_16x16x32_bf16 v[176:179], a[168:171], v[216:219], v[176:179]
    buffer_load_dwordx4 v237, s[8:11], s29 offen offset:1024 nt lds
    s_waitcnt lgkmcnt(5)
    v_mfma_f32_16x16x32_bf16 v[160:163], a[172:175], v[204:207], v[160:163]
    ds_read_b128 a[164:167], v225 offset:8192
    v_exp_f32_e32 v131, v131
    v_cvt_pk_bf16_f32 v128, v128, v129
    v_exp_f32_e32 v132, v132
    v_mfma_f32_16x16x32_bf16 v[176:179], a[172:175], v[220:223], v[176:179]
    v_exp_f32_e32 v133, v133
    s_waitcnt lgkmcnt(2)
    v_mfma_f32_16x16x32_bf16 v[164:167], a[176:179], v[192:195], 0
    ds_read_b128 a[168:171], v226 offset:8192
    v_cvt_pk_bf16_f32 v129, v130, v131
    v_mfma_f32_16x16x32_bf16 v[180:183], a[176:179], v[208:211], 0
    buffer_load_dwordx4 v238, s[8:11], s29 offen offset:2048 nt lds
    v_mfma_f32_16x16x32_bf16 v[164:167], a[180:183], v[196:199], v[164:167]
    ds_read_b128 a[172:175], v227 offset:8192
    v_exp_f32_e32 v134, v134
    v_exp_f32_e32 v135, v135
    v_mfma_f32_16x16x32_bf16 v[180:183], a[180:183], v[212:215], v[180:183]
    buffer_load_dwordx4 v239, s[8:11], s29 offen offset:3072 nt lds
    v_cvt_pk_bf16_f32 v130, v132, v133
    v_mfma_f32_16x16x32_bf16 v[164:167], a[184:187], v[200:203], v[164:167]
    ds_read_b128 a[176:179], v224 offset:12288
    v_cvt_pk_bf16_f32 v131, v134, v135
    v_exp_f32_e32 v144, v144
    v_mfma_f32_16x16x32_bf16 v[180:183], a[184:187], v[216:219], v[180:183]
    v_exp_f32_e32 v145, v145
    v_mfma_f32_16x16x32_bf16 v[164:167], a[188:191], v[204:207], v[164:167]
    ds_read_b128 a[180:183], v225 offset:12288
    v_mfma_f32_16x16x32_bf16 v[246:249], v[242:245], v[128:131], 0
    s_add_u32 s29, s29, 16384
    v_mfma_f32_16x16x32_bf16 v[180:183], a[188:191], v[220:223], v[180:183]
    v_exp_f32_e32 v146, v146
    s_waitcnt lgkmcnt(2)
    v_mfma_f32_16x16x32_bf16 v[168:171], a[160:163], v[192:195], 0
    ds_read_b128 a[184:187], v226 offset:12288
    v_exp_f32_e32 v147, v147
    v_mfma_f32_16x16x32_bf16 v[184:187], a[160:163], v[208:211], 0
    s_add_u32 m0, s34, 16384
    v_cvt_pk_bf16_f32 v144, v144, v145
    v_exp_f32_e32 v148, v148
    v_mfma_f32_16x16x32_bf16 v[168:171], a[164:167], v[196:199], v[168:171]
    ds_read_b128 a[188:191], v227 offset:12288
    v_exp_f32_e32 v149, v149
    v_mfma_f32_16x16x32_bf16 v[184:187], a[164:167], v[212:215], v[184:187]
    buffer_load_dwordx4 v240, s[12:15], s30 offen offset:0 nt lds
    v_cvt_pk_bf16_f32 v145, v146, v147
    v_mfma_f32_16x16x32_bf16 v[168:171], a[168:171], v[200:203], v[168:171]
    v_add_u32_e32 v228, s33, v228
    ds_read_b64_tr_b16 a[160:161], v228 offset:32768
    ds_read_b64_tr_b16 a[162:163], v228 offset:36864
    v_exp_f32_e32 v150, v150
    v_mfma_f32_16x16x32_bf16 v[184:187], a[168:171], v[216:219], v[184:187]
    v_exp_f32_e32 v151, v151
    v_mfma_f32_16x16x32_bf16 v[168:171], a[172:175], v[204:207], v[168:171]
    v_add_u32_e32 v229, s33, v229
    ds_read_b64_tr_b16 a[164:165], v229 offset:32768
    ds_read_b64_tr_b16 a[166:167], v229 offset:36864
    v_cvt_pk_bf16_f32 v146, v148, v149
    v_mfma_f32_16x16x32_bf16 v[184:187], a[172:175], v[220:223], v[184:187]
    buffer_load_dwordx4 v241, s[12:15], s30 offen offset:1024 nt lds
    v_cvt_pk_bf16_f32 v147, v150, v151
    s_waitcnt lgkmcnt(4)
    v_mfma_f32_16x16x32_bf16 v[172:175], a[176:179], v[192:195], 0
    v_add_u32_e32 v230, s33, v230
    ds_read_b64_tr_b16 a[168:169], v230 offset:32768
    ds_read_b64_tr_b16 a[170:171], v230 offset:36864
    v_exp_f32_e32 v136, v136
    v_mfma_f32_16x16x32_bf16 v[188:191], a[176:179], v[208:211], 0
    buffer_load_dwordx4 v240, s[12:15], s30 offen offset:2048 nt lds
    v_mfma_f32_16x16x32_bf16 v[172:175], a[180:183], v[196:199], v[172:175]
    v_add_u32_e32 v231, s33, v231
    ds_read_b64_tr_b16 a[172:173], v231 offset:32768
    ds_read_b64_tr_b16 a[174:175], v231 offset:36864
    v_mfma_f32_16x16x32_bf16 v[188:191], a[180:183], v[212:215], v[188:191]
    v_exp_f32_e32 v137, v137
    v_mfma_f32_16x16x32_bf16 v[250:253], v[242:245], v[144:147], 0
    v_exp_f32_e32 v138, v138
    v_exp_f32_e32 v139, v139
    v_mfma_f32_16x16x32_bf16 v[172:175], a[184:187], v[200:203], v[172:175]
    v_add_u32_e32 v232, s33, v232
    ds_read_b64_tr_b16 a[176:177], v232 offset:32768
    ds_read_b64_tr_b16 a[178:179], v232 offset:36864
    v_cvt_pk_bf16_f32 v136, v136, v137
    v_mfma_f32_16x16x32_bf16 v[188:191], a[184:187], v[216:219], v[188:191]
    buffer_load_dwordx4 v241, s[12:15], s30 offen offset:3072 nt lds
    v_mfma_f32_16x16x32_bf16 v[172:175], a[188:191], v[204:207], v[172:175]
    v_add_u32_e32 v233, s33, v233
    ds_read_b64_tr_b16 a[180:181], v233 offset:32768
    ds_read_b64_tr_b16 a[182:183], v233 offset:36864
    v_exp_f32_e32 v140, v140
    v_mfma_f32_16x16x32_bf16 v[188:191], a[188:191], v[220:223], v[188:191]
    s_add_u32 s30, s30, 16384
    v_exp_f32_e32 v141, v141
    v_cvt_pk_bf16_f32 v137, v138, v139
    v_exp_f32_e32 v142, v142
    s_waitcnt lgkmcnt(4)
    v_mfma_f32_16x16x32_bf16 v[0:3], a[160:163], a[0:3], 0
    v_add_u32_e32 v234, s33, v234
    ds_read_b64_tr_b16 a[184:185], v234 offset:32768
    ds_read_b64_tr_b16 a[186:187], v234 offset:36864
    v_exp_f32_e32 v143, v143
    v_mfma_f32_16x16x32_bf16 v[32:35], a[160:163], a[4:7], 0
    v_cvt_pk_bf16_f32 v138, v140, v141
    v_cvt_pk_bf16_f32 v139, v142, v143
    v_mfma_f32_16x16x32_bf16 v[4:7], a[164:167], a[0:3], 0
    v_add_u32_e32 v235, s33, v235
    ds_read_b64_tr_b16 a[188:189], v235 offset:32768
    ds_read_b64_tr_b16 a[190:191], v235 offset:36864
    v_exp_f32_e32 v152, v152
    v_mfma_f32_16x16x32_bf16 v[36:39], a[164:167], a[4:7], 0
    v_exp_f32_e32 v153, v153
    v_mfma_f32_16x16x32_bf16 v[8:11], a[168:171], a[0:3], 0
    ds_read_b64_tr_b16 a[160:161], v228 offset:40960
    ds_read_b64_tr_b16 a[162:163], v228 offset:45056
    v_mfma_f32_16x16x32_bf16 v[246:249], v[242:245], v[136:139], v[246:249]
    v_mfma_f32_16x16x32_bf16 v[40:43], a[168:171], a[4:7], 0
    v_exp_f32_e32 v154, v154
    v_mfma_f32_16x16x32_bf16 v[12:15], a[172:175], a[0:3], 0
    ds_read_b64_tr_b16 a[164:165], v229 offset:40960
    ds_read_b64_tr_b16 a[166:167], v229 offset:45056
    v_exp_f32_e32 v155, v155
    v_mfma_f32_16x16x32_bf16 v[44:47], a[172:175], a[4:7], 0
    v_cvt_pk_bf16_f32 v152, v152, v153
    v_exp_f32_e32 v156, v156
    s_waitcnt lgkmcnt(4)
    v_mfma_f32_16x16x32_bf16 v[16:19], a[176:179], a[0:3], 0
    ds_read_b64_tr_b16 a[168:169], v230 offset:40960
    ds_read_b64_tr_b16 a[170:171], v230 offset:45056
    v_mfma_f32_16x16x32_bf16 v[48:51], a[176:179], a[4:7], 0
    v_exp_f32_e32 v157, v157
    v_mfma_f32_16x16x32_bf16 v[20:23], a[180:183], a[0:3], 0
    ds_read_b64_tr_b16 a[172:173], v231 offset:40960
    ds_read_b64_tr_b16 a[174:175], v231 offset:45056
    v_cvt_pk_bf16_f32 v153, v154, v155
    v_exp_f32_e32 v158, v158
    v_mfma_f32_16x16x32_bf16 v[52:55], a[180:183], a[4:7], 0
    v_exp_f32_e32 v159, v159
    v_mfma_f32_16x16x32_bf16 v[24:27], a[184:187], a[0:3], 0
    ds_read_b64_tr_b16 a[176:177], v232 offset:40960
    ds_read_b64_tr_b16 a[178:179], v232 offset:45056
    v_mfma_f32_16x16x32_bf16 v[56:59], a[184:187], a[4:7], 0
    v_cvt_pk_bf16_f32 v154, v156, v157
    v_cvt_pk_bf16_f32 v155, v158, v159
    v_mfma_f32_16x16x32_bf16 v[28:31], a[188:191], a[0:3], 0
    ds_read_b64_tr_b16 a[180:181], v233 offset:40960
    ds_read_b64_tr_b16 a[182:183], v233 offset:45056
    v_mfma_f32_16x16x32_bf16 v[60:63], a[188:191], a[4:7], 0
    v_exp_f32_e32 v160, v160
    s_waitcnt lgkmcnt(4)
    v_mfma_f32_16x16x32_bf16 v[0:3], a[160:163], a[8:11], v[0:3]
    ds_read_b64_tr_b16 a[184:185], v234 offset:40960
    ds_read_b64_tr_b16 a[186:187], v234 offset:45056
    v_mfma_f32_16x16x32_bf16 v[32:35], a[160:163], a[12:15], v[32:35]
    v_exp_f32_e32 v161, v161
    v_mfma_f32_16x16x32_bf16 v[4:7], a[164:167], a[8:11], v[4:7]
    ds_read_b64_tr_b16 a[188:189], v235 offset:40960
    ds_read_b64_tr_b16 a[190:191], v235 offset:45056
    v_mfma_f32_16x16x32_bf16 v[36:39], a[164:167], a[12:15], v[36:39]
    v_mfma_f32_16x16x32_bf16 v[250:253], v[242:245], v[152:155], v[250:253]
    v_mfma_f32_16x16x32_bf16 v[8:11], a[168:171], a[8:11], v[8:11]
    ds_read_b64_tr_b16 a[160:161], v228 offset:16384
    ds_read_b64_tr_b16 a[162:163], v228 offset:20480
    v_mfma_f32_16x16x32_bf16 v[40:43], a[168:171], a[12:15], v[40:43]
    v_exp_f32_e32 v162, v162
    v_mfma_f32_16x16x32_bf16 v[12:15], a[172:175], a[8:11], v[12:15]
    ds_read_b64_tr_b16 a[164:165], v229 offset:16384
    ds_read_b64_tr_b16 a[166:167], v229 offset:20480
    v_mfma_f32_16x16x32_bf16 v[44:47], a[172:175], a[12:15], v[44:47]
    v_exp_f32_e32 v163, v163
    s_waitcnt lgkmcnt(4)
    v_mfma_f32_16x16x32_bf16 v[16:19], a[176:179], a[8:11], v[16:19]
    ds_read_b64_tr_b16 a[168:169], v230 offset:16384
    ds_read_b64_tr_b16 a[170:171], v230 offset:20480
    v_mfma_f32_16x16x32_bf16 v[48:51], a[176:179], a[12:15], v[48:51]
    v_cvt_pk_bf16_f32 v160, v160, v161
    v_exp_f32_e32 v164, v164
    v_mfma_f32_16x16x32_bf16 v[20:23], a[180:183], a[8:11], v[20:23]
    ds_read_b64_tr_b16 a[172:173], v231 offset:16384
    ds_read_b64_tr_b16 a[174:175], v231 offset:20480
    v_mfma_f32_16x16x32_bf16 v[52:55], a[180:183], a[12:15], v[52:55]
    v_exp_f32_e32 v165, v165
    v_mfma_f32_16x16x32_bf16 v[24:27], a[184:187], a[8:11], v[24:27]
    ds_read_b64_tr_b16 a[176:177], v232 offset:16384
    ds_read_b64_tr_b16 a[178:179], v232 offset:20480
    v_mfma_f32_16x16x32_bf16 v[56:59], a[184:187], a[12:15], v[56:59]
    v_cvt_pk_bf16_f32 v161, v162, v163
    v_exp_f32_e32 v166, v166
    v_mfma_f32_16x16x32_bf16 v[28:31], a[188:191], a[8:11], v[28:31]
    ds_read_b64_tr_b16 a[180:181], v233 offset:16384
    ds_read_b64_tr_b16 a[182:183], v233 offset:20480
    v_mfma_f32_16x16x32_bf16 v[60:63], a[188:191], a[12:15], v[60:63]
    v_exp_f32_e32 v167, v167
    s_waitcnt lgkmcnt(4)
    v_mfma_f32_16x16x32_bf16 v[64:67], a[160:163], v[128:131], 0
    ds_read_b64_tr_b16 a[184:185], v234 offset:16384
    ds_read_b64_tr_b16 a[186:187], v234 offset:20480
    v_mfma_f32_16x16x32_bf16 v[96:99], a[160:163], v[144:147], 0
    v_cvt_pk_bf16_f32 v162, v164, v165
    v_cvt_pk_bf16_f32 v163, v166, v167
    v_mfma_f32_16x16x32_bf16 v[68:71], a[164:167], v[128:131], 0
    ds_read_b64_tr_b16 a[188:189], v235 offset:16384
    ds_read_b64_tr_b16 a[190:191], v235 offset:20480
    v_mfma_f32_16x16x32_bf16 v[100:103], a[164:167], v[144:147], 0
    v_exp_f32_e32 v176, v176
    v_mfma_f32_16x16x32_bf16 v[72:75], a[168:171], v[128:131], 0
    ds_read_b64_tr_b16 a[160:161], v228 offset:24576
    ds_read_b64_tr_b16 a[162:163], v228 offset:28672
    v_mfma_f32_16x16x32_bf16 v[104:107], a[168:171], v[144:147], 0
    v_exp_f32_e32 v177, v177
    v_mfma_f32_16x16x32_bf16 v[76:79], a[172:175], v[128:131], 0
    ds_read_b64_tr_b16 a[164:165], v229 offset:24576
    ds_read_b64_tr_b16 a[166:167], v229 offset:28672
    v_mfma_f32_16x16x32_bf16 v[108:111], a[172:175], v[144:147], 0
    v_mfma_f32_16x16x32_bf16 v[246:249], v[242:245], v[160:163], v[246:249]
    s_waitcnt lgkmcnt(4)
    v_mfma_f32_16x16x32_bf16 v[80:83], a[176:179], v[128:131], 0
    ds_read_b64_tr_b16 a[168:169], v230 offset:24576
    ds_read_b64_tr_b16 a[170:171], v230 offset:28672
    v_mfma_f32_16x16x32_bf16 v[112:115], a[176:179], v[144:147], 0
    v_exp_f32_e32 v178, v178
    v_mfma_f32_16x16x32_bf16 v[84:87], a[180:183], v[128:131], 0
    ds_read_b64_tr_b16 a[172:173], v231 offset:24576
    ds_read_b64_tr_b16 a[174:175], v231 offset:28672
    v_mfma_f32_16x16x32_bf16 v[116:119], a[180:183], v[144:147], 0
    v_exp_f32_e32 v179, v179
    v_mfma_f32_16x16x32_bf16 v[88:91], a[184:187], v[128:131], 0
    ds_read_b64_tr_b16 a[176:177], v232 offset:24576
    ds_read_b64_tr_b16 a[178:179], v232 offset:28672
    v_mfma_f32_16x16x32_bf16 v[120:123], a[184:187], v[144:147], 0
    v_cvt_pk_bf16_f32 v176, v176, v177
    v_mfma_f32_16x16x32_bf16 v[92:95], a[188:191], v[128:131], 0
    ds_read_b64_tr_b16 a[180:181], v233 offset:24576
    ds_read_b64_tr_b16 a[182:183], v233 offset:28672
    v_mfma_f32_16x16x32_bf16 v[124:127], a[188:191], v[144:147], 0
    v_exp_f32_e32 v180, v180
    s_waitcnt lgkmcnt(4)
    v_mfma_f32_16x16x32_bf16 v[64:67], a[160:163], v[136:139], v[64:67]
    ds_read_b64_tr_b16 a[184:185], v234 offset:24576
    ds_read_b64_tr_b16 a[186:187], v234 offset:28672
    v_mfma_f32_16x16x32_bf16 v[96:99], a[160:163], v[152:155], v[96:99]
    v_exp_f32_e32 v181, v181
    v_mfma_f32_16x16x32_bf16 v[68:71], a[164:167], v[136:139], v[68:71]
    ds_read_b64_tr_b16 a[188:189], v235 offset:24576
    ds_read_b64_tr_b16 a[190:191], v235 offset:28672
    v_mfma_f32_16x16x32_bf16 v[100:103], a[164:167], v[152:155], v[100:103]
    v_cvt_pk_bf16_f32 v177, v178, v179
    v_mfma_f32_16x16x32_bf16 v[72:75], a[168:171], v[136:139], v[72:75]
    v_exp_f32_e32 v182, v182
    v_mfma_f32_16x16x32_bf16 v[104:107], a[168:171], v[152:155], v[104:107]
    v_exp_f32_e32 v183, v183
    v_mfma_f32_16x16x32_bf16 v[76:79], a[172:175], v[136:139], v[76:79]
    v_mfma_f32_16x16x32_bf16 v[108:111], a[172:175], v[152:155], v[108:111]
    v_cvt_pk_bf16_f32 v178, v180, v181
    s_waitcnt lgkmcnt(0)
    v_mfma_f32_16x16x32_bf16 v[80:83], a[176:179], v[136:139], v[80:83]
    v_cvt_pk_bf16_f32 v179, v182, v183
    v_mfma_f32_16x16x32_bf16 v[112:115], a[176:179], v[152:155], v[112:115]
    s_waitcnt vmcnt(8)
    s_barrier
    s_mov_b32 s50, s32
    s_add_u32 s34, s32, s38
    s_add_u32 s32, s32, s42
    s_cmp_eq_u32 s32, 159744
    s_cselect_b32 s33, s43, s42
    s_cselect_b32 s32, 0, s32
    s_sub_u32 s39, 159744, s32
    v_add_u32_e32 v224, s33, v224
    ds_read_b128 a[160:163], v224 offset:0
    v_add_u32_e32 v225, s33, v225
    ds_read_b128 a[164:167], v225 offset:0
    v_add_u32_e32 v226, s33, v226
    ds_read_b128 a[168:171], v226 offset:0
    v_mfma_f32_16x16x32_bf16 v[84:87], a[180:183], v[136:139], v[84:87]
    v_add_u32_e32 v227, s33, v227
    ds_read_b128 a[172:175], v227 offset:0
    v_mfma_f32_16x16x32_bf16 v[116:119], a[180:183], v[152:155], v[116:119]
    v_exp_f32_e32 v168, v168
    v_mfma_f32_16x16x32_bf16 v[88:91], a[184:187], v[136:139], v[88:91]
    ds_read_b128 a[176:179], v224 offset:4096
    v_exp_f32_e32 v169, v169
    v_mfma_f32_16x16x32_bf16 v[120:123], a[184:187], v[152:155], v[120:123]
    v_mfma_f32_16x16x32_bf16 v[92:95], a[188:191], v[136:139], v[92:95]
    ds_read_b128 a[180:183], v225 offset:4096
    v_mfma_f32_16x16x32_bf16 v[250:253], v[242:245], v[176:179], v[250:253]
    v_mfma_f32_16x16x32_bf16 v[124:127], a[188:191], v[152:155], v[124:127]
    s_waitcnt lgkmcnt(2)
    v_mfma_f32_16x16x32_bf16 v[128:131], a[160:163], v[192:195], 0
    ds_read_b128 a[184:187], v226 offset:4096
    s_add_u32 m0, s34, 0
    v_mfma_f32_16x16x32_bf16 v[144:147], a[160:163], v[208:211], 0
    v_exp_f32_e32 v170, v170
    v_mfma_f32_16x16x32_bf16 v[128:131], a[164:167], v[196:199], v[128:131]
    ds_read_b128 a[188:191], v227 offset:4096
    v_exp_f32_e32 v171, v171
    v_mfma_f32_16x16x32_bf16 v[144:147], a[164:167], v[212:215], v[144:147]
    buffer_load_dwordx4 v236, s[8:11], s29 offen offset:0 nt lds
    v_mfma_f32_16x16x32_bf16 v[128:131], a[168:171], v[200:203], v[128:131]
    ds_read_b128 a[160:163], v224 offset:8192
    v_cvt_pk_bf16_f32 v168, v168, v169
    v_mfma_f32_16x16x32_bf16 v[144:147], a[168:171], v[216:219], v[144:147]
    buffer_load_dwordx4 v237, s[8:11], s29 offen offset:1024 nt lds
    v_mfma_f32_16x16x32_bf16 v[128:131], a[172:175], v[204:207], v[128:131]
    ds_read_b128 a[164:167], v225 offset:8192
    v_exp_f32_e32 v172, v172
    v_mfma_f32_16x16x32_bf16 v[144:147], a[172:175], v[220:223], v[144:147]
    v_exp_f32_e32 v173, v173
    s_waitcnt lgkmcnt(2)
    v_mfma_f32_16x16x32_bf16 v[132:135], a[176:179], v[192:195], 0
    ds_read_b128 a[168:171], v226 offset:8192
    v_mfma_f32_16x16x32_bf16 v[148:151], a[176:179], v[208:211], 0
    buffer_load_dwordx4 v238, s[8:11], s29 offen offset:2048 nt lds
    v_mfma_f32_16x16x32_bf16 v[132:135], a[180:183], v[196:199], v[132:135]
    ds_read_b128 a[172:175], v227 offset:8192
    v_cvt_pk_bf16_f32 v169, v170, v171
    v_mfma_f32_16x16x32_bf16 v[148:151], a[180:183], v[212:215], v[148:151]
    buffer_load_dwordx4 v239, s[8:11], s29 offen offset:3072 nt lds
    v_mfma_f32_16x16x32_bf16 v[132:135], a[184:187], v[200:203], v[132:135]
    ds_read_b128 a[176:179], v224 offset:12288
    v_exp_f32_e32 v174, v174
    v_mfma_f32_16x16x32_bf16 v[148:151], a[184:187], v[216:219], v[148:151]
    v_exp_f32_e32 v175, v175
    v_mfma_f32_16x16x32_bf16 v[132:135], a[188:191], v[204:207], v[132:135]
    ds_read_b128 a[180:183], v225 offset:12288
    v_cvt_pk_bf16_f32 v170, v172, v173
    v_mfma_f32_16x16x32_bf16 v[148:151], a[188:191], v[220:223], v[148:151]
    s_add_u32 s29, s29, 16384
    s_waitcnt lgkmcnt(2)
    v_mfma_f32_16x16x32_bf16 v[136:139], a[160:163], v[192:195], 0
    v_cvt_pk_bf16_f32 v171, v174, v175
    ds_read_b128 a[184:187], v226 offset:12288
    v_mfma_f32_16x16x32_bf16 v[152:155], a[160:163], v[208:211], 0
    s_add_u32 m0, s34, 16384
    v_mfma_f32_16x16x32_bf16 v[136:139], a[164:167], v[196:199], v[136:139]
    v_exp_f32_e32 v184, v184
    ds_read_b128 a[188:191], v227 offset:12288
    v_mfma_f32_16x16x32_bf16 v[152:155], a[164:167], v[212:215], v[152:155]
    buffer_load_dwordx4 v240, s[12:15], s30 offen offset:0 nt lds
    v_mfma_f32_16x16x32_bf16 v[136:139], a[168:171], v[200:203], v[136:139]
    v_add_u32_e32 v228, s33, v228
    v_add_u32_e32 v254, s39, v228
    ds_read_b64_tr_b16 a[160:161], v254 offset:0
    ds_read_b64_tr_b16 a[162:163], v228 offset:32768
    v_mfma_f32_16x16x32_bf16 v[152:155], a[168:171], v[216:219], v[152:155]
    v_exp_f32_e32 v185, v185
    v_mfma_f32_16x16x32_bf16 v[136:139], a[172:175], v[204:207], v[136:139]
    v_add_u32_e32 v229, s33, v229
    v_add_u32_e32 v254, s39, v229
    ds_read_b64_tr_b16 a[164:165], v254 offset:0
    ds_read_b64_tr_b16 a[166:167], v229 offset:32768
    v_mfma_f32_16x16x32_bf16 v[152:155], a[172:175], v[220:223], v[152:155]
    buffer_load_dwordx4 v241, s[12:15], s30 offen offset:1024 nt lds
    s_waitcnt lgkmcnt(4)
    v_mfma_f32_16x16x32_bf16 v[140:143], a[176:179], v[192:195], 0
    v_add_u32_e32 v230, s33, v230
    v_add_u32_e32 v254, s39, v230
    ds_read_b64_tr_b16 a[168:169], v254 offset:0
    ds_read_b64_tr_b16 a[170:171], v230 offset:32768
    v_mfma_f32_16x16x32_bf16 v[156:159], a[176:179], v[208:211], 0
    buffer_load_dwordx4 v240, s[12:15], s30 offen offset:2048 nt lds
    v_mfma_f32_16x16x32_bf16 v[140:143], a[180:183], v[196:199], v[140:143]
    v_add_u32_e32 v231, s33, v231
    v_add_u32_e32 v254, s39, v231
    v_mfma_f32_16x16x32_bf16 v[246:249], v[242:245], v[168:171], v[246:249]
    ds_read_b64_tr_b16 a[172:173], v254 offset:0
    ds_read_b64_tr_b16 a[174:175], v231 offset:32768
    v_mfma_f32_16x16x32_bf16 v[156:159], a[180:183], v[212:215], v[156:159]
    v_exp_f32_e32 v186, v186
    v_mfma_f32_16x16x32_bf16 v[140:143], a[184:187], v[200:203], v[140:143]
    v_add_u32_e32 v232, s33, v232
    v_add_u32_e32 v254, s39, v232
    ds_read_b64_tr_b16 a[176:177], v254 offset:0
    ds_read_b64_tr_b16 a[178:179], v232 offset:32768
    v_mfma_f32_16x16x32_bf16 v[156:159], a[184:187], v[216:219], v[156:159]
    buffer_load_dwordx4 v241, s[12:15], s30 offen offset:3072 nt lds
    v_mfma_f32_16x16x32_bf16 v[140:143], a[188:191], v[204:207], v[140:143]
    v_add_u32_e32 v233, s33, v233
    v_add_u32_e32 v254, s39, v233
    ds_read_b64_tr_b16 a[180:181], v254 offset:0
    ds_read_b64_tr_b16 a[182:183], v233 offset:32768
    v_exp_f32_e32 v187, v187
    v_mfma_f32_16x16x32_bf16 v[156:159], a[188:191], v[220:223], v[156:159]
    s_add_u32 s30, s30, 16384
    v_cvt_pk_bf16_f32 v184, v184, v185
    s_waitcnt lgkmcnt(4)
    v_mfma_f32_16x16x32_bf16 v[0:3], a[160:163], a[16:19], v[0:3]
    v_add_u32_e32 v234, s33, v234
    v_add_u32_e32 v254, s39, v234
    ds_read_b64_tr_b16 a[184:185], v254 offset:0
    ds_read_b64_tr_b16 a[186:187], v234 offset:32768
    v_mfma_f32_16x16x32_bf16 v[32:35], a[160:163], a[20:23], v[32:35]
    v_exp_f32_e32 v188, v188
    v_mfma_f32_16x16x32_bf16 v[4:7], a[164:167], a[16:19], v[4:7]
    v_add_u32_e32 v235, s33, v235
    v_add_u32_e32 v254, s39, v235
    ds_read_b64_tr_b16 a[188:189], v254 offset:0
    ds_read_b64_tr_b16 a[190:191], v235 offset:32768
    v_exp_f32_e32 v189, v189
    v_mfma_f32_16x16x32_bf16 v[36:39], a[164:167], a[20:23], v[36:39]
    v_cvt_pk_bf16_f32 v185, v186, v187
    v_exp_f32_e32 v190, v190
    v_mfma_f32_16x16x32_bf16 v[8:11], a[168:171], a[16:19], v[8:11]
    ds_read_b64_tr_b16 a[160:161], v228 offset:36864
    ds_read_b64_tr_b16 a[162:163], v228 offset:40960
    v_mfma_f32_16x16x32_bf16 v[40:43], a[168:171], a[20:23], v[40:43]
    v_exp_f32_e32 v191, v191
    v_mfma_f32_16x16x32_bf16 v[12:15], a[172:175], a[16:19], v[12:15]
    ds_read_b64_tr_b16 a[164:165], v229 offset:36864
    ds_read_b64_tr_b16 a[166:167], v229 offset:40960
    v_mfma_f32_16x16x32_bf16 v[44:47], a[172:175], a[20:23], v[44:47]
    v_cvt_pk_bf16_f32 v186, v188, v189
    v_cvt_pk_bf16_f32 v187, v190, v191
    s_waitcnt lgkmcnt(4)
    v_mfma_f32_16x16x32_bf16 v[16:19], a[176:179], a[16:19], v[16:19]
    ds_read_b64_tr_b16 a[168:169], v230 offset:36864
    ds_read_b64_tr_b16 a[170:171], v230 offset:40960
    v_mfma_f32_16x16x32_bf16 v[48:51], a[176:179], a[20:23], v[48:51]
    v_exp_f32_e32 v128, v128
    v_mfma_f32_16x16x32_bf16 v[20:23], a[180:183], a[16:19], v[20:23]
    ds_read_b64_tr_b16 a[172:173], v231 offset:36864
    ds_read_b64_tr_b16 a[174:175], v231 offset:40960
    v_mfma_f32_16x16x32_bf16 v[52:55], a[180:183], a[20:23], v[52:55]
    v_exp_f32_e32 v129, v129
    v_mfma_f32_16x16x32_bf16 v[24:27], a[184:187], a[16:19], v[24:27]
    ds_read_b64_tr_b16 a[176:177], v232 offset:36864
    ds_read_b64_tr_b16 a[178:179], v232 offset:40960
    v_mfma_f32_16x16x32_bf16 v[56:59], a[184:187], a[20:23], v[56:59]
    v_mfma_f32_16x16x32_bf16 v[250:253], v[242:245], v[184:187], v[250:253]
    v_mfma_f32_16x16x32_bf16 v[28:31], a[188:191], a[16:19], v[28:31]
    ds_read_b64_tr_b16 a[180:181], v233 offset:36864
    ds_read_b64_tr_b16 a[182:183], v233 offset:40960
    v_mfma_f32_16x16x32_bf16 v[60:63], a[188:191], a[20:23], v[60:63]
    v_exp_f32_e32 v130, v130
    s_waitcnt lgkmcnt(4)
    v_mfma_f32_16x16x32_bf16 v[0:3], a[160:163], a[24:27], v[0:3]
    ds_read_b64_tr_b16 a[184:185], v234 offset:36864
    ds_read_b64_tr_b16 a[186:187], v234 offset:40960
    v_mfma_f32_16x16x32_bf16 v[32:35], a[160:163], a[28:31], v[32:35]
    v_mfma_f32_16x16x32_bf16 v[4:7], a[164:167], a[24:27], v[4:7]
    ds_read_b64_tr_b16 a[188:189], v235 offset:36864
    ds_read_b64_tr_b16 a[190:191], v235 offset:40960
    v_mfma_f32_16x16x32_bf16 v[36:39], a[164:167], a[28:31], v[36:39]
    v_exp_f32_e32 v131, v131
    v_mfma_f32_16x16x32_bf16 v[8:11], a[168:171], a[24:27], v[8:11]
    ds_read_b64_tr_b16 a[160:161], v228 offset:45056
    ds_read_b64_tr_b16 a[162:163], v228 offset:49152
    v_mfma_f32_16x16x32_bf16 v[40:43], a[168:171], a[28:31], v[40:43]
    v_cvt_pk_bf16_f32 v128, v128, v129
    v_mfma_f32_16x16x32_bf16 v[12:15], a[172:175], a[24:27], v[12:15]
    ds_read_b64_tr_b16 a[164:165], v229 offset:45056
    ds_read_b64_tr_b16 a[166:167], v229 offset:49152
    v_mfma_f32_16x16x32_bf16 v[44:47], a[172:175], a[28:31], v[44:47]
    v_exp_f32_e32 v132, v132
    s_waitcnt lgkmcnt(4)
    v_mfma_f32_16x16x32_bf16 v[16:19], a[176:179], a[24:27], v[16:19]
    ds_read_b64_tr_b16 a[168:169], v230 offset:45056
    ds_read_b64_tr_b16 a[170:171], v230 offset:49152
    v_mfma_f32_16x16x32_bf16 v[48:51], a[176:179], a[28:31], v[48:51]
    v_exp_f32_e32 v133, v133
    v_mfma_f32_16x16x32_bf16 v[20:23], a[180:183], a[24:27], v[20:23]
    ds_read_b64_tr_b16 a[172:173], v231 offset:45056
    ds_read_b64_tr_b16 a[174:175], v231 offset:49152
    v_mfma_f32_16x16x32_bf16 v[52:55], a[180:183], a[28:31], v[52:55]
    v_cvt_pk_bf16_f32 v129, v130, v131
    v_mfma_f32_16x16x32_bf16 v[24:27], a[184:187], a[24:27], v[24:27]
    ds_read_b64_tr_b16 a[176:177], v232 offset:45056
    ds_read_b64_tr_b16 a[178:179], v232 offset:49152
    v_mfma_f32_16x16x32_bf16 v[56:59], a[184:187], a[28:31], v[56:59]
    v_exp_f32_e32 v134, v134
    v_mfma_f32_16x16x32_bf16 v[28:31], a[188:191], a[24:27], v[28:31]
    ds_read_b64_tr_b16 a[180:181], v233 offset:45056
    ds_read_b64_tr_b16 a[182:183], v233 offset:49152
    v_mfma_f32_16x16x32_bf16 v[60:63], a[188:191], a[28:31], v[60:63]
    v_exp_f32_e32 v135, v135
    s_waitcnt lgkmcnt(4)
    v_mfma_f32_16x16x32_bf16 v[0:3], a[160:163], a[32:35], v[0:3]
    ds_read_b64_tr_b16 a[184:185], v234 offset:45056
    ds_read_b64_tr_b16 a[186:187], v234 offset:49152
    v_mfma_f32_16x16x32_bf16 v[32:35], a[160:163], a[36:39], v[32:35]
    v_cvt_pk_bf16_f32 v130, v132, v133
    v_mfma_f32_16x16x32_bf16 v[4:7], a[164:167], a[32:35], v[4:7]
    ds_read_b64_tr_b16 a[188:189], v235 offset:45056
    ds_read_b64_tr_b16 a[190:191], v235 offset:49152
    v_mfma_f32_16x16x32_bf16 v[36:39], a[164:167], a[36:39], v[36:39]
    v_cvt_pk_bf16_f32 v131, v134, v135
    v_mfma_f32_16x16x32_bf16 v[8:11], a[168:171], a[32:35], v[8:11]
    ds_read_b64_tr_b16 a[160:161], v228 offset:16384
    ds_read_b64_tr_b16 a[162:163], v228 offset:20480
    v_mfma_f32_16x16x32_bf16 v[40:43], a[168:171], a[36:39], v[40:43]
    v_exp_f32_e32 v144, v144
    v_mfma_f32_16x16x32_bf16 v[12:15], a[172:175], a[32:35], v[12:15]
    ds_read_b64_tr_b16 a[164:165], v229 offset:16384
    ds_read_b64_tr_b16 a[166:167], v229 offset:20480
    v_mfma_f32_16x16x32_bf16 v[44:47], a[172:175], a[36:39], v[44:47]
    v_exp_f32_e32 v145, v145
    s_waitcnt lgkmcnt(4)
    v_mfma_f32_16x16x32_bf16 v[16:19], a[176:179], a[32:35], v[16:19]
    ds_read_b64_tr_b16 a[168:169], v230 offset:16384
    ds_read_b64_tr_b16 a[170:171], v230 offset:20480
    v_mfma_f32_16x16x32_bf16 v[48:51], a[176:179], a[36:39], v[48:51]
    v_mfma_f32_16x16x32_bf16 v[246:249], v[242:245], v[128:131], v[246:249]
    v_mfma_f32_16x16x32_bf16 v[20:23], a[180:183], a[32:35], v[20:23]
    ds_read_b64_tr_b16 a[172:173], v231 offset:16384
    ds_read_b64_tr_b16 a[174:175], v231 offset:20480
    v_mfma_f32_16x16x32_bf16 v[52:55], a[180:183], a[36:39], v[52:55]
    v_exp_f32_e32 v146, v146
    v_mfma_f32_16x16x32_bf16 v[24:27], a[184:187], a[32:35], v[24:27]
    ds_read_b64_tr_b16 a[176:177], v232 offset:16384
    ds_read_b64_tr_b16 a[178:179], v232 offset:20480
    v_mfma_f32_16x16x32_bf16 v[56:59], a[184:187], a[36:39], v[56:59]
    v_mfma_f32_16x16x32_bf16 v[28:31], a[188:191], a[32:35], v[28:31]
    ds_read_b64_tr_b16 a[180:181], v233 offset:16384
    ds_read_b64_tr_b16 a[182:183], v233 offset:20480
    v_mfma_f32_16x16x32_bf16 v[60:63], a[188:191], a[36:39], v[60:63]
    v_exp_f32_e32 v147, v147
    s_waitcnt lgkmcnt(4)
    v_mfma_f32_16x16x32_bf16 v[64:67], a[160:163], v[160:163], v[64:67]
    ds_read_b64_tr_b16 a[184:185], v234 offset:16384
    ds_read_b64_tr_b16 a[186:187], v234 offset:20480
    v_mfma_f32_16x16x32_bf16 v[96:99], a[160:163], v[176:179], v[96:99]
    v_cvt_pk_bf16_f32 v144, v144, v145
    v_mfma_f32_16x16x32_bf16 v[68:71], a[164:167], v[160:163], v[68:71]
    ds_read_b64_tr_b16 a[188:189], v235 offset:16384
    ds_read_b64_tr_b16 a[190:191], v235 offset:20480
    v_mfma_f32_16x16x32_bf16 v[100:103], a[164:167], v[176:179], v[100:103]
    v_exp_f32_e32 v148, v148
    v_mfma_f32_16x16x32_bf16 v[72:75], a[168:171], v[160:163], v[72:75]
    ds_read_b64_tr_b16 a[160:161], v228 offset:24576
    ds_read_b64_tr_b16 a[162:163], v228 offset:28672
    v_mfma_f32_16x16x32_bf16 v[104:107], a[168:171], v[176:179], v[104:107]
    v_exp_f32_e32 v149, v149
    v_mfma_f32_16x16x32_bf16 v[76:79], a[172:175], v[160:163], v[76:79]
    ds_read_b64_tr_b16 a[164:165], v229 offset:24576
    ds_read_b64_tr_b16 a[166:167], v229 offset:28672
    v_mfma_f32_16x16x32_bf16 v[108:111], a[172:175], v[176:179], v[108:111]
    v_cvt_pk_bf16_f32 v145, v146, v147
    s_waitcnt lgkmcnt(4)
    v_mfma_f32_16x16x32_bf16 v[80:83], a[176:179], v[160:163], v[80:83]
    ds_read_b64_tr_b16 a[168:169], v230 offset:24576
    ds_read_b64_tr_b16 a[170:171], v230 offset:28672
    v_mfma_f32_16x16x32_bf16 v[112:115], a[176:179], v[176:179], v[112:115]
    v_exp_f32_e32 v150, v150
    v_mfma_f32_16x16x32_bf16 v[84:87], a[180:183], v[160:163], v[84:87]
    ds_read_b64_tr_b16 a[172:173], v231 offset:24576
    ds_read_b64_tr_b16 a[174:175], v231 offset:28672
    v_mfma_f32_16x16x32_bf16 v[116:119], a[180:183], v[176:179], v[116:119]
    v_exp_f32_e32 v151, v151
    v_mfma_f32_16x16x32_bf16 v[88:91], a[184:187], v[160:163], v[88:91]
    ds_read_b64_tr_b16 a[176:177], v232 offset:24576
    ds_read_b64_tr_b16 a[178:179], v232 offset:28672
    v_mfma_f32_16x16x32_bf16 v[120:123], a[184:187], v[176:179], v[120:123]
    v_cvt_pk_bf16_f32 v146, v148, v149
    v_mfma_f32_16x16x32_bf16 v[92:95], a[188:191], v[160:163], v[92:95]
    ds_read_b64_tr_b16 a[180:181], v233 offset:24576
    ds_read_b64_tr_b16 a[182:183], v233 offset:28672
    v_mfma_f32_16x16x32_bf16 v[124:127], a[188:191], v[176:179], v[124:127]
    v_cvt_pk_bf16_f32 v147, v150, v151
    s_waitcnt lgkmcnt(4)
    v_mfma_f32_16x16x32_bf16 v[64:67], a[160:163], v[168:171], v[64:67]
    ds_read_b64_tr_b16 a[184:185], v234 offset:24576
    ds_read_b64_tr_b16 a[186:187], v234 offset:28672
    v_mfma_f32_16x16x32_bf16 v[96:99], a[160:163], v[184:187], v[96:99]
    v_exp_f32_e32 v136, v136
    v_mfma_f32_16x16x32_bf16 v[68:71], a[164:167], v[168:171], v[68:71]
    ds_read_b64_tr_b16 a[188:189], v235 offset:24576
    ds_read_b64_tr_b16 a[190:191], v235 offset:28672
    v_mfma_f32_16x16x32_bf16 v[100:103], a[164:167], v[184:187], v[100:103]
    v_exp_f32_e32 v137, v137
    v_mfma_f32_16x16x32_bf16 v[72:75], a[168:171], v[168:171], v[72:75]
    v_mfma_f32_16x16x32_bf16 v[104:107], a[168:171], v[184:187], v[104:107]
    v_mfma_f32_16x16x32_bf16 v[250:253], v[242:245], v[144:147], v[250:253]
    v_mfma_f32_16x16x32_bf16 v[76:79], a[172:175], v[168:171], v[76:79]
    v_mfma_f32_16x16x32_bf16 v[108:111], a[172:175], v[184:187], v[108:111]
    v_exp_f32_e32 v138, v138
    s_waitcnt lgkmcnt(0)
    v_mfma_f32_16x16x32_bf16 v[80:83], a[176:179], v[168:171], v[80:83]
    v_mfma_f32_16x16x32_bf16 v[112:115], a[176:179], v[184:187], v[112:115]
    s_waitcnt vmcnt(8)
    s_barrier
    s_mov_b32 s50, s32
    s_add_u32 s34, s32, s38
    s_add_u32 s32, s32, s42
    s_cmp_eq_u32 s32, 159744
    s_cselect_b32 s33, s43, s42
    s_cselect_b32 s32, 0, s32
    v_add_u32_e32 v224, s33, v224
    ds_read_b128 a[160:163], v224 offset:0
    v_add_u32_e32 v225, s33, v225
    ds_read_b128 a[164:167], v225 offset:0
    v_add_u32_e32 v226, s33, v226
    ds_read_b128 a[168:171], v226 offset:0
    v_mfma_f32_16x16x32_bf16 v[84:87], a[180:183], v[168:171], v[84:87]
    v_add_u32_e32 v227, s33, v227
    ds_read_b128 a[172:175], v227 offset:0
    v_mfma_f32_16x16x32_bf16 v[116:119], a[180:183], v[184:187], v[116:119]
    v_exp_f32_e32 v139, v139
    v_mfma_f32_16x16x32_bf16 v[88:91], a[184:187], v[168:171], v[88:91]
    ds_read_b128 a[176:179], v224 offset:4096
    v_cvt_pk_bf16_f32 v136, v136, v137
    v_mfma_f32_16x16x32_bf16 v[120:123], a[184:187], v[184:187], v[120:123]
    ds_read_b128 a[180:183], v225 offset:4096
    v_mfma_f32_16x16x32_bf16 v[92:95], a[188:191], v[168:171], v[92:95]
    v_exp_f32_e32 v140, v140
    v_mfma_f32_16x16x32_bf16 v[124:127], a[188:191], v[184:187], v[124:127]
    s_waitcnt lgkmcnt(2)
    v_mfma_f32_16x16x32_bf16 v[160:163], a[160:163], v[192:195], 0
    ds_read_b128 a[184:187], v226 offset:4096
    s_add_u32 m0, s34, 0
    v_mfma_f32_16x16x32_bf16 v[176:179], a[160:163], v[208:211], 0
    v_exp_f32_e32 v141, v141
    v_mfma_f32_16x16x32_bf16 v[160:163], a[164:167], v[196:199], v[160:163]
    ds_read_b128 a[188:191], v227 offset:4096
    v_mfma_f32_16x16x32_bf16 v[176:179], a[164:167], v[212:215], v[176:179]
    buffer_load_dwordx4 v236, s[8:11], s29 offen offset:0 nt lds
    v_mfma_f32_16x16x32_bf16 v[160:163], a[168:171], v[200:203], v[160:163]
    ds_read_b128 a[160:163], v224 offset:8192
    v_cvt_pk_bf16_f32 v137, v138, v139
    v_mfma_f32_16x16x32_bf16 v[176:179], a[168:171], v[216:219], v[176:179]
    buffer_load_dwordx4 v237, s[8:11], s29 offen offset:1024 nt lds
    v_mfma_f32_16x16x32_bf16 v[160:163], a[172:175], v[204:207], v[160:163]
    ds_read_b128 a[164:167], v225 offset:8192
    v_exp_f32_e32 v142, v142
    v_mfma_f32_16x16x32_bf16 v[176:179], a[172:175], v[220:223], v[176:179]
    v_exp_f32_e32 v143, v143
    s_waitcnt lgkmcnt(2)
    v_mfma_f32_16x16x32_bf16 v[164:167], a[176:179], v[192:195], 0
    ds_read_b128 a[168:171], v226 offset:8192
    v_mfma_f32_16x16x32_bf16 v[180:183], a[176:179], v[208:211], 0
    buffer_load_dwordx4 v238, s[8:11], s29 offen offset:2048 nt lds
    v_mfma_f32_16x16x32_bf16 v[164:167], a[180:183], v[196:199], v[164:167]
    ds_read_b128 a[172:175], v227 offset:8192
    v_cvt_pk_bf16_f32 v138, v140, v141
    v_mfma_f32_16x16x32_bf16 v[180:183], a[180:183], v[212:215], v[180:183]
    buffer_load_dwordx4 v239, s[8:11], s29 offen offset:3072 nt lds
    v_mfma_f32_16x16x32_bf16 v[164:167], a[184:187], v[200:203], v[164:167]
    ds_read_b128 a[176:179], v224 offset:12288
    v_cvt_pk_bf16_f32 v139, v142, v143
    v_mfma_f32_16x16x32_bf16 v[180:183], a[184:187], v[216:219], v[180:183]
    v_exp_f32_e32 v152, v152
    v_mfma_f32_16x16x32_bf16 v[164:167], a[188:191], v[204:207], v[164:167]
    ds_read_b128 a[180:183], v225 offset:12288
    v_exp_f32_e32 v153, v153
    v_mfma_f32_16x16x32_bf16 v[180:183], a[188:191], v[220:223], v[180:183]
    s_add_u32 s29, s29, 16384
    s_waitcnt lgkmcnt(2)
    v_mfma_f32_16x16x32_bf16 v[168:171], a[160:163], v[192:195], 0
    ds_read_b128 a[184:187], v226 offset:12288
    v_mfma_f32_16x16x32_bf16 v[184:187], a[160:163], v[208:211], 0
    s_add_u32 m0, s34, 16384
    v_mfma_f32_16x16x32_bf16 v[246:249], v[242:245], v[136:139], v[246:249]
    v_mfma_f32_16x16x32_bf16 v[168:171], a[164:167], v[196:199], v[168:171]
    ds_read_b128 a[188:191], v227 offset:12288
    v_mfma_f32_16x16x32_bf16 v[184:187], a[164:167], v[212:215], v[184:187]
    buffer_load_dwordx4 v240, s[12:15], s30 offen offset:0 nt lds
    v_mfma_f32_16x16x32_bf16 v[168:171], a[168:171], v[200:203], v[168:171]
    v_add_u32_e32 v228, s33, v228
    ds_read_b64_tr_b16 a[160:161], v228 offset:32768
    ds_read_b64_tr_b16 a[162:163], v228 offset:36864
    v_mfma_f32_16x16x32_bf16 v[184:187], a[168:171], v[216:219], v[184:187]
    v_exp_f32_e32 v154, v154
    v_mfma_f32_16x16x32_bf16 v[168:171], a[172:175], v[204:207], v[168:171]
    v_add_u32_e32 v229, s33, v229
    ds_read_b64_tr_b16 a[164:165], v229 offset:32768
    ds_read_b64_tr_b16 a[166:167], v229 offset:36864
    v_mfma_f32_16x16x32_bf16 v[184:187], a[172:175], v[220:223], v[184:187]
    buffer_load_dwordx4 v241, s[12:15], s30 offen offset:1024 nt lds
    s_waitcnt lgkmcnt(4)
    v_mfma_f32_16x16x32_bf16 v[172:175], a[176:179], v[192:195], 0
    v_add_u32_e32 v230, s33, v230
    ds_read_b64_tr_b16 a[168:169], v230 offset:32768
    ds_read_b64_tr_b16 a[170:171], v230 offset:36864
    v_mfma_f32_16x16x32_bf16 v[188:191], a[176:179], v[208:211], 0
    buffer_load_dwordx4 v240, s[12:15], s30 offen offset:2048 nt lds
    v_mfma_f32_16x16x32_bf16 v[172:175], a[180:183], v[196:199], v[172:175]
    v_add_u32_e32 v231, s33, v231
    ds_read_b64_tr_b16 a[172:173], v231 offset:32768
    ds_read_b64_tr_b16 a[174:175], v231 offset:36864
    v_mfma_f32_16x16x32_bf16 v[188:191], a[180:183], v[212:215], v[188:191]
    v_exp_f32_e32 v155, v155
    v_mfma_f32_16x16x32_bf16 v[172:175], a[184:187], v[200:203], v[172:175]
    v_add_u32_e32 v232, s33, v232
    ds_read_b64_tr_b16 a[176:177], v232 offset:32768
    ds_read_b64_tr_b16 a[178:179], v232 offset:36864
    v_mfma_f32_16x16x32_bf16 v[188:191], a[184:187], v[216:219], v[188:191]
    buffer_load_dwordx4 v241, s[12:15], s30 offen offset:3072 nt lds
    v_cvt_pk_bf16_f32 v152, v152, v153
    v_mfma_f32_16x16x32_bf16 v[172:175], a[188:191], v[204:207], v[172:175]
    v_add_u32_e32 v233, s33, v233
    ds_read_b64_tr_b16 a[180:181], v233 offset:32768
    ds_read_b64_tr_b16 a[182:183], v233 offset:36864
    v_mfma_f32_16x16x32_bf16 v[188:191], a[188:191], v[220:223], v[188:191]
    s_add_u32 s30, s30, 16384
    v_exp_f32_e32 v156, v156
    s_waitcnt lgkmcnt(4)
    v_mfma_f32_16x16x32_bf16 v[0:3], a[160:163], a[40:43], v[0:3]
    v_add_u32_e32 v234, s33, v234
    ds_read_b64_tr_b16 a[184:185], v234 offset:32768
    ds_read_b64_tr_b16 a[186:187], v234 offset:36864
    v_mfma_f32_16x16x32_bf16 v[32:35], a[160:163], a[44:47], v[32:35]
    v_exp_f32_e32 v157, v157
    v_mfma_f32_16x16x32_bf16 v[4:7], a[164:167], a[40:43], v[4:7]
    v_add_u32_e32 v235, s33, v235
    ds_read_b64_tr_b16 a[188:189], v235 offset:32768
    ds_read_b64_tr_b16 a[190:191], v235 offset:36864
    v_mfma_f32_16x16x32_bf16 v[36:39], a[164:167], a[44:47], v[36:39]
    v_cvt_pk_bf16_f32 v153, v154, v155
    v_exp_f32_e32 v158, v158
    v_mfma_f32_16x16x32_bf16 v[8:11], a[168:171], a[40:43], v[8:11]
    ds_read_b64_tr_b16 a[160:161], v228 offset:40960
    ds_read_b64_tr_b16 a[162:163], v228 offset:45056
    v_mfma_f32_16x16x32_bf16 v[40:43], a[168:171], a[44:47], v[40:43]
    v_exp_f32_e32 v159, v159
    v_mfma_f32_16x16x32_bf16 v[12:15], a[172:175], a[40:43], v[12:15]
    ds_read_b64_tr_b16 a[164:165], v229 offset:40960
    ds_read_b64_tr_b16 a[166:167], v229 offset:45056
    v_mfma_f32_16x16x32_bf16 v[44:47], a[172:175], a[44:47], v[44:47]
    v_cvt_pk_bf16_f32 v154, v156, v157
    v_cvt_pk_bf16_f32 v155, v158, v159
    s_waitcnt lgkmcnt(4)
    v_mfma_f32_16x16x32_bf16 v[16:19], a[176:179], a[40:43], v[16:19]
    ds_read_b64_tr_b16 a[168:169], v230 offset:40960
    ds_read_b64_tr_b16 a[170:171], v230 offset:45056
    v_mfma_f32_16x16x32_bf16 v[48:51], a[176:179], a[44:47], v[48:51]
    v_exp_f32_e32 v160, v160
    v_mfma_f32_16x16x32_bf16 v[20:23], a[180:183], a[40:43], v[20:23]
    ds_read_b64_tr_b16 a[172:173], v231 offset:40960
    ds_read_b64_tr_b16 a[174:175], v231 offset:45056
    v_mfma_f32_16x16x32_bf16 v[52:55], a[180:183], a[44:47], v[52:55]
    v_exp_f32_e32 v161, v161
    v_mfma_f32_16x16x32_bf16 v[24:27], a[184:187], a[40:43], v[24:27]
    ds_read_b64_tr_b16 a[176:177], v232 offset:40960
    ds_read_b64_tr_b16 a[178:179], v232 offset:45056
    v_mfma_f32_16x16x32_bf16 v[56:59], a[184:187], a[44:47], v[56:59]
    v_mfma_f32_16x16x32_bf16 v[250:253], v[242:245], v[152:155], v[250:253]
    v_mfma_f32_16x16x32_bf16 v[28:31], a[188:191], a[40:43], v[28:31]
    ds_read_b64_tr_b16 a[180:181], v233 offset:40960
    ds_read_b64_tr_b16 a[182:183], v233 offset:45056
    v_mfma_f32_16x16x32_bf16 v[60:63], a[188:191], a[44:47], v[60:63]
    v_exp_f32_e32 v162, v162
    s_waitcnt lgkmcnt(4)
    v_mfma_f32_16x16x32_bf16 v[0:3], a[160:163], a[48:51], v[0:3]
    ds_read_b64_tr_b16 a[184:185], v234 offset:40960
    ds_read_b64_tr_b16 a[186:187], v234 offset:45056
    v_mfma_f32_16x16x32_bf16 v[32:35], a[160:163], a[52:55], v[32:35]
    v_exp_f32_e32 v163, v163
    v_mfma_f32_16x16x32_bf16 v[4:7], a[164:167], a[48:51], v[4:7]
    ds_read_b64_tr_b16 a[188:189], v235 offset:40960
    ds_read_b64_tr_b16 a[190:191], v235 offset:45056
    v_mfma_f32_16x16x32_bf16 v[36:39], a[164:167], a[52:55], v[36:39]
    v_cvt_pk_bf16_f32 v160, v160, v161
    v_mfma_f32_16x16x32_bf16 v[8:11], a[168:171], a[48:51], v[8:11]
    ds_read_b64_tr_b16 a[160:161], v228 offset:16384
    ds_read_b64_tr_b16 a[162:163], v228 offset:20480
    v_mfma_f32_16x16x32_bf16 v[40:43], a[168:171], a[52:55], v[40:43]
    v_exp_f32_e32 v164, v164
    v_mfma_f32_16x16x32_bf16 v[12:15], a[172:175], a[48:51], v[12:15]
    ds_read_b64_tr_b16 a[164:165], v229 offset:16384
    ds_read_b64_tr_b16 a[166:167], v229 offset:20480
    v_mfma_f32_16x16x32_bf16 v[44:47], a[172:175], a[52:55], v[44:47]
    v_exp_f32_e32 v165, v165
    s_waitcnt lgkmcnt(4)
    v_mfma_f32_16x16x32_bf16 v[16:19], a[176:179], a[48:51], v[16:19]
    ds_read_b64_tr_b16 a[168:169], v230 offset:16384
    ds_read_b64_tr_b16 a[170:171], v230 offset:20480
    v_mfma_f32_16x16x32_bf16 v[48:51], a[176:179], a[52:55], v[48:51]
    v_cvt_pk_bf16_f32 v161, v162, v163
    v_exp_f32_e32 v166, v166
    v_mfma_f32_16x16x32_bf16 v[20:23], a[180:183], a[48:51], v[20:23]
    ds_read_b64_tr_b16 a[172:173], v231 offset:16384
    ds_read_b64_tr_b16 a[174:175], v231 offset:20480
    v_mfma_f32_16x16x32_bf16 v[52:55], a[180:183], a[52:55], v[52:55]
    v_exp_f32_e32 v167, v167
    v_mfma_f32_16x16x32_bf16 v[24:27], a[184:187], a[48:51], v[24:27]
    ds_read_b64_tr_b16 a[176:177], v232 offset:16384
    ds_read_b64_tr_b16 a[178:179], v232 offset:20480
    v_mfma_f32_16x16x32_bf16 v[56:59], a[184:187], a[52:55], v[56:59]
    v_cvt_pk_bf16_f32 v162, v164, v165
    v_mfma_f32_16x16x32_bf16 v[28:31], a[188:191], a[48:51], v[28:31]
    ds_read_b64_tr_b16 a[180:181], v233 offset:16384
    ds_read_b64_tr_b16 a[182:183], v233 offset:20480
    v_mfma_f32_16x16x32_bf16 v[60:63], a[188:191], a[52:55], v[60:63]
    v_cvt_pk_bf16_f32 v163, v166, v167
    s_waitcnt lgkmcnt(4)
    v_mfma_f32_16x16x32_bf16 v[64:67], a[160:163], v[128:131], v[64:67]
    ds_read_b64_tr_b16 a[184:185], v234 offset:16384
    ds_read_b64_tr_b16 a[186:187], v234 offset:20480
    v_mfma_f32_16x16x32_bf16 v[96:99], a[160:163], v[144:147], v[96:99]
    v_exp_f32_e32 v176, v176
    v_mfma_f32_16x16x32_bf16 v[68:71], a[164:167], v[128:131], v[68:71]
    ds_read_b64_tr_b16 a[188:189], v235 offset:16384
    ds_read_b64_tr_b16 a[190:191], v235 offset:20480
    v_mfma_f32_16x16x32_bf16 v[100:103], a[164:167], v[144:147], v[100:103]
    v_exp_f32_e32 v177, v177
    v_mfma_f32_16x16x32_bf16 v[72:75], a[168:171], v[128:131], v[72:75]
    ds_read_b64_tr_b16 a[160:161], v228 offset:24576
    ds_read_b64_tr_b16 a[162:163], v228 offset:28672
    v_mfma_f32_16x16x32_bf16 v[104:107], a[168:171], v[144:147], v[104:107]
    v_mfma_f32_16x16x32_bf16 v[246:249], v[242:245], v[160:163], v[246:249]
    v_mfma_f32_16x16x32_bf16 v[76:79], a[172:175], v[128:131], v[76:79]
    ds_read_b64_tr_b16 a[164:165], v229 offset:24576
    ds_read_b64_tr_b16 a[166:167], v229 offset:28672
    v_mfma_f32_16x16x32_bf16 v[108:111], a[172:175], v[144:147], v[108:111]
    v_exp_f32_e32 v178, v178
    s_waitcnt lgkmcnt(4)
    v_mfma_f32_16x16x32_bf16 v[80:83], a[176:179], v[128:131], v[80:83]
    ds_read_b64_tr_b16 a[168:169], v230 offset:24576
    ds_read_b64_tr_b16 a[170:171], v230 offset:28672
    v_mfma_f32_16x16x32_bf16 v[112:115], a[176:179], v[144:147], v[112:115]
    v_exp_f32_e32 v179, v179
    v_mfma_f32_16x16x32_bf16 v[84:87], a[180:183], v[128:131], v[84:87]
    ds_read_b64_tr_b16 a[172:173], v231 offset:24576
    ds_read_b64_tr_b16 a[174:175], v231 offset:28672
    v_mfma_f32_16x16x32_bf16 v[116:119], a[180:183], v[144:147], v[116:119]
    v_cvt_pk_bf16_f32 v176, v176, v177
    v_mfma_f32_16x16x32_bf16 v[88:91], a[184:187], v[128:131], v[88:91]
    ds_read_b64_tr_b16 a[176:177], v232 offset:24576
    ds_read_b64_tr_b16 a[178:179], v232 offset:28672
    v_mfma_f32_16x16x32_bf16 v[120:123], a[184:187], v[144:147], v[120:123]
    v_exp_f32_e32 v180, v180
    v_mfma_f32_16x16x32_bf16 v[92:95], a[188:191], v[128:131], v[92:95]
    ds_read_b64_tr_b16 a[180:181], v233 offset:24576
    ds_read_b64_tr_b16 a[182:183], v233 offset:28672
    v_mfma_f32_16x16x32_bf16 v[124:127], a[188:191], v[144:147], v[124:127]
    v_exp_f32_e32 v181, v181
    s_waitcnt lgkmcnt(4)
    v_mfma_f32_16x16x32_bf16 v[64:67], a[160:163], v[136:139], v[64:67]
    ds_read_b64_tr_b16 a[184:185], v234 offset:24576
    ds_read_b64_tr_b16 a[186:187], v234 offset:28672
    v_mfma_f32_16x16x32_bf16 v[96:99], a[160:163], v[152:155], v[96:99]
    v_cvt_pk_bf16_f32 v177, v178, v179
    v_exp_f32_e32 v182, v182
    v_mfma_f32_16x16x32_bf16 v[68:71], a[164:167], v[136:139], v[68:71]
    ds_read_b64_tr_b16 a[188:189], v235 offset:24576
    ds_read_b64_tr_b16 a[190:191], v235 offset:28672
    v_mfma_f32_16x16x32_bf16 v[100:103], a[164:167], v[152:155], v[100:103]
    v_exp_f32_e32 v183, v183
    v_mfma_f32_16x16x32_bf16 v[72:75], a[168:171], v[136:139], v[72:75]
    v_mfma_f32_16x16x32_bf16 v[104:107], a[168:171], v[152:155], v[104:107]
    v_cvt_pk_bf16_f32 v178, v180, v181
    v_mfma_f32_16x16x32_bf16 v[76:79], a[172:175], v[136:139], v[76:79]
    v_cvt_pk_bf16_f32 v179, v182, v183
    v_mfma_f32_16x16x32_bf16 v[108:111], a[172:175], v[152:155], v[108:111]
    s_waitcnt lgkmcnt(0)
    v_mfma_f32_16x16x32_bf16 v[80:83], a[176:179], v[136:139], v[80:83]
    v_exp_f32_e32 v168, v168
    v_mfma_f32_16x16x32_bf16 v[112:115], a[176:179], v[152:155], v[112:115]
    s_waitcnt vmcnt(8)
    s_barrier
    s_mov_b32 s50, s32
    s_add_u32 s34, s32, s38
    s_add_u32 s32, s32, s42
    s_cmp_eq_u32 s32, 159744
    s_cselect_b32 s33, s43, s42
    s_cselect_b32 s32, 0, s32
    s_sub_u32 s39, 159744, s32
    v_add_u32_e32 v224, s33, v224
    ds_read_b128 a[160:163], v224 offset:0
    v_add_u32_e32 v225, s33, v225
    ds_read_b128 a[164:167], v225 offset:0
    v_add_u32_e32 v226, s33, v226
    ds_read_b128 a[168:171], v226 offset:0
    v_mfma_f32_16x16x32_bf16 v[84:87], a[180:183], v[136:139], v[84:87]
    v_add_u32_e32 v227, s33, v227
    ds_read_b128 a[172:175], v227 offset:0
    v_mfma_f32_16x16x32_bf16 v[116:119], a[180:183], v[152:155], v[116:119]
    v_exp_f32_e32 v169, v169
    v_mfma_f32_16x16x32_bf16 v[88:91], a[184:187], v[136:139], v[88:91]
    ds_read_b128 a[176:179], v224 offset:4096
    v_mfma_f32_16x16x32_bf16 v[250:253], v[242:245], v[176:179], v[250:253]
    v_mfma_f32_16x16x32_bf16 v[120:123], a[184:187], v[152:155], v[120:123]
    ds_read_b128 a[180:183], v225 offset:4096
    v_mfma_f32_16x16x32_bf16 v[92:95], a[188:191], v[136:139], v[92:95]
    v_exp_f32_e32 v170, v170
    v_mfma_f32_16x16x32_bf16 v[124:127], a[188:191], v[152:155], v[124:127]
    s_waitcnt lgkmcnt(2)
    v_mfma_f32_16x16x32_bf16 v[128:131], a[160:163], v[192:195], 0
    ds_read_b128 a[184:187], v226 offset:4096
    s_add_u32 m0, s34, 0
    v_mfma_f32_16x16x32_bf16 v[144:147], a[160:163], v[208:211], 0
    v_exp_f32_e32 v171, v171
    v_mfma_f32_16x16x32_bf16 v[128:131], a[164:167], v[196:199], v[128:131]
    ds_read_b128 a[188:191], v227 offset:4096
    v_cvt_pk_bf16_f32 v168, v168, v169
    v_mfma_f32_16x16x32_bf16 v[144:147], a[164:167], v[212:215], v[144:147]
    buffer_load_dwordx4 v236, s[8:11], s29 offen offset:0 nt lds
    v_mfma_f32_16x16x32_bf16 v[128:131], a[168:171], v[200:203], v[128:131]
    ds_read_b128 a[160:163], v224 offset:8192
    v_exp_f32_e32 v172, v172
    v_mfma_f32_16x16x32_bf16 v[144:147], a[168:171], v[216:219], v[144:147]
    buffer_load_dwordx4 v237, s[8:11], s29 offen offset:1024 nt lds
    v_mfma_f32_16x16x32_bf16 v[128:131], a[172:175], v[204:207], v[128:131]
    ds_read_b128 a[164:167], v225 offset:8192
    v_exp_f32_e32 v173, v173
    v_mfma_f32_16x16x32_bf16 v[144:147], a[172:175], v[220:223], v[144:147]
    s_waitcnt lgkmcnt(2)
    v_mfma_f32_16x16x32_bf16 v[132:135], a[176:179], v[192:195], 0
    ds_read_b128 a[168:171], v226 offset:8192
    v_mfma_f32_16x16x32_bf16 v[148:151], a[176:179], v[208:211], 0
    buffer_load_dwordx4 v238, s[8:11], s29 offen offset:2048 nt lds
    v_mfma_f32_16x16x32_bf16 v[132:135], a[180:183], v[196:199], v[132:135]
    ds_read_b128 a[172:175], v227 offset:8192
    v_cvt_pk_bf16_f32 v169, v170, v171
    v_mfma_f32_16x16x32_bf16 v[148:151], a[180:183], v[212:215], v[148:151]
    buffer_load_dwordx4 v239, s[8:11], s29 offen offset:3072 nt lds
    v_mfma_f32_16x16x32_bf16 v[132:135], a[184:187], v[200:203], v[132:135]
    ds_read_b128 a[176:179], v224 offset:12288
    v_exp_f32_e32 v174, v174
    v_mfma_f32_16x16x32_bf16 v[148:151], a[184:187], v[216:219], v[148:151]
    v_exp_f32_e32 v175, v175
    v_mfma_f32_16x16x32_bf16 v[132:135], a[188:191], v[204:207], v[132:135]
    ds_read_b128 a[180:183], v225 offset:12288
    v_cvt_pk_bf16_f32 v170, v172, v173
    v_mfma_f32_16x16x32_bf16 v[148:151], a[188:191], v[220:223], v[148:151]
    s_add_u32 s29, s29, 16384
    s_waitcnt lgkmcnt(2)
    v_mfma_f32_16x16x32_bf16 v[136:139], a[160:163], v[192:195], 0
    v_cvt_pk_bf16_f32 v171, v174, v175
    ds_read_b128 a[184:187], v226 offset:12288
    v_mfma_f32_16x16x32_bf16 v[152:155], a[160:163], v[208:211], 0
    s_add_u32 m0, s34, 16384
    v_exp_f32_e32 v184, v184
    v_mfma_f32_16x16x32_bf16 v[136:139], a[164:167], v[196:199], v[136:139]
    ds_read_b128 a[188:191], v227 offset:12288
    v_exp_f32_e32 v185, v185
    v_mfma_f32_16x16x32_bf16 v[152:155], a[164:167], v[212:215], v[152:155]
    buffer_load_dwordx4 v240, s[12:15], s30 offen offset:0 nt lds
    v_mfma_f32_16x16x32_bf16 v[136:139], a[168:171], v[200:203], v[136:139]
    v_add_u32_e32 v228, s33, v228
    v_add_u32_e32 v254, s39, v228
    v_mfma_f32_16x16x32_bf16 v[152:155], a[168:171], v[216:219], v[152:155]
    ds_read_b64_tr_b16 a[160:161], v254 offset:0
    ds_read_b64_tr_b16 a[162:163], v228 offset:32768
    v_mfma_f32_16x16x32_bf16 v[246:249], v[242:245], v[168:171], v[246:249]
    v_add_u32_e32 v229, s33, v229
    v_mfma_f32_16x16x32_bf16 v[136:139], a[172:175], v[204:207], v[136:139]
    v_add_u32_e32 v254, s39, v229
    ds_read_b64_tr_b16 a[164:165], v254 offset:0
    ds_read_b64_tr_b16 a[166:167], v229 offset:32768
    v_mfma_f32_16x16x32_bf16 v[152:155], a[172:175], v[220:223], v[152:155]
    buffer_load_dwordx4 v241, s[12:15], s30 offen offset:1024 nt lds
    s_waitcnt lgkmcnt(4)
    v_mfma_f32_16x16x32_bf16 v[140:143], a[176:179], v[192:195], 0
    v_add_u32_e32 v230, s33, v230
    v_add_u32_e32 v254, s39, v230
    ds_read_b64_tr_b16 a[168:169], v254 offset:0
    ds_read_b64_tr_b16 a[170:171], v230 offset:32768
    v_mfma_f32_16x16x32_bf16 v[156:159], a[176:179], v[208:211], 0
    buffer_load_dwordx4 v240, s[12:15], s30 offen offset:2048 nt lds
    v_mfma_f32_16x16x32_bf16 v[140:143], a[180:183], v[196:199], v[140:143]
    v_add_u32_e32 v231, s33, v231
    v_add_u32_e32 v254, s39, v231
    ds_read_b64_tr_b16 a[172:173], v254 offset:0
    ds_read_b64_tr_b16 a[174:175], v231 offset:32768
    v_exp_f32_e32 v186, v186
    v_mfma_f32_16x16x32_bf16 v[156:159], a[180:183], v[212:215], v[156:159]
    v_exp_f32_e32 v187, v187
    v_mfma_f32_16x16x32_bf16 v[140:143], a[184:187], v[200:203], v[140:143]
    v_add_u32_e32 v232, s33, v232
    v_add_u32_e32 v254, s39, v232
    ds_read_b64_tr_b16 a[176:177], v254 offset:0
    ds_read_b64_tr_b16 a[178:179], v232 offset:32768
    v_mfma_f32_16x16x32_bf16 v[156:159], a[184:187], v[216:219], v[156:159]
    buffer_load_dwordx4 v241, s[12:15], s30 offen offset:3072 nt lds
    v_mfma_f32_16x16x32_bf16 v[140:143], a[188:191], v[204:207], v[140:143]
    v_add_u32_e32 v233, s33, v233
    v_add_u32_e32 v254, s39, v233
    ds_read_b64_tr_b16 a[180:181], v254 offset:0
    ds_read_b64_tr_b16 a[182:183], v233 offset:32768
    v_mfma_f32_16x16x32_bf16 v[156:159], a[188:191], v[220:223], v[156:159]
    s_add_u32 s30, s30, 16384
    v_cvt_pk_bf16_f32 v184, v184, v185
    s_waitcnt lgkmcnt(4)
    v_mfma_f32_16x16x32_bf16 v[0:3], a[160:163], a[56:59], v[0:3]
    v_add_u32_e32 v234, s33, v234
    v_add_u32_e32 v254, s39, v234
    ds_read_b64_tr_b16 a[184:185], v254 offset:0
    ds_read_b64_tr_b16 a[186:187], v234 offset:32768
    v_mfma_f32_16x16x32_bf16 v[32:35], a[160:163], a[60:63], v[32:35]
    v_exp_f32_e32 v188, v188
    v_mfma_f32_16x16x32_bf16 v[4:7], a[164:167], a[56:59], v[4:7]
    v_add_u32_e32 v235, s33, v235
    v_add_u32_e32 v254, s39, v235
    ds_read_b64_tr_b16 a[188:189], v254 offset:0
    ds_read_b64_tr_b16 a[190:191], v235 offset:32768
    v_exp_f32_e32 v189, v189
    v_mfma_f32_16x16x32_bf16 v[36:39], a[164:167], a[60:63], v[36:39]
    v_cvt_pk_bf16_f32 v185, v186, v187
    v_exp_f32_e32 v190, v190
    v_mfma_f32_16x16x32_bf16 v[8:11], a[168:171], a[56:59], v[8:11]
    ds_read_b64_tr_b16 a[160:161], v228 offset:36864
    ds_read_b64_tr_b16 a[162:163], v228 offset:40960
    v_mfma_f32_16x16x32_bf16 v[40:43], a[168:171], a[60:63], v[40:43]
    v_exp_f32_e32 v191, v191
    v_mfma_f32_16x16x32_bf16 v[12:15], a[172:175], a[56:59], v[12:15]
    ds_read_b64_tr_b16 a[164:165], v229 offset:36864
    ds_read_b64_tr_b16 a[166:167], v229 offset:40960
    v_mfma_f32_16x16x32_bf16 v[44:47], a[172:175], a[60:63], v[44:47]
    v_cvt_pk_bf16_f32 v186, v188, v189
    v_cvt_pk_bf16_f32 v187, v190, v191
    s_waitcnt lgkmcnt(4)
    v_mfma_f32_16x16x32_bf16 v[16:19], a[176:179], a[56:59], v[16:19]
    ds_read_b64_tr_b16 a[168:169], v230 offset:36864
    ds_read_b64_tr_b16 a[170:171], v230 offset:40960
    v_mfma_f32_16x16x32_bf16 v[48:51], a[176:179], a[60:63], v[48:51]
    v_exp_f32_e32 v128, v128
    v_mfma_f32_16x16x32_bf16 v[20:23], a[180:183], a[56:59], v[20:23]
    ds_read_b64_tr_b16 a[172:173], v231 offset:36864
    ds_read_b64_tr_b16 a[174:175], v231 offset:40960
    v_mfma_f32_16x16x32_bf16 v[52:55], a[180:183], a[60:63], v[52:55]
    v_exp_f32_e32 v129, v129
    v_mfma_f32_16x16x32_bf16 v[24:27], a[184:187], a[56:59], v[24:27]
    ds_read_b64_tr_b16 a[176:177], v232 offset:36864
    ds_read_b64_tr_b16 a[178:179], v232 offset:40960
    v_mfma_f32_16x16x32_bf16 v[56:59], a[184:187], a[60:63], v[56:59]
    v_mfma_f32_16x16x32_bf16 v[250:253], v[242:245], v[184:187], v[250:253]
    v_mfma_f32_16x16x32_bf16 v[28:31], a[188:191], a[56:59], v[28:31]
    ds_read_b64_tr_b16 a[180:181], v233 offset:36864
    ds_read_b64_tr_b16 a[182:183], v233 offset:40960
    v_mfma_f32_16x16x32_bf16 v[60:63], a[188:191], a[60:63], v[60:63]
    v_exp_f32_e32 v130, v130
    s_waitcnt lgkmcnt(4)
    v_mfma_f32_16x16x32_bf16 v[0:3], a[160:163], a[64:67], v[0:3]
    ds_read_b64_tr_b16 a[184:185], v234 offset:36864
    ds_read_b64_tr_b16 a[186:187], v234 offset:40960
    v_mfma_f32_16x16x32_bf16 v[32:35], a[160:163], a[68:71], v[32:35]
    v_mfma_f32_16x16x32_bf16 v[4:7], a[164:167], a[64:67], v[4:7]
    ds_read_b64_tr_b16 a[188:189], v235 offset:36864
    ds_read_b64_tr_b16 a[190:191], v235 offset:40960
    v_mfma_f32_16x16x32_bf16 v[36:39], a[164:167], a[68:71], v[36:39]
    v_exp_f32_e32 v131, v131
    v_mfma_f32_16x16x32_bf16 v[8:11], a[168:171], a[64:67], v[8:11]
    ds_read_b64_tr_b16 a[160:161], v228 offset:45056
    ds_read_b64_tr_b16 a[162:163], v228 offset:49152
    v_mfma_f32_16x16x32_bf16 v[40:43], a[168:171], a[68:71], v[40:43]
    v_cvt_pk_bf16_f32 v128, v128, v129
    v_mfma_f32_16x16x32_bf16 v[12:15], a[172:175], a[64:67], v[12:15]
    ds_read_b64_tr_b16 a[164:165], v229 offset:45056
    ds_read_b64_tr_b16 a[166:167], v229 offset:49152
    v_mfma_f32_16x16x32_bf16 v[44:47], a[172:175], a[68:71], v[44:47]
    v_exp_f32_e32 v132, v132
    s_waitcnt lgkmcnt(4)
    v_mfma_f32_16x16x32_bf16 v[16:19], a[176:179], a[64:67], v[16:19]
    ds_read_b64_tr_b16 a[168:169], v230 offset:45056
    ds_read_b64_tr_b16 a[170:171], v230 offset:49152
    v_mfma_f32_16x16x32_bf16 v[48:51], a[176:179], a[68:71], v[48:51]
    v_exp_f32_e32 v133, v133
    v_mfma_f32_16x16x32_bf16 v[20:23], a[180:183], a[64:67], v[20:23]
    ds_read_b64_tr_b16 a[172:173], v231 offset:45056
    ds_read_b64_tr_b16 a[174:175], v231 offset:49152
    v_mfma_f32_16x16x32_bf16 v[52:55], a[180:183], a[68:71], v[52:55]
    v_cvt_pk_bf16_f32 v129, v130, v131
    v_mfma_f32_16x16x32_bf16 v[24:27], a[184:187], a[64:67], v[24:27]
    ds_read_b64_tr_b16 a[176:177], v232 offset:45056
    ds_read_b64_tr_b16 a[178:179], v232 offset:49152
    v_mfma_f32_16x16x32_bf16 v[56:59], a[184:187], a[68:71], v[56:59]
    v_exp_f32_e32 v134, v134
    v_mfma_f32_16x16x32_bf16 v[28:31], a[188:191], a[64:67], v[28:31]
    ds_read_b64_tr_b16 a[180:181], v233 offset:45056
    ds_read_b64_tr_b16 a[182:183], v233 offset:49152
    v_mfma_f32_16x16x32_bf16 v[60:63], a[188:191], a[68:71], v[60:63]
    v_exp_f32_e32 v135, v135
    s_waitcnt lgkmcnt(4)
    v_mfma_f32_16x16x32_bf16 v[0:3], a[160:163], a[72:75], v[0:3]
    ds_read_b64_tr_b16 a[184:185], v234 offset:45056
    ds_read_b64_tr_b16 a[186:187], v234 offset:49152
    v_mfma_f32_16x16x32_bf16 v[32:35], a[160:163], a[76:79], v[32:35]
    v_cvt_pk_bf16_f32 v130, v132, v133
    v_mfma_f32_16x16x32_bf16 v[4:7], a[164:167], a[72:75], v[4:7]
    ds_read_b64_tr_b16 a[188:189], v235 offset:45056
    ds_read_b64_tr_b16 a[190:191], v235 offset:49152
    v_mfma_f32_16x16x32_bf16 v[36:39], a[164:167], a[76:79], v[36:39]
    v_cvt_pk_bf16_f32 v131, v134, v135
    v_mfma_f32_16x16x32_bf16 v[8:11], a[168:171], a[72:75], v[8:11]
    ds_read_b64_tr_b16 a[160:161], v228 offset:16384
    ds_read_b64_tr_b16 a[162:163], v228 offset:20480
    v_mfma_f32_16x16x32_bf16 v[40:43], a[168:171], a[76:79], v[40:43]
    v_exp_f32_e32 v144, v144
    v_mfma_f32_16x16x32_bf16 v[12:15], a[172:175], a[72:75], v[12:15]
    ds_read_b64_tr_b16 a[164:165], v229 offset:16384
    ds_read_b64_tr_b16 a[166:167], v229 offset:20480
    v_mfma_f32_16x16x32_bf16 v[44:47], a[172:175], a[76:79], v[44:47]
    v_exp_f32_e32 v145, v145
    s_waitcnt lgkmcnt(4)
    v_mfma_f32_16x16x32_bf16 v[16:19], a[176:179], a[72:75], v[16:19]
    ds_read_b64_tr_b16 a[168:169], v230 offset:16384
    ds_read_b64_tr_b16 a[170:171], v230 offset:20480
    v_mfma_f32_16x16x32_bf16 v[48:51], a[176:179], a[76:79], v[48:51]
    v_mfma_f32_16x16x32_bf16 v[246:249], v[242:245], v[128:131], v[246:249]
    v_mfma_f32_16x16x32_bf16 v[20:23], a[180:183], a[72:75], v[20:23]
    ds_read_b64_tr_b16 a[172:173], v231 offset:16384
    ds_read_b64_tr_b16 a[174:175], v231 offset:20480
    v_mfma_f32_16x16x32_bf16 v[52:55], a[180:183], a[76:79], v[52:55]
    v_exp_f32_e32 v146, v146
    v_mfma_f32_16x16x32_bf16 v[24:27], a[184:187], a[72:75], v[24:27]
    ds_read_b64_tr_b16 a[176:177], v232 offset:16384
    ds_read_b64_tr_b16 a[178:179], v232 offset:20480
    v_mfma_f32_16x16x32_bf16 v[56:59], a[184:187], a[76:79], v[56:59]
    v_mfma_f32_16x16x32_bf16 v[28:31], a[188:191], a[72:75], v[28:31]
    ds_read_b64_tr_b16 a[180:181], v233 offset:16384
    ds_read_b64_tr_b16 a[182:183], v233 offset:20480
    v_mfma_f32_16x16x32_bf16 v[60:63], a[188:191], a[76:79], v[60:63]
    v_exp_f32_e32 v147, v147
    s_waitcnt lgkmcnt(4)
    v_mfma_f32_16x16x32_bf16 v[64:67], a[160:163], v[160:163], v[64:67]
    ds_read_b64_tr_b16 a[184:185], v234 offset:16384
    ds_read_b64_tr_b16 a[186:187], v234 offset:20480
    v_mfma_f32_16x16x32_bf16 v[96:99], a[160:163], v[176:179], v[96:99]
    v_cvt_pk_bf16_f32 v144, v144, v145
    v_mfma_f32_16x16x32_bf16 v[68:71], a[164:167], v[160:163], v[68:71]
    ds_read_b64_tr_b16 a[188:189], v235 offset:16384
    ds_read_b64_tr_b16 a[190:191], v235 offset:20480
    v_mfma_f32_16x16x32_bf16 v[100:103], a[164:167], v[176:179], v[100:103]
    v_exp_f32_e32 v148, v148
    v_mfma_f32_16x16x32_bf16 v[72:75], a[168:171], v[160:163], v[72:75]
    ds_read_b64_tr_b16 a[160:161], v228 offset:24576
    ds_read_b64_tr_b16 a[162:163], v228 offset:28672
    v_mfma_f32_16x16x32_bf16 v[104:107], a[168:171], v[176:179], v[104:107]
    v_exp_f32_e32 v149, v149
    v_mfma_f32_16x16x32_bf16 v[76:79], a[172:175], v[160:163], v[76:79]
    ds_read_b64_tr_b16 a[164:165], v229 offset:24576
    ds_read_b64_tr_b16 a[166:167], v229 offset:28672
    v_mfma_f32_16x16x32_bf16 v[108:111], a[172:175], v[176:179], v[108:111]
    v_cvt_pk_bf16_f32 v145, v146, v147
    s_waitcnt lgkmcnt(4)
    v_mfma_f32_16x16x32_bf16 v[80:83], a[176:179], v[160:163], v[80:83]
    ds_read_b64_tr_b16 a[168:169], v230 offset:24576
    ds_read_b64_tr_b16 a[170:171], v230 offset:28672
    v_mfma_f32_16x16x32_bf16 v[112:115], a[176:179], v[176:179], v[112:115]
    v_exp_f32_e32 v150, v150
    v_mfma_f32_16x16x32_bf16 v[84:87], a[180:183], v[160:163], v[84:87]
    ds_read_b64_tr_b16 a[172:173], v231 offset:24576
    ds_read_b64_tr_b16 a[174:175], v231 offset:28672
    v_mfma_f32_16x16x32_bf16 v[116:119], a[180:183], v[176:179], v[116:119]
    v_exp_f32_e32 v151, v151
    v_mfma_f32_16x16x32_bf16 v[88:91], a[184:187], v[160:163], v[88:91]
    ds_read_b64_tr_b16 a[176:177], v232 offset:24576
    ds_read_b64_tr_b16 a[178:179], v232 offset:28672
    v_mfma_f32_16x16x32_bf16 v[120:123], a[184:187], v[176:179], v[120:123]
    v_cvt_pk_bf16_f32 v146, v148, v149
    v_mfma_f32_16x16x32_bf16 v[92:95], a[188:191], v[160:163], v[92:95]
    ds_read_b64_tr_b16 a[180:181], v233 offset:24576
    ds_read_b64_tr_b16 a[182:183], v233 offset:28672
    v_mfma_f32_16x16x32_bf16 v[124:127], a[188:191], v[176:179], v[124:127]
    v_cvt_pk_bf16_f32 v147, v150, v151
    s_waitcnt lgkmcnt(4)
    v_mfma_f32_16x16x32_bf16 v[64:67], a[160:163], v[168:171], v[64:67]
    ds_read_b64_tr_b16 a[184:185], v234 offset:24576
    ds_read_b64_tr_b16 a[186:187], v234 offset:28672
    v_mfma_f32_16x16x32_bf16 v[96:99], a[160:163], v[184:187], v[96:99]
    v_exp_f32_e32 v136, v136
    v_mfma_f32_16x16x32_bf16 v[68:71], a[164:167], v[168:171], v[68:71]
    ds_read_b64_tr_b16 a[188:189], v235 offset:24576
    ds_read_b64_tr_b16 a[190:191], v235 offset:28672
    v_mfma_f32_16x16x32_bf16 v[100:103], a[164:167], v[184:187], v[100:103]
    v_exp_f32_e32 v137, v137
    v_mfma_f32_16x16x32_bf16 v[72:75], a[168:171], v[168:171], v[72:75]
    v_mfma_f32_16x16x32_bf16 v[104:107], a[168:171], v[184:187], v[104:107]
    v_mfma_f32_16x16x32_bf16 v[250:253], v[242:245], v[144:147], v[250:253]
    v_mfma_f32_16x16x32_bf16 v[76:79], a[172:175], v[168:171], v[76:79]
    v_mfma_f32_16x16x32_bf16 v[108:111], a[172:175], v[184:187], v[108:111]
    v_exp_f32_e32 v138, v138
    s_waitcnt lgkmcnt(0)
    v_mfma_f32_16x16x32_bf16 v[80:83], a[176:179], v[168:171], v[80:83]
    v_mfma_f32_16x16x32_bf16 v[112:115], a[176:179], v[184:187], v[112:115]
    s_waitcnt vmcnt(8)
    s_barrier
    s_mov_b32 s50, s32
    s_add_u32 s34, s32, s38
    s_add_u32 s32, s32, s42
    s_cmp_eq_u32 s32, 159744
    s_cselect_b32 s33, s43, s42
    s_cselect_b32 s32, 0, s32
    v_add_u32_e32 v224, s33, v224
    ds_read_b128 a[160:163], v224 offset:0
    v_add_u32_e32 v225, s33, v225
    ds_read_b128 a[164:167], v225 offset:0
    v_add_u32_e32 v226, s33, v226
    ds_read_b128 a[168:171], v226 offset:0
    v_mfma_f32_16x16x32_bf16 v[84:87], a[180:183], v[168:171], v[84:87]
    v_add_u32_e32 v227, s33, v227
    ds_read_b128 a[172:175], v227 offset:0
    v_mfma_f32_16x16x32_bf16 v[116:119], a[180:183], v[184:187], v[116:119]
    v_exp_f32_e32 v139, v139
    v_mfma_f32_16x16x32_bf16 v[88:91], a[184:187], v[168:171], v[88:91]
    ds_read_b128 a[176:179], v224 offset:4096
    v_cvt_pk_bf16_f32 v136, v136, v137
    v_mfma_f32_16x16x32_bf16 v[120:123], a[184:187], v[184:187], v[120:123]
    ds_read_b128 a[180:183], v225 offset:4096
    v_mfma_f32_16x16x32_bf16 v[92:95], a[188:191], v[168:171], v[92:95]
    v_exp_f32_e32 v140, v140
    v_mfma_f32_16x16x32_bf16 v[124:127], a[188:191], v[184:187], v[124:127]
    s_waitcnt lgkmcnt(2)
    v_mfma_f32_16x16x32_bf16 v[160:163], a[160:163], v[192:195], 0
    ds_read_b128 a[184:187], v226 offset:4096
    s_add_u32 m0, s34, 0
    v_mfma_f32_16x16x32_bf16 v[176:179], a[160:163], v[208:211], 0
    v_exp_f32_e32 v141, v141
    v_mfma_f32_16x16x32_bf16 v[160:163], a[164:167], v[196:199], v[160:163]
    ds_read_b128 a[188:191], v227 offset:4096
    v_mfma_f32_16x16x32_bf16 v[176:179], a[164:167], v[212:215], v[176:179]
    buffer_load_dwordx4 v236, s[8:11], s29 offen offset:0 nt lds
    v_mfma_f32_16x16x32_bf16 v[160:163], a[168:171], v[200:203], v[160:163]
    ds_read_b128 a[160:163], v224 offset:8192
    v_cvt_pk_bf16_f32 v137, v138, v139
    v_mfma_f32_16x16x32_bf16 v[176:179], a[168:171], v[216:219], v[176:179]
    buffer_load_dwordx4 v237, s[8:11], s29 offen offset:1024 nt lds
    v_mfma_f32_16x16x32_bf16 v[160:163], a[172:175], v[204:207], v[160:163]
    ds_read_b128 a[164:167], v225 offset:8192
    v_exp_f32_e32 v142, v142
    v_mfma_f32_16x16x32_bf16 v[176:179], a[172:175], v[220:223], v[176:179]
    v_exp_f32_e32 v143, v143
    s_waitcnt lgkmcnt(2)
    v_mfma_f32_16x16x32_bf16 v[164:167], a[176:179], v[192:195], 0
    ds_read_b128 a[168:171], v226 offset:8192
    v_mfma_f32_16x16x32_bf16 v[180:183], a[176:179], v[208:211], 0
    buffer_load_dwordx4 v238, s[8:11], s29 offen offset:2048 nt lds
    v_mfma_f32_16x16x32_bf16 v[164:167], a[180:183], v[196:199], v[164:167]
    ds_read_b128 a[172:175], v227 offset:8192
    v_cvt_pk_bf16_f32 v138, v140, v141
    v_mfma_f32_16x16x32_bf16 v[180:183], a[180:183], v[212:215], v[180:183]
    buffer_load_dwordx4 v239, s[8:11], s29 offen offset:3072 nt lds
    v_mfma_f32_16x16x32_bf16 v[164:167], a[184:187], v[200:203], v[164:167]
    ds_read_b128 a[176:179], v224 offset:12288
    v_cvt_pk_bf16_f32 v139, v142, v143
    v_mfma_f32_16x16x32_bf16 v[180:183], a[184:187], v[216:219], v[180:183]
    v_exp_f32_e32 v152, v152
    v_mfma_f32_16x16x32_bf16 v[164:167], a[188:191], v[204:207], v[164:167]
    ds_read_b128 a[180:183], v225 offset:12288
    v_exp_f32_e32 v153, v153
    v_mfma_f32_16x16x32_bf16 v[180:183], a[188:191], v[220:223], v[180:183]
    s_add_u32 s29, s29, 16384
    s_waitcnt lgkmcnt(2)
    v_mfma_f32_16x16x32_bf16 v[168:171], a[160:163], v[192:195], 0
    ds_read_b128 a[184:187], v226 offset:12288
    v_mfma_f32_16x16x32_bf16 v[184:187], a[160:163], v[208:211], 0
    s_add_u32 m0, s34, 16384
    v_mfma_f32_16x16x32_bf16 v[246:249], v[242:245], v[136:139], v[246:249]
    v_mfma_f32_16x16x32_bf16 v[168:171], a[164:167], v[196:199], v[168:171]
    ds_read_b128 a[188:191], v227 offset:12288
    v_mfma_f32_16x16x32_bf16 v[184:187], a[164:167], v[212:215], v[184:187]
    buffer_load_dwordx4 v240, s[12:15], s30 offen offset:0 nt lds
    v_mfma_f32_16x16x32_bf16 v[168:171], a[168:171], v[200:203], v[168:171]
    v_add_u32_e32 v228, s33, v228
    ds_read_b64_tr_b16 a[160:161], v228 offset:32768
    ds_read_b64_tr_b16 a[162:163], v228 offset:36864
    v_mfma_f32_16x16x32_bf16 v[184:187], a[168:171], v[216:219], v[184:187]
    v_exp_f32_e32 v154, v154
    v_mfma_f32_16x16x32_bf16 v[168:171], a[172:175], v[204:207], v[168:171]
    v_add_u32_e32 v229, s33, v229
    ds_read_b64_tr_b16 a[164:165], v229 offset:32768
    ds_read_b64_tr_b16 a[166:167], v229 offset:36864
    v_mfma_f32_16x16x32_bf16 v[184:187], a[172:175], v[220:223], v[184:187]
    buffer_load_dwordx4 v241, s[12:15], s30 offen offset:1024 nt lds
    s_waitcnt lgkmcnt(4)
    v_mfma_f32_16x16x32_bf16 v[172:175], a[176:179], v[192:195], 0
    v_add_u32_e32 v230, s33, v230
    ds_read_b64_tr_b16 a[168:169], v230 offset:32768
    ds_read_b64_tr_b16 a[170:171], v230 offset:36864
    v_mfma_f32_16x16x32_bf16 v[188:191], a[176:179], v[208:211], 0
    buffer_load_dwordx4 v240, s[12:15], s30 offen offset:2048 nt lds
    v_mfma_f32_16x16x32_bf16 v[172:175], a[180:183], v[196:199], v[172:175]
    v_add_u32_e32 v231, s33, v231
    ds_read_b64_tr_b16 a[172:173], v231 offset:32768
    ds_read_b64_tr_b16 a[174:175], v231 offset:36864
    v_mfma_f32_16x16x32_bf16 v[188:191], a[180:183], v[212:215], v[188:191]
    v_exp_f32_e32 v155, v155
    v_mfma_f32_16x16x32_bf16 v[172:175], a[184:187], v[200:203], v[172:175]
    v_add_u32_e32 v232, s33, v232
    ds_read_b64_tr_b16 a[176:177], v232 offset:32768
    ds_read_b64_tr_b16 a[178:179], v232 offset:36864
    v_mfma_f32_16x16x32_bf16 v[188:191], a[184:187], v[216:219], v[188:191]
    buffer_load_dwordx4 v241, s[12:15], s30 offen offset:3072 nt lds
    v_cvt_pk_bf16_f32 v152, v152, v153
    v_mfma_f32_16x16x32_bf16 v[172:175], a[188:191], v[204:207], v[172:175]
    v_add_u32_e32 v233, s33, v233
    ds_read_b64_tr_b16 a[180:181], v233 offset:32768
    ds_read_b64_tr_b16 a[182:183], v233 offset:36864
    v_mfma_f32_16x16x32_bf16 v[188:191], a[188:191], v[220:223], v[188:191]
    s_add_u32 s30, s30, 16384
    v_exp_f32_e32 v156, v156
    s_waitcnt lgkmcnt(4)
    v_mfma_f32_16x16x32_bf16 v[0:3], a[160:163], a[80:83], v[0:3]
    v_add_u32_e32 v234, s33, v234
    ds_read_b64_tr_b16 a[184:185], v234 offset:32768
    ds_read_b64_tr_b16 a[186:187], v234 offset:36864
    v_mfma_f32_16x16x32_bf16 v[32:35], a[160:163], a[84:87], v[32:35]
    v_exp_f32_e32 v157, v157
    v_mfma_f32_16x16x32_bf16 v[4:7], a[164:167], a[80:83], v[4:7]
    v_add_u32_e32 v235, s33, v235
    ds_read_b64_tr_b16 a[188:189], v235 offset:32768
    ds_read_b64_tr_b16 a[190:191], v235 offset:36864
    v_mfma_f32_16x16x32_bf16 v[36:39], a[164:167], a[84:87], v[36:39]
    v_cvt_pk_bf16_f32 v153, v154, v155
    v_exp_f32_e32 v158, v158
    v_mfma_f32_16x16x32_bf16 v[8:11], a[168:171], a[80:83], v[8:11]
    ds_read_b64_tr_b16 a[160:161], v228 offset:40960
    ds_read_b64_tr_b16 a[162:163], v228 offset:45056
    v_mfma_f32_16x16x32_bf16 v[40:43], a[168:171], a[84:87], v[40:43]
    v_exp_f32_e32 v159, v159
    v_mfma_f32_16x16x32_bf16 v[12:15], a[172:175], a[80:83], v[12:15]
    ds_read_b64_tr_b16 a[164:165], v229 offset:40960
    ds_read_b64_tr_b16 a[166:167], v229 offset:45056
    v_mfma_f32_16x16x32_bf16 v[44:47], a[172:175], a[84:87], v[44:47]
    v_cvt_pk_bf16_f32 v154, v156, v157
    v_cvt_pk_bf16_f32 v155, v158, v159
    s_waitcnt lgkmcnt(4)
    v_mfma_f32_16x16x32_bf16 v[16:19], a[176:179], a[80:83], v[16:19]
    ds_read_b64_tr_b16 a[168:169], v230 offset:40960
    ds_read_b64_tr_b16 a[170:171], v230 offset:45056
    v_mfma_f32_16x16x32_bf16 v[48:51], a[176:179], a[84:87], v[48:51]
    v_exp_f32_e32 v160, v160
    v_mfma_f32_16x16x32_bf16 v[20:23], a[180:183], a[80:83], v[20:23]
    ds_read_b64_tr_b16 a[172:173], v231 offset:40960
    ds_read_b64_tr_b16 a[174:175], v231 offset:45056
    v_mfma_f32_16x16x32_bf16 v[52:55], a[180:183], a[84:87], v[52:55]
    v_exp_f32_e32 v161, v161
    v_mfma_f32_16x16x32_bf16 v[24:27], a[184:187], a[80:83], v[24:27]
    ds_read_b64_tr_b16 a[176:177], v232 offset:40960
    ds_read_b64_tr_b16 a[178:179], v232 offset:45056
    v_mfma_f32_16x16x32_bf16 v[56:59], a[184:187], a[84:87], v[56:59]
    v_mfma_f32_16x16x32_bf16 v[250:253], v[242:245], v[152:155], v[250:253]
    v_mfma_f32_16x16x32_bf16 v[28:31], a[188:191], a[80:83], v[28:31]
    ds_read_b64_tr_b16 a[180:181], v233 offset:40960
    ds_read_b64_tr_b16 a[182:183], v233 offset:45056
    v_mfma_f32_16x16x32_bf16 v[60:63], a[188:191], a[84:87], v[60:63]
    v_exp_f32_e32 v162, v162
    s_waitcnt lgkmcnt(4)
    v_mfma_f32_16x16x32_bf16 v[0:3], a[160:163], a[88:91], v[0:3]
    ds_read_b64_tr_b16 a[184:185], v234 offset:40960
    ds_read_b64_tr_b16 a[186:187], v234 offset:45056
    v_mfma_f32_16x16x32_bf16 v[32:35], a[160:163], a[92:95], v[32:35]
    v_exp_f32_e32 v163, v163
    v_mfma_f32_16x16x32_bf16 v[4:7], a[164:167], a[88:91], v[4:7]
    ds_read_b64_tr_b16 a[188:189], v235 offset:40960
    ds_read_b64_tr_b16 a[190:191], v235 offset:45056
    v_mfma_f32_16x16x32_bf16 v[36:39], a[164:167], a[92:95], v[36:39]
    v_cvt_pk_bf16_f32 v160, v160, v161
    v_mfma_f32_16x16x32_bf16 v[8:11], a[168:171], a[88:91], v[8:11]
    ds_read_b64_tr_b16 a[160:161], v228 offset:16384
    ds_read_b64_tr_b16 a[162:163], v228 offset:20480
    v_mfma_f32_16x16x32_bf16 v[40:43], a[168:171], a[92:95], v[40:43]
    v_exp_f32_e32 v164, v164
    v_mfma_f32_16x16x32_bf16 v[12:15], a[172:175], a[88:91], v[12:15]
    ds_read_b64_tr_b16 a[164:165], v229 offset:16384
    ds_read_b64_tr_b16 a[166:167], v229 offset:20480
    v_mfma_f32_16x16x32_bf16 v[44:47], a[172:175], a[92:95], v[44:47]
    v_exp_f32_e32 v165, v165
    s_waitcnt lgkmcnt(4)
    v_mfma_f32_16x16x32_bf16 v[16:19], a[176:179], a[88:91], v[16:19]
    ds_read_b64_tr_b16 a[168:169], v230 offset:16384
    ds_read_b64_tr_b16 a[170:171], v230 offset:20480
    v_mfma_f32_16x16x32_bf16 v[48:51], a[176:179], a[92:95], v[48:51]
    v_cvt_pk_bf16_f32 v161, v162, v163
    v_exp_f32_e32 v166, v166
    v_mfma_f32_16x16x32_bf16 v[20:23], a[180:183], a[88:91], v[20:23]
    ds_read_b64_tr_b16 a[172:173], v231 offset:16384
    ds_read_b64_tr_b16 a[174:175], v231 offset:20480
    v_mfma_f32_16x16x32_bf16 v[52:55], a[180:183], a[92:95], v[52:55]
    v_exp_f32_e32 v167, v167
    v_mfma_f32_16x16x32_bf16 v[24:27], a[184:187], a[88:91], v[24:27]
    ds_read_b64_tr_b16 a[176:177], v232 offset:16384
    ds_read_b64_tr_b16 a[178:179], v232 offset:20480
    v_mfma_f32_16x16x32_bf16 v[56:59], a[184:187], a[92:95], v[56:59]
    v_cvt_pk_bf16_f32 v162, v164, v165
    v_mfma_f32_16x16x32_bf16 v[28:31], a[188:191], a[88:91], v[28:31]
    ds_read_b64_tr_b16 a[180:181], v233 offset:16384
    ds_read_b64_tr_b16 a[182:183], v233 offset:20480
    v_mfma_f32_16x16x32_bf16 v[60:63], a[188:191], a[92:95], v[60:63]
    v_cvt_pk_bf16_f32 v163, v166, v167
    s_waitcnt lgkmcnt(4)
    v_mfma_f32_16x16x32_bf16 v[64:67], a[160:163], v[128:131], v[64:67]
    ds_read_b64_tr_b16 a[184:185], v234 offset:16384
    ds_read_b64_tr_b16 a[186:187], v234 offset:20480
    v_mfma_f32_16x16x32_bf16 v[96:99], a[160:163], v[144:147], v[96:99]
    v_exp_f32_e32 v176, v176
    v_mfma_f32_16x16x32_bf16 v[68:71], a[164:167], v[128:131], v[68:71]
    ds_read_b64_tr_b16 a[188:189], v235 offset:16384
    ds_read_b64_tr_b16 a[190:191], v235 offset:20480
    v_mfma_f32_16x16x32_bf16 v[100:103], a[164:167], v[144:147], v[100:103]
    v_exp_f32_e32 v177, v177
    v_mfma_f32_16x16x32_bf16 v[72:75], a[168:171], v[128:131], v[72:75]
    ds_read_b64_tr_b16 a[160:161], v228 offset:24576
    ds_read_b64_tr_b16 a[162:163], v228 offset:28672
    v_mfma_f32_16x16x32_bf16 v[104:107], a[168:171], v[144:147], v[104:107]
    v_mfma_f32_16x16x32_bf16 v[246:249], v[242:245], v[160:163], v[246:249]
    v_mfma_f32_16x16x32_bf16 v[76:79], a[172:175], v[128:131], v[76:79]
    ds_read_b64_tr_b16 a[164:165], v229 offset:24576
    ds_read_b64_tr_b16 a[166:167], v229 offset:28672
    v_mfma_f32_16x16x32_bf16 v[108:111], a[172:175], v[144:147], v[108:111]
    v_exp_f32_e32 v178, v178
    s_waitcnt lgkmcnt(4)
    v_mfma_f32_16x16x32_bf16 v[80:83], a[176:179], v[128:131], v[80:83]
    ds_read_b64_tr_b16 a[168:169], v230 offset:24576
    ds_read_b64_tr_b16 a[170:171], v230 offset:28672
    v_mfma_f32_16x16x32_bf16 v[112:115], a[176:179], v[144:147], v[112:115]
    v_exp_f32_e32 v179, v179
    v_mfma_f32_16x16x32_bf16 v[84:87], a[180:183], v[128:131], v[84:87]
    ds_read_b64_tr_b16 a[172:173], v231 offset:24576
    ds_read_b64_tr_b16 a[174:175], v231 offset:28672
    v_mfma_f32_16x16x32_bf16 v[116:119], a[180:183], v[144:147], v[116:119]
    v_cvt_pk_bf16_f32 v176, v176, v177
    v_mfma_f32_16x16x32_bf16 v[88:91], a[184:187], v[128:131], v[88:91]
    ds_read_b64_tr_b16 a[176:177], v232 offset:24576
    ds_read_b64_tr_b16 a[178:179], v232 offset:28672
    v_mfma_f32_16x16x32_bf16 v[120:123], a[184:187], v[144:147], v[120:123]
    v_exp_f32_e32 v180, v180
    v_mfma_f32_16x16x32_bf16 v[92:95], a[188:191], v[128:131], v[92:95]
    ds_read_b64_tr_b16 a[180:181], v233 offset:24576
    ds_read_b64_tr_b16 a[182:183], v233 offset:28672
    v_mfma_f32_16x16x32_bf16 v[124:127], a[188:191], v[144:147], v[124:127]
    v_exp_f32_e32 v181, v181
    s_waitcnt lgkmcnt(4)
    v_mfma_f32_16x16x32_bf16 v[64:67], a[160:163], v[136:139], v[64:67]
    ds_read_b64_tr_b16 a[184:185], v234 offset:24576
    ds_read_b64_tr_b16 a[186:187], v234 offset:28672
    v_mfma_f32_16x16x32_bf16 v[96:99], a[160:163], v[152:155], v[96:99]
    v_cvt_pk_bf16_f32 v177, v178, v179
    v_exp_f32_e32 v182, v182
    v_mfma_f32_16x16x32_bf16 v[68:71], a[164:167], v[136:139], v[68:71]
    ds_read_b64_tr_b16 a[188:189], v235 offset:24576
    ds_read_b64_tr_b16 a[190:191], v235 offset:28672
    v_mfma_f32_16x16x32_bf16 v[100:103], a[164:167], v[152:155], v[100:103]
    v_exp_f32_e32 v183, v183
    v_mfma_f32_16x16x32_bf16 v[72:75], a[168:171], v[136:139], v[72:75]
    v_mfma_f32_16x16x32_bf16 v[104:107], a[168:171], v[152:155], v[104:107]
    v_cvt_pk_bf16_f32 v178, v180, v181
    v_mfma_f32_16x16x32_bf16 v[76:79], a[172:175], v[136:139], v[76:79]
    v_cvt_pk_bf16_f32 v179, v182, v183
    v_mfma_f32_16x16x32_bf16 v[108:111], a[172:175], v[152:155], v[108:111]
    s_waitcnt lgkmcnt(0)
    v_mfma_f32_16x16x32_bf16 v[80:83], a[176:179], v[136:139], v[80:83]
    v_exp_f32_e32 v168, v168
    v_mfma_f32_16x16x32_bf16 v[112:115], a[176:179], v[152:155], v[112:115]
    s_waitcnt vmcnt(8)
    s_barrier
    s_mov_b32 s50, s32
    s_add_u32 s34, s32, s38
    s_add_u32 s32, s32, s42
    s_cmp_eq_u32 s32, 159744
    s_cselect_b32 s33, s43, s42
    s_cselect_b32 s32, 0, s32
    s_sub_u32 s39, 159744, s32
    v_add_u32_e32 v224, s33, v224
    ds_read_b128 a[160:163], v224 offset:0
    v_add_u32_e32 v225, s33, v225
    ds_read_b128 a[164:167], v225 offset:0
    v_add_u32_e32 v226, s33, v226
    ds_read_b128 a[168:171], v226 offset:0
    v_mfma_f32_16x16x32_bf16 v[84:87], a[180:183], v[136:139], v[84:87]
    v_add_u32_e32 v227, s33, v227
    ds_read_b128 a[172:175], v227 offset:0
    v_mfma_f32_16x16x32_bf16 v[116:119], a[180:183], v[152:155], v[116:119]
    v_exp_f32_e32 v169, v169
    v_mfma_f32_16x16x32_bf16 v[88:91], a[184:187], v[136:139], v[88:91]
    ds_read_b128 a[176:179], v224 offset:4096
    v_mfma_f32_16x16x32_bf16 v[250:253], v[242:245], v[176:179], v[250:253]
    v_mfma_f32_16x16x32_bf16 v[120:123], a[184:187], v[152:155], v[120:123]
    ds_read_b128 a[180:183], v225 offset:4096
    v_mfma_f32_16x16x32_bf16 v[92:95], a[188:191], v[136:139], v[92:95]
    v_exp_f32_e32 v170, v170
    v_mfma_f32_16x16x32_bf16 v[124:127], a[188:191], v[152:155], v[124:127]
    s_waitcnt lgkmcnt(2)
    v_mfma_f32_16x16x32_bf16 v[128:131], a[160:163], v[192:195], 0
    ds_read_b128 a[184:187], v226 offset:4096
    s_add_u32 m0, s34, 0
    v_mfma_f32_16x16x32_bf16 v[144:147], a[160:163], v[208:211], 0
    v_exp_f32_e32 v171, v171
    v_mfma_f32_16x16x32_bf16 v[128:131], a[164:167], v[196:199], v[128:131]
    ds_read_b128 a[188:191], v227 offset:4096
    v_cvt_pk_bf16_f32 v168, v168, v169
    v_mfma_f32_16x16x32_bf16 v[144:147], a[164:167], v[212:215], v[144:147]
    buffer_load_dwordx4 v236, s[8:11], s29 offen offset:0 nt lds
    v_mfma_f32_16x16x32_bf16 v[128:131], a[168:171], v[200:203], v[128:131]
    ds_read_b128 a[160:163], v224 offset:8192
    v_exp_f32_e32 v172, v172
    v_mfma_f32_16x16x32_bf16 v[144:147], a[168:171], v[216:219], v[144:147]
    buffer_load_dwordx4 v237, s[8:11], s29 offen offset:1024 nt lds
    v_mfma_f32_16x16x32_bf16 v[128:131], a[172:175], v[204:207], v[128:131]
    ds_read_b128 a[164:167], v225 offset:8192
    v_exp_f32_e32 v173, v173
    v_mfma_f32_16x16x32_bf16 v[144:147], a[172:175], v[220:223], v[144:147]
    s_waitcnt lgkmcnt(2)
    v_mfma_f32_16x16x32_bf16 v[132:135], a[176:179], v[192:195], 0
    ds_read_b128 a[168:171], v226 offset:8192
    v_mfma_f32_16x16x32_bf16 v[148:151], a[176:179], v[208:211], 0
    buffer_load_dwordx4 v238, s[8:11], s29 offen offset:2048 nt lds
    v_mfma_f32_16x16x32_bf16 v[132:135], a[180:183], v[196:199], v[132:135]
    ds_read_b128 a[172:175], v227 offset:8192
    v_cvt_pk_bf16_f32 v169, v170, v171
    v_mfma_f32_16x16x32_bf16 v[148:151], a[180:183], v[212:215], v[148:151]
    buffer_load_dwordx4 v239, s[8:11], s29 offen offset:3072 nt lds
    v_mfma_f32_16x16x32_bf16 v[132:135], a[184:187], v[200:203], v[132:135]
    ds_read_b128 a[176:179], v224 offset:12288
    v_exp_f32_e32 v174, v174
    v_mfma_f32_16x16x32_bf16 v[148:151], a[184:187], v[216:219], v[148:151]
    v_exp_f32_e32 v175, v175
    v_mfma_f32_16x16x32_bf16 v[132:135], a[188:191], v[204:207], v[132:135]
    ds_read_b128 a[180:183], v225 offset:12288
    v_cvt_pk_bf16_f32 v170, v172, v173
    v_mfma_f32_16x16x32_bf16 v[148:151], a[188:191], v[220:223], v[148:151]
    s_add_u32 s29, s29, 16384
    s_waitcnt lgkmcnt(2)
    v_mfma_f32_16x16x32_bf16 v[136:139], a[160:163], v[192:195], 0
    v_cvt_pk_bf16_f32 v171, v174, v175
    ds_read_b128 a[184:187], v226 offset:12288
    v_mfma_f32_16x16x32_bf16 v[152:155], a[160:163], v[208:211], 0
    s_add_u32 m0, s34, 16384
    v_exp_f32_e32 v184, v184
    v_mfma_f32_16x16x32_bf16 v[136:139], a[164:167], v[196:199], v[136:139]
    ds_read_b128 a[188:191], v227 offset:12288
    v_exp_f32_e32 v185, v185
    v_mfma_f32_16x16x32_bf16 v[152:155], a[164:167], v[212:215], v[152:155]
    buffer_load_dwordx4 v240, s[12:15], s30 offen offset:0 nt lds
    v_mfma_f32_16x16x32_bf16 v[136:139], a[168:171], v[200:203], v[136:139]
    v_add_u32_e32 v228, s33, v228
    v_add_u32_e32 v254, s39, v228
    v_mfma_f32_16x16x32_bf16 v[152:155], a[168:171], v[216:219], v[152:155]
    ds_read_b64_tr_b16 a[160:161], v254 offset:0
    ds_read_b64_tr_b16 a[162:163], v228 offset:32768
    v_mfma_f32_16x16x32_bf16 v[246:249], v[242:245], v[168:171], v[246:249]
    v_add_u32_e32 v229, s33, v229
    v_mfma_f32_16x16x32_bf16 v[136:139], a[172:175], v[204:207], v[136:139]
    v_add_u32_e32 v254, s39, v229
    ds_read_b64_tr_b16 a[164:165], v254 offset:0
    ds_read_b64_tr_b16 a[166:167], v229 offset:32768
    v_mfma_f32_16x16x32_bf16 v[152:155], a[172:175], v[220:223], v[152:155]
    buffer_load_dwordx4 v241, s[12:15], s30 offen offset:1024 nt lds
    s_waitcnt lgkmcnt(4)
    v_mfma_f32_16x16x32_bf16 v[140:143], a[176:179], v[192:195], 0
    v_add_u32_e32 v230, s33, v230
    v_add_u32_e32 v254, s39, v230
    ds_read_b64_tr_b16 a[168:169], v254 offset:0
    ds_read_b64_tr_b16 a[170:171], v230 offset:32768
    v_mfma_f32_16x16x32_bf16 v[156:159], a[176:179], v[208:211], 0
    buffer_load_dwordx4 v240, s[12:15], s30 offen offset:2048 nt lds
    v_mfma_f32_16x16x32_bf16 v[140:143], a[180:183], v[196:199], v[140:143]
    v_add_u32_e32 v231, s33, v231
    v_add_u32_e32 v254, s39, v231
    ds_read_b64_tr_b16 a[172:173], v254 offset:0
    ds_read_b64_tr_b16 a[174:175], v231 offset:32768
    v_exp_f32_e32 v186, v186
    v_mfma_f32_16x16x32_bf16 v[156:159], a[180:183], v[212:215], v[156:159]
    v_exp_f32_e32 v187, v187
    v_mfma_f32_16x16x32_bf16 v[140:143], a[184:187], v[200:203], v[140:143]
    v_add_u32_e32 v232, s33, v232
    v_add_u32_e32 v254, s39, v232
    ds_read_b64_tr_b16 a[176:177], v254 offset:0
    ds_read_b64_tr_b16 a[178:179], v232 offset:32768
    v_mfma_f32_16x16x32_bf16 v[156:159], a[184:187], v[216:219], v[156:159]
    buffer_load_dwordx4 v241, s[12:15], s30 offen offset:3072 nt lds
    v_mfma_f32_16x16x32_bf16 v[140:143], a[188:191], v[204:207], v[140:143]
    v_add_u32_e32 v233, s33, v233
    v_add_u32_e32 v254, s39, v233
    ds_read_b64_tr_b16 a[180:181], v254 offset:0
    ds_read_b64_tr_b16 a[182:183], v233 offset:32768
    v_mfma_f32_16x16x32_bf16 v[156:159], a[188:191], v[220:223], v[156:159]
    s_add_u32 s30, s30, 16384
    v_cvt_pk_bf16_f32 v184, v184, v185
    s_waitcnt lgkmcnt(4)
    v_mfma_f32_16x16x32_bf16 v[0:3], a[160:163], a[96:99], v[0:3]
    v_add_u32_e32 v234, s33, v234
    v_add_u32_e32 v254, s39, v234
    ds_read_b64_tr_b16 a[184:185], v254 offset:0
    ds_read_b64_tr_b16 a[186:187], v234 offset:32768
    v_mfma_f32_16x16x32_bf16 v[32:35], a[160:163], a[100:103], v[32:35]
    v_exp_f32_e32 v188, v188
    v_mfma_f32_16x16x32_bf16 v[4:7], a[164:167], a[96:99], v[4:7]
    v_add_u32_e32 v235, s33, v235
    v_add_u32_e32 v254, s39, v235
    ds_read_b64_tr_b16 a[188:189], v254 offset:0
    ds_read_b64_tr_b16 a[190:191], v235 offset:32768
    v_exp_f32_e32 v189, v189
    v_mfma_f32_16x16x32_bf16 v[36:39], a[164:167], a[100:103], v[36:39]
    v_cvt_pk_bf16_f32 v185, v186, v187
    v_exp_f32_e32 v190, v190
    v_mfma_f32_16x16x32_bf16 v[8:11], a[168:171], a[96:99], v[8:11]
    ds_read_b64_tr_b16 a[160:161], v228 offset:36864
    ds_read_b64_tr_b16 a[162:163], v228 offset:40960
    v_mfma_f32_16x16x32_bf16 v[40:43], a[168:171], a[100:103], v[40:43]
    v_exp_f32_e32 v191, v191
    v_mfma_f32_16x16x32_bf16 v[12:15], a[172:175], a[96:99], v[12:15]
    ds_read_b64_tr_b16 a[164:165], v229 offset:36864
    ds_read_b64_tr_b16 a[166:167], v229 offset:40960
    v_mfma_f32_16x16x32_bf16 v[44:47], a[172:175], a[100:103], v[44:47]
    v_cvt_pk_bf16_f32 v186, v188, v189
    v_cvt_pk_bf16_f32 v187, v190, v191
    s_waitcnt lgkmcnt(4)
    v_mfma_f32_16x16x32_bf16 v[16:19], a[176:179], a[96:99], v[16:19]
    ds_read_b64_tr_b16 a[168:169], v230 offset:36864
    ds_read_b64_tr_b16 a[170:171], v230 offset:40960
    v_mfma_f32_16x16x32_bf16 v[48:51], a[176:179], a[100:103], v[48:51]
    v_exp_f32_e32 v128, v128
    v_mfma_f32_16x16x32_bf16 v[20:23], a[180:183], a[96:99], v[20:23]
    ds_read_b64_tr_b16 a[172:173], v231 offset:36864
    ds_read_b64_tr_b16 a[174:175], v231 offset:40960
    v_mfma_f32_16x16x32_bf16 v[52:55], a[180:183], a[100:103], v[52:55]
    v_exp_f32_e32 v129, v129
    v_mfma_f32_16x16x32_bf16 v[24:27], a[184:187], a[96:99], v[24:27]
    ds_read_b64_tr_b16 a[176:177], v232 offset:36864
    ds_read_b64_tr_b16 a[178:179], v232 offset:40960
    v_mfma_f32_16x16x32_bf16 v[56:59], a[184:187], a[100:103], v[56:59]
    v_mfma_f32_16x16x32_bf16 v[250:253], v[242:245], v[184:187], v[250:253]
    v_mfma_f32_16x16x32_bf16 v[28:31], a[188:191], a[96:99], v[28:31]
    ds_read_b64_tr_b16 a[180:181], v233 offset:36864
    ds_read_b64_tr_b16 a[182:183], v233 offset:40960
    v_mfma_f32_16x16x32_bf16 v[60:63], a[188:191], a[100:103], v[60:63]
    v_exp_f32_e32 v130, v130
    s_waitcnt lgkmcnt(4)
    v_mfma_f32_16x16x32_bf16 v[0:3], a[160:163], a[104:107], v[0:3]
    ds_read_b64_tr_b16 a[184:185], v234 offset:36864
    ds_read_b64_tr_b16 a[186:187], v234 offset:40960
    v_mfma_f32_16x16x32_bf16 v[32:35], a[160:163], a[108:111], v[32:35]
    v_mfma_f32_16x16x32_bf16 v[4:7], a[164:167], a[104:107], v[4:7]
    ds_read_b64_tr_b16 a[188:189], v235 offset:36864
    ds_read_b64_tr_b16 a[190:191], v235 offset:40960
    v_mfma_f32_16x16x32_bf16 v[36:39], a[164:167], a[108:111], v[36:39]
    v_exp_f32_e32 v131, v131
    v_mfma_f32_16x16x32_bf16 v[8:11], a[168:171], a[104:107], v[8:11]
    ds_read_b64_tr_b16 a[160:161], v228 offset:45056
    ds_read_b64_tr_b16 a[162:163], v228 offset:49152
    v_mfma_f32_16x16x32_bf16 v[40:43], a[168:171], a[108:111], v[40:43]
    v_cvt_pk_bf16_f32 v128, v128, v129
    v_mfma_f32_16x16x32_bf16 v[12:15], a[172:175], a[104:107], v[12:15]
    ds_read_b64_tr_b16 a[164:165], v229 offset:45056
    ds_read_b64_tr_b16 a[166:167], v229 offset:49152
    v_mfma_f32_16x16x32_bf16 v[44:47], a[172:175], a[108:111], v[44:47]
    v_exp_f32_e32 v132, v132
    s_waitcnt lgkmcnt(4)
    v_mfma_f32_16x16x32_bf16 v[16:19], a[176:179], a[104:107], v[16:19]
    ds_read_b64_tr_b16 a[168:169], v230 offset:45056
    ds_read_b64_tr_b16 a[170:171], v230 offset:49152
    v_mfma_f32_16x16x32_bf16 v[48:51], a[176:179], a[108:111], v[48:51]
    v_exp_f32_e32 v133, v133
    v_mfma_f32_16x16x32_bf16 v[20:23], a[180:183], a[104:107], v[20:23]
    ds_read_b64_tr_b16 a[172:173], v231 offset:45056
    ds_read_b64_tr_b16 a[174:175], v231 offset:49152
    v_mfma_f32_16x16x32_bf16 v[52:55], a[180:183], a[108:111], v[52:55]
    v_cvt_pk_bf16_f32 v129, v130, v131
    v_mfma_f32_16x16x32_bf16 v[24:27], a[184:187], a[104:107], v[24:27]
    ds_read_b64_tr_b16 a[176:177], v232 offset:45056
    ds_read_b64_tr_b16 a[178:179], v232 offset:49152
    v_mfma_f32_16x16x32_bf16 v[56:59], a[184:187], a[108:111], v[56:59]
    v_exp_f32_e32 v134, v134
    v_mfma_f32_16x16x32_bf16 v[28:31], a[188:191], a[104:107], v[28:31]
    ds_read_b64_tr_b16 a[180:181], v233 offset:45056
    ds_read_b64_tr_b16 a[182:183], v233 offset:49152
    v_mfma_f32_16x16x32_bf16 v[60:63], a[188:191], a[108:111], v[60:63]
    v_exp_f32_e32 v135, v135
    s_waitcnt lgkmcnt(4)
    v_mfma_f32_16x16x32_bf16 v[0:3], a[160:163], a[112:115], v[0:3]
    ds_read_b64_tr_b16 a[184:185], v234 offset:45056
    ds_read_b64_tr_b16 a[186:187], v234 offset:49152
    v_mfma_f32_16x16x32_bf16 v[32:35], a[160:163], a[116:119], v[32:35]
    v_cvt_pk_bf16_f32 v130, v132, v133
    v_mfma_f32_16x16x32_bf16 v[4:7], a[164:167], a[112:115], v[4:7]
    ds_read_b64_tr_b16 a[188:189], v235 offset:45056
    ds_read_b64_tr_b16 a[190:191], v235 offset:49152
    v_mfma_f32_16x16x32_bf16 v[36:39], a[164:167], a[116:119], v[36:39]
    v_cvt_pk_bf16_f32 v131, v134, v135
    v_mfma_f32_16x16x32_bf16 v[8:11], a[168:171], a[112:115], v[8:11]
    ds_read_b64_tr_b16 a[160:161], v228 offset:16384
    ds_read_b64_tr_b16 a[162:163], v228 offset:20480
    v_mfma_f32_16x16x32_bf16 v[40:43], a[168:171], a[116:119], v[40:43]
    v_exp_f32_e32 v144, v144
    v_mfma_f32_16x16x32_bf16 v[12:15], a[172:175], a[112:115], v[12:15]
    ds_read_b64_tr_b16 a[164:165], v229 offset:16384
    ds_read_b64_tr_b16 a[166:167], v229 offset:20480
    v_mfma_f32_16x16x32_bf16 v[44:47], a[172:175], a[116:119], v[44:47]
    v_exp_f32_e32 v145, v145
    s_waitcnt lgkmcnt(4)
    v_mfma_f32_16x16x32_bf16 v[16:19], a[176:179], a[112:115], v[16:19]
    ds_read_b64_tr_b16 a[168:169], v230 offset:16384
    ds_read_b64_tr_b16 a[170:171], v230 offset:20480
    v_mfma_f32_16x16x32_bf16 v[48:51], a[176:179], a[116:119], v[48:51]
    v_mfma_f32_16x16x32_bf16 v[246:249], v[242:245], v[128:131], v[246:249]
    v_mfma_f32_16x16x32_bf16 v[20:23], a[180:183], a[112:115], v[20:23]
    ds_read_b64_tr_b16 a[172:173], v231 offset:16384
    ds_read_b64_tr_b16 a[174:175], v231 offset:20480
    v_mfma_f32_16x16x32_bf16 v[52:55], a[180:183], a[116:119], v[52:55]
    v_exp_f32_e32 v146, v146
    v_mfma_f32_16x16x32_bf16 v[24:27], a[184:187], a[112:115], v[24:27]
    ds_read_b64_tr_b16 a[176:177], v232 offset:16384
    ds_read_b64_tr_b16 a[178:179], v232 offset:20480
    v_mfma_f32_16x16x32_bf16 v[56:59], a[184:187], a[116:119], v[56:59]
    v_mfma_f32_16x16x32_bf16 v[28:31], a[188:191], a[112:115], v[28:31]
    ds_read_b64_tr_b16 a[180:181], v233 offset:16384
    ds_read_b64_tr_b16 a[182:183], v233 offset:20480
    v_mfma_f32_16x16x32_bf16 v[60:63], a[188:191], a[116:119], v[60:63]
    v_exp_f32_e32 v147, v147
    s_waitcnt lgkmcnt(4)
    v_mfma_f32_16x16x32_bf16 v[64:67], a[160:163], v[160:163], v[64:67]
    ds_read_b64_tr_b16 a[184:185], v234 offset:16384
    ds_read_b64_tr_b16 a[186:187], v234 offset:20480
    v_mfma_f32_16x16x32_bf16 v[96:99], a[160:163], v[176:179], v[96:99]
    v_cvt_pk_bf16_f32 v144, v144, v145
    v_mfma_f32_16x16x32_bf16 v[68:71], a[164:167], v[160:163], v[68:71]
    ds_read_b64_tr_b16 a[188:189], v235 offset:16384
    ds_read_b64_tr_b16 a[190:191], v235 offset:20480
    v_mfma_f32_16x16x32_bf16 v[100:103], a[164:167], v[176:179], v[100:103]
    v_exp_f32_e32 v148, v148
    v_mfma_f32_16x16x32_bf16 v[72:75], a[168:171], v[160:163], v[72:75]
    ds_read_b64_tr_b16 a[160:161], v228 offset:24576
    ds_read_b64_tr_b16 a[162:163], v228 offset:28672
    v_mfma_f32_16x16x32_bf16 v[104:107], a[168:171], v[176:179], v[104:107]
    v_exp_f32_e32 v149, v149
    v_mfma_f32_16x16x32_bf16 v[76:79], a[172:175], v[160:163], v[76:79]
    ds_read_b64_tr_b16 a[164:165], v229 offset:24576
    ds_read_b64_tr_b16 a[166:167], v229 offset:28672
    v_mfma_f32_16x16x32_bf16 v[108:111], a[172:175], v[176:179], v[108:111]
    v_cvt_pk_bf16_f32 v145, v146, v147
    s_waitcnt lgkmcnt(4)
    v_mfma_f32_16x16x32_bf16 v[80:83], a[176:179], v[160:163], v[80:83]
    ds_read_b64_tr_b16 a[168:169], v230 offset:24576
    ds_read_b64_tr_b16 a[170:171], v230 offset:28672
    v_mfma_f32_16x16x32_bf16 v[112:115], a[176:179], v[176:179], v[112:115]
    v_exp_f32_e32 v150, v150
    v_mfma_f32_16x16x32_bf16 v[84:87], a[180:183], v[160:163], v[84:87]
    ds_read_b64_tr_b16 a[172:173], v231 offset:24576
    ds_read_b64_tr_b16 a[174:175], v231 offset:28672
    v_mfma_f32_16x16x32_bf16 v[116:119], a[180:183], v[176:179], v[116:119]
    v_exp_f32_e32 v151, v151
    v_mfma_f32_16x16x32_bf16 v[88:91], a[184:187], v[160:163], v[88:91]
    ds_read_b64_tr_b16 a[176:177], v232 offset:24576
    ds_read_b64_tr_b16 a[178:179], v232 offset:28672
    v_mfma_f32_16x16x32_bf16 v[120:123], a[184:187], v[176:179], v[120:123]
    v_cvt_pk_bf16_f32 v146, v148, v149
    v_mfma_f32_16x16x32_bf16 v[92:95], a[188:191], v[160:163], v[92:95]
    ds_read_b64_tr_b16 a[180:181], v233 offset:24576
    ds_read_b64_tr_b16 a[182:183], v233 offset:28672
    v_mfma_f32_16x16x32_bf16 v[124:127], a[188:191], v[176:179], v[124:127]
    v_cvt_pk_bf16_f32 v147, v150, v151
    s_waitcnt lgkmcnt(4)
    v_mfma_f32_16x16x32_bf16 v[64:67], a[160:163], v[168:171], v[64:67]
    ds_read_b64_tr_b16 a[184:185], v234 offset:24576
    ds_read_b64_tr_b16 a[186:187], v234 offset:28672
    v_mfma_f32_16x16x32_bf16 v[96:99], a[160:163], v[184:187], v[96:99]
    v_exp_f32_e32 v136, v136
    v_mfma_f32_16x16x32_bf16 v[68:71], a[164:167], v[168:171], v[68:71]
    ds_read_b64_tr_b16 a[188:189], v235 offset:24576
    ds_read_b64_tr_b16 a[190:191], v235 offset:28672
    v_mfma_f32_16x16x32_bf16 v[100:103], a[164:167], v[184:187], v[100:103]
    v_exp_f32_e32 v137, v137
    v_mfma_f32_16x16x32_bf16 v[72:75], a[168:171], v[168:171], v[72:75]
    v_mfma_f32_16x16x32_bf16 v[104:107], a[168:171], v[184:187], v[104:107]
    v_mfma_f32_16x16x32_bf16 v[250:253], v[242:245], v[144:147], v[250:253]
    v_mfma_f32_16x16x32_bf16 v[76:79], a[172:175], v[168:171], v[76:79]
    v_mfma_f32_16x16x32_bf16 v[108:111], a[172:175], v[184:187], v[108:111]
    v_exp_f32_e32 v138, v138
    s_waitcnt lgkmcnt(0)
    v_mfma_f32_16x16x32_bf16 v[80:83], a[176:179], v[168:171], v[80:83]
    v_mfma_f32_16x16x32_bf16 v[112:115], a[176:179], v[184:187], v[112:115]
    s_waitcnt vmcnt(8)
    s_barrier
    s_mov_b32 s50, s32
    s_add_u32 s34, s32, s38
    s_add_u32 s32, s32, s42
    s_cmp_eq_u32 s32, 159744
    s_cselect_b32 s33, s43, s42
    s_cselect_b32 s32, 0, s32
    v_add_u32_e32 v224, s33, v224
    ds_read_b128 a[160:163], v224 offset:0
    v_add_u32_e32 v225, s33, v225
    ds_read_b128 a[164:167], v225 offset:0
    v_add_u32_e32 v226, s33, v226
    ds_read_b128 a[168:171], v226 offset:0
    v_mfma_f32_16x16x32_bf16 v[84:87], a[180:183], v[168:171], v[84:87]
    v_exp_f32_e32 v139, v139
    v_mfma_f32_16x16x32_bf16 v[116:119], a[180:183], v[184:187], v[116:119]
    v_mfma_f32_16x16x32_bf16 v[88:91], a[184:187], v[168:171], v[88:91]
    v_cvt_pk_bf16_f32 v136, v136, v137
    v_mfma_f32_16x16x32_bf16 v[120:123], a[184:187], v[184:187], v[120:123]
    v_mfma_f32_16x16x32_bf16 v[92:95], a[188:191], v[168:171], v[92:95]
    v_exp_f32_e32 v140, v140
    v_mfma_f32_16x16x32_bf16 v[124:127], a[188:191], v[184:187], v[124:127]
    s_cmp_eq_u32 s35, 3
    s_cbranch_scc1 A_A_last
    s_waitcnt lgkmcnt(0)
    v_mfma_f32_16x16x32_bf16 v[160:163], a[160:163], v[192:195], 0
    v_add_u32_e32 v227, s33, v227
    ds_read_b128 a[172:175], v227 offset:0
    ds_read_b128 a[176:179], v224 offset:4096
    ds_read_b128 a[180:183], v225 offset:4096
    ds_read_b128 a[184:187], v226 offset:4096
    v_mfma_f32_16x16x32_bf16 v[176:179], a[160:163], v[208:211], 0
    s_add_u32 m0, s34, 0
    v_exp_f32_e32 v141, v141
    v_cvt_pk_bf16_f32 v137, v138, v139
    v_exp_f32_e32 v142, v142
    v_mfma_f32_16x16x32_bf16 v[160:163], a[164:167], v[196:199], v[160:163]
    ds_read_b128 a[188:191], v227 offset:4096
    v_exp_f32_e32 v143, v143
    v_cvt_pk_bf16_f32 v138, v140, v141
    v_cvt_pk_bf16_f32 v139, v142, v143
    v_mfma_f32_16x16x32_bf16 v[176:179], a[164:167], v[212:215], v[176:179]
    buffer_load_dwordx4 v236, s[8:11], s29 offen offset:0 nt lds
    v_mfma_f32_16x16x32_bf16 v[160:163], a[168:171], v[200:203], v[160:163]
    ds_read_b128 a[160:163], v224 offset:8192
    v_exp_f32_e32 v152, v152
    v_exp_f32_e32 v153, v153
    v_mfma_f32_16x16x32_bf16 v[176:179], a[168:171], v[216:219], v[176:179]
    buffer_load_dwordx4 v237, s[8:11], s29 offen offset:1024 nt lds
    s_waitcnt lgkmcnt(5)
    v_mfma_f32_16x16x32_bf16 v[160:163], a[172:175], v[204:207], v[160:163]
    ds_read_b128 a[164:167], v225 offset:8192
    v_mfma_f32_16x16x32_bf16 v[246:249], v[242:245], v[136:139], v[246:249]
    v_exp_f32_e32 v154, v154
    v_mfma_f32_16x16x32_bf16 v[176:179], a[172:175], v[220:223], v[176:179]
    v_exp_f32_e32 v155, v155
    s_waitcnt lgkmcnt(2)
    v_mfma_f32_16x16x32_bf16 v[164:167], a[176:179], v[192:195], 0
    ds_read_b128 a[168:171], v226 offset:8192
    v_mfma_f32_16x16x32_bf16 v[180:183], a[176:179], v[208:211], 0
    buffer_load_dwordx4 v238, s[8:11], s29 offen offset:2048 nt lds
    v_mfma_f32_16x16x32_bf16 v[164:167], a[180:183], v[196:199], v[164:167]
    ds_read_b128 a[172:175], v227 offset:8192
    v_cvt_pk_bf16_f32 v152, v152, v153
    v_mfma_f32_16x16x32_bf16 v[180:183], a[180:183], v[212:215], v[180:183]
    buffer_load_dwordx4 v239, s[8:11], s29 offen offset:3072 nt lds
    v_mfma_f32_16x16x32_bf16 v[164:167], a[184:187], v[200:203], v[164:167]
    ds_read_b128 a[176:179], v224 offset:12288
    v_exp_f32_e32 v156, v156
    v_mfma_f32_16x16x32_bf16 v[180:183], a[184:187], v[216:219], v[180:183]
    v_exp_f32_e32 v157, v157
    v_mfma_f32_16x16x32_bf16 v[164:167], a[188:191], v[204:207], v[164:167]
    ds_read_b128 a[180:183], v225 offset:12288
    v_cvt_pk_bf16_f32 v153, v154, v155
    v_mfma_f32_16x16x32_bf16 v[180:183], a[188:191], v[220:223], v[180:183]
    s_add_u32 s29, s29, 16384
    s_waitcnt lgkmcnt(2)
    v_mfma_f32_16x16x32_bf16 v[168:171], a[160:163], v[192:195], 0
    ds_read_b128 a[184:187], v226 offset:12288
    v_mfma_f32_16x16x32_bf16 v[184:187], a[160:163], v[208:211], 0
    s_add_u32 m0, s34, 16384
    v_mfma_f32_16x16x32_bf16 v[168:171], a[164:167], v[196:199], v[168:171]
    ds_read_b128 a[188:191], v227 offset:12288
    v_exp_f32_e32 v158, v158
    v_mfma_f32_16x16x32_bf16 v[184:187], a[164:167], v[212:215], v[184:187]
    buffer_load_dwordx4 v240, s[12:15], s30 offen offset:0 nt lds
    v_mfma_f32_16x16x32_bf16 v[168:171], a[168:171], v[200:203], v[168:171]
    v_add_u32_e32 v228, s33, v228
    ds_read_b64_tr_b16 a[160:161], v228 offset:32768
    v_mfma_f32_16x16x32_bf16 v[184:187], a[168:171], v[216:219], v[184:187]
    ds_read_b64_tr_b16 a[162:163], v228 offset:36864
    v_mfma_f32_16x16x32_bf16 v[168:171], a[172:175], v[204:207], v[168:171]
    v_add_u32_e32 v229, s33, v229
    ds_read_b64_tr_b16 a[164:165], v229 offset:32768
    ds_read_b64_tr_b16 a[166:167], v229 offset:36864
    v_mfma_f32_16x16x32_bf16 v[184:187], a[172:175], v[220:223], v[184:187]
    buffer_load_dwordx4 v241, s[12:15], s30 offen offset:1024 nt lds
    s_waitcnt lgkmcnt(4)
    v_mfma_f32_16x16x32_bf16 v[172:175], a[176:179], v[192:195], 0
    v_add_u32_e32 v230, s33, v230
    ds_read_b64_tr_b16 a[168:169], v230 offset:32768
    ds_read_b64_tr_b16 a[170:171], v230 offset:36864
    v_mfma_f32_16x16x32_bf16 v[188:191], a[176:179], v[208:211], 0
    buffer_load_dwordx4 v240, s[12:15], s30 offen offset:2048 nt lds
    v_mfma_f32_16x16x32_bf16 v[172:175], a[180:183], v[196:199], v[172:175]
    v_add_u32_e32 v231, s33, v231
    ds_read_b64_tr_b16 a[172:173], v231 offset:32768
    ds_read_b64_tr_b16 a[174:175], v231 offset:36864
    v_mfma_f32_16x16x32_bf16 v[188:191], a[180:183], v[212:215], v[188:191]
    v_exp_f32_e32 v159, v159
    v_mfma_f32_16x16x32_bf16 v[172:175], a[184:187], v[200:203], v[172:175]
    v_add_u32_e32 v232, s33, v232
    ds_read_b64_tr_b16 a[176:177], v232 offset:32768
    ds_read_b64_tr_b16 a[178:179], v232 offset:36864
    v_mfma_f32_16x16x32_bf16 v[188:191], a[184:187], v[216:219], v[188:191]
    buffer_load_dwordx4 v241, s[12:15], s30 offen offset:3072 nt lds
    v_mfma_f32_16x16x32_bf16 v[172:175], a[188:191], v[204:207], v[172:175]
    v_add_u32_e32 v233, s33, v233
    ds_read_b64_tr_b16 a[180:181], v233 offset:32768
    ds_read_b64_tr_b16 a[182:183], v233 offset:36864
    v_mfma_f32_16x16x32_bf16 v[188:191], a[188:191], v[220:223], v[188:191]
    s_add_u32 s30, s30, 16384
    s_waitcnt lgkmcnt(4)
    v_mfma_f32_16x16x32_bf16 v[0:3], a[160:163], a[120:123], v[0:3]
    v_add_u32_e32 v234, s33, v234
    ds_read_b64_tr_b16 a[184:185], v234 offset:32768
    ds_read_b64_tr_b16 a[186:187], v234 offset:36864
    v_mfma_f32_16x16x32_bf16 v[32:35], a[160:163], a[124:127], v[32:35]
    v_cvt_pk_bf16_f32 v154, v156, v157
    v_mfma_f32_16x16x32_bf16 v[4:7], a[164:167], a[120:123], v[4:7]
    v_add_u32_e32 v235, s33, v235
    ds_read_b64_tr_b16 a[188:189], v235 offset:32768
    v_mfma_f32_16x16x32_bf16 v[36:39], a[164:167], a[124:127], v[36:39]
    ds_read_b64_tr_b16 a[190:191], v235 offset:36864
    v_mfma_f32_16x16x32_bf16 v[8:11], a[168:171], a[120:123], v[8:11]
    ds_read_b64_tr_b16 a[160:161], v228 offset:40960
    ds_read_b64_tr_b16 a[162:163], v228 offset:45056
    v_mfma_f32_16x16x32_bf16 v[40:43], a[168:171], a[124:127], v[40:43]
    v_cvt_pk_bf16_f32 v155, v158, v159
    v_mfma_f32_16x16x32_bf16 v[12:15], a[172:175], a[120:123], v[12:15]
    ds_read_b64_tr_b16 a[164:165], v229 offset:40960
    ds_read_b64_tr_b16 a[166:167], v229 offset:45056
    v_mfma_f32_16x16x32_bf16 v[44:47], a[172:175], a[124:127], v[44:47]
    s_waitcnt lgkmcnt(4)
    v_mfma_f32_16x16x32_bf16 v[16:19], a[176:179], a[120:123], v[16:19]
    ds_read_b64_tr_b16 a[168:169], v230 offset:40960
    ds_read_b64_tr_b16 a[170:171], v230 offset:45056
    v_mfma_f32_16x16x32_bf16 v[48:51], a[176:179], a[124:127], v[48:51]
    v_exp_f32_e32 v160, v160
    v_mfma_f32_16x16x32_bf16 v[20:23], a[180:183], a[120:123], v[20:23]
    ds_read_b64_tr_b16 a[172:173], v231 offset:40960
    ds_read_b64_tr_b16 a[174:175], v231 offset:45056
    v_mfma_f32_16x16x32_bf16 v[52:55], a[180:183], a[124:127], v[52:55]
    v_exp_f32_e32 v161, v161
    v_mfma_f32_16x16x32_bf16 v[24:27], a[184:187], a[120:123], v[24:27]
    ds_read_b64_tr_b16 a[176:177], v232 offset:40960
    ds_read_b64_tr_b16 a[178:179], v232 offset:45056
    v_mfma_f32_16x16x32_bf16 v[56:59], a[184:187], a[124:127], v[56:59]
    v_mfma_f32_16x16x32_bf16 v[250:253], v[242:245], v[152:155], v[250:253]
    v_mfma_f32_16x16x32_bf16 v[28:31], a[188:191], a[120:123], v[28:31]
    ds_read_b64_tr_b16 a[180:181], v233 offset:40960
    ds_read_b64_tr_b16 a[182:183], v233 offset:45056
    v_mfma_f32_16x16x32_bf16 v[60:63], a[188:191], a[124:127], v[60:63]
    v_exp_f32_e32 v162, v162
    s_waitcnt lgkmcnt(4)
    v_mfma_f32_16x16x32_bf16 v[0:3], a[160:163], a[128:131], v[0:3]
    ds_read_b64_tr_b16 a[184:185], v234 offset:40960
    ds_read_b64_tr_b16 a[186:187], v234 offset:45056
    v_exp_f32_e32 v163, v163
    v_mfma_f32_16x16x32_bf16 v[32:35], a[160:163], a[132:135], v[32:35]
    v_cvt_pk_bf16_f32 v160, v160, v161
    v_exp_f32_e32 v164, v164
    v_mfma_f32_16x16x32_bf16 v[4:7], a[164:167], a[128:131], v[4:7]
    ds_read_b64_tr_b16 a[188:189], v235 offset:40960
    ds_read_b64_tr_b16 a[190:191], v235 offset:45056
    v_mfma_f32_16x16x32_bf16 v[36:39], a[164:167], a[132:135], v[36:39]
    v_exp_f32_e32 v165, v165
    v_mfma_f32_16x16x32_bf16 v[8:11], a[168:171], a[128:131], v[8:11]
    ds_read_b64_tr_b16 a[160:161], v228 offset:16384
    ds_read_b64_tr_b16 a[162:163], v228 offset:20480
    v_mfma_f32_16x16x32_bf16 v[40:43], a[168:171], a[132:135], v[40:43]
    v_cvt_pk_bf16_f32 v161, v162, v163
    v_exp_f32_e32 v166, v166
    v_mfma_f32_16x16x32_bf16 v[12:15], a[172:175], a[128:131], v[12:15]
    ds_read_b64_tr_b16 a[164:165], v229 offset:16384
    ds_read_b64_tr_b16 a[166:167], v229 offset:20480
    v_mfma_f32_16x16x32_bf16 v[44:47], a[172:175], a[132:135], v[44:47]
    v_exp_f32_e32 v167, v167
    s_waitcnt lgkmcnt(4)
    v_mfma_f32_16x16x32_bf16 v[16:19], a[176:179], a[128:131], v[16:19]
    ds_read_b64_tr_b16 a[168:169], v230 offset:16384
    ds_read_b64_tr_b16 a[170:171], v230 offset:20480
    v_mfma_f32_16x16x32_bf16 v[48:51], a[176:179], a[132:135], v[48:51]
    v_cvt_pk_bf16_f32 v162, v164, v165
    v_cvt_pk_bf16_f32 v163, v166, v167
    v_mfma_f32_16x16x32_bf16 v[20:23], a[180:183], a[128:131], v[20:23]
    ds_read_b64_tr_b16 a[172:173], v231 offset:16384
    ds_read_b64_tr_b16 a[174:175], v231 offset:20480
    v_mfma_f32_16x16x32_bf16 v[52:55], a[180:183], a[132:135], v[52:55]
    v_exp_f32_e32 v176, v176
    v_mfma_f32_16x16x32_bf16 v[24:27], a[184:187], a[128:131], v[24:27]
    ds_read_b64_tr_b16 a[176:177], v232 offset:16384
    ds_read_b64_tr_b16 a[178:179], v232 offset:20480
    v_mfma_f32_16x16x32_bf16 v[56:59], a[184:187], a[132:135], v[56:59]
    v_exp_f32_e32 v177, v177
    v_mfma_f32_16x16x32_bf16 v[246:249], v[242:245], v[160:163], v[246:249]
    v_mfma_f32_16x16x32_bf16 v[28:31], a[188:191], a[128:131], v[28:31]
    ds_read_b64_tr_b16 a[180:181], v233 offset:16384
    ds_read_b64_tr_b16 a[182:183], v233 offset:20480
    v_mfma_f32_16x16x32_bf16 v[60:63], a[188:191], a[132:135], v[60:63]
    v_exp_f32_e32 v178, v178
    s_waitcnt lgkmcnt(4)
    v_mfma_f32_16x16x32_bf16 v[64:67], a[160:163], v[128:131], v[64:67]
    ds_read_b64_tr_b16 a[184:185], v234 offset:16384
    ds_read_b64_tr_b16 a[186:187], v234 offset:20480
    v_exp_f32_e32 v179, v179
    v_mfma_f32_16x16x32_bf16 v[96:99], a[160:163], v[144:147], v[96:99]
    v_cvt_pk_bf16_f32 v176, v176, v177
    v_exp_f32_e32 v180, v180
    v_mfma_f32_16x16x32_bf16 v[68:71], a[164:167], v[128:131], v[68:71]
    ds_read_b64_tr_b16 a[188:189], v235 offset:16384
    ds_read_b64_tr_b16 a[190:191], v235 offset:20480
    v_mfma_f32_16x16x32_bf16 v[100:103], a[164:167], v[144:147], v[100:103]
    v_exp_f32_e32 v181, v181
    v_mfma_f32_16x16x32_bf16 v[72:75], a[168:171], v[128:131], v[72:75]
    ds_read_b64_tr_b16 a[160:161], v228 offset:24576
    ds_read_b64_tr_b16 a[162:163], v228 offset:28672
    v_mfma_f32_16x16x32_bf16 v[104:107], a[168:171], v[144:147], v[104:107]
    v_cvt_pk_bf16_f32 v177, v178, v179
    v_exp_f32_e32 v182, v182
    v_mfma_f32_16x16x32_bf16 v[76:79], a[172:175], v[128:131], v[76:79]
    ds_read_b64_tr_b16 a[164:165], v229 offset:24576
    ds_read_b64_tr_b16 a[166:167], v229 offset:28672
    v_mfma_f32_16x16x32_bf16 v[108:111], a[172:175], v[144:147], v[108:111]
    v_exp_f32_e32 v183, v183
    s_waitcnt lgkmcnt(4)
    v_mfma_f32_16x16x32_bf16 v[80:83], a[176:179], v[128:131], v[80:83]
    ds_read_b64_tr_b16 a[168:169], v230 offset:24576
    ds_read_b64_tr_b16 a[170:171], v230 offset:28672
    v_mfma_f32_16x16x32_bf16 v[112:115], a[176:179], v[144:147], v[112:115]
    v_cvt_pk_bf16_f32 v178, v180, v181
    v_cvt_pk_bf16_f32 v179, v182, v183
    v_mfma_f32_16x16x32_bf16 v[84:87], a[180:183], v[128:131], v[84:87]
    ds_read_b64_tr_b16 a[172:173], v231 offset:24576
    ds_read_b64_tr_b16 a[174:175], v231 offset:28672
    v_mfma_f32_16x16x32_bf16 v[116:119], a[180:183], v[144:147], v[116:119]
    v_exp_f32_e32 v168, v168
    v_mfma_f32_16x16x32_bf16 v[88:91], a[184:187], v[128:131], v[88:91]
    ds_read_b64_tr_b16 a[176:177], v232 offset:24576
    ds_read_b64_tr_b16 a[178:179], v232 offset:28672
    v_mfma_f32_16x16x32_bf16 v[120:123], a[184:187], v[144:147], v[120:123]
    v_exp_f32_e32 v169, v169
    v_mfma_f32_16x16x32_bf16 v[250:253], v[242:245], v[176:179], v[250:253]
    v_mfma_f32_16x16x32_bf16 v[92:95], a[188:191], v[128:131], v[92:95]
    ds_read_b64_tr_b16 a[180:181], v233 offset:24576
    ds_read_b64_tr_b16 a[182:183], v233 offset:28672
    v_mfma_f32_16x16x32_bf16 v[124:127], a[188:191], v[144:147], v[124:127]
    v_exp_f32_e32 v170, v170
    s_waitcnt lgkmcnt(4)
    v_mfma_f32_16x16x32_bf16 v[64:67], a[160:163], v[136:139], v[64:67]
    ds_read_b64_tr_b16 a[184:185], v234 offset:24576
    ds_read_b64_tr_b16 a[186:187], v234 offset:28672
    v_mfma_f32_16x16x32_bf16 v[96:99], a[160:163], v[152:155], v[96:99]
    v_exp_f32_e32 v171, v171
    v_mfma_f32_16x16x32_bf16 v[68:71], a[164:167], v[136:139], v[68:71]
    ds_read_b64_tr_b16 a[188:189], v235 offset:24576
    ds_read_b64_tr_b16 a[190:191], v235 offset:28672
    v_cvt_pk_bf16_f32 v168, v168, v169
    v_mfma_f32_16x16x32_bf16 v[100:103], a[164:167], v[152:155], v[100:103]
    v_exp_f32_e32 v172, v172
    v_mfma_f32_16x16x32_bf16 v[72:75], a[168:171], v[136:139], v[72:75]
    v_exp_f32_e32 v173, v173
    v_mfma_f32_16x16x32_bf16 v[104:107], a[168:171], v[152:155], v[104:107]
    v_cvt_pk_bf16_f32 v169, v170, v171
    v_exp_f32_e32 v174, v174
    v_mfma_f32_16x16x32_bf16 v[76:79], a[172:175], v[136:139], v[76:79]
    v_exp_f32_e32 v175, v175
    v_mfma_f32_16x16x32_bf16 v[108:111], a[172:175], v[152:155], v[108:111]
    v_cvt_pk_bf16_f32 v170, v172, v173
    v_cvt_pk_bf16_f32 v171, v174, v175
    s_waitcnt lgkmcnt(0)
    v_mfma_f32_16x16x32_bf16 v[80:83], a[176:179], v[136:139], v[80:83]
    v_exp_f32_e32 v184, v184
    v_mfma_f32_16x16x32_bf16 v[112:115], a[176:179], v[152:155], v[112:115]
    s_waitcnt vmcnt(8)
    s_barrier
    s_mov_b32 s50, s32
    s_add_u32 s34, s32, s38
    s_add_u32 s32, s32, s42
    s_cmp_eq_u32 s32, 159744
    s_cselect_b32 s33, s43, s42
    s_cselect_b32 s32, 0, s32
    s_sub_u32 s39, 159744, s32
    v_add_u32_e32 v228, s33, v228
    v_add_u32_e32 v254, s39, v228
    ds_read_b64_tr_b16 a[160:161], v254 offset:0
    ds_read_b64_tr_b16 a[162:163], v228 offset:32768
    ds_read_b64_tr_b16 a[164:165], v228 offset:36864
    ds_read_b64_tr_b16 a[166:167], v228 offset:40960
    ds_read_b64_tr_b16 a[168:169], v228 offset:45056
    ds_read_b64_tr_b16 a[170:171], v228 offset:49152
    v_mfma_f32_16x16x32_bf16 v[84:87], a[180:183], v[136:139], v[84:87]
    v_add_u32_e32 v229, s33, v229
    v_add_u32_e32 v254, s39, v229
    ds_read_b64_tr_b16 a[172:173], v254 offset:0
    ds_read_b64_tr_b16 a[174:175], v229 offset:32768
    v_mfma_f32_16x16x32_bf16 v[116:119], a[180:183], v[152:155], v[116:119]
    v_exp_f32_e32 v185, v185
    v_mfma_f32_16x16x32_bf16 v[88:91], a[184:187], v[136:139], v[88:91]
    ds_read_b64_tr_b16 a[176:177], v229 offset:36864
    ds_read_b64_tr_b16 a[178:179], v229 offset:40960
    v_mfma_f32_16x16x32_bf16 v[120:123], a[184:187], v[152:155], v[120:123]
    v_mfma_f32_16x16x32_bf16 v[246:249], v[242:245], v[168:171], v[246:249]
    v_mfma_f32_16x16x32_bf16 v[92:95], a[188:191], v[136:139], v[92:95]
    ds_read_b64_tr_b16 a[180:181], v229 offset:45056
    ds_read_b64_tr_b16 a[182:183], v229 offset:49152
    v_mfma_f32_16x16x32_bf16 v[124:127], a[188:191], v[152:155], v[124:127]
    v_exp_f32_e32 v186, v186
    s_waitcnt lgkmcnt(4)
    v_mfma_f32_16x16x32_bf16 v[0:3], a[160:163], a[136:139], v[0:3]
    v_add_u32_e32 v230, s33, v230
    v_add_u32_e32 v254, s39, v230
    ds_read_b64_tr_b16 a[184:185], v254 offset:0
    ds_read_b64_tr_b16 a[186:187], v230 offset:32768
    v_mfma_f32_16x16x32_bf16 v[32:35], a[160:163], a[140:143], v[32:35]
    s_add_u32 m0, s34, 0
    v_exp_f32_e32 v187, v187
    v_mfma_f32_16x16x32_bf16 v[0:3], a[164:167], a[144:147], v[0:3]
    ds_read_b64_tr_b16 a[188:189], v230 offset:36864
    ds_read_b64_tr_b16 a[190:191], v230 offset:40960
    v_cvt_pk_bf16_f32 v184, v184, v185
    v_mfma_f32_16x16x32_bf16 v[32:35], a[164:167], a[148:151], v[32:35]
    buffer_load_dwordx4 v236, s[8:11], s29 offen offset:0 nt lds
    v_mfma_f32_16x16x32_bf16 v[0:3], a[168:171], a[152:155], v[0:3]
    ds_read_b64_tr_b16 a[160:161], v230 offset:45056
    ds_read_b64_tr_b16 a[162:163], v230 offset:49152
    v_exp_f32_e32 v188, v188
    v_exp_f32_e32 v189, v189
    v_mfma_f32_16x16x32_bf16 v[32:35], a[168:171], a[156:159], v[32:35]
    buffer_load_dwordx4 v237, s[8:11], s29 offen offset:1024 nt lds
    v_mfma_f32_16x16x32_bf16 v[4:7], a[172:175], a[136:139], v[4:7]
    v_add_u32_e32 v231, s33, v231
    v_add_u32_e32 v254, s39, v231
    ds_read_b64_tr_b16 a[164:165], v254 offset:0
    ds_read_b64_tr_b16 a[166:167], v231 offset:32768
    v_cvt_pk_bf16_f32 v185, v186, v187
    v_mfma_f32_16x16x32_bf16 v[36:39], a[172:175], a[140:143], v[36:39]
    v_exp_f32_e32 v190, v190
    s_waitcnt lgkmcnt(4)
    v_mfma_f32_16x16x32_bf16 v[4:7], a[176:179], a[144:147], v[4:7]
    ds_read_b64_tr_b16 a[168:169], v231 offset:36864
    ds_read_b64_tr_b16 a[170:171], v231 offset:40960
    v_exp_f32_e32 v191, v191
    v_mfma_f32_16x16x32_bf16 v[36:39], a[176:179], a[148:151], v[36:39]
    buffer_load_dwordx4 v238, s[8:11], s29 offen offset:2048 nt lds
    v_mfma_f32_16x16x32_bf16 v[4:7], a[180:183], a[152:155], v[4:7]
    ds_read_b64_tr_b16 a[172:173], v231 offset:45056
    ds_read_b64_tr_b16 a[174:175], v231 offset:49152
    v_mfma_f32_16x16x32_bf16 v[36:39], a[180:183], a[156:159], v[36:39]
    buffer_load_dwordx4 v239, s[8:11], s29 offen offset:3072 nt lds
    v_mfma_f32_16x16x32_bf16 v[8:11], a[184:187], a[136:139], v[8:11]
    v_add_u32_e32 v232, s33, v232
    v_add_u32_e32 v254, s39, v232
    ds_read_b64_tr_b16 a[176:177], v254 offset:0
    ds_read_b64_tr_b16 a[178:179], v232 offset:32768
    v_mfma_f32_16x16x32_bf16 v[40:43], a[184:187], a[140:143], v[40:43]
    v_cvt_pk_bf16_f32 v186, v188, v189
    v_cvt_pk_bf16_f32 v187, v190, v191
    s_nop 1
    v_mfma_f32_16x16x32_bf16 v[250:253], v[242:245], v[184:187], v[250:253]
    v_mfma_f32_16x16x32_bf16 v[8:11], a[188:191], a[144:147], v[8:11]
    ds_read_b64_tr_b16 a[180:181], v232 offset:36864
    ds_read_b64_tr_b16 a[182:183], v232 offset:40960
    v_mfma_f32_16x16x32_bf16 v[40:43], a[188:191], a[148:151], v[40:43]
    s_add_u32 s29, s29, 16384
    s_mov_b64 s[44:45], -1
    v_cmp_le_f32_e32 vcc, 0x33800000, v246
    s_nop 0
    s_and_b64 s[44:45], s[44:45], vcc
    v_cmp_ge_f32_e32 vcc, 0x4b800000, v246
    s_nop 0
    s_and_b64 s[44:45], s[44:45], vcc
    v_cmp_le_f32_e32 vcc, 0x33800000, v250
    s_nop 0
    s_and_b64 s[44:45], s[44:45], vcc
    v_cmp_ge_f32_e32 vcc, 0x4b800000, v250
    s_nop 0
    s_and_b64 s[44:45], s[44:45], vcc
    s_cmp_eq_u64 s[44:45], -1
    s_cbranch_scc1 A_A_fast_ok0
    s_mov_b32 s87, 0
    s_branch A_A_slow
A_A_slow_ret0:
A_A_fast_ok0:
    v_rcp_f32_e32 v246, v246
    v_rcp_f32_e32 v250, v250
    s_waitcnt lgkmcnt(4)
    v_mfma_f32_16x16x32_bf16 v[8:11], a[160:163], a[152:155], v[8:11]
    ds_read_b64_tr_b16 a[184:185], v232 offset:45056
    ds_read_b64_tr_b16 a[186:187], v232 offset:49152
    v_mfma_f32_16x16x32_bf16 v[40:43], a[160:163], a[156:159], v[40:43]
    s_add_u32 m0, s34, 16384
    v_mul_f32_e32 v0, s41, v0
    v_mfma_f32_16x16x32_bf16 v[12:15], a[164:167], a[136:139], v[12:15]
    v_add_u32_e32 v233, s33, v233
    v_add_u32_e32 v254, s39, v233
    ds_read_b64_tr_b16 a[188:189], v254 offset:0
    ds_read_b64_tr_b16 a[190:191], v233 offset:32768
    v_mul_f32_e32 v1, s41, v1
    v_mul_f32_e32 v2, s41, v2
    v_mfma_f32_16x16x32_bf16 v[44:47], a[164:167], a[140:143], v[44:47]
    buffer_load_dwordx4 v240, s[12:15], s30 offen offset:0 nt lds
    v_mul_f32_e32 v3, s41, v3
    v_mfma_f32_16x16x32_bf16 v[12:15], a[168:171], a[144:147], v[12:15]
    ds_read_b64_tr_b16 a[160:161], v233 offset:36864
    ds_read_b64_tr_b16 a[162:163], v233 offset:40960
    v_mul_f32_e32 v4, s41, v4
    v_mul_f32_e32 v5, s41, v5
    v_mul_f32_e32 v6, s41, v6
    v_mul_f32_e32 v7, s41, v7
    v_mfma_f32_16x16x32_bf16 v[44:47], a[168:171], a[148:151], v[44:47]
    v_mul_f32_e32 v32, s41, v32
    v_mul_f32_e32 v33, s41, v33
    v_mul_f32_e32 v34, s41, v34
    v_mfma_f32_16x16x32_bf16 v[12:15], a[172:175], a[152:155], v[12:15]
    ds_read_b64_tr_b16 a[164:165], v233 offset:45056
    ds_read_b64_tr_b16 a[166:167], v233 offset:49152
    v_mul_f32_e32 v35, s41, v35
    v_mul_f32_e32 v36, s41, v36
    v_mul_f32_e32 v37, s41, v37
    v_mfma_f32_16x16x32_bf16 v[44:47], a[172:175], a[156:159], v[44:47]
    buffer_load_dwordx4 v241, s[12:15], s30 offen offset:1024 nt lds
    v_mul_f32_e32 v38, s41, v38
    s_waitcnt lgkmcnt(4)
    v_mfma_f32_16x16x32_bf16 v[16:19], a[176:179], a[136:139], v[16:19]
    v_add_u32_e32 v234, s33, v234
    v_add_u32_e32 v254, s39, v234
    ds_read_b64_tr_b16 a[168:169], v254 offset:0
    ds_read_b64_tr_b16 a[170:171], v234 offset:32768
    v_mul_f32_e32 v39, s41, v39
    v_mfma_f32_16x16x32_bf16 v[48:51], a[176:179], a[140:143], v[48:51]
    buffer_load_dwordx4 v240, s[12:15], s30 offen offset:2048 nt lds
    v_cvt_pk_bf16_f32 v192, v0, v1
    v_mfma_f32_16x16x32_bf16 v[16:19], a[180:183], a[144:147], v[16:19]
    ds_read_b64_tr_b16 a[172:173], v234 offset:36864
    ds_read_b64_tr_b16 a[174:175], v234 offset:40960
    v_cvt_pk_bf16_f32 v193, v2, v3
    v_cvt_pk_bf16_f32 v194, v4, v5
    v_cvt_pk_bf16_f32 v195, v6, v7
    v_cvt_pk_bf16_f32 v208, v32, v33
    v_mfma_f32_16x16x32_bf16 v[48:51], a[180:183], a[148:151], v[48:51]
    v_cvt_pk_bf16_f32 v209, v34, v35
    v_cvt_pk_bf16_f32 v210, v36, v37
    v_cvt_pk_bf16_f32 v211, v38, v39
    v_permlane32_swap_b32_e32 v192, v194
    v_permlane32_swap_b32_e32 v193, v195
    v_mfma_f32_16x16x32_bf16 v[16:19], a[184:187], a[152:155], v[16:19]
    ds_read_b64_tr_b16 a[176:177], v234 offset:45056
    ds_read_b64_tr_b16 a[178:179], v234 offset:49152
    v_permlane32_swap_b32_e32 v208, v210
    v_permlane32_swap_b32_e32 v209, v211
    v_mfma_f32_16x16x32_bf16 v[48:51], a[184:187], a[156:159], v[48:51]
    buffer_load_dwordx4 v241, s[12:15], s30 offen offset:3072 nt lds
    v_permlane16_swap_b32_e32 v192, v194
    v_mfma_f32_16x16x32_bf16 v[20:23], a[188:191], a[136:139], v[20:23]
    v_add_u32_e32 v235, s33, v235
    v_add_u32_e32 v254, s39, v235
    ds_read_b64_tr_b16 a[180:181], v254 offset:0
    ds_read_b64_tr_b16 a[182:183], v235 offset:32768
    v_permlane16_swap_b32_e32 v193, v195
    v_permlane16_swap_b32_e32 v208, v210
    v_mfma_f32_16x16x32_bf16 v[52:55], a[188:191], a[140:143], v[52:55]
    s_add_u32 s30, s30, 16384
    v_permlane16_swap_b32_e32 v209, v211
    v_mul_f32_e32 v8, s41, v8
    v_mul_f32_e32 v9, s41, v9
    v_mul_f32_e32 v10, s41, v10
    v_mul_f32_e32 v11, s41, v11
    s_waitcnt lgkmcnt(4)
    v_mfma_f32_16x16x32_bf16 v[20:23], a[160:163], a[144:147], v[20:23]
    ds_read_b64_tr_b16 a[184:185], v235 offset:36864
    ds_read_b64_tr_b16 a[186:187], v235 offset:40960
    v_mul_f32_e32 v12, s41, v12
    v_mul_f32_e32 v13, s41, v13
    v_mfma_f32_16x16x32_bf16 v[52:55], a[160:163], a[148:151], v[52:55]
    v_mul_f32_e32 v14, s41, v14
    v_mul_f32_e32 v15, s41, v15
    v_mul_f32_e32 v40, s41, v40
    v_mfma_f32_16x16x32_bf16 v[20:23], a[164:167], a[152:155], v[20:23]
    ds_read_b64_tr_b16 a[188:189], v235 offset:45056
    ds_read_b64_tr_b16 a[190:191], v235 offset:49152
    v_mul_f32_e32 v41, s41, v41
    v_mul_f32_e32 v42, s41, v42
    v_mfma_f32_16x16x32_bf16 v[52:55], a[164:167], a[156:159], v[52:55]
    v_mul_f32_e32 v43, s41, v43
    v_mul_f32_e32 v44, s41, v44
    v_mul_f32_e32 v45, s41, v45
    v_mfma_f32_16x16x32_bf16 v[24:27], a[168:171], a[136:139], v[24:27]
    ds_read_b64_tr_b16 a[160:161], v228 offset:16384
    ds_read_b64_tr_b16 a[162:163], v228 offset:20480
    v_mul_f32_e32 v46, s41, v46
    v_mul_f32_e32 v47, s41, v47
    v_mfma_f32_16x16x32_bf16 v[56:59], a[168:171], a[140:143], v[56:59]
    v_cvt_pk_bf16_f32 v196, v8, v9
    v_cvt_pk_bf16_f32 v197, v10, v11
    v_cvt_pk_bf16_f32 v198, v12, v13
    v_mfma_f32_16x16x32_bf16 v[24:27], a[172:175], a[144:147], v[24:27]
    ds_read_b64_tr_b16 a[164:165], v228 offset:24576
    ds_read_b64_tr_b16 a[166:167], v228 offset:28672
    v_cvt_pk_bf16_f32 v199, v14, v15
    v_cvt_pk_bf16_f32 v212, v40, v41
    v_mfma_f32_16x16x32_bf16 v[56:59], a[172:175], a[148:151], v[56:59]
    v_cvt_pk_bf16_f32 v213, v42, v43
    v_cvt_pk_bf16_f32 v214, v44, v45
    v_cvt_pk_bf16_f32 v215, v46, v47
    s_waitcnt lgkmcnt(4)
    v_mfma_f32_16x16x32_bf16 v[24:27], a[176:179], a[152:155], v[24:27]
    ds_read_b64_tr_b16 a[168:169], v229 offset:16384
    ds_read_b64_tr_b16 a[170:171], v229 offset:20480
    v_permlane32_swap_b32_e32 v196, v198
    v_permlane32_swap_b32_e32 v197, v199
    v_mfma_f32_16x16x32_bf16 v[56:59], a[176:179], a[156:159], v[56:59]
    v_permlane32_swap_b32_e32 v212, v214
    v_permlane32_swap_b32_e32 v213, v215
    v_mfma_f32_16x16x32_bf16 v[28:31], a[180:183], a[136:139], v[28:31]
    ds_read_b64_tr_b16 a[172:173], v229 offset:24576
    ds_read_b64_tr_b16 a[174:175], v229 offset:28672
    v_permlane16_swap_b32_e32 v196, v198
    v_permlane16_swap_b32_e32 v197, v199
    v_permlane16_swap_b32_e32 v212, v214
    v_mfma_f32_16x16x32_bf16 v[60:63], a[180:183], a[140:143], v[60:63]
    v_permlane16_swap_b32_e32 v213, v215
    v_mul_f32_e32 v16, s41, v16
    v_mfma_f32_16x16x32_bf16 v[28:31], a[184:187], a[144:147], v[28:31]
    ds_read_b64_tr_b16 a[176:177], v230 offset:16384
    ds_read_b64_tr_b16 a[178:179], v230 offset:20480
    v_mul_f32_e32 v17, s41, v17
    v_mul_f32_e32 v18, s41, v18
    v_mul_f32_e32 v19, s41, v19
    v_mfma_f32_16x16x32_bf16 v[60:63], a[184:187], a[148:151], v[60:63]
    v_mul_f32_e32 v20, s41, v20
    v_mul_f32_e32 v21, s41, v21
    v_mfma_f32_16x16x32_bf16 v[28:31], a[188:191], a[152:155], v[28:31]
    ds_read_b64_tr_b16 a[180:181], v230 offset:24576
    ds_read_b64_tr_b16 a[182:183], v230 offset:28672
    v_mul_f32_e32 v22, s41, v22
    v_mul_f32_e32 v23, s41, v23
    v_mul_f32_e32 v48, s41, v48
    v_mfma_f32_16x16x32_bf16 v[60:63], a[188:191], a[156:159], v[60:63]
    v_mul_f32_e32 v49, s41, v49
    v_mul_f32_e32 v50, s41, v50
    s_waitcnt lgkmcnt(4)
    v_mfma_f32_16x16x32_bf16 v[64:67], a[160:163], v[160:163], v[64:67]
    ds_read_b64_tr_b16 a[184:185], v231 offset:16384
    ds_read_b64_tr_b16 a[186:187], v231 offset:20480
    v_mul_f32_e32 v51, s41, v51
    v_mul_f32_e32 v52, s41, v52
    v_mul_f32_e32 v53, s41, v53
    v_mfma_f32_16x16x32_bf16 v[96:99], a[160:163], v[176:179], v[96:99]
    v_mul_f32_e32 v54, s41, v54
    v_mul_f32_e32 v55, s41, v55
    v_mfma_f32_16x16x32_bf16 v[64:67], a[164:167], v[168:171], v[64:67]
    ds_read_b64_tr_b16 a[188:189], v231 offset:24576
    ds_read_b64_tr_b16 a[190:191], v231 offset:28672
    v_cvt_pk_bf16_f32 v200, v16, v17
    v_cvt_pk_bf16_f32 v201, v18, v19
    v_cvt_pk_bf16_f32 v202, v20, v21
    v_mfma_f32_16x16x32_bf16 v[96:99], a[164:167], v[184:187], v[96:99]
    v_cvt_pk_bf16_f32 v203, v22, v23
    v_cvt_pk_bf16_f32 v216, v48, v49
    v_mfma_f32_16x16x32_bf16 v[68:71], a[168:171], v[160:163], v[68:71]
    ds_read_b64_tr_b16 a[160:161], v232 offset:16384
    ds_read_b64_tr_b16 a[162:163], v232 offset:20480
    v_cvt_pk_bf16_f32 v217, v50, v51
    v_cvt_pk_bf16_f32 v218, v52, v53
    v_cvt_pk_bf16_f32 v219, v54, v55
    v_mfma_f32_16x16x32_bf16 v[100:103], a[168:171], v[176:179], v[100:103]
    v_permlane32_swap_b32_e32 v200, v202
    v_permlane32_swap_b32_e32 v201, v203
    v_mfma_f32_16x16x32_bf16 v[68:71], a[172:175], v[168:171], v[68:71]
    ds_read_b64_tr_b16 a[164:165], v232 offset:24576
    ds_read_b64_tr_b16 a[166:167], v232 offset:28672
    v_permlane32_swap_b32_e32 v216, v218
    v_permlane32_swap_b32_e32 v217, v219
    v_mfma_f32_16x16x32_bf16 v[100:103], a[172:175], v[184:187], v[100:103]
    v_permlane16_swap_b32_e32 v200, v202
    v_permlane16_swap_b32_e32 v201, v203
    v_permlane16_swap_b32_e32 v216, v218
    s_waitcnt lgkmcnt(4)
    v_mfma_f32_16x16x32_bf16 v[72:75], a[176:179], v[160:163], v[72:75]
    ds_read_b64_tr_b16 a[168:169], v233 offset:16384
    ds_read_b64_tr_b16 a[170:171], v233 offset:20480
    v_permlane16_swap_b32_e32 v217, v219
    v_mul_f32_e32 v24, s41, v24
    v_mfma_f32_16x16x32_bf16 v[104:107], a[176:179], v[176:179], v[104:107]
    v_mul_f32_e32 v25, s41, v25
    v_mul_f32_e32 v26, s41, v26
    v_mul_f32_e32 v27, s41, v27
    v_mfma_f32_16x16x32_bf16 v[72:75], a[180:183], v[168:171], v[72:75]
    ds_read_b64_tr_b16 a[172:173], v233 offset:24576
    ds_read_b64_tr_b16 a[174:175], v233 offset:28672
    v_mul_f32_e32 v28, s41, v28
    v_mul_f32_e32 v29, s41, v29
    v_mfma_f32_16x16x32_bf16 v[104:107], a[180:183], v[184:187], v[104:107]
    v_mul_f32_e32 v30, s41, v30
    v_mul_f32_e32 v31, s41, v31
    v_mul_f32_e32 v56, s41, v56
    v_mfma_f32_16x16x32_bf16 v[76:79], a[184:187], v[160:163], v[76:79]
    ds_read_b64_tr_b16 a[176:177], v234 offset:16384
    ds_read_b64_tr_b16 a[178:179], v234 offset:20480
    v_mul_f32_e32 v57, s41, v57
    v_mul_f32_e32 v58, s41, v58
    v_mfma_f32_16x16x32_bf16 v[108:111], a[184:187], v[176:179], v[108:111]
    v_mul_f32_e32 v59, s41, v59
    v_mul_f32_e32 v60, s41, v60
    v_mul_f32_e32 v61, s41, v61
    v_mfma_f32_16x16x32_bf16 v[76:79], a[188:191], v[168:171], v[76:79]
    ds_read_b64_tr_b16 a[180:181], v234 offset:24576
    ds_read_b64_tr_b16 a[182:183], v234 offset:28672
    v_mul_f32_e32 v62, s41, v62
    v_mul_f32_e32 v63, s41, v63
    v_mfma_f32_16x16x32_bf16 v[108:111], a[188:191], v[184:187], v[108:111]
    v_cvt_pk_bf16_f32 v204, v24, v25
    v_cvt_pk_bf16_f32 v205, v26, v27
    v_cvt_pk_bf16_f32 v206, v28, v29
    s_waitcnt lgkmcnt(4)
    v_mfma_f32_16x16x32_bf16 v[80:83], a[160:163], v[160:163], v[80:83]
    ds_read_b64_tr_b16 a[184:185], v235 offset:16384
    ds_read_b64_tr_b16 a[186:187], v235 offset:20480
    v_cvt_pk_bf16_f32 v207, v30, v31
    v_cvt_pk_bf16_f32 v220, v56, v57
    v_mfma_f32_16x16x32_bf16 v[112:115], a[160:163], v[176:179], v[112:115]
    v_cvt_pk_bf16_f32 v221, v58, v59
    v_cvt_pk_bf16_f32 v222, v60, v61
    v_cvt_pk_bf16_f32 v223, v62, v63
    v_mfma_f32_16x16x32_bf16 v[80:83], a[164:167], v[168:171], v[80:83]
    ds_read_b64_tr_b16 a[188:189], v235 offset:24576
    ds_read_b64_tr_b16 a[190:191], v235 offset:28672
    v_permlane32_swap_b32_e32 v204, v206
    v_permlane32_swap_b32_e32 v205, v207
    v_mfma_f32_16x16x32_bf16 v[112:115], a[164:167], v[184:187], v[112:115]
    v_permlane32_swap_b32_e32 v220, v222
    v_permlane32_swap_b32_e32 v221, v223
    v_mfma_f32_16x16x32_bf16 v[84:87], a[168:171], v[160:163], v[84:87]
    v_add_u32_e32 v224, s33, v224
    ds_read_b128 a[160:163], v224 offset:0
    v_mfma_f32_16x16x32_bf16 v[116:119], a[168:171], v[176:179], v[116:119]
    v_permlane16_swap_b32_e32 v204, v206
    v_permlane16_swap_b32_e32 v205, v207
    v_mfma_f32_16x16x32_bf16 v[84:87], a[172:175], v[168:171], v[84:87]
    v_add_u32_e32 v225, s33, v225
    ds_read_b128 a[164:167], v225 offset:0
    v_mfma_f32_16x16x32_bf16 v[116:119], a[172:175], v[184:187], v[116:119]
    v_permlane16_swap_b32_e32 v220, v222
    v_permlane16_swap_b32_e32 v221, v223
    v_mul_f32_e32 v64, v246, v64
    v_mul_f32_e32 v65, v246, v65
    v_mul_f32_e32 v66, v246, v66
    v_mul_f32_e32 v67, v246, v67
    s_waitcnt lgkmcnt(2)
    v_mfma_f32_16x16x32_bf16 v[88:91], a[176:179], v[160:163], v[88:91]
    v_add_u32_e32 v226, s33, v226
    ds_read_b128 a[168:171], v226 offset:0
    v_mul_f32_e32 v68, v246, v68
    v_mul_f32_e32 v69, v246, v69
    v_mul_f32_e32 v70, v246, v70
    v_mfma_f32_16x16x32_bf16 v[120:123], a[176:179], v[176:179], v[120:123]
    v_mul_f32_e32 v71, v246, v71
    v_cvt_pk_bf16_f32 v64, v64, v65
    v_cvt_pk_bf16_f32 v65, v66, v67
    v_cvt_pk_bf16_f32 v66, v68, v69
    v_cvt_pk_bf16_f32 v67, v70, v71
    v_mul_f32_e32 v96, v250, v96
    v_mfma_f32_16x16x32_bf16 v[88:91], a[180:183], v[168:171], v[88:91]
    v_add_u32_e32 v227, s33, v227
    ds_read_b128 a[172:175], v227 offset:0
    v_mul_f32_e32 v97, v250, v97
    v_mul_f32_e32 v98, v250, v98
    v_mul_f32_e32 v99, v250, v99
    v_mul_f32_e32 v100, v250, v100
    v_mfma_f32_16x16x32_bf16 v[120:123], a[180:183], v[184:187], v[120:123]
    v_mul_f32_e32 v101, v250, v101
    v_mul_f32_e32 v102, v250, v102
    v_mul_f32_e32 v103, v250, v103
    v_cvt_pk_bf16_f32 v96, v96, v97
    v_cvt_pk_bf16_f32 v97, v98, v99
    v_mfma_f32_16x16x32_bf16 v[92:95], a[184:187], v[160:163], v[92:95]
    ds_read_b128 a[176:179], v224 offset:4096
    v_cvt_pk_bf16_f32 v98, v100, v101
    v_cvt_pk_bf16_f32 v99, v102, v103
    v_permlane16_swap_b32_e32 v64, v96
    v_mfma_f32_16x16x32_bf16 v[124:127], a[184:187], v[176:179], v[124:127]
    v_permlane16_swap_b32_e32 v65, v97
    v_permlane16_swap_b32_e32 v66, v98
    v_permlane16_swap_b32_e32 v67, v99
    v_mfma_f32_16x16x32_bf16 v[92:95], a[188:191], v[168:171], v[92:95]
    ds_read_b128 a[180:183], v225 offset:4096
    v_permlane32_swap_b32_e32 v64, v96
    v_permlane32_swap_b32_e32 v65, v97
    v_permlane32_swap_b32_e32 v66, v98
    v_permlane32_swap_b32_e32 v67, v99
    v_mfma_f32_16x16x32_bf16 v[124:127], a[188:191], v[184:187], v[124:127]
    v_mul_f32_e32 v72, v246, v72
    v_mul_f32_e32 v73, v246, v73
    v_mul_f32_e32 v74, v246, v74
    s_waitcnt lgkmcnt(2)
    v_mfma_f32_16x16x32_bf16 v[128:131], a[160:163], v[192:195], 0
    ds_read_b128 a[184:187], v226 offset:4096
    v_mul_f32_e32 v75, v246, v75
    v_mul_f32_e32 v76, v246, v76
    v_mul_f32_e32 v77, v246, v77
    v_mfma_f32_16x16x32_bf16 v[144:147], a[160:163], v[208:211], 0
    v_mul_f32_e32 v78, v246, v78
    v_mul_f32_e32 v79, v246, v79
    v_cvt_pk_bf16_f32 v72, v72, v73
    v_mfma_f32_16x16x32_bf16 v[128:131], a[164:167], v[196:199], v[128:131]
    ds_read_b128 a[188:191], v227 offset:4096
    v_cvt_pk_bf16_f32 v73, v74, v75
    v_cvt_pk_bf16_f32 v74, v76, v77
    v_cvt_pk_bf16_f32 v75, v78, v79
    v_mfma_f32_16x16x32_bf16 v[144:147], a[164:167], v[212:215], v[144:147]
    v_mul_f32_e32 v104, v250, v104
    v_mul_f32_e32 v105, v250, v105
    v_mul_f32_e32 v106, v250, v106
    v_mul_f32_e32 v107, v250, v107
    v_mfma_f32_16x16x32_bf16 v[128:131], a[168:171], v[200:203], v[128:131]
    ds_read_b128 a[160:163], v224 offset:8192
    v_mul_f32_e32 v108, v250, v108
    v_mul_f32_e32 v109, v250, v109
    v_mul_f32_e32 v110, v250, v110
    v_mfma_f32_16x16x32_bf16 v[144:147], a[168:171], v[216:219], v[144:147]
    v_mul_f32_e32 v111, v250, v111
    v_cvt_pk_bf16_f32 v104, v104, v105
    v_cvt_pk_bf16_f32 v105, v106, v107
    v_mfma_f32_16x16x32_bf16 v[128:131], a[172:175], v[204:207], v[128:131]
    ds_read_b128 a[164:167], v225 offset:8192
    v_cvt_pk_bf16_f32 v106, v108, v109
    v_cvt_pk_bf16_f32 v107, v110, v111
    v_permlane16_swap_b32_e32 v72, v104
    v_mfma_f32_16x16x32_bf16 v[144:147], a[172:175], v[220:223], v[144:147]
    v_permlane16_swap_b32_e32 v73, v105
    v_permlane16_swap_b32_e32 v74, v106
    v_permlane16_swap_b32_e32 v75, v107
    s_waitcnt lgkmcnt(2)
    v_mfma_f32_16x16x32_bf16 v[132:135], a[176:179], v[192:195], 0
    ds_read_b128 a[168:171], v226 offset:8192
    v_permlane32_swap_b32_e32 v72, v104
    v_permlane32_swap_b32_e32 v73, v105
    v_permlane32_swap_b32_e32 v74, v106
    v_permlane32_swap_b32_e32 v75, v107
    v_mfma_f32_16x16x32_bf16 v[148:151], a[176:179], v[208:211], 0
    v_mul_f32_e32 v80, v246, v80
    v_mul_f32_e32 v81, v246, v81
    v_mul_f32_e32 v82, v246, v82
    v_mfma_f32_16x16x32_bf16 v[132:135], a[180:183], v[196:199], v[132:135]
    ds_read_b128 a[172:175], v227 offset:8192
    v_mul_f32_e32 v83, v246, v83
    v_mul_f32_e32 v84, v246, v84
    v_mul_f32_e32 v85, v246, v85
    v_mfma_f32_16x16x32_bf16 v[148:151], a[180:183], v[212:215], v[148:151]
    v_mul_f32_e32 v86, v246, v86
    v_mul_f32_e32 v87, v246, v87
    v_cvt_pk_bf16_f32 v80, v80, v81
    v_mfma_f32_16x16x32_bf16 v[132:135], a[184:187], v[200:203], v[132:135]
    ds_read_b128 a[176:179], v224 offset:12288
    v_cvt_pk_bf16_f32 v81, v82, v83
    v_cvt_pk_bf16_f32 v82, v84, v85
    v_cvt_pk_bf16_f32 v83, v86, v87
    v_mfma_f32_16x16x32_bf16 v[148:151], a[184:187], v[216:219], v[148:151]
    v_mul_f32_e32 v112, v250, v112
    v_mul_f32_e32 v113, v250, v113
    v_mul_f32_e32 v114, v250, v114
    v_mul_f32_e32 v115, v250, v115
    v_mfma_f32_16x16x32_bf16 v[132:135], a[188:191], v[204:207], v[132:135]
    ds_read_b128 a[180:183], v225 offset:12288
    v_mul_f32_e32 v116, v250, v116
    v_mul_f32_e32 v117, v250, v117
    v_mul_f32_e32 v118, v250, v118
    v_mfma_f32_16x16x32_bf16 v[148:151], a[188:191], v[220:223], v[148:151]
    v_mul_f32_e32 v119, v250, v119
    v_cvt_pk_bf16_f32 v112, v112, v113
    v_cvt_pk_bf16_f32 v113, v114, v115
    s_waitcnt lgkmcnt(2)
    v_mfma_f32_16x16x32_bf16 v[136:139], a[160:163], v[192:195], 0
    ds_read_b128 a[184:187], v226 offset:12288
    v_cvt_pk_bf16_f32 v114, v116, v117
    v_cvt_pk_bf16_f32 v115, v118, v119
    v_permlane16_swap_b32_e32 v80, v112
    v_mfma_f32_16x16x32_bf16 v[152:155], a[160:163], v[208:211], 0
    v_permlane16_swap_b32_e32 v81, v113
    v_permlane16_swap_b32_e32 v82, v114
    v_permlane16_swap_b32_e32 v83, v115
    v_mfma_f32_16x16x32_bf16 v[136:139], a[164:167], v[196:199], v[136:139]
    ds_read_b128 a[188:191], v227 offset:12288
    v_permlane32_swap_b32_e32 v80, v112
    v_permlane32_swap_b32_e32 v81, v113
    v_permlane32_swap_b32_e32 v82, v114
    v_permlane32_swap_b32_e32 v83, v115
    v_mfma_f32_16x16x32_bf16 v[152:155], a[164:167], v[212:215], v[152:155]
    v_mul_f32_e32 v88, v246, v88
    v_mul_f32_e32 v89, v246, v89
    v_mul_f32_e32 v90, v246, v90
    v_mfma_f32_16x16x32_bf16 v[136:139], a[168:171], v[200:203], v[136:139]
    v_mul_f32_e32 v91, v246, v91
    v_mul_f32_e32 v92, v246, v92
    v_mul_f32_e32 v93, v246, v93
    v_mfma_f32_16x16x32_bf16 v[152:155], a[168:171], v[216:219], v[152:155]
    v_mul_f32_e32 v94, v246, v94
    v_mul_f32_e32 v95, v246, v95
    v_cvt_pk_bf16_f32 v88, v88, v89
    v_mfma_f32_16x16x32_bf16 v[136:139], a[172:175], v[204:207], v[136:139]
    v_cvt_pk_bf16_f32 v89, v90, v91
    v_cvt_pk_bf16_f32 v90, v92, v93
    v_cvt_pk_bf16_f32 v91, v94, v95
    v_mfma_f32_16x16x32_bf16 v[152:155], a[172:175], v[220:223], v[152:155]
    v_mul_f32_e32 v120, v250, v120
    v_mul_f32_e32 v121, v250, v121
    v_mul_f32_e32 v122, v250, v122
    v_mul_f32_e32 v123, v250, v123
    s_waitcnt lgkmcnt(0)
    v_mfma_f32_16x16x32_bf16 v[140:143], a[176:179], v[192:195], 0
    v_mul_f32_e32 v124, v250, v124
    v_mul_f32_e32 v125, v250, v125
    v_mul_f32_e32 v126, v250, v126
    v_mfma_f32_16x16x32_bf16 v[156:159], a[176:179], v[208:211], 0
    s_waitcnt vmcnt(8)
    s_barrier
    s_mov_b32 s50, s32
    s_add_u32 s34, s32, s38
    s_add_u32 s32, s32, s42
    s_cmp_eq_u32 s32, 159744
    s_cselect_b32 s33, s43, s42
    s_cselect_b32 s32, 0, s32
    v_add_u32_e32 v224, s33, v224
    ds_read_b128 a[160:163], v224 offset:0
    v_add_u32_e32 v225, s33, v225
    ds_read_b128 a[164:167], v225 offset:0
    v_add_u32_e32 v226, s33, v226
    ds_read_b128 a[168:171], v226 offset:0
    v_mfma_f32_16x16x32_bf16 v[140:143], a[180:183], v[196:199], v[140:143]
    v_mul_f32_e32 v127, v250, v127
    v_cvt_pk_bf16_f32 v120, v120, v121
    v_cvt_pk_bf16_f32 v121, v122, v123
    v_cvt_pk_bf16_f32 v122, v124, v125
    v_cvt_pk_bf16_f32 v123, v126, v127
    v_permlane16_swap_b32_e32 v88, v120
    v_mfma_f32_16x16x32_bf16 v[156:159], a[180:183], v[212:215], v[156:159]
    v_permlane16_swap_b32_e32 v89, v121
    v_permlane16_swap_b32_e32 v90, v122
    v_permlane16_swap_b32_e32 v91, v123
    v_mfma_f32_16x16x32_bf16 v[140:143], a[184:187], v[200:203], v[140:143]
    v_permlane32_swap_b32_e32 v88, v120
    v_permlane32_swap_b32_e32 v89, v121
    v_mfma_f32_16x16x32_bf16 v[156:159], a[184:187], v[216:219], v[156:159]
    v_permlane32_swap_b32_e32 v90, v122
    v_mfma_f32_16x16x32_bf16 v[140:143], a[188:191], v[204:207], v[140:143]
    v_permlane32_swap_b32_e32 v91, v123
    s_cmp_eq_u32 s35, 0
    v_mfma_f32_16x16x32_bf16 v[156:159], a[188:191], v[220:223], v[156:159]
    s_cbranch_scc1 A_A_st0
    s_cmp_eq_u32 s35, 1
    s_cbranch_scc1 A_A_st1
    v_accvgpr_write_b32 a0, v64
    v_accvgpr_write_b32 a1, v65
    v_accvgpr_write_b32 a2, v96
    v_accvgpr_write_b32 a3, v97
    v_accvgpr_write_b32 a4, v66
    v_accvgpr_write_b32 a5, v67
    v_accvgpr_write_b32 a6, v98
    v_accvgpr_write_b32 a7, v99
    v_accvgpr_write_b32 a8, v72
    v_accvgpr_write_b32 a9, v73
    v_accvgpr_write_b32 a10, v104
    v_accvgpr_write_b32 a11, v105
    v_accvgpr_write_b32 a12, v74
    v_accvgpr_write_b32 a13, v75
    v_accvgpr_write_b32 a14, v106
    v_accvgpr_write_b32 a15, v107
    v_accvgpr_write_b32 a16, v80
    v_accvgpr_write_b32 a17, v81
    v_accvgpr_write_b32 a18, v112
    v_accvgpr_write_b32 a19, v113
    v_accvgpr_write_b32 a20, v82
    v_accvgpr_write_b32 a21, v83
    v_accvgpr_write_b32 a22, v114
    v_accvgpr_write_b32 a23, v115
    v_accvgpr_write_b32 a24, v88
    v_accvgpr_write_b32 a25, v89
    v_accvgpr_write_b32 a26, v120
    v_accvgpr_write_b32 a27, v121
    v_accvgpr_write_b32 a28, v90
    v_accvgpr_write_b32 a29, v91
    v_accvgpr_write_b32 a30, v122
    v_accvgpr_write_b32 a31, v123
    s_branch A_A_st_done
A_A_st0:
    v_accvgpr_write_b32 a192, v64
    v_accvgpr_write_b32 a193, v65
    v_accvgpr_write_b32 a194, v96
    v_accvgpr_write_b32 a195, v97
    v_accvgpr_write_b32 a196, v66
    v_accvgpr_write_b32 a197, v67
    v_accvgpr_write_b32 a198, v98
    v_accvgpr_write_b32 a199, v99
    v_accvgpr_write_b32 a200, v72
    v_accvgpr_write_b32 a201, v73
    v_accvgpr_write_b32 a202, v104
    v_accvgpr_write_b32 a203, v105
    v_accvgpr_write_b32 a204, v74
    v_accvgpr_write_b32 a205, v75
    v_accvgpr_write_b32 a206, v106
    v_accvgpr_write_b32 a207, v107
    v_accvgpr_write_b32 a208, v80
    v_accvgpr_write_b32 a209, v81
    v_accvgpr_write_b32 a210, v112
    v_accvgpr_write_b32 a211, v113
    v_accvgpr_write_b32 a212, v82
    v_accvgpr_write_b32 a213, v83
    v_accvgpr_write_b32 a214, v114
    v_accvgpr_write_b32 a215, v115
    v_accvgpr_write_b32 a216, v88
    v_accvgpr_write_b32 a217, v89
    v_accvgpr_write_b32 a218, v120
    v_accvgpr_write_b32 a219, v121
    v_accvgpr_write_b32 a220, v90
    v_accvgpr_write_b32 a221, v91
    v_accvgpr_write_b32 a222, v122
    v_accvgpr_write_b32 a223, v123
    s_branch A_A_st_done
A_A_st1:
    v_accvgpr_write_b32 a224, v64
    v_accvgpr_write_b32 a225, v65
    v_accvgpr_write_b32 a226, v96
    v_accvgpr_write_b32 a227, v97
    v_accvgpr_write_b32 a228, v66
    v_accvgpr_write_b32 a229, v67
    v_accvgpr_write_b32 a230, v98
    v_accvgpr_write_b32 a231, v99
    v_accvgpr_write_b32 a232, v72
    v_accvgpr_write_b32 a233, v73
    v_accvgpr_write_b32 a234, v104
    v_accvgpr_write_b32 a235, v105
    v_accvgpr_write_b32 a236, v74
    v_accvgpr_write_b32 a237, v75
    v_accvgpr_write_b32 a238, v106
    v_accvgpr_write_b32 a239, v107
    v_accvgpr_write_b32 a240, v80
    v_accvgpr_write_b32 a241, v81
    v_accvgpr_write_b32 a242, v112
    v_accvgpr_write_b32 a243, v113
    v_accvgpr_write_b32 a244, v82
    v_accvgpr_write_b32 a245, v83
    v_accvgpr_write_b32 a246, v114
    v_accvgpr_write_b32 a247, v115
    v_accvgpr_write_b32 a248, v88
    v_accvgpr_write_b32 a249, v89
    v_accvgpr_write_b32 a250, v120
    v_accvgpr_write_b32 a251, v121
    v_accvgpr_write_b32 a252, v90
    v_accvgpr_write_b32 a253, v91
    v_accvgpr_write_b32 a254, v122
    v_accvgpr_write_b32 a255, v123
A_A_st_done:
    s_add_u32 s35, s35, 1
    s_branch A_A_head
A_A_last:
    s_waitcnt lgkmcnt(0)
    v_mfma_f32_16x16x32_bf16 v[160:163], a[160:163], v[192:195], 0
    v_add_u32_e32 v227, s33, v227
    ds_read_b128 a[172:175], v227 offset:0
    ds_read_b128 a[176:179], v224 offset:4096
    ds_read_b128 a[180:183], v225 offset:4096
    ds_read_b128 a[184:187], v226 offset:4096
    v_mfma_f32_16x16x32_bf16 v[176:179], a[160:163], v[208:211], 0
    v_mbcnt_lo_u32_b32 v0, -1, 0
    v_mbcnt_hi_u32_b32 v0, -1, v0
    v_and_b32_e32 v3, 15, v0
    v_lshrrev_b32_e32 v4, 4, v0
    s_mul_i32 s38, s28, 4096
    s_mul_i32 s7, s28, 20480
    v_mul_u32_u24_e32 v11, 1280, v4
    v_lshlrev_b32_e32 v5, 1, v4
    v_add_u32_e32 v5, 0, v5
    v_lshlrev_b32_e32 v5, 1, v5
    v_xor_b32_e32 v5, v5, v3
    v_lshlrev_b32_e32 v12, 4, v5
    v_add3_u32 v12, v12, v11, s7
    v_add_u32_e32 v236, 0, v12
    v_lshlrev_b32_e32 v5, 1, v4
    v_add_u32_e32 v5, 1, v5
    v_lshlrev_b32_e32 v5, 1, v5
    v_xor_b32_e32 v5, v5, v3
    v_lshlrev_b32_e32 v12, 4, v5
    v_add3_u32 v12, v12, v11, s7
    v_add_u32_e32 v237, 4096, v12
    v_lshlrev_b32_e32 v5, 1, v4
    v_add_u32_e32 v5, 0, v5
    v_lshlrev_b32_e32 v5, 1, v5
    v_xor_b32_e32 v5, v5, v3
    v_lshlrev_b32_e32 v12, 4, v5
    v_add3_u32 v12, v12, v11, s7
    v_add_u32_e32 v238, 8192, v12
    v_lshlrev_b32_e32 v5, 1, v4
    v_add_u32_e32 v5, 1, v5
    v_lshlrev_b32_e32 v5, 1, v5
    v_xor_b32_e32 v5, v5, v3
    v_lshlrev_b32_e32 v12, 4, v5
    v_add3_u32 v12, v12, v11, s7
    v_add_u32_e32 v239, 12288, v12
    s_mov_b32 s16, s82
    s_mov_b32 s17, s83
    s_mov_b32 s18, 655360
    s_mov_b32 s19, 0x20000
    s_mov_b32 s47, 0
    s_add_u32 s34, s38, 32768
    v_mfma_f32_16x16x32_bf16 v[160:163], a[164:167], v[196:199], v[160:163]
    ds_read_b128 a[188:191], v227 offset:4096
    v_exp_f32_e32 v141, v141
    v_cvt_pk_bf16_f32 v137, v138, v139
    v_exp_f32_e32 v142, v142
    v_mfma_f32_16x16x32_bf16 v[176:179], a[164:167], v[212:215], v[176:179]
    s_add_u32 m0, s34, 0
    v_exp_f32_e32 v143, v143
    v_cvt_pk_bf16_f32 v138, v140, v141
    v_cvt_pk_bf16_f32 v139, v142, v143
    v_mfma_f32_16x16x32_bf16 v[160:163], a[168:171], v[200:203], v[160:163]
    ds_read_b128 a[160:163], v224 offset:8192
    v_exp_f32_e32 v152, v152
    v_mfma_f32_16x16x32_bf16 v[176:179], a[168:171], v[216:219], v[176:179]
    v_exp_f32_e32 v153, v153
    v_mfma_f32_16x16x32_bf16 v[246:249], v[242:245], v[136:139], v[246:249]
    v_exp_f32_e32 v154, v154
    v_exp_f32_e32 v155, v155
    s_waitcnt lgkmcnt(5)
    v_mfma_f32_16x16x32_bf16 v[160:163], a[172:175], v[204:207], v[160:163]
    ds_read_b128 a[164:167], v225 offset:8192
    v_cvt_pk_bf16_f32 v152, v152, v153
    v_exp_f32_e32 v156, v156
    v_mfma_f32_16x16x32_bf16 v[176:179], a[172:175], v[220:223], v[176:179]
    s_add_u32 s37, s47, 0
    s_waitcnt lgkmcnt(2)
    v_mfma_f32_16x16x32_bf16 v[164:167], a[176:179], v[192:195], 0
    v_exp_f32_e32 v157, v157
    ds_read_b128 a[168:171], v226 offset:8192
    v_mfma_f32_16x16x32_bf16 v[180:183], a[176:179], v[208:211], 0
    v_cvt_pk_bf16_f32 v153, v154, v155
    v_mfma_f32_16x16x32_bf16 v[164:167], a[180:183], v[196:199], v[164:167]
    v_exp_f32_e32 v158, v158
    ds_read_b128 a[172:175], v227 offset:8192
    v_mfma_f32_16x16x32_bf16 v[180:183], a[180:183], v[212:215], v[180:183]
    buffer_load_dwordx4 v236, s[16:19], s37 offen offset:0  lds
    v_mfma_f32_16x16x32_bf16 v[164:167], a[184:187], v[200:203], v[164:167]
    ds_read_b128 a[176:179], v224 offset:12288
    v_mfma_f32_16x16x32_bf16 v[180:183], a[184:187], v[216:219], v[180:183]
    v_mfma_f32_16x16x32_bf16 v[164:167], a[188:191], v[204:207], v[164:167]
    ds_read_b128 a[180:183], v225 offset:12288
    v_mfma_f32_16x16x32_bf16 v[180:183], a[188:191], v[220:223], v[180:183]
    buffer_load_dwordx4 v237, s[16:19], s37 offen offset:1024  lds
    s_waitcnt lgkmcnt(2)
    v_mfma_f32_16x16x32_bf16 v[168:171], a[160:163], v[192:195], 0
    ds_read_b128 a[184:187], v226 offset:12288
    v_mfma_f32_16x16x32_bf16 v[184:187], a[160:163], v[208:211], 0
    buffer_load_dwordx4 v238, s[16:19], s37 offen offset:2048  lds
    v_mfma_f32_16x16x32_bf16 v[168:171], a[164:167], v[196:199], v[168:171]
    ds_read_b128 a[188:191], v227 offset:12288
    v_exp_f32_e32 v159, v159
    v_mfma_f32_16x16x32_bf16 v[184:187], a[164:167], v[212:215], v[184:187]
    v_add_u32_e32 v228, s33, v228
    v_mfma_f32_16x16x32_bf16 v[168:171], a[168:171], v[200:203], v[168:171]
    ds_read_b64_tr_b16 a[160:161], v228 offset:16384
    ds_read_b64_tr_b16 a[162:163], v228 offset:20480
    v_mfma_f32_16x16x32_bf16 v[184:187], a[168:171], v[216:219], v[184:187]
    buffer_load_dwordx4 v239, s[16:19], s37 offen offset:3072  lds
    v_mfma_f32_16x16x32_bf16 v[168:171], a[172:175], v[204:207], v[168:171]
    v_add_u32_e32 v229, s33, v229
    ds_read_b64_tr_b16 a[164:165], v229 offset:16384
    ds_read_b64_tr_b16 a[166:167], v229 offset:20480
    v_mfma_f32_16x16x32_bf16 v[184:187], a[172:175], v[220:223], v[184:187]
    v_cvt_pk_bf16_f32 v154, v156, v157
    s_waitcnt lgkmcnt(4)
    v_mfma_f32_16x16x32_bf16 v[172:175], a[176:179], v[192:195], 0
    v_add_u32_e32 v230, s33, v230
    ds_read_b64_tr_b16 a[168:169], v230 offset:16384
    ds_read_b64_tr_b16 a[170:171], v230 offset:20480
    v_mfma_f32_16x16x32_bf16 v[188:191], a[176:179], v[208:211], 0
    s_add_u32 s47, s47, 163840
    v_cvt_pk_bf16_f32 v155, v158, v159
    v_mfma_f32_16x16x32_bf16 v[172:175], a[180:183], v[196:199], v[172:175]
    v_add_u32_e32 v231, s33, v231
    ds_read_b64_tr_b16 a[172:173], v231 offset:16384
    v_mfma_f32_16x16x32_bf16 v[188:191], a[180:183], v[212:215], v[188:191]
    ds_read_b64_tr_b16 a[174:175], v231 offset:20480
    v_mfma_f32_16x16x32_bf16 v[172:175], a[184:187], v[200:203], v[172:175]
    v_add_u32_e32 v232, s33, v232
    ds_read_b64_tr_b16 a[176:177], v232 offset:16384
    ds_read_b64_tr_b16 a[178:179], v232 offset:20480
    v_mfma_f32_16x16x32_bf16 v[188:191], a[184:187], v[216:219], v[188:191]
    s_add_u32 s34, s38, 65536
    v_exp_f32_e32 v160, v160
    v_mfma_f32_16x16x32_bf16 v[172:175], a[188:191], v[204:207], v[172:175]
    v_add_u32_e32 v233, s33, v233
    ds_read_b64_tr_b16 a[180:181], v233 offset:16384
    ds_read_b64_tr_b16 a[182:183], v233 offset:20480
    v_mfma_f32_16x16x32_bf16 v[188:191], a[188:191], v[220:223], v[188:191]
    v_exp_f32_e32 v161, v161
    s_add_u32 m0, s34, 0
    v_mfma_f32_16x16x32_bf16 v[250:253], v[242:245], v[152:155], v[250:253]
    v_exp_f32_e32 v162, v162
    s_waitcnt lgkmcnt(4)
    v_mfma_f32_16x16x32_bf16 v[64:67], a[160:163], v[128:131], v[64:67]
    v_add_u32_e32 v234, s33, v234
    ds_read_b64_tr_b16 a[184:185], v234 offset:16384
    ds_read_b64_tr_b16 a[186:187], v234 offset:20480
    v_exp_f32_e32 v163, v163
    v_mfma_f32_16x16x32_bf16 v[96:99], a[160:163], v[144:147], v[96:99]
    v_cvt_pk_bf16_f32 v160, v160, v161
    v_exp_f32_e32 v164, v164
    v_mfma_f32_16x16x32_bf16 v[68:71], a[164:167], v[128:131], v[68:71]
    v_add_u32_e32 v235, s33, v235
    ds_read_b64_tr_b16 a[188:189], v235 offset:16384
    ds_read_b64_tr_b16 a[190:191], v235 offset:20480
    v_exp_f32_e32 v165, v165
    v_cvt_pk_bf16_f32 v161, v162, v163
    v_mfma_f32_16x16x32_bf16 v[100:103], a[164:167], v[144:147], v[100:103]
    s_add_u32 s37, s47, 0
    v_exp_f32_e32 v166, v166
    v_exp_f32_e32 v167, v167
    v_mfma_f32_16x16x32_bf16 v[72:75], a[168:171], v[128:131], v[72:75]
    ds_read_b64_tr_b16 a[160:161], v228 offset:24576
    ds_read_b64_tr_b16 a[162:163], v228 offset:28672
    v_cvt_pk_bf16_f32 v162, v164, v165
    v_cvt_pk_bf16_f32 v163, v166, v167
    v_mfma_f32_16x16x32_bf16 v[104:107], a[168:171], v[144:147], v[104:107]
    v_exp_f32_e32 v176, v176
    v_exp_f32_e32 v177, v177
    v_mfma_f32_16x16x32_bf16 v[76:79], a[172:175], v[128:131], v[76:79]
    ds_read_b64_tr_b16 a[164:165], v229 offset:24576
    ds_read_b64_tr_b16 a[166:167], v229 offset:28672
    v_mfma_f32_16x16x32_bf16 v[246:249], v[242:245], v[160:163], v[246:249]
    v_mfma_f32_16x16x32_bf16 v[108:111], a[172:175], v[144:147], v[108:111]
    buffer_load_dwordx4 v236, s[16:19], s37 offen offset:0  lds
    s_waitcnt lgkmcnt(4)
    v_mfma_f32_16x16x32_bf16 v[80:83], a[176:179], v[128:131], v[80:83]
    ds_read_b64_tr_b16 a[168:169], v230 offset:24576
    ds_read_b64_tr_b16 a[170:171], v230 offset:28672
    v_exp_f32_e32 v178, v178
    v_mfma_f32_16x16x32_bf16 v[112:115], a[176:179], v[144:147], v[112:115]
    v_exp_f32_e32 v179, v179
    v_cvt_pk_bf16_f32 v176, v176, v177
    v_exp_f32_e32 v180, v180
    v_mfma_f32_16x16x32_bf16 v[84:87], a[180:183], v[128:131], v[84:87]
    ds_read_b64_tr_b16 a[172:173], v231 offset:24576
    ds_read_b64_tr_b16 a[174:175], v231 offset:28672
    v_exp_f32_e32 v181, v181
    v_cvt_pk_bf16_f32 v177, v178, v179
    v_mfma_f32_16x16x32_bf16 v[116:119], a[180:183], v[144:147], v[116:119]
    buffer_load_dwordx4 v237, s[16:19], s37 offen offset:1024  lds
    v_mfma_f32_16x16x32_bf16 v[88:91], a[184:187], v[128:131], v[88:91]
    ds_read_b64_tr_b16 a[176:177], v232 offset:24576
    ds_read_b64_tr_b16 a[178:179], v232 offset:28672
    v_exp_f32_e32 v182, v182
    v_exp_f32_e32 v183, v183
    v_mfma_f32_16x16x32_bf16 v[120:123], a[184:187], v[144:147], v[120:123]
    buffer_load_dwordx4 v238, s[16:19], s37 offen offset:2048  lds
    v_cvt_pk_bf16_f32 v178, v180, v181
    v_mfma_f32_16x16x32_bf16 v[92:95], a[188:191], v[128:131], v[92:95]
    ds_read_b64_tr_b16 a[180:181], v233 offset:24576
    ds_read_b64_tr_b16 a[182:183], v233 offset:28672
    v_cvt_pk_bf16_f32 v179, v182, v183
    v_exp_f32_e32 v168, v168
    v_mfma_f32_16x16x32_bf16 v[124:127], a[188:191], v[144:147], v[124:127]
    v_exp_f32_e32 v169, v169
    v_mfma_f32_16x16x32_bf16 v[250:253], v[242:245], v[176:179], v[250:253]
    v_exp_f32_e32 v170, v170
    s_waitcnt lgkmcnt(4)
    v_mfma_f32_16x16x32_bf16 v[64:67], a[160:163], v[136:139], v[64:67]
    ds_read_b64_tr_b16 a[184:185], v234 offset:24576
    ds_read_b64_tr_b16 a[186:187], v234 offset:28672
    v_exp_f32_e32 v171, v171
    v_cvt_pk_bf16_f32 v168, v168, v169
    v_mfma_f32_16x16x32_bf16 v[96:99], a[160:163], v[152:155], v[96:99]
    buffer_load_dwordx4 v239, s[16:19], s37 offen offset:3072  lds
    v_mfma_f32_16x16x32_bf16 v[68:71], a[164:167], v[136:139], v[68:71]
    ds_read_b64_tr_b16 a[188:189], v235 offset:24576
    ds_read_b64_tr_b16 a[190:191], v235 offset:28672
    v_exp_f32_e32 v172, v172
    v_exp_f32_e32 v173, v173
    v_mfma_f32_16x16x32_bf16 v[100:103], a[164:167], v[152:155], v[100:103]
    v_cvt_pk_bf16_f32 v169, v170, v171
    v_exp_f32_e32 v174, v174
    v_exp_f32_e32 v175, v175
    v_mfma_f32_16x16x32_bf16 v[72:75], a[168:171], v[136:139], v[72:75]
    v_cvt_pk_bf16_f32 v170, v172, v173
    v_cvt_pk_bf16_f32 v171, v174, v175
    v_exp_f32_e32 v184, v184
    v_mfma_f32_16x16x32_bf16 v[104:107], a[168:171], v[152:155], v[104:107]
    s_add_u32 s47, s47, 163840
    v_mfma_f32_16x16x32_bf16 v[76:79], a[172:175], v[136:139], v[76:79]
    v_exp_f32_e32 v185, v185
    v_mfma_f32_16x16x32_bf16 v[246:249], v[242:245], v[168:171], v[246:249]
    v_exp_f32_e32 v186, v186
    v_mfma_f32_16x16x32_bf16 v[108:111], a[172:175], v[152:155], v[108:111]
    v_exp_f32_e32 v187, v187
    s_waitcnt lgkmcnt(0)
    v_mfma_f32_16x16x32_bf16 v[80:83], a[176:179], v[136:139], v[80:83]
    v_cvt_pk_bf16_f32 v184, v184, v185
    v_exp_f32_e32 v188, v188
    v_mfma_f32_16x16x32_bf16 v[112:115], a[176:179], v[152:155], v[112:115]
    s_waitcnt vmcnt(8)
    s_barrier
    s_mov_b32 s50, s32
    s_add_u32 s34, s32, s38
    s_add_u32 s32, s32, s42
    s_cmp_eq_u32 s32, 159744
    s_cselect_b32 s33, s43, s42
    s_cselect_b32 s32, 0, s32
    v_add_u32_e32 v228, s33, v228
    ds_read_b64_tr_b16 a[160:161], v228 offset:16384
    ds_read_b64_tr_b16 a[162:163], v228 offset:20480
    ds_read_b64_tr_b16 a[164:165], v228 offset:24576
    ds_read_b64_tr_b16 a[166:167], v228 offset:28672
    v_add_u32_e32 v229, s33, v229
    ds_read_b64_tr_b16 a[168:169], v229 offset:16384
    ds_read_b64_tr_b16 a[170:171], v229 offset:20480
    v_mfma_f32_16x16x32_bf16 v[84:87], a[180:183], v[136:139], v[84:87]
    ds_read_b64_tr_b16 a[172:173], v229 offset:24576
    ds_read_b64_tr_b16 a[174:175], v229 offset:28672
    v_exp_f32_e32 v189, v189
    v_cvt_pk_bf16_f32 v185, v186, v187
    v_mfma_f32_16x16x32_bf16 v[116:119], a[180:183], v[152:155], v[116:119]
    v_exp_f32_e32 v190, v190
    v_exp_f32_e32 v191, v191
    v_mfma_f32_16x16x32_bf16 v[88:91], a[184:187], v[136:139], v[88:91]
    v_add_u32_e32 v230, s33, v230
    ds_read_b64_tr_b16 a[176:177], v230 offset:16384
    ds_read_b64_tr_b16 a[178:179], v230 offset:20480
    v_mfma_f32_16x16x32_bf16 v[120:123], a[184:187], v[152:155], v[120:123]
    v_cvt_pk_bf16_f32 v186, v188, v189
    v_cvt_pk_bf16_f32 v187, v190, v191
    v_mfma_f32_16x16x32_bf16 v[92:95], a[188:191], v[136:139], v[92:95]
    ds_read_b64_tr_b16 a[180:181], v230 offset:24576
    ds_read_b64_tr_b16 a[182:183], v230 offset:28672
    v_mfma_f32_16x16x32_bf16 v[124:127], a[188:191], v[152:155], v[124:127]
    v_mfma_f32_16x16x32_bf16 v[250:253], v[242:245], v[184:187], v[250:253]
    v_add_u32_e32 v231, s33, v231
    s_waitcnt lgkmcnt(4)
    v_mfma_f32_16x16x32_bf16 v[64:67], a[160:163], v[160:163], v[64:67]
    ds_read_b64_tr_b16 a[184:185], v231 offset:16384
    ds_read_b64_tr_b16 a[186:187], v231 offset:20480
    v_mfma_f32_16x16x32_bf16 v[96:99], a[160:163], v[176:179], v[96:99]
    v_mbcnt_lo_u32_b32 v0, -1, 0
    v_mbcnt_hi_u32_b32 v0, -1, v0
    v_and_b32_e32 v3, 15, v0
    v_lshrrev_b32_e32 v4, 4, v0
    s_lshl_b32 s7, s28, 11
    v_lshlrev_b32_e32 v11, 4, v0
    v_add_u32_e32 v224, s7, v11
    s_mov_b32 s40, 4294938624
    s_mov_b32 s51, 0
    v_lshrrev_b32_e32 v2, 5, v0
    v_lshrrev_b32_e32 v6, 2, v3
    v_and_b32_e32 v7, 3, v0
    v_and_b32_e32 v8, 1, v4
    v_lshl_add_u32 v9, v2, 2, v6
    v_lshlrev_b32_e32 v9, 8, v9
    v_lshl_add_u32 v9, v7, 3, v9
    v_xor_b32_e32 v8, v8, v2
    v_lshl_add_u32 v9, v8, 5, v9
    v_xor_b32_e32 v11, 0, v6
    v_lshl_add_u32 v225, v11, 6, v9
    v_add_u32_e32 v241, 0x10000, v225
    v_xor_b32_e32 v11, 1, v6
    v_lshl_add_u32 v226, v11, 6, v9
    v_add_u32_e32 v242, 0x10000, v226
    v_xor_b32_e32 v11, 2, v6
    v_lshl_add_u32 v227, v11, 6, v9
    v_add_u32_e32 v243, 0x10000, v227
    v_xor_b32_e32 v11, 3, v6
    v_lshl_add_u32 v240, v11, 6, v9
    v_add_u32_e32 v244, 0x10000, v240
    s_mov_b32 s42, 32768
    s_mov_b32 s43, 4294836224
    s_add_u32 s34, s38, 98304
    v_mfma_f32_16x16x32_bf16 v[64:67], a[164:167], v[168:171], v[64:67]
    ds_read_b64_tr_b16 a[188:189], v231 offset:24576
    ds_read_b64_tr_b16 a[190:191], v231 offset:28672
    v_mfma_f32_16x16x32_bf16 v[96:99], a[164:167], v[184:187], v[96:99]
    s_add_u32 m0, s34, 0
    s_mov_b64 s[44:45], -1
    v_cmp_le_f32_e32 vcc, 0x33800000, v246
    s_nop 0
    s_and_b64 s[44:45], s[44:45], vcc
    v_cmp_ge_f32_e32 vcc, 0x4b800000, v246
    s_nop 0
    s_and_b64 s[44:45], s[44:45], vcc
    v_cmp_le_f32_e32 vcc, 0x33800000, v250
    s_nop 0
    s_and_b64 s[44:45], s[44:45], vcc
    v_cmp_ge_f32_e32 vcc, 0x4b800000, v250
    s_nop 0
    s_and_b64 s[44:45], s[44:45], vcc
    s_cmp_eq_u64 s[44:45], -1
    s_cbranch_scc1 A_A_fast_ok1
    s_mov_b32 s87, 1
    s_branch A_A_slow
A_A_slow_ret1:
A_A_fast_ok1:
    v_rcp_f32_e32 v246, v246
    v_rcp_f32_e32 v250, v250
    v_mfma_f32_16x16x32_bf16 v[68:71], a[168:171], v[160:163], v[68:71]
    v_add_u32_e32 v232, s33, v232
    ds_read_b64_tr_b16 a[160:161], v232 offset:16384
    ds_read_b64_tr_b16 a[162:163], v232 offset:20480
    v_mfma_f32_16x16x32_bf16 v[100:103], a[168:171], v[176:179], v[100:103]
    s_add_u32 s37, s47, 0
    v_mfma_f32_16x16x32_bf16 v[68:71], a[172:175], v[168:171], v[68:71]
    ds_read_b64_tr_b16 a[164:165], v232 offset:24576
    ds_read_b64_tr_b16 a[166:167], v232 offset:28672
    v_mfma_f32_16x16x32_bf16 v[100:103], a[172:175], v[184:187], v[100:103]
    buffer_load_dwordx4 v236, s[16:19], s37 offen offset:0  lds
    s_waitcnt lgkmcnt(4)
    v_mfma_f32_16x16x32_bf16 v[72:75], a[176:179], v[160:163], v[72:75]
    v_add_u32_e32 v233, s33, v233
    ds_read_b64_tr_b16 a[168:169], v233 offset:16384
    v_mfma_f32_16x16x32_bf16 v[104:107], a[176:179], v[176:179], v[104:107]
    ds_read_b64_tr_b16 a[170:171], v233 offset:20480
    v_mfma_f32_16x16x32_bf16 v[72:75], a[180:183], v[168:171], v[72:75]
    ds_read_b64_tr_b16 a[172:173], v233 offset:24576
    ds_read_b64_tr_b16 a[174:175], v233 offset:28672
    v_mul_f32_e32 v64, v246, v64
    v_mul_f32_e32 v65, v246, v65
    v_mul_f32_e32 v66, v246, v66
    v_mul_f32_e32 v67, v246, v67
    v_mfma_f32_16x16x32_bf16 v[104:107], a[180:183], v[184:187], v[104:107]
    buffer_load_dwordx4 v237, s[16:19], s37 offen offset:1024  lds
    v_mul_f32_e32 v68, v246, v68
    v_mfma_f32_16x16x32_bf16 v[76:79], a[184:187], v[160:163], v[76:79]
    v_add_u32_e32 v234, s33, v234
    ds_read_b64_tr_b16 a[176:177], v234 offset:16384
    ds_read_b64_tr_b16 a[178:179], v234 offset:20480
    v_mul_f32_e32 v69, v246, v69
    v_mul_f32_e32 v70, v246, v70
    v_mul_f32_e32 v71, v246, v71
    v_mfma_f32_16x16x32_bf16 v[108:111], a[184:187], v[176:179], v[108:111]
    buffer_load_dwordx4 v238, s[16:19], s37 offen offset:2048  lds
    v_cvt_pk_bf16_f32 v64, v64, v65
    v_mfma_f32_16x16x32_bf16 v[76:79], a[188:191], v[168:171], v[76:79]
    ds_read_b64_tr_b16 a[180:181], v234 offset:24576
    ds_read_b64_tr_b16 a[182:183], v234 offset:28672
    v_cvt_pk_bf16_f32 v65, v66, v67
    v_cvt_pk_bf16_f32 v66, v68, v69
    v_cvt_pk_bf16_f32 v67, v70, v71
    v_mul_f32_e32 v96, v250, v96
    v_mfma_f32_16x16x32_bf16 v[108:111], a[188:191], v[184:187], v[108:111]
    buffer_load_dwordx4 v239, s[16:19], s37 offen offset:3072  lds
    v_mul_f32_e32 v97, v250, v97
    s_waitcnt lgkmcnt(4)
    v_mfma_f32_16x16x32_bf16 v[80:83], a[160:163], v[160:163], v[80:83]
    v_add_u32_e32 v235, s33, v235
    ds_read_b64_tr_b16 a[184:185], v235 offset:16384
    ds_read_b64_tr_b16 a[186:187], v235 offset:20480
    v_mul_f32_e32 v98, v250, v98
    v_mul_f32_e32 v99, v250, v99
    v_mfma_f32_16x16x32_bf16 v[112:115], a[160:163], v[176:179], v[112:115]
    s_add_u32 s47, s47, 163840
    v_mul_f32_e32 v100, v250, v100
    v_mul_f32_e32 v101, v250, v101
    v_mul_f32_e32 v102, v250, v102
    v_mul_f32_e32 v103, v250, v103
    v_cvt_pk_bf16_f32 v96, v96, v97
    v_mfma_f32_16x16x32_bf16 v[80:83], a[164:167], v[168:171], v[80:83]
    ds_read_b64_tr_b16 a[188:189], v235 offset:24576
    ds_read_b64_tr_b16 a[190:191], v235 offset:28672
    v_cvt_pk_bf16_f32 v97, v98, v99
    v_cvt_pk_bf16_f32 v98, v100, v101
    v_cvt_pk_bf16_f32 v99, v102, v103
    v_permlane16_swap_b32_e32 v64, v96
    v_mfma_f32_16x16x32_bf16 v[112:115], a[164:167], v[184:187], v[112:115]
    v_permlane16_swap_b32_e32 v65, v97
    v_permlane16_swap_b32_e32 v66, v98
    v_permlane16_swap_b32_e32 v67, v99
    v_permlane32_swap_b32_e32 v64, v96
    v_permlane32_swap_b32_e32 v65, v97
    v_permlane32_swap_b32_e32 v66, v98
    v_mfma_f32_16x16x32_bf16 v[84:87], a[168:171], v[160:163], v[84:87]
    v_permlane32_swap_b32_e32 v67, v99
    v_mul_f32_e32 v72, v246, v72
    v_mul_f32_e32 v73, v246, v73
    v_mul_f32_e32 v74, v246, v74
    v_mul_f32_e32 v75, v246, v75
    v_mul_f32_e32 v76, v246, v76
    v_mfma_f32_16x16x32_bf16 v[116:119], a[168:171], v[176:179], v[116:119]
    v_mul_f32_e32 v77, v246, v77
    v_mul_f32_e32 v78, v246, v78
    v_mul_f32_e32 v79, v246, v79
    v_cvt_pk_bf16_f32 v72, v72, v73
    v_cvt_pk_bf16_f32 v73, v74, v75
    v_cvt_pk_bf16_f32 v74, v76, v77
    v_mfma_f32_16x16x32_bf16 v[84:87], a[172:175], v[168:171], v[84:87]
    v_cvt_pk_bf16_f32 v75, v78, v79
    v_mul_f32_e32 v104, v250, v104
    v_mul_f32_e32 v105, v250, v105
    v_mul_f32_e32 v106, v250, v106
    v_mul_f32_e32 v107, v250, v107
    v_mul_f32_e32 v108, v250, v108
    v_mfma_f32_16x16x32_bf16 v[116:119], a[172:175], v[184:187], v[116:119]
    v_mul_f32_e32 v109, v250, v109
    v_mul_f32_e32 v110, v250, v110
    v_mul_f32_e32 v111, v250, v111
    v_cvt_pk_bf16_f32 v104, v104, v105
    v_cvt_pk_bf16_f32 v105, v106, v107
    v_cvt_pk_bf16_f32 v106, v108, v109
    s_waitcnt lgkmcnt(0)
    v_mfma_f32_16x16x32_bf16 v[88:91], a[176:179], v[160:163], v[88:91]
    v_cvt_pk_bf16_f32 v107, v110, v111
    v_permlane16_swap_b32_e32 v72, v104
    v_permlane16_swap_b32_e32 v73, v105
    v_permlane16_swap_b32_e32 v74, v106
    v_permlane16_swap_b32_e32 v75, v107
    v_mfma_f32_16x16x32_bf16 v[120:123], a[176:179], v[176:179], v[120:123]
    s_waitcnt vmcnt(8)
    s_barrier
    ds_read_b64_tr_b16 a[160:161], v225 offset:32768
    ds_read_b64_tr_b16 a[162:163], v225 offset:34816
    ds_read_b64_tr_b16 a[164:165], v225 offset:36864
    ds_read_b64_tr_b16 a[166:167], v225 offset:38912
    ds_read_b64_tr_b16 a[168:169], v225 offset:40960
    ds_read_b64_tr_b16 a[170:171], v225 offset:43008
    v_mfma_f32_16x16x32_bf16 v[88:91], a[180:183], v[168:171], v[88:91]
    v_permlane32_swap_b32_e32 v72, v104
    v_permlane32_swap_b32_e32 v73, v105
    v_permlane32_swap_b32_e32 v74, v106
    v_permlane32_swap_b32_e32 v75, v107
    v_mul_f32_e32 v80, v246, v80
    v_mul_f32_e32 v81, v246, v81
    v_mfma_f32_16x16x32_bf16 v[120:123], a[180:183], v[184:187], v[120:123]
    v_mul_f32_e32 v82, v246, v82
    v_mul_f32_e32 v83, v246, v83
    v_mul_f32_e32 v84, v246, v84
    v_mul_f32_e32 v85, v246, v85
    v_mul_f32_e32 v86, v246, v86
    v_mul_f32_e32 v87, v246, v87
    v_mfma_f32_16x16x32_bf16 v[92:95], a[184:187], v[160:163], v[92:95]
    v_cvt_pk_bf16_f32 v80, v80, v81
    v_cvt_pk_bf16_f32 v81, v82, v83
    v_cvt_pk_bf16_f32 v82, v84, v85
    v_cvt_pk_bf16_f32 v83, v86, v87
    v_mul_f32_e32 v112, v250, v112
    v_mul_f32_e32 v113, v250, v113
    v_mfma_f32_16x16x32_bf16 v[124:127], a[184:187], v[176:179], v[124:127]
    v_mul_f32_e32 v114, v250, v114
    v_mul_f32_e32 v115, v250, v115
    v_mul_f32_e32 v116, v250, v116
    v_mul_f32_e32 v117, v250, v117
    v_mul_f32_e32 v118, v250, v118
    v_mul_f32_e32 v119, v250, v119
    v_mfma_f32_16x16x32_bf16 v[92:95], a[188:191], v[168:171], v[92:95]
    v_cvt_pk_bf16_f32 v112, v112, v113
    v_cvt_pk_bf16_f32 v113, v114, v115
    v_cvt_pk_bf16_f32 v114, v116, v117
    v_cvt_pk_bf16_f32 v115, v118, v119
    v_permlane16_swap_b32_e32 v80, v112
    v_permlane16_swap_b32_e32 v81, v113
    v_mfma_f32_16x16x32_bf16 v[124:127], a[188:191], v[184:187], v[124:127]
    v_permlane16_swap_b32_e32 v82, v114
    v_permlane16_swap_b32_e32 v83, v115
    v_permlane32_swap_b32_e32 v80, v112
    v_permlane32_swap_b32_e32 v81, v113
    v_permlane32_swap_b32_e32 v82, v114
    v_permlane32_swap_b32_e32 v83, v115
    v_mul_f32_e32 v88, v246, v88
    v_mul_f32_e32 v89, v246, v89
    v_mul_f32_e32 v90, v246, v90
    v_mul_f32_e32 v91, v246, v91
    v_mul_f32_e32 v92, v246, v92
    v_mul_f32_e32 v93, v246, v93
    v_mul_f32_e32 v94, v246, v94
    v_mul_f32_e32 v95, v246, v95
    v_cvt_pk_bf16_f32 v88, v88, v89
    v_cvt_pk_bf16_f32 v89, v90, v91
    v_cvt_pk_bf16_f32 v90, v92, v93
    v_cvt_pk_bf16_f32 v91, v94, v95
    v_mul_f32_e32 v120, v250, v120
    v_mul_f32_e32 v121, v250, v121
    v_mul_f32_e32 v122, v250, v122
    v_mul_f32_e32 v123, v250, v123
    v_mul_f32_e32 v124, v250, v124
    v_mul_f32_e32 v125, v250, v125
    v_mul_f32_e32 v126, v250, v126
    v_mul_f32_e32 v127, v250, v127
    v_cvt_pk_bf16_f32 v120, v120, v121
    v_cvt_pk_bf16_f32 v121, v122, v123
    v_cvt_pk_bf16_f32 v122, v124, v125
    v_cvt_pk_bf16_f32 v123, v126, v127
    v_permlane16_swap_b32_e32 v88, v120
    v_permlane16_swap_b32_e32 v89, v121
    v_permlane16_swap_b32_e32 v90, v122
    v_permlane16_swap_b32_e32 v91, v123
    v_permlane32_swap_b32_e32 v88, v120
    v_permlane32_swap_b32_e32 v89, v121
    v_permlane32_swap_b32_e32 v90, v122
    v_permlane32_swap_b32_e32 v91, v123
    v_accvgpr_write_b32 a32, v64
    v_accvgpr_write_b32 a33, v65
    v_accvgpr_write_b32 a34, v96
    v_accvgpr_write_b32 a35, v97
    v_accvgpr_write_b32 a36, v66
    v_accvgpr_write_b32 a37, v67
    v_accvgpr_write_b32 a38, v98
    v_accvgpr_write_b32 a39, v99
    v_accvgpr_write_b32 a40, v72
    v_accvgpr_write_b32 a41, v73
    v_accvgpr_write_b32 a42, v104
    v_accvgpr_write_b32 a43, v105
    v_accvgpr_write_b32 a44, v74
    v_accvgpr_write_b32 a45, v75
    v_accvgpr_write_b32 a46, v106
    v_accvgpr_write_b32 a47, v107
    v_accvgpr_write_b32 a48, v80
    v_accvgpr_write_b32 a49, v81
    v_accvgpr_write_b32 a50, v112
    v_accvgpr_write_b32 a51, v113
    v_accvgpr_write_b32 a52, v82
    v_accvgpr_write_b32 a53, v83
    v_accvgpr_write_b32 a54, v114
    v_accvgpr_write_b32 a55, v115
    v_accvgpr_write_b32 a56, v88
    v_accvgpr_write_b32 a57, v89
    v_accvgpr_write_b32 a58, v120
    v_accvgpr_write_b32 a59, v121
    v_accvgpr_write_b32 a60, v90
    v_accvgpr_write_b32 a61, v91
    v_accvgpr_write_b32 a62, v122
    v_accvgpr_write_b32 a63, v123
    v_mbcnt_lo_u32_b32 v0, -1, 0
    v_mbcnt_hi_u32_b32 v0, -1, v0
    v_and_b32_e32 v3, 15, v0
    v_lshrrev_b32_e32 v4, 4, v0
    s_lshl_b32 s60, s5, 4
    s_add_u32 s60, s60, s4
    s_mul_i32 s61, s60, 1146880
    s_add_u32 s8, s68, s61
    s_addc_u32 s9, s69, 0
    s_mov_b32 s10, 1146880
    s_mov_b32 s11, 0x20000
    s_mov_b32 s12, s100
    s_mov_b32 s13, s101
    s_mov_b32 s14, 4587520
    s_mov_b32 s15, 0x20000
    s_mov_b32 s96, s90
    s_mov_b32 s97, s91
    s_mov_b32 s98, 256
    s_mov_b32 s99, 0x20000
    s_lshl_b32 s61, s60, 2
    v_mov_b32_e32 v114, s61
    s_add_u32 s96, s68, 36700160
    s_addc_u32 s97, s69, 0
    s_mov_b32 s98, 8192
    s_lshl_b32 s62, s6, 2
    s_add_u32 s62, s62, s28
    s_lshr_b32 s63, s62, 1
    s_and_b32 s64, s62, 1
    s_cmp_ge_u32 s63, 7
    s_cselect_b32 s65, 1, 0
    s_mul_i32 s66, s65, 7
    s_sub_u32 s66, s63, s66
    s_lshl_b32 s67, s65, 1
    s_add_u32 s67, s67, s64
    s_mul_i32 s67, s67, 7
    s_add_u32 s67, s67, s66
    s_lshl_b32 s52, s67, 10
    s_mul_i32 s61, s4, 286720
    s_mul_i32 s67, s5, 1280
    s_add_u32 s61, s61, s67
    s_mul_i32 s67, s66, 40960
    s_add_u32 s61, s61, s67
    s_lshl_b32 s67, s65, 7
    s_add_u32 s61, s61, s67
    s_lshl_b32 s67, s64, 6
    s_add_u32 s53, s61, s67
    s_sub_u32 s52, s52, 57344
    s_sub_u32 s53, s53, 768
    s_cmp_lt_u32 s62, 28
    s_cselect_b32 s52, s52, 1073741824
    s_cselect_b32 s53, s53, 1073741824
    v_lshlrev_b32_e32 v110, 4, v0
    v_mul_u32_u24_e32 v111, 2560, v3
    v_lshl_add_u32 v111, v4, 4, v111
    s_lshl_b32 s61, s60, 8
    v_mov_b32_e32 v114, s61
    v_cmp_eq_u32_e32 vcc, 0, v0
    v_mov_b32_e32 v5, 1073741824
    s_nop 0
    v_cndmask_b32_e32 v113, v5, v114, vcc
A_A_ng:
    s_waitcnt lgkmcnt(0)
    v_mfma_f32_32x32x16_bf16 v[0:15], a[160:163], a[192:195], 0
    s_cmp_eq_u32 s51, 0
    s_cselect_b32 s22, 0, 143360
    s_add_u32 m0, s38, 0
    ds_read_b64_tr_b16 a[172:173], v225 offset:45056
    ds_read_b64_tr_b16 a[174:175], v225 offset:47104
    ds_read_b64_tr_b16 a[176:177], v225 offset:49152
    ds_read_b64_tr_b16 a[178:179], v225 offset:51200
    ds_read_b64_tr_b16 a[180:181], v225 offset:53248
    v_mfma_f32_32x32x16_bf16 v[0:15], a[164:167], a[196:199], v[0:15]
    ds_read_b64_tr_b16 a[182:183], v225 offset:55296
    ds_read_b64_tr_b16 a[184:185], v225 offset:57344
    ds_read_b64_tr_b16 a[186:187], v225 offset:59392
    ds_read_b64_tr_b16 a[188:189], v225 offset:61440
    ds_read_b64_tr_b16 a[190:191], v225 offset:63488
    v_mfma_f32_32x32x16_bf16 v[0:15], a[168:171], a[200:203], v[0:15]
    ds_read_b64_tr_b16 a[160:161], v226 offset:32768
    ds_read_b64_tr_b16 a[162:163], v226 offset:34816
    s_waitcnt lgkmcnt(10)
    v_mfma_f32_32x32x16_bf16 v[0:15], a[172:175], a[204:207], v[0:15]
    ds_read_b64_tr_b16 a[164:165], v226 offset:36864
    ds_read_b64_tr_b16 a[166:167], v226 offset:38912
    s_waitcnt lgkmcnt(4)
    v_mfma_f32_32x32x16_bf16 v[0:15], a[176:179], a[208:211], v[0:15]
    s_add_u32 s37, s47, 0
    ds_read_b64_tr_b16 a[168:169], v226 offset:40960
    ds_read_b64_tr_b16 a[170:171], v226 offset:43008
    v_mfma_f32_32x32x16_bf16 v[0:15], a[180:183], a[212:215], v[0:15]
    ds_read_b64_tr_b16 a[172:173], v226 offset:45056
    ds_read_b64_tr_b16 a[174:175], v226 offset:47104
    s_add_u32 s36, s40, 0
    v_mfma_f32_32x32x16_bf16 v[0:15], a[184:187], a[216:219], v[0:15]
    buffer_store_dwordx4 v[128:131], v224, s[20:23], s36 offen sc0 sc1
    v_mfma_f32_32x32x16_bf16 v[0:15], a[188:191], a[220:223], v[0:15]
    ds_read_b64_tr_b16 a[176:177], v226 offset:49152
    ds_read_b64_tr_b16 a[178:179], v226 offset:51200
    ds_read_b64_tr_b16 a[180:181], v226 offset:53248
    ds_read_b64_tr_b16 a[182:183], v226 offset:55296
    s_waitcnt lgkmcnt(4)
    v_mfma_f32_32x32x16_bf16 v[16:31], a[160:163], a[192:195], 0
    buffer_load_dwordx4 v236, s[16:19], s37 offen offset:0  lds
    v_mfma_f32_32x32x16_bf16 v[16:31], a[164:167], a[196:199], v[16:31]
    ds_read_b64_tr_b16 a[184:185], v226 offset:57344
    ds_read_b64_tr_b16 a[186:187], v226 offset:59392
    ds_read_b64_tr_b16 a[188:189], v226 offset:61440
    ds_read_b64_tr_b16 a[190:191], v226 offset:63488
    v_mfma_f32_32x32x16_bf16 v[16:31], a[168:171], a[200:203], v[16:31]
    ds_read_b64_tr_b16 a[160:161], v227 offset:32768
    ds_read_b64_tr_b16 a[162:163], v227 offset:34816
    v_mfma_f32_32x32x16_bf16 v[16:31], a[172:175], a[204:207], v[16:31]
    ds_read_b64_tr_b16 a[164:165], v227 offset:36864
    ds_read_b64_tr_b16 a[166:167], v227 offset:38912
    s_waitcnt lgkmcnt(4)
    v_mfma_f32_32x32x16_bf16 v[16:31], a[176:179], a[208:211], v[16:31]
    buffer_load_dwordx4 v237, s[16:19], s37 offen offset:1024  lds
    v_mfma_f32_32x32x16_bf16 v[16:31], a[180:183], a[212:215], v[16:31]
    ds_read_b64_tr_b16 a[168:169], v227 offset:40960
    ds_read_b64_tr_b16 a[170:171], v227 offset:43008
    ds_read_b64_tr_b16 a[172:173], v227 offset:45056
    ds_read_b64_tr_b16 a[174:175], v227 offset:47104
    v_mfma_f32_32x32x16_bf16 v[16:31], a[184:187], a[216:219], v[16:31]
    ds_read_b64_tr_b16 a[176:177], v227 offset:49152
    ds_read_b64_tr_b16 a[178:179], v227 offset:51200
    v_mfma_f32_32x32x16_bf16 v[16:31], a[188:191], a[220:223], v[16:31]
    ds_read_b64_tr_b16 a[180:181], v227 offset:53248
    ds_read_b64_tr_b16 a[182:183], v227 offset:55296
    s_waitcnt lgkmcnt(4)
    v_mfma_f32_32x32x16_bf16 v[32:47], a[160:163], a[192:195], 0
    buffer_load_dwordx4 v238, s[16:19], s37 offen offset:2048  lds
    v_mfma_f32_32x32x16_bf16 v[32:47], a[164:167], a[196:199], v[32:47]
    ds_read_b64_tr_b16 a[184:185], v227 offset:57344
    ds_read_b64_tr_b16 a[186:187], v227 offset:59392
    ds_read_b64_tr_b16 a[188:189], v227 offset:61440
    ds_read_b64_tr_b16 a[190:191], v227 offset:63488
    s_add_u32 s36, s40, 1024
    v_mfma_f32_32x32x16_bf16 v[32:47], a[168:171], a[200:203], v[32:47]
    buffer_store_dwordx4 v[144:147], v224, s[20:23], s36 offen sc0 sc1
    v_mfma_f32_32x32x16_bf16 v[32:47], a[172:175], a[204:207], v[32:47]
    ds_read_b64_tr_b16 a[160:161], v240 offset:32768
    ds_read_b64_tr_b16 a[162:163], v240 offset:34816
    ds_read_b64_tr_b16 a[164:165], v240 offset:36864
    ds_read_b64_tr_b16 a[166:167], v240 offset:38912
    s_waitcnt lgkmcnt(4)
    v_mfma_f32_32x32x16_bf16 v[32:47], a[176:179], a[208:211], v[32:47]
    buffer_load_dwordx4 v239, s[16:19], s37 offen offset:3072  lds
    v_mfma_f32_32x32x16_bf16 v[32:47], a[180:183], a[212:215], v[32:47]
    ds_read_b64_tr_b16 a[168:169], v240 offset:40960
    ds_read_b64_tr_b16 a[170:171], v240 offset:43008
    ds_read_b64_tr_b16 a[172:173], v240 offset:45056
    ds_read_b64_tr_b16 a[174:175], v240 offset:47104
    v_mfma_f32_32x32x16_bf16 v[32:47], a[184:187], a[216:219], v[32:47]
    ds_read_b64_tr_b16 a[176:177], v240 offset:49152
    ds_read_b64_tr_b16 a[178:179], v240 offset:51200
    v_mfma_f32_32x32x16_bf16 v[32:47], a[188:191], a[220:223], v[32:47]
    ds_read_b64_tr_b16 a[180:181], v240 offset:53248
    ds_read_b64_tr_b16 a[182:183], v240 offset:55296
    s_waitcnt lgkmcnt(4)
    v_mfma_f32_32x32x16_bf16 v[48:63], a[160:163], a[192:195], 0
    s_add_u32 s47, s47, 4294476032
    ds_read_b64_tr_b16 a[184:185], v240 offset:57344
    ds_read_b64_tr_b16 a[186:187], v240 offset:59392
    v_mfma_f32_32x32x16_bf16 v[48:63], a[164:167], a[196:199], v[48:63]
    ds_read_b64_tr_b16 a[188:189], v240 offset:61440
    ds_read_b64_tr_b16 a[190:191], v240 offset:63488
    v_mfma_f32_32x32x16_bf16 v[48:63], a[168:171], a[200:203], v[48:63]
    s_add_u32 s36, s40, 7168
    v_mfma_f32_32x32x16_bf16 v[48:63], a[172:175], a[204:207], v[48:63]
    buffer_store_dwordx4 v[132:135], v224, s[20:23], s36 offen sc0 sc1
    s_waitcnt lgkmcnt(0)
    v_mfma_f32_32x32x16_bf16 v[48:63], a[176:179], a[208:211], v[48:63]
    s_waitcnt vmcnt(11)
    s_barrier
    ds_read_b64_tr_b16 a[160:161], v241 offset:0
    ds_read_b64_tr_b16 a[162:163], v241 offset:2048
    ds_read_b64_tr_b16 a[164:165], v242 offset:0
    ds_read_b64_tr_b16 a[166:167], v242 offset:2048
    ds_read_b64_tr_b16 a[168:169], v243 offset:0
    ds_read_b64_tr_b16 a[170:171], v243 offset:2048
    v_mfma_f32_32x32x16_bf16 v[48:63], a[180:183], a[212:215], v[48:63]
    ds_read_b64_tr_b16 a[172:173], v244 offset:0
    ds_read_b64_tr_b16 a[174:175], v244 offset:2048
    v_mfma_f32_32x32x16_bf16 v[48:63], a[184:187], a[216:219], v[48:63]
    ds_read_b64_tr_b16 a[176:177], v241 offset:4096
    ds_read_b64_tr_b16 a[178:179], v241 offset:6144
    v_mfma_f32_32x32x16_bf16 v[48:63], a[188:191], a[220:223], v[48:63]
    ds_read_b64_tr_b16 a[180:181], v242 offset:4096
    ds_read_b64_tr_b16 a[182:183], v242 offset:6144
    s_waitcnt lgkmcnt(4)
    v_mfma_f32_32x32x16_bf16 v[0:15], a[160:163], a[224:227], v[0:15]
    s_cmp_ge_u32 s51, 4
    s_cselect_b32 s18, 0, s18
    ds_read_b64_tr_b16 a[184:185], v243 offset:4096
    ds_read_b64_tr_b16 a[186:187], v243 offset:6144
    v_mfma_f32_32x32x16_bf16 v[16:31], a[164:167], a[224:227], v[16:31]
    ds_read_b64_tr_b16 a[188:189], v244 offset:4096
    ds_read_b64_tr_b16 a[190:191], v244 offset:6144
    v_mfma_f32_32x32x16_bf16 v[32:47], a[168:171], a[224:227], v[32:47]
    ds_read_b64_tr_b16 a[160:161], v241 offset:8192
    ds_read_b64_tr_b16 a[162:163], v241 offset:10240
    v_mfma_f32_32x32x16_bf16 v[48:63], a[172:175], a[224:227], v[48:63]
    s_add_u32 m0, s38, 32768
    ds_read_b64_tr_b16 a[164:165], v242 offset:8192
    ds_read_b64_tr_b16 a[166:167], v242 offset:10240
    s_waitcnt lgkmcnt(4)
    v_mfma_f32_32x32x16_bf16 v[0:15], a[176:179], a[228:231], v[0:15]
    ds_read_b64_tr_b16 a[168:169], v243 offset:8192
    ds_read_b64_tr_b16 a[170:171], v243 offset:10240
    v_mfma_f32_32x32x16_bf16 v[16:31], a[180:183], a[228:231], v[16:31]
    ds_read_b64_tr_b16 a[172:173], v244 offset:8192
    ds_read_b64_tr_b16 a[174:175], v244 offset:10240
    s_cmp_lt_u32 s51, 3
    v_mfma_f32_32x32x16_bf16 v[32:47], a[184:187], a[228:231], v[32:47]
    s_cbranch_scc1 A_sum_done1
    s_waitcnt vmcnt(11)
    v_lshlrev_b32_e32 v96, 16, v64
    v_and_b32_e32 v97, 0xffff0000, v64
    v_lshlrev_b32_e32 v98, 16, v65
    v_and_b32_e32 v99, 0xffff0000, v65
    v_lshlrev_b32_e32 v100, 16, v66
    v_and_b32_e32 v101, 0xffff0000, v66
    v_lshlrev_b32_e32 v102, 16, v67
    v_and_b32_e32 v103, 0xffff0000, v67
    v_lshlrev_b32_e32 v108, 16, v68
    v_and_b32_e32 v109, 0xffff0000, v68
    v_add_f32_e32 v96, v96, v108
    v_add_f32_e32 v97, v97, v109
    v_lshlrev_b32_e32 v108, 16, v69
    v_and_b32_e32 v109, 0xffff0000, v69
    v_add_f32_e32 v98, v98, v108
    v_add_f32_e32 v99, v99, v109
    v_lshlrev_b32_e32 v108, 16, v70
    v_and_b32_e32 v109, 0xffff0000, v70
    v_add_f32_e32 v100, v100, v108
    v_add_f32_e32 v101, v101, v109
    v_lshlrev_b32_e32 v108, 16, v71
    v_and_b32_e32 v109, 0xffff0000, v71
    v_add_f32_e32 v102, v102, v108
    v_add_f32_e32 v103, v103, v109
    v_lshlrev_b32_e32 v108, 16, v72
    v_and_b32_e32 v109, 0xffff0000, v72
    v_add_f32_e32 v96, v96, v108
    v_add_f32_e32 v97, v97, v109
    v_lshlrev_b32_e32 v108, 16, v73
    v_and_b32_e32 v109, 0xffff0000, v73
    v_add_f32_e32 v98, v98, v108
    v_add_f32_e32 v99, v99, v109
    v_lshlrev_b32_e32 v108, 16, v74
    v_and_b32_e32 v109, 0xffff0000, v74
    v_add_f32_e32 v100, v100, v108
    v_add_f32_e32 v101, v101, v109
    v_lshlrev_b32_e32 v108, 16, v75
    v_and_b32_e32 v109, 0xffff0000, v75
    v_add_f32_e32 v102, v102, v108
    v_add_f32_e32 v103, v103, v109
    v_lshlrev_b32_e32 v108, 16, v76
    v_and_b32_e32 v109, 0xffff0000, v76
    v_add_f32_e32 v96, v96, v108
    v_add_f32_e32 v97, v97, v109
    v_lshlrev_b32_e32 v108, 16, v77
    v_and_b32_e32 v109, 0xffff0000, v77
    v_add_f32_e32 v98, v98, v108
    v_add_f32_e32 v99, v99, v109
    v_lshlrev_b32_e32 v108, 16, v78
    v_and_b32_e32 v109, 0xffff0000, v78
    v_add_f32_e32 v100, v100, v108
    v_add_f32_e32 v101, v101, v109
    v_lshlrev_b32_e32 v108, 16, v79
    v_and_b32_e32 v109, 0xffff0000, v79
    v_add_f32_e32 v102, v102, v108
    v_add_f32_e32 v103, v103, v109
    v_lshlrev_b32_e32 v108, 16, v80
    v_and_b32_e32 v109, 0xffff0000, v80
    v_add_f32_e32 v96, v96, v108
    v_add_f32_e32 v97, v97, v109
    v_lshlrev_b32_e32 v108, 16, v81
    v_and_b32_e32 v109, 0xffff0000, v81
    v_add_f32_e32 v98, v98, v108
    v_add_f32_e32 v99, v99, v109
    v_lshlrev_b32_e32 v108, 16, v82
    v_and_b32_e32 v109, 0xffff0000, v82
    v_add_f32_e32 v100, v100, v108
    v_add_f32_e32 v101, v101, v109
    v_lshlrev_b32_e32 v108, 16, v83
    v_and_b32_e32 v109, 0xffff0000, v83
    v_add_f32_e32 v102, v102, v108
    v_add_f32_e32 v103, v103, v109
    v_lshlrev_b32_e32 v108, 16, v84
    v_and_b32_e32 v109, 0xffff0000, v84
    v_add_f32_e32 v96, v96, v108
    v_add_f32_e32 v97, v97, v109
    v_lshlrev_b32_e32 v108, 16, v85
    v_and_b32_e32 v109, 0xffff0000, v85
    v_add_f32_e32 v98, v98, v108
    v_add_f32_e32 v99, v99, v109
    v_lshlrev_b32_e32 v108, 16, v86
    v_and_b32_e32 v109, 0xffff0000, v86
    v_add_f32_e32 v100, v100, v108
    v_add_f32_e32 v101, v101, v109
    v_lshlrev_b32_e32 v108, 16, v87
    v_and_b32_e32 v109, 0xffff0000, v87
    v_add_f32_e32 v102, v102, v108
    v_add_f32_e32 v103, v103, v109
    v_lshlrev_b32_e32 v108, 16, v88
    v_and_b32_e32 v109, 0xffff0000, v88
    v_add_f32_e32 v96, v96, v108
    v_add_f32_e32 v97, v97, v109
    v_lshlrev_b32_e32 v108, 16, v89
    v_and_b32_e32 v109, 0xffff0000, v89
    v_add_f32_e32 v98, v98, v108
    v_add_f32_e32 v99, v99, v109
    v_lshlrev_b32_e32 v108, 16, v90
    v_and_b32_e32 v109, 0xffff0000, v90
    v_add_f32_e32 v100, v100, v108
    v_add_f32_e32 v101, v101, v109
    v_lshlrev_b32_e32 v108, 16, v91
    v_and_b32_e32 v109, 0xffff0000, v91
    v_add_f32_e32 v102, v102, v108
    v_add_f32_e32 v103, v103, v109
    s_waitcnt vmcnt(11)
    v_lshlrev_b32_e32 v108, 16, v92
    v_and_b32_e32 v109, 0xffff0000, v92
    v_add_f32_e32 v96, v96, v108
    v_add_f32_e32 v97, v97, v109
    v_lshlrev_b32_e32 v108, 16, v93
    v_and_b32_e32 v109, 0xffff0000, v93
    v_add_f32_e32 v98, v98, v108
    v_add_f32_e32 v99, v99, v109
    v_lshlrev_b32_e32 v108, 16, v94
    v_and_b32_e32 v109, 0xffff0000, v94
    v_add_f32_e32 v100, v100, v108
    v_add_f32_e32 v101, v101, v109
    v_lshlrev_b32_e32 v108, 16, v95
    v_and_b32_e32 v109, 0xffff0000, v95
    v_add_f32_e32 v102, v102, v108
    v_add_f32_e32 v103, v103, v109
    v_cvt_pk_bf16_f32 v104, v96, v97
    v_cvt_pk_bf16_f32 v105, v98, v99
    v_cvt_pk_bf16_f32 v106, v100, v101
    v_cvt_pk_bf16_f32 v107, v102, v103
    s_nop 0
    v_permlane32_swap_b32_e32 v104, v106
    v_permlane32_swap_b32_e32 v105, v107
    s_nop 0
    v_permlane16_swap_b32_e32 v104, v106
    v_permlane16_swap_b32_e32 v105, v107
    buffer_store_dwordx4 v[104:107], v111, s[12:15], s53 offen sc0 sc1
A_sum_done1:
    ds_read_b64_tr_b16 a[176:177], v241 offset:12288
    ds_read_b64_tr_b16 a[178:179], v241 offset:14336
    v_mfma_f32_32x32x16_bf16 v[48:63], a[188:191], a[228:231], v[48:63]
    s_add_u32 s37, s47, 0
    ds_read_b64_tr_b16 a[180:181], v242 offset:12288
    ds_read_b64_tr_b16 a[182:183], v242 offset:14336
    s_waitcnt lgkmcnt(4)
    v_mfma_f32_32x32x16_bf16 v[0:15], a[160:163], a[232:235], v[0:15]
    ds_read_b64_tr_b16 a[184:185], v243 offset:12288
    ds_read_b64_tr_b16 a[186:187], v243 offset:14336
    ds_read_b64_tr_b16 a[188:189], v244 offset:12288
    ds_read_b64_tr_b16 a[190:191], v244 offset:14336
    s_add_u32 s36, s40, 8192
    v_mfma_f32_32x32x16_bf16 v[16:31], a[164:167], a[232:235], v[16:31]
    buffer_store_dwordx4 v[148:151], v224, s[20:23], s36 offen sc0 sc1
    v_mfma_f32_32x32x16_bf16 v[32:47], a[168:171], a[232:235], v[32:47]
    buffer_load_dwordx4 v236, s[16:19], s37 offen offset:0  lds
    v_mfma_f32_32x32x16_bf16 v[48:63], a[172:175], a[232:235], v[48:63]
    ds_read_b64_tr_b16 a[160:161], v241 offset:16384
    ds_read_b64_tr_b16 a[162:163], v241 offset:18432
    ds_read_b64_tr_b16 a[164:165], v242 offset:16384
    ds_read_b64_tr_b16 a[166:167], v242 offset:18432
    s_waitcnt lgkmcnt(4)
    v_mfma_f32_32x32x16_bf16 v[0:15], a[176:179], a[236:239], v[0:15]
    ds_read_b64_tr_b16 a[168:169], v243 offset:16384
    ds_read_b64_tr_b16 a[170:171], v243 offset:18432
    v_mfma_f32_32x32x16_bf16 v[16:31], a[180:183], a[236:239], v[16:31]
    ds_read_b64_tr_b16 a[172:173], v244 offset:16384
    ds_read_b64_tr_b16 a[174:175], v244 offset:18432
    v_mfma_f32_32x32x16_bf16 v[32:47], a[184:187], a[236:239], v[32:47]
    buffer_load_dwordx4 v237, s[16:19], s37 offen offset:1024  lds
    v_mfma_f32_32x32x16_bf16 v[48:63], a[188:191], a[236:239], v[48:63]
    ds_read_b64_tr_b16 a[176:177], v241 offset:20480
    ds_read_b64_tr_b16 a[178:179], v241 offset:22528
    ds_read_b64_tr_b16 a[180:181], v242 offset:20480
    ds_read_b64_tr_b16 a[182:183], v242 offset:22528
    s_waitcnt lgkmcnt(4)
    v_mfma_f32_32x32x16_bf16 v[0:15], a[160:163], a[240:243], v[0:15]
    ds_read_b64_tr_b16 a[184:185], v243 offset:20480
    ds_read_b64_tr_b16 a[186:187], v243 offset:22528
    v_mfma_f32_32x32x16_bf16 v[16:31], a[164:167], a[240:243], v[16:31]
    buffer_load_dwordx4 v238, s[16:19], s37 offen offset:2048  lds
    v_mfma_f32_32x32x16_bf16 v[32:47], a[168:171], a[240:243], v[32:47]
    ds_read_b64_tr_b16 a[188:189], v244 offset:20480
    ds_read_b64_tr_b16 a[190:191], v244 offset:22528
    ds_read_b64_tr_b16 a[160:161], v241 offset:24576
    ds_read_b64_tr_b16 a[162:163], v241 offset:26624
    v_mfma_f32_32x32x16_bf16 v[48:63], a[172:175], a[240:243], v[48:63]
    ds_read_b64_tr_b16 a[164:165], v242 offset:24576
    ds_read_b64_tr_b16 a[166:167], v242 offset:26624
    s_waitcnt lgkmcnt(4)
    v_mfma_f32_32x32x16_bf16 v[0:15], a[176:179], a[244:247], v[0:15]
    ds_read_b64_tr_b16 a[168:169], v243 offset:24576
    ds_read_b64_tr_b16 a[170:171], v243 offset:26624
    v_mfma_f32_32x32x16_bf16 v[16:31], a[180:183], a[244:247], v[16:31]
    buffer_load_dwordx4 v239, s[16:19], s37 offen offset:3072  lds
    ds_read_b64_tr_b16 a[172:173], v244 offset:24576
    ds_read_b64_tr_b16 a[174:175], v244 offset:26624
    v_mfma_f32_32x32x16_bf16 v[32:47], a[184:187], a[244:247], v[32:47]
    s_add_u32 s36, s40, 14336
    buffer_store_dwordx4 v[136:139], v224, s[20:23], s36 offen sc0 sc1
    v_mfma_f32_32x32x16_bf16 v[48:63], a[188:191], a[244:247], v[48:63]
    ds_read_b64_tr_b16 a[176:177], v241 offset:28672
    ds_read_b64_tr_b16 a[178:179], v241 offset:30720
    ds_read_b64_tr_b16 a[180:181], v242 offset:28672
    ds_read_b64_tr_b16 a[182:183], v242 offset:30720
    s_waitcnt lgkmcnt(4)
    v_mfma_f32_32x32x16_bf16 v[0:15], a[160:163], a[248:251], v[0:15]
    s_add_u32 s47, s47, 163840
    ds_read_b64_tr_b16 a[184:185], v243 offset:28672
    ds_read_b64_tr_b16 a[186:187], v243 offset:30720
    v_mfma_f32_32x32x16_bf16 v[16:31], a[164:167], a[248:251], v[16:31]
    ds_read_b64_tr_b16 a[188:189], v244 offset:28672
    ds_read_b64_tr_b16 a[190:191], v244 offset:30720
    v_mfma_f32_32x32x16_bf16 v[32:47], a[168:171], a[248:251], v[32:47]
    v_mfma_f32_32x32x16_bf16 v[48:63], a[172:175], a[248:251], v[48:63]
    s_waitcnt lgkmcnt(0)
    v_mfma_f32_32x32x16_bf16 v[0:15], a[176:179], a[252:255], v[0:15]
    s_waitcnt vmcnt(13)
    s_barrier
    ds_read_b64_tr_b16 a[160:161], v241 offset:32768
    ds_read_b64_tr_b16 a[162:163], v241 offset:34816
    ds_read_b64_tr_b16 a[164:165], v242 offset:32768
    ds_read_b64_tr_b16 a[166:167], v242 offset:34816
    ds_read_b64_tr_b16 a[168:169], v243 offset:32768
    ds_read_b64_tr_b16 a[170:171], v243 offset:34816
    v_mfma_f32_32x32x16_bf16 v[16:31], a[180:183], a[252:255], v[16:31]
    ds_read_b64_tr_b16 a[172:173], v244 offset:32768
    ds_read_b64_tr_b16 a[174:175], v244 offset:34816
    v_mfma_f32_32x32x16_bf16 v[32:47], a[184:187], a[252:255], v[32:47]
    ds_read_b64_tr_b16 a[176:177], v241 offset:36864
    ds_read_b64_tr_b16 a[178:179], v241 offset:38912
    v_mfma_f32_32x32x16_bf16 v[48:63], a[188:191], a[252:255], v[48:63]
    ds_read_b64_tr_b16 a[180:181], v242 offset:36864
    ds_read_b64_tr_b16 a[182:183], v242 offset:38912
    s_waitcnt lgkmcnt(4)
    v_mfma_f32_32x32x16_bf16 v[0:15], a[160:163], a[0:3], v[0:15]
    s_add_u32 m0, s38, 65536
    ds_read_b64_tr_b16 a[184:185], v243 offset:36864
    ds_read_b64_tr_b16 a[186:187], v243 offset:38912
    v_mfma_f32_32x32x16_bf16 v[16:31], a[164:167], a[0:3], v[16:31]
    ds_read_b64_tr_b16 a[188:189], v244 offset:36864
    ds_read_b64_tr_b16 a[190:191], v244 offset:38912
    s_add_u32 s36, s40, 15360
    v_mfma_f32_32x32x16_bf16 v[32:47], a[168:171], a[0:3], v[32:47]
    buffer_store_dwordx4 v[152:155], v224, s[20:23], s36 offen sc0 sc1
    v_mfma_f32_32x32x16_bf16 v[48:63], a[172:175], a[0:3], v[48:63]
    ds_read_b64_tr_b16 a[160:161], v241 offset:40960
    ds_read_b64_tr_b16 a[162:163], v241 offset:43008
    ds_read_b64_tr_b16 a[164:165], v242 offset:40960
    ds_read_b64_tr_b16 a[166:167], v242 offset:43008
    s_waitcnt lgkmcnt(4)
    v_mfma_f32_32x32x16_bf16 v[0:15], a[176:179], a[4:7], v[0:15]
    s_add_u32 s37, s47, 0
    ds_read_b64_tr_b16 a[168:169], v243 offset:40960
    ds_read_b64_tr_b16 a[170:171], v243 offset:43008
    v_mfma_f32_32x32x16_bf16 v[16:31], a[180:183], a[4:7], v[16:31]
    ds_read_b64_tr_b16 a[172:173], v244 offset:40960
    ds_read_b64_tr_b16 a[174:175], v244 offset:43008
    v_mfma_f32_32x32x16_bf16 v[32:47], a[184:187], a[4:7], v[32:47]
    ds_read_b64_tr_b16 a[176:177], v241 offset:45056
    ds_read_b64_tr_b16 a[178:179], v241 offset:47104
    v_mfma_f32_32x32x16_bf16 v[48:63], a[188:191], a[4:7], v[48:63]
    ds_read_b64_tr_b16 a[180:181], v242 offset:45056
    ds_read_b64_tr_b16 a[182:183], v242 offset:47104
    s_waitcnt lgkmcnt(4)
    v_mfma_f32_32x32x16_bf16 v[0:15], a[160:163], a[8:11], v[0:15]
    buffer_load_dwordx4 v236, s[16:19], s37 offen offset:0  lds
    v_mfma_f32_32x32x16_bf16 v[16:31], a[164:167], a[8:11], v[16:31]
    ds_read_b64_tr_b16 a[184:185], v243 offset:45056
    ds_read_b64_tr_b16 a[186:187], v243 offset:47104
    ds_read_b64_tr_b16 a[188:189], v244 offset:45056
    ds_read_b64_tr_b16 a[190:191], v244 offset:47104
    v_mfma_f32_32x32x16_bf16 v[32:47], a[168:171], a[8:11], v[32:47]
    ds_read_b64_tr_b16 a[160:161], v241 offset:49152
    ds_read_b64_tr_b16 a[162:163], v241 offset:51200
    v_mfma_f32_32x32x16_bf16 v[48:63], a[172:175], a[8:11], v[48:63]
    ds_read_b64_tr_b16 a[164:165], v242 offset:49152
    ds_read_b64_tr_b16 a[166:167], v242 offset:51200
    s_waitcnt lgkmcnt(4)
    v_mfma_f32_32x32x16_bf16 v[0:15], a[176:179], a[12:15], v[0:15]
    buffer_load_dwordx4 v237, s[16:19], s37 offen offset:1024  lds
    v_mfma_f32_32x32x16_bf16 v[16:31], a[180:183], a[12:15], v[16:31]
    ds_read_b64_tr_b16 a[168:169], v243 offset:49152
    ds_read_b64_tr_b16 a[170:171], v243 offset:51200
    ds_read_b64_tr_b16 a[172:173], v244 offset:49152
    ds_read_b64_tr_b16 a[174:175], v244 offset:51200
    s_add_u32 s36, s40, 21504
    v_mfma_f32_32x32x16_bf16 v[32:47], a[184:187], a[12:15], v[32:47]
    buffer_store_dwordx4 v[140:143], v224, s[20:23], s36 offen sc0 sc1
    v_mfma_f32_32x32x16_bf16 v[48:63], a[188:191], a[12:15], v[48:63]
    ds_read_b64_tr_b16 a[176:177], v241 offset:53248
    ds_read_b64_tr_b16 a[178:179], v241 offset:55296
    ds_read_b64_tr_b16 a[180:181], v242 offset:53248
    ds_read_b64_tr_b16 a[182:183], v242 offset:55296
    s_waitcnt lgkmcnt(4)
    v_mfma_f32_32x32x16_bf16 v[0:15], a[160:163], a[16:19], v[0:15]
    buffer_load_dwordx4 v238, s[16:19], s37 offen offset:2048  lds
    v_mfma_f32_32x32x16_bf16 v[16:31], a[164:167], a[16:19], v[16:31]
    ds_read_b64_tr_b16 a[184:185], v243 offset:53248
    ds_read_b64_tr_b16 a[186:187], v243 offset:55296
    ds_read_b64_tr_b16 a[188:189], v244 offset:53248
    ds_read_b64_tr_b16 a[190:191], v244 offset:55296
    v_mfma_f32_32x32x16_bf16 v[32:47], a[168:171], a[16:19], v[32:47]
    ds_read_b64_tr_b16 a[160:161], v241 offset:57344
    ds_read_b64_tr_b16 a[162:163], v241 offset:59392
    v_mfma_f32_32x32x16_bf16 v[48:63], a[172:175], a[16:19], v[48:63]
    ds_read_b64_tr_b16 a[164:165], v242 offset:57344
    ds_read_b64_tr_b16 a[166:167], v242 offset:59392
    s_waitcnt lgkmcnt(4)
    v_mfma_f32_32x32x16_bf16 v[0:15], a[176:179], a[20:23], v[0:15]
    buffer_load_dwordx4 v239, s[16:19], s37 offen offset:3072  lds
    v_mfma_f32_32x32x16_bf16 v[16:31], a[180:183], a[20:23], v[16:31]
    ds_read_b64_tr_b16 a[168:169], v243 offset:57344
    ds_read_b64_tr_b16 a[170:171], v243 offset:59392
    ds_read_b64_tr_b16 a[172:173], v244 offset:57344
    ds_read_b64_tr_b16 a[174:175], v244 offset:59392
    v_mfma_f32_32x32x16_bf16 v[32:47], a[184:187], a[20:23], v[32:47]
    ds_read_b64_tr_b16 a[176:177], v241 offset:61440
    ds_read_b64_tr_b16 a[178:179], v241 offset:63488
    v_mfma_f32_32x32x16_bf16 v[48:63], a[188:191], a[20:23], v[48:63]
    ds_read_b64_tr_b16 a[180:181], v242 offset:61440
    ds_read_b64_tr_b16 a[182:183], v242 offset:63488
    s_waitcnt lgkmcnt(4)
    v_mfma_f32_32x32x16_bf16 v[0:15], a[160:163], a[24:27], v[0:15]
    s_add_u32 s47, s47, 163840
    ds_read_b64_tr_b16 a[184:185], v243 offset:61440
    ds_read_b64_tr_b16 a[186:187], v243 offset:63488
    v_mfma_f32_32x32x16_bf16 v[16:31], a[164:167], a[24:27], v[16:31]
    ds_read_b64_tr_b16 a[188:189], v244 offset:61440
    ds_read_b64_tr_b16 a[190:191], v244 offset:63488
    s_add_u32 s36, s40, 22528
    v_mfma_f32_32x32x16_bf16 v[32:47], a[168:171], a[24:27], v[32:47]
    buffer_store_dwordx4 v[156:159], v224, s[20:23], s36 offen sc0 sc1
    v_mfma_f32_32x32x16_bf16 v[48:63], a[172:175], a[24:27], v[48:63]
    s_waitcnt lgkmcnt(0)
    v_mfma_f32_32x32x16_bf16 v[0:15], a[176:179], a[28:31], v[0:15]
    s_waitcnt vmcnt(14)
    s_barrier
    ds_read_b64_tr_b16 a[160:161], v225 offset:0
    ds_read_b64_tr_b16 a[162:163], v225 offset:2048
    ds_read_b64_tr_b16 a[164:165], v225 offset:4096
    ds_read_b64_tr_b16 a[166:167], v225 offset:6144
    ds_read_b64_tr_b16 a[168:169], v225 offset:8192
    ds_read_b64_tr_b16 a[170:171], v225 offset:10240
    v_mfma_f32_32x32x16_bf16 v[16:31], a[180:183], a[28:31], v[16:31]
    ds_read_b64_tr_b16 a[172:173], v225 offset:12288
    ds_read_b64_tr_b16 a[174:175], v225 offset:14336
    v_mfma_f32_32x32x16_bf16 v[32:47], a[184:187], a[28:31], v[32:47]
    ds_read_b64_tr_b16 a[176:177], v225 offset:16384
    ds_read_b64_tr_b16 a[178:179], v225 offset:18432
    v_mfma_f32_32x32x16_bf16 v[48:63], a[188:191], a[28:31], v[48:63]
    ds_read_b64_tr_b16 a[180:181], v225 offset:20480
    ds_read_b64_tr_b16 a[182:183], v225 offset:22528
    s_waitcnt lgkmcnt(4)
    v_mfma_f32_32x32x16_bf16 v[0:15], a[160:163], a[32:35], v[0:15]
    s_cmp_ge_u32 s51, 2
    s_cselect_b32 s54, s52, 1073741824
    s_add_u32 m0, s38, 98304
    ds_read_b64_tr_b16 a[184:185], v225 offset:24576
    ds_read_b64_tr_b16 a[186:187], v225 offset:26624
    v_mfma_f32_32x32x16_bf16 v[0:15], a[164:167], a[36:39], v[0:15]
    s_add_u32 s57, s54, 0
    buffer_load_dwordx4 v[64:67], v110, s[8:11], s57 offen sc1
    ds_read_b64_tr_b16 a[188:189], v225 offset:28672
    ds_read_b64_tr_b16 a[190:191], v225 offset:30720
    v_mfma_f32_32x32x16_bf16 v[0:15], a[168:171], a[40:43], v[0:15]
    s_add_u32 s57, s54, 143360
    buffer_load_dwordx4 v[68:71], v110, s[8:11], s57 offen sc1
    ds_read_b64_tr_b16 a[160:161], v226 offset:0
    ds_read_b64_tr_b16 a[162:163], v226 offset:2048
    v_mfma_f32_32x32x16_bf16 v[0:15], a[172:175], a[44:47], v[0:15]
    s_add_u32 s57, s54, 286720
    buffer_load_dwordx4 v[72:75], v110, s[8:11], s57 offen sc1
    ds_read_b64_tr_b16 a[164:165], v226 offset:4096
    ds_read_b64_tr_b16 a[166:167], v226 offset:6144
    s_waitcnt lgkmcnt(4)
    v_mfma_f32_32x32x16_bf16 v[0:15], a[176:179], a[48:51], v[0:15]
    s_add_u32 s57, s54, 430080
    buffer_load_dwordx4 v[76:79], v110, s[8:11], s57 offen sc1
    s_add_u32 s37, s47, 0
    ds_read_b64_tr_b16 a[168:169], v226 offset:8192
    ds_read_b64_tr_b16 a[170:171], v226 offset:10240
    v_mfma_f32_32x32x16_bf16 v[0:15], a[180:183], a[52:55], v[0:15]
    s_add_u32 s57, s54, 573440
    buffer_load_dwordx4 v[80:83], v110, s[8:11], s57 offen sc1
    ds_read_b64_tr_b16 a[172:173], v226 offset:12288
    ds_read_b64_tr_b16 a[174:175], v226 offset:14336
    v_mfma_f32_32x32x16_bf16 v[0:15], a[184:187], a[56:59], v[0:15]
    s_add_u32 s57, s54, 716800
    buffer_load_dwordx4 v[84:87], v110, s[8:11], s57 offen sc1
    ds_read_b64_tr_b16 a[176:177], v226 offset:16384
    ds_read_b64_tr_b16 a[178:179], v226 offset:18432
    v_mfma_f32_32x32x16_bf16 v[0:15], a[188:191], a[60:63], v[0:15]
    s_add_u32 s57, s54, 860160
    buffer_load_dwordx4 v[88:91], v110, s[8:11], s57 offen sc1
    ds_read_b64_tr_b16 a[180:181], v226 offset:20480
    ds_read_b64_tr_b16 a[182:183], v226 offset:22528
    s_waitcnt lgkmcnt(4)
    v_mfma_f32_32x32x16_bf16 v[16:31], a[160:163], a[32:35], v[16:31]
    s_add_u32 s57, s54, 1003520
    buffer_load_dwordx4 v[92:95], v110, s[8:11], s57 offen sc1
    buffer_load_dwordx4 v236, s[16:19], s37 offen offset:0  lds
    ds_read_b64_tr_b16 a[184:185], v226 offset:24576
    ds_read_b64_tr_b16 a[186:187], v226 offset:26624
    v_mfma_f32_32x32x16_bf16 v[16:31], a[164:167], a[36:39], v[16:31]
    ds_read_b64_tr_b16 a[188:189], v226 offset:28672
    ds_read_b64_tr_b16 a[190:191], v226 offset:30720
    v_cvt_pk_bf16_f32 v128, v0, v1
    v_cvt_pk_bf16_f32 v129, v2, v3
    v_cvt_pk_bf16_f32 v144, v4, v5
    v_cvt_pk_bf16_f32 v145, v6, v7
    v_mfma_f32_32x32x16_bf16 v[16:31], a[168:171], a[40:43], v[16:31]
    ds_read_b64_tr_b16 a[160:161], v227 offset:0
    ds_read_b64_tr_b16 a[162:163], v227 offset:2048
    v_cvt_pk_bf16_f32 v130, v8, v9
    v_cvt_pk_bf16_f32 v131, v10, v11
    v_cvt_pk_bf16_f32 v146, v12, v13
    v_cvt_pk_bf16_f32 v147, v14, v15
    v_mfma_f32_32x32x16_bf16 v[16:31], a[172:175], a[44:47], v[16:31]
    ds_read_b64_tr_b16 a[164:165], v227 offset:4096
    ds_read_b64_tr_b16 a[166:167], v227 offset:6144
    v_permlane32_swap_b32_e32 v128, v144
    v_permlane32_swap_b32_e32 v129, v145
    v_permlane32_swap_b32_e32 v130, v146
    v_permlane32_swap_b32_e32 v131, v147
    s_waitcnt lgkmcnt(4)
    v_mfma_f32_32x32x16_bf16 v[16:31], a[176:179], a[48:51], v[16:31]
    s_add_u32 s40, s40, 28672
    buffer_load_dwordx4 v237, s[16:19], s37 offen offset:1024  lds
    ds_read_b64_tr_b16 a[168:169], v227 offset:8192
    ds_read_b64_tr_b16 a[170:171], v227 offset:10240
    v_mfma_f32_32x32x16_bf16 v[16:31], a[180:183], a[52:55], v[16:31]
    ds_read_b64_tr_b16 a[172:173], v227 offset:12288
    ds_read_b64_tr_b16 a[174:175], v227 offset:14336
    v_permlane16_swap_b32_e32 v128, v144
    v_permlane16_swap_b32_e32 v129, v145
    v_permlane16_swap_b32_e32 v130, v146
    v_mfma_f32_32x32x16_bf16 v[16:31], a[184:187], a[56:59], v[16:31]
    v_permlane16_swap_b32_e32 v131, v147
    ds_read_b64_tr_b16 a[176:177], v227 offset:16384
    ds_read_b64_tr_b16 a[178:179], v227 offset:18432
    v_mfma_f32_32x32x16_bf16 v[16:31], a[188:191], a[60:63], v[16:31]
    ds_read_b64_tr_b16 a[180:181], v227 offset:20480
    ds_read_b64_tr_b16 a[182:183], v227 offset:22528
    s_waitcnt lgkmcnt(4)
    v_mfma_f32_32x32x16_bf16 v[32:47], a[160:163], a[32:35], v[32:47]
    buffer_load_dwordx4 v238, s[16:19], s37 offen offset:2048  lds
    ds_read_b64_tr_b16 a[184:185], v227 offset:24576
    ds_read_b64_tr_b16 a[186:187], v227 offset:26624
    v_mfma_f32_32x32x16_bf16 v[32:47], a[164:167], a[36:39], v[32:47]
    ds_read_b64_tr_b16 a[188:189], v227 offset:28672
    ds_read_b64_tr_b16 a[190:191], v227 offset:30720
    s_nop 1
    v_cvt_pk_bf16_f32 v132, v16, v17
    v_cvt_pk_bf16_f32 v133, v18, v19
    v_cvt_pk_bf16_f32 v148, v20, v21
    v_cvt_pk_bf16_f32 v149, v22, v23
    v_mfma_f32_32x32x16_bf16 v[32:47], a[168:171], a[40:43], v[32:47]
    ds_read_b64_tr_b16 a[160:161], v240 offset:0
    ds_read_b64_tr_b16 a[162:163], v240 offset:2048
    v_cvt_pk_bf16_f32 v134, v24, v25
    v_cvt_pk_bf16_f32 v135, v26, v27
    v_cvt_pk_bf16_f32 v150, v28, v29
    v_cvt_pk_bf16_f32 v151, v30, v31
    v_mfma_f32_32x32x16_bf16 v[32:47], a[172:175], a[44:47], v[32:47]
    ds_read_b64_tr_b16 a[164:165], v240 offset:4096
    ds_read_b64_tr_b16 a[166:167], v240 offset:6144
    v_permlane32_swap_b32_e32 v132, v148
    v_permlane32_swap_b32_e32 v133, v149
    v_permlane32_swap_b32_e32 v134, v150
    v_permlane32_swap_b32_e32 v135, v151
    s_waitcnt lgkmcnt(4)
    v_mfma_f32_32x32x16_bf16 v[32:47], a[176:179], a[48:51], v[32:47]
    buffer_load_dwordx4 v239, s[16:19], s37 offen offset:3072  lds
    ds_read_b64_tr_b16 a[168:169], v240 offset:8192
    ds_read_b64_tr_b16 a[170:171], v240 offset:10240
    v_mfma_f32_32x32x16_bf16 v[32:47], a[180:183], a[52:55], v[32:47]
    ds_read_b64_tr_b16 a[172:173], v240 offset:12288
    ds_read_b64_tr_b16 a[174:175], v240 offset:14336
    v_permlane16_swap_b32_e32 v132, v148
    v_permlane16_swap_b32_e32 v133, v149
    v_permlane16_swap_b32_e32 v134, v150
    v_mfma_f32_32x32x16_bf16 v[32:47], a[184:187], a[56:59], v[32:47]
    v_permlane16_swap_b32_e32 v135, v151
    ds_read_b64_tr_b16 a[176:177], v240 offset:16384
    ds_read_b64_tr_b16 a[178:179], v240 offset:18432
    v_mfma_f32_32x32x16_bf16 v[32:47], a[188:191], a[60:63], v[32:47]
    ds_read_b64_tr_b16 a[180:181], v240 offset:20480
    ds_read_b64_tr_b16 a[182:183], v240 offset:22528
    s_waitcnt lgkmcnt(4)
    v_mfma_f32_32x32x16_bf16 v[48:63], a[160:163], a[32:35], v[48:63]
    s_add_u32 s47, s47, 163840
    ds_read_b64_tr_b16 a[184:185], v240 offset:24576
    ds_read_b64_tr_b16 a[186:187], v240 offset:26624
    v_mfma_f32_32x32x16_bf16 v[48:63], a[164:167], a[36:39], v[48:63]
    ds_read_b64_tr_b16 a[188:189], v240 offset:28672
    ds_read_b64_tr_b16 a[190:191], v240 offset:30720
    s_nop 1
    v_cvt_pk_bf16_f32 v136, v32, v33
    v_cvt_pk_bf16_f32 v137, v34, v35
    v_cvt_pk_bf16_f32 v152, v36, v37
    v_cvt_pk_bf16_f32 v153, v38, v39
    v_mfma_f32_32x32x16_bf16 v[48:63], a[168:171], a[40:43], v[48:63]
    v_cvt_pk_bf16_f32 v138, v40, v41
    v_cvt_pk_bf16_f32 v139, v42, v43
    v_cvt_pk_bf16_f32 v154, v44, v45
    v_cvt_pk_bf16_f32 v155, v46, v47
    v_permlane32_swap_b32_e32 v136, v152
    v_permlane32_swap_b32_e32 v137, v153
    v_mfma_f32_32x32x16_bf16 v[48:63], a[172:175], a[44:47], v[48:63]
    s_add_u32 s52, s52, 28672
    s_add_u32 s53, s53, 256
    v_permlane32_swap_b32_e32 v138, v154
    v_permlane32_swap_b32_e32 v139, v155
    v_permlane16_swap_b32_e32 v136, v152
    v_permlane16_swap_b32_e32 v137, v153
    s_waitcnt lgkmcnt(0)
    v_mfma_f32_32x32x16_bf16 v[48:63], a[176:179], a[48:51], v[48:63]
    s_waitcnt vmcnt(20)
    s_waitcnt vmcnt(12)
    s_barrier
    ds_read_b64_tr_b16 a[160:161], v225 offset:32768
    ds_read_b64_tr_b16 a[162:163], v225 offset:34816
    ds_read_b64_tr_b16 a[164:165], v225 offset:36864
    ds_read_b64_tr_b16 a[166:167], v225 offset:38912
    ds_read_b64_tr_b16 a[168:169], v225 offset:40960
    ds_read_b64_tr_b16 a[170:171], v225 offset:43008
    v_mfma_f32_32x32x16_bf16 v[48:63], a[180:183], a[52:55], v[48:63]
    v_permlane16_swap_b32_e32 v138, v154
    v_permlane16_swap_b32_e32 v139, v155
    v_mfma_f32_32x32x16_bf16 v[48:63], a[184:187], a[56:59], v[48:63]
    v_mfma_f32_32x32x16_bf16 v[48:63], a[188:191], a[60:63], v[48:63]
    s_nop 11
    v_cvt_pk_bf16_f32 v140, v48, v49
    v_cvt_pk_bf16_f32 v141, v50, v51
    v_cvt_pk_bf16_f32 v156, v52, v53
    v_cvt_pk_bf16_f32 v157, v54, v55
    v_cvt_pk_bf16_f32 v142, v56, v57
    v_cvt_pk_bf16_f32 v143, v58, v59
    v_cvt_pk_bf16_f32 v158, v60, v61
    v_cvt_pk_bf16_f32 v159, v62, v63
    v_permlane32_swap_b32_e32 v140, v156
    v_permlane32_swap_b32_e32 v141, v157
    v_permlane32_swap_b32_e32 v142, v158
    v_permlane32_swap_b32_e32 v143, v159
    v_permlane16_swap_b32_e32 v140, v156
    v_permlane16_swap_b32_e32 v141, v157
    v_permlane16_swap_b32_e32 v142, v158
    v_permlane16_swap_b32_e32 v143, v159
    s_add_u32 s51, s51, 1
    s_cmp_lt_u32 s51, 5
    s_cbranch_scc1 A_A_ng
    s_mov_b32 s22, 143360
    s_add_u32 s36, s40, 0
    buffer_store_dwordx4 v[128:131], v224, s[20:23], s36 offen sc0 sc1
    s_add_u32 s36, s40, 1024
    buffer_store_dwordx4 v[144:147], v224, s[20:23], s36 offen sc0 sc1
    s_add_u32 s36, s40, 7168
    buffer_store_dwordx4 v[132:135], v224, s[20:23], s36 offen sc0 sc1
    s_add_u32 s36, s40, 8192
    buffer_store_dwordx4 v[148:151], v224, s[20:23], s36 offen sc0 sc1
    s_add_u32 s36, s40, 14336
    buffer_store_dwordx4 v[136:139], v224, s[20:23], s36 offen sc0 sc1
    s_add_u32 s36, s40, 15360
    buffer_store_dwordx4 v[152:155], v224, s[20:23], s36 offen sc0 sc1
    s_add_u32 s36, s40, 21504
    buffer_store_dwordx4 v[140:143], v224, s[20:23], s36 offen sc0 sc1
    s_add_u32 s36, s40, 22528
    buffer_store_dwordx4 v[156:159], v224, s[20:23], s36 offen sc0 sc1
    s_waitcnt lgkmcnt(0)
    s_branch A_red
A_A_slow:
    s_nop 15
    s_nop 15
    v_mbcnt_lo_u32_b32 v182, -1, 0
    v_mbcnt_hi_u32_b32 v182, -1, v182
    v_and_b32_e32 v183, 15, v182
    v_lshrrev_b32_e32 v182, 4, v182
    v_lshlrev_b32_e32 v176, 8, v183
    v_lshl_add_u32 v176, v182, 4, v176
    v_lshlrev_b32_e32 v177, 10, v182
    v_lshl_add_u32 v177, v183, 1, v177
    v_add_u32_e32 v178, 0x1000, v177
    s_lshl_b32 s48, s35, 17
    v_mov_b32_e32 v179, 0xff800000
    s_mov_b32 s89, 0
A_A_slow_max0:
    s_lshl_b32 s88, s89, 12
    s_add_u32 s88, s88, s48
    buffer_load_dwordx4 v[128:131], v176, s[8:11], s88 offen offset:0
    buffer_load_dwordx4 v[132:135], v176, s[8:11], s88 offen offset:64
    buffer_load_dwordx4 v[136:139], v176, s[8:11], s88 offen offset:128
    buffer_load_dwordx4 v[140:143], v176, s[8:11], s88 offen offset:192
    s_waitcnt vmcnt(0)
    v_mfma_f32_16x16x32_bf16 v[144:147], v[128:131], v[192:195], 0
    v_mfma_f32_16x16x32_bf16 v[144:147], v[132:135], v[196:199], v[144:147]
    v_mfma_f32_16x16x32_bf16 v[144:147], v[136:139], v[200:203], v[144:147]
    v_mfma_f32_16x16x32_bf16 v[144:147], v[140:143], v[204:207], v[144:147]
    s_nop 15
    v_max3_f32 v179, v179, v144, v145
    v_max3_f32 v179, v179, v146, v147
    s_add_u32 s89, s89, 1
    s_cmp_lt_u32 s89, 32
    s_cbranch_scc1 A_A_slow_max0
    v_mov_b32_e32 v180, v179
    s_nop 1
    v_permlane32_swap_b32_e32 v179, v180
    v_max_f32_e32 v179, v179, v180
    v_mov_b32_e32 v180, v179
    s_nop 1
    v_permlane16_swap_b32_e32 v179, v180
    v_max_f32_e32 v179, v179, v180
    v_mov_b32_e32 v246, 0
    v_mov_b32_e32 v64, 0
    v_mov_b32_e32 v65, 0
    v_mov_b32_e32 v66, 0
    v_mov_b32_e32 v67, 0
    v_mov_b32_e32 v68, 0
    v_mov_b32_e32 v69, 0
    v_mov_b32_e32 v70, 0
    v_mov_b32_e32 v71, 0
    v_mov_b32_e32 v72, 0
    v_mov_b32_e32 v73, 0
    v_mov_b32_e32 v74, 0
    v_mov_b32_e32 v75, 0
    v_mov_b32_e32 v76, 0
    v_mov_b32_e32 v77, 0
    v_mov_b32_e32 v78, 0
    v_mov_b32_e32 v79, 0
    v_mov_b32_e32 v80, 0
    v_mov_b32_e32 v81, 0
    v_mov_b32_e32 v82, 0
    v_mov_b32_e32 v83, 0
    v_mov_b32_e32 v84, 0
    v_mov_b32_e32 v85, 0
    v_mov_b32_e32 v86, 0
    v_mov_b32_e32 v87, 0
    v_mov_b32_e32 v88, 0
    v_mov_b32_e32 v89, 0
    v_mov_b32_e32 v90, 0
    v_mov_b32_e32 v91, 0
    v_mov_b32_e32 v92, 0
    v_mov_b32_e32 v93, 0
    v_mov_b32_e32 v94, 0
    v_mov_b32_e32 v95, 0
    s_mov_b32 s89, 0
A_A_slow_pv0:
    s_lshl_b32 s88, s89, 13
    s_add_u32 s88, s88, s48
    buffer_load_dwordx4 v[128:131], v176, s[8:11], s88 offen offset:0
    buffer_load_dwordx4 v[132:135], v176, s[8:11], s88 offen offset:64
    buffer_load_dwordx4 v[136:139], v176, s[8:11], s88 offen offset:128
    buffer_load_dwordx4 v[140:143], v176, s[8:11], s88 offen offset:192
    s_waitcnt vmcnt(0)
    v_mfma_f32_16x16x32_bf16 v[144:147], v[128:131], v[192:195], 0
    v_mfma_f32_16x16x32_bf16 v[144:147], v[132:135], v[196:199], v[144:147]
    v_mfma_f32_16x16x32_bf16 v[144:147], v[136:139], v[200:203], v[144:147]
    v_mfma_f32_16x16x32_bf16 v[144:147], v[140:143], v[204:207], v[144:147]
    s_nop 15
    s_add_u32 s88, s88, 4096
    buffer_load_dwordx4 v[128:131], v176, s[8:11], s88 offen offset:0
    buffer_load_dwordx4 v[132:135], v176, s[8:11], s88 offen offset:64
    buffer_load_dwordx4 v[136:139], v176, s[8:11], s88 offen offset:128
    buffer_load_dwordx4 v[140:143], v176, s[8:11], s88 offen offset:192
    s_waitcnt vmcnt(0)
    v_mfma_f32_16x16x32_bf16 v[148:151], v[128:131], v[192:195], 0
    v_mfma_f32_16x16x32_bf16 v[148:151], v[132:135], v[196:199], v[148:151]
    v_mfma_f32_16x16x32_bf16 v[148:151], v[136:139], v[200:203], v[148:151]
    v_mfma_f32_16x16x32_bf16 v[148:151], v[140:143], v[204:207], v[148:151]
    s_nop 15
    s_sub_u32 s88, s88, 4096
    v_sub_f32_e32 v144, v144, v179
    v_sub_f32_e32 v145, v145, v179
    v_sub_f32_e32 v146, v146, v179
    v_sub_f32_e32 v147, v147, v179
    v_sub_f32_e32 v148, v148, v179
    v_sub_f32_e32 v149, v149, v179
    v_sub_f32_e32 v150, v150, v179
    v_sub_f32_e32 v151, v151, v179
    v_exp_f32_e32 v144, v144
    v_exp_f32_e32 v145, v145
    v_exp_f32_e32 v146, v146
    v_exp_f32_e32 v147, v147
    v_exp_f32_e32 v148, v148
    v_exp_f32_e32 v149, v149
    v_exp_f32_e32 v150, v150
    v_exp_f32_e32 v151, v151
    s_nop 0
    v_add_f32_e32 v246, v246, v144
    v_add_f32_e32 v246, v246, v145
    v_add_f32_e32 v246, v246, v146
    v_add_f32_e32 v246, v246, v147
    v_add_f32_e32 v246, v246, v148
    v_add_f32_e32 v246, v246, v149
    v_add_f32_e32 v246, v246, v150
    v_add_f32_e32 v246, v246, v151
    v_cvt_pk_bf16_f32 v152, v144, v145
    v_cvt_pk_bf16_f32 v153, v146, v147
    v_cvt_pk_bf16_f32 v154, v148, v149
    v_cvt_pk_bf16_f32 v155, v150, v151
    buffer_load_ushort v160, v177, s[12:15], s88 offen offset:0
    buffer_load_ushort v161, v177, s[12:15], s88 offen offset:256
    buffer_load_ushort v162, v177, s[12:15], s88 offen offset:512
    buffer_load_ushort v163, v177, s[12:15], s88 offen offset:768
    buffer_load_ushort v164, v178, s[12:15], s88 offen offset:0
    buffer_load_ushort v165, v178, s[12:15], s88 offen offset:256
    buffer_load_ushort v166, v178, s[12:15], s88 offen offset:512
    buffer_load_ushort v167, v178, s[12:15], s88 offen offset:768
    s_waitcnt vmcnt(0)
    v_lshl_or_b32 v168, v161, 16, v160
    v_lshl_or_b32 v169, v163, 16, v162
    v_lshl_or_b32 v170, v165, 16, v164
    v_lshl_or_b32 v171, v167, 16, v166
    s_nop 1
    v_mfma_f32_16x16x32_bf16 v[64:67], v[168:171], v[152:155], v[64:67]
    s_nop 7
    buffer_load_ushort v160, v177, s[12:15], s88 offen offset:32
    buffer_load_ushort v161, v177, s[12:15], s88 offen offset:288
    buffer_load_ushort v162, v177, s[12:15], s88 offen offset:544
    buffer_load_ushort v163, v177, s[12:15], s88 offen offset:800
    buffer_load_ushort v164, v178, s[12:15], s88 offen offset:32
    buffer_load_ushort v165, v178, s[12:15], s88 offen offset:288
    buffer_load_ushort v166, v178, s[12:15], s88 offen offset:544
    buffer_load_ushort v167, v178, s[12:15], s88 offen offset:800
    s_waitcnt vmcnt(0)
    v_lshl_or_b32 v168, v161, 16, v160
    v_lshl_or_b32 v169, v163, 16, v162
    v_lshl_or_b32 v170, v165, 16, v164
    v_lshl_or_b32 v171, v167, 16, v166
    s_nop 1
    v_mfma_f32_16x16x32_bf16 v[68:71], v[168:171], v[152:155], v[68:71]
    s_nop 7
    buffer_load_ushort v160, v177, s[12:15], s88 offen offset:64
    buffer_load_ushort v161, v177, s[12:15], s88 offen offset:320
    buffer_load_ushort v162, v177, s[12:15], s88 offen offset:576
    buffer_load_ushort v163, v177, s[12:15], s88 offen offset:832
    buffer_load_ushort v164, v178, s[12:15], s88 offen offset:64
    buffer_load_ushort v165, v178, s[12:15], s88 offen offset:320
    buffer_load_ushort v166, v178, s[12:15], s88 offen offset:576
    buffer_load_ushort v167, v178, s[12:15], s88 offen offset:832
    s_waitcnt vmcnt(0)
    v_lshl_or_b32 v168, v161, 16, v160
    v_lshl_or_b32 v169, v163, 16, v162
    v_lshl_or_b32 v170, v165, 16, v164
    v_lshl_or_b32 v171, v167, 16, v166
    s_nop 1
    v_mfma_f32_16x16x32_bf16 v[72:75], v[168:171], v[152:155], v[72:75]
    s_nop 7
    buffer_load_ushort v160, v177, s[12:15], s88 offen offset:96
    buffer_load_ushort v161, v177, s[12:15], s88 offen offset:352
    buffer_load_ushort v162, v177, s[12:15], s88 offen offset:608
    buffer_load_ushort v163, v177, s[12:15], s88 offen offset:864
    buffer_load_ushort v164, v178, s[12:15], s88 offen offset:96
    buffer_load_ushort v165, v178, s[12:15], s88 offen offset:352
    buffer_load_ushort v166, v178, s[12:15], s88 offen offset:608
    buffer_load_ushort v167, v178, s[12:15], s88 offen offset:864
    s_waitcnt vmcnt(0)
    v_lshl_or_b32 v168, v161, 16, v160
    v_lshl_or_b32 v169, v163, 16, v162
    v_lshl_or_b32 v170, v165, 16, v164
    v_lshl_or_b32 v171, v167, 16, v166
    s_nop 1
    v_mfma_f32_16x16x32_bf16 v[76:79], v[168:171], v[152:155], v[76:79]
    s_nop 7
    buffer_load_ushort v160, v177, s[12:15], s88 offen offset:128
    buffer_load_ushort v161, v177, s[12:15], s88 offen offset:384
    buffer_load_ushort v162, v177, s[12:15], s88 offen offset:640
    buffer_load_ushort v163, v177, s[12:15], s88 offen offset:896
    buffer_load_ushort v164, v178, s[12:15], s88 offen offset:128
    buffer_load_ushort v165, v178, s[12:15], s88 offen offset:384
    buffer_load_ushort v166, v178, s[12:15], s88 offen offset:640
    buffer_load_ushort v167, v178, s[12:15], s88 offen offset:896
    s_waitcnt vmcnt(0)
    v_lshl_or_b32 v168, v161, 16, v160
    v_lshl_or_b32 v169, v163, 16, v162
    v_lshl_or_b32 v170, v165, 16, v164
    v_lshl_or_b32 v171, v167, 16, v166
    s_nop 1
    v_mfma_f32_16x16x32_bf16 v[80:83], v[168:171], v[152:155], v[80:83]
    s_nop 7
    buffer_load_ushort v160, v177, s[12:15], s88 offen offset:160
    buffer_load_ushort v161, v177, s[12:15], s88 offen offset:416
    buffer_load_ushort v162, v177, s[12:15], s88 offen offset:672
    buffer_load_ushort v163, v177, s[12:15], s88 offen offset:928
    buffer_load_ushort v164, v178, s[12:15], s88 offen offset:160
    buffer_load_ushort v165, v178, s[12:15], s88 offen offset:416
    buffer_load_ushort v166, v178, s[12:15], s88 offen offset:672
    buffer_load_ushort v167, v178, s[12:15], s88 offen offset:928
    s_waitcnt vmcnt(0)
    v_lshl_or_b32 v168, v161, 16, v160
    v_lshl_or_b32 v169, v163, 16, v162
    v_lshl_or_b32 v170, v165, 16, v164
    v_lshl_or_b32 v171, v167, 16, v166
    s_nop 1
    v_mfma_f32_16x16x32_bf16 v[84:87], v[168:171], v[152:155], v[84:87]
    s_nop 7
    buffer_load_ushort v160, v177, s[12:15], s88 offen offset:192
    buffer_load_ushort v161, v177, s[12:15], s88 offen offset:448
    buffer_load_ushort v162, v177, s[12:15], s88 offen offset:704
    buffer_load_ushort v163, v177, s[12:15], s88 offen offset:960
    buffer_load_ushort v164, v178, s[12:15], s88 offen offset:192
    buffer_load_ushort v165, v178, s[12:15], s88 offen offset:448
    buffer_load_ushort v166, v178, s[12:15], s88 offen offset:704
    buffer_load_ushort v167, v178, s[12:15], s88 offen offset:960
    s_waitcnt vmcnt(0)
    v_lshl_or_b32 v168, v161, 16, v160
    v_lshl_or_b32 v169, v163, 16, v162
    v_lshl_or_b32 v170, v165, 16, v164
    v_lshl_or_b32 v171, v167, 16, v166
    s_nop 1
    v_mfma_f32_16x16x32_bf16 v[88:91], v[168:171], v[152:155], v[88:91]
    s_nop 7
    buffer_load_ushort v160, v177, s[12:15], s88 offen offset:224
    buffer_load_ushort v161, v177, s[12:15], s88 offen offset:480
    buffer_load_ushort v162, v177, s[12:15], s88 offen offset:736
    buffer_load_ushort v163, v177, s[12:15], s88 offen offset:992
    buffer_load_ushort v164, v178, s[12:15], s88 offen offset:224
    buffer_load_ushort v165, v178, s[12:15], s88 offen offset:480
    buffer_load_ushort v166, v178, s[12:15], s88 offen offset:736
    buffer_load_ushort v167, v178, s[12:15], s88 offen offset:992
    s_waitcnt vmcnt(0)
    v_lshl_or_b32 v168, v161, 16, v160
    v_lshl_or_b32 v169, v163, 16, v162
    v_lshl_or_b32 v170, v165, 16, v164
    v_lshl_or_b32 v171, v167, 16, v166
    s_nop 1
    v_mfma_f32_16x16x32_bf16 v[92:95], v[168:171], v[152:155], v[92:95]
    s_nop 7
    s_add_u32 s89, s89, 1
    s_cmp_lt_u32 s89, 16
    s_cbranch_scc1 A_A_slow_pv0
    v_mov_b32_e32 v180, v246
    s_nop 1
    v_permlane32_swap_b32_e32 v246, v180
    v_add_f32_e32 v246, v246, v180
    v_mov_b32_e32 v180, v246
    s_nop 1
    v_permlane16_swap_b32_e32 v246, v180
    v_add_f32_e32 v246, v246, v180
    v_mov_b32_e32 v179, 0xff800000
    s_mov_b32 s89, 0
A_A_slow_max1:
    s_lshl_b32 s88, s89, 12
    s_add_u32 s88, s88, s48
    buffer_load_dwordx4 v[128:131], v176, s[8:11], s88 offen offset:0
    buffer_load_dwordx4 v[132:135], v176, s[8:11], s88 offen offset:64
    buffer_load_dwordx4 v[136:139], v176, s[8:11], s88 offen offset:128
    buffer_load_dwordx4 v[140:143], v176, s[8:11], s88 offen offset:192
    s_waitcnt vmcnt(0)
    v_mfma_f32_16x16x32_bf16 v[144:147], v[128:131], v[208:211], 0
    v_mfma_f32_16x16x32_bf16 v[144:147], v[132:135], v[212:215], v[144:147]
    v_mfma_f32_16x16x32_bf16 v[144:147], v[136:139], v[216:219], v[144:147]
    v_mfma_f32_16x16x32_bf16 v[144:147], v[140:143], v[220:223], v[144:147]
    s_nop 15
    v_max3_f32 v179, v179, v144, v145
    v_max3_f32 v179, v179, v146, v147
    s_add_u32 s89, s89, 1
    s_cmp_lt_u32 s89, 32
    s_cbranch_scc1 A_A_slow_max1
    v_mov_b32_e32 v180, v179
    s_nop 1
    v_permlane32_swap_b32_e32 v179, v180
    v_max_f32_e32 v179, v179, v180
    v_mov_b32_e32 v180, v179
    s_nop 1
    v_permlane16_swap_b32_e32 v179, v180
    v_max_f32_e32 v179, v179, v180
    v_mov_b32_e32 v250, 0
    v_mov_b32_e32 v96, 0
    v_mov_b32_e32 v97, 0
    v_mov_b32_e32 v98, 0
    v_mov_b32_e32 v99, 0
    v_mov_b32_e32 v100, 0
    v_mov_b32_e32 v101, 0
    v_mov_b32_e32 v102, 0
    v_mov_b32_e32 v103, 0
    v_mov_b32_e32 v104, 0
    v_mov_b32_e32 v105, 0
    v_mov_b32_e32 v106, 0
    v_mov_b32_e32 v107, 0
    v_mov_b32_e32 v108, 0
    v_mov_b32_e32 v109, 0
    v_mov_b32_e32 v110, 0
    v_mov_b32_e32 v111, 0
    v_mov_b32_e32 v112, 0
    v_mov_b32_e32 v113, 0
    v_mov_b32_e32 v114, 0
    v_mov_b32_e32 v115, 0
    v_mov_b32_e32 v116, 0
    v_mov_b32_e32 v117, 0
    v_mov_b32_e32 v118, 0
    v_mov_b32_e32 v119, 0
    v_mov_b32_e32 v120, 0
    v_mov_b32_e32 v121, 0
    v_mov_b32_e32 v122, 0
    v_mov_b32_e32 v123, 0
    v_mov_b32_e32 v124, 0
    v_mov_b32_e32 v125, 0
    v_mov_b32_e32 v126, 0
    v_mov_b32_e32 v127, 0
    s_mov_b32 s89, 0
A_A_slow_pv1:
    s_lshl_b32 s88, s89, 13
    s_add_u32 s88, s88, s48
    buffer_load_dwordx4 v[128:131], v176, s[8:11], s88 offen offset:0
    buffer_load_dwordx4 v[132:135], v176, s[8:11], s88 offen offset:64
    buffer_load_dwordx4 v[136:139], v176, s[8:11], s88 offen offset:128
    buffer_load_dwordx4 v[140:143], v176, s[8:11], s88 offen offset:192
    s_waitcnt vmcnt(0)
    v_mfma_f32_16x16x32_bf16 v[144:147], v[128:131], v[208:211], 0
    v_mfma_f32_16x16x32_bf16 v[144:147], v[132:135], v[212:215], v[144:147]
    v_mfma_f32_16x16x32_bf16 v[144:147], v[136:139], v[216:219], v[144:147]
    v_mfma_f32_16x16x32_bf16 v[144:147], v[140:143], v[220:223], v[144:147]
    s_nop 15
    s_add_u32 s88, s88, 4096
    buffer_load_dwordx4 v[128:131], v176, s[8:11], s88 offen offset:0
    buffer_load_dwordx4 v[132:135], v176, s[8:11], s88 offen offset:64
    buffer_load_dwordx4 v[136:139], v176, s[8:11], s88 offen offset:128
    buffer_load_dwordx4 v[140:143], v176, s[8:11], s88 offen offset:192
    s_waitcnt vmcnt(0)
    v_mfma_f32_16x16x32_bf16 v[148:151], v[128:131], v[208:211], 0
    v_mfma_f32_16x16x32_bf16 v[148:151], v[132:135], v[212:215], v[148:151]
    v_mfma_f32_16x16x32_bf16 v[148:151], v[136:139], v[216:219], v[148:151]
    v_mfma_f32_16x16x32_bf16 v[148:151], v[140:143], v[220:223], v[148:151]
    s_nop 15
    s_sub_u32 s88, s88, 4096
    v_sub_f32_e32 v144, v144, v179
    v_sub_f32_e32 v145, v145, v179
    v_sub_f32_e32 v146, v146, v179
    v_sub_f32_e32 v147, v147, v179
    v_sub_f32_e32 v148, v148, v179
    v_sub_f32_e32 v149, v149, v179
    v_sub_f32_e32 v150, v150, v179
    v_sub_f32_e32 v151, v151, v179
    v_exp_f32_e32 v144, v144
    v_exp_f32_e32 v145, v145
    v_exp_f32_e32 v146, v146
    v_exp_f32_e32 v147, v147
    v_exp_f32_e32 v148, v148
    v_exp_f32_e32 v149, v149
    v_exp_f32_e32 v150, v150
    v_exp_f32_e32 v151, v151
    s_nop 0
    v_add_f32_e32 v250, v250, v144
    v_add_f32_e32 v250, v250, v145
    v_add_f32_e32 v250, v250, v146
    v_add_f32_e32 v250, v250, v147
    v_add_f32_e32 v250, v250, v148
    v_add_f32_e32 v250, v250, v149
    v_add_f32_e32 v250, v250, v150
    v_add_f32_e32 v250, v250, v151
    v_cvt_pk_bf16_f32 v152, v144, v145
    v_cvt_pk_bf16_f32 v153, v146, v147
    v_cvt_pk_bf16_f32 v154, v148, v149
    v_cvt_pk_bf16_f32 v155, v150, v151
    buffer_load_ushort v160, v177, s[12:15], s88 offen offset:0
    buffer_load_ushort v161, v177, s[12:15], s88 offen offset:256
    buffer_load_ushort v162, v177, s[12:15], s88 offen offset:512
    buffer_load_ushort v163, v177, s[12:15], s88 offen offset:768
    buffer_load_ushort v164, v178, s[12:15], s88 offen offset:0
    buffer_load_ushort v165, v178, s[12:15], s88 offen offset:256
    buffer_load_ushort v166, v178, s[12:15], s88 offen offset:512
    buffer_load_ushort v167, v178, s[12:15], s88 offen offset:768
    s_waitcnt vmcnt(0)
    v_lshl_or_b32 v168, v161, 16, v160
    v_lshl_or_b32 v169, v163, 16, v162
    v_lshl_or_b32 v170, v165, 16, v164
    v_lshl_or_b32 v171, v167, 16, v166
    s_nop 1
    v_mfma_f32_16x16x32_bf16 v[96:99], v[168:171], v[152:155], v[96:99]
    s_nop 7
    buffer_load_ushort v160, v177, s[12:15], s88 offen offset:32
    buffer_load_ushort v161, v177, s[12:15], s88 offen offset:288
    buffer_load_ushort v162, v177, s[12:15], s88 offen offset:544
    buffer_load_ushort v163, v177, s[12:15], s88 offen offset:800
    buffer_load_ushort v164, v178, s[12:15], s88 offen offset:32
    buffer_load_ushort v165, v178, s[12:15], s88 offen offset:288
    buffer_load_ushort v166, v178, s[12:15], s88 offen offset:544
    buffer_load_ushort v167, v178, s[12:15], s88 offen offset:800
    s_waitcnt vmcnt(0)
    v_lshl_or_b32 v168, v161, 16, v160
    v_lshl_or_b32 v169, v163, 16, v162
    v_lshl_or_b32 v170, v165, 16, v164
    v_lshl_or_b32 v171, v167, 16, v166
    s_nop 1
    v_mfma_f32_16x16x32_bf16 v[100:103], v[168:171], v[152:155], v[100:103]
    s_nop 7
    buffer_load_ushort v160, v177, s[12:15], s88 offen offset:64
    buffer_load_ushort v161, v177, s[12:15], s88 offen offset:320
    buffer_load_ushort v162, v177, s[12:15], s88 offen offset:576
    buffer_load_ushort v163, v177, s[12:15], s88 offen offset:832
    buffer_load_ushort v164, v178, s[12:15], s88 offen offset:64
    buffer_load_ushort v165, v178, s[12:15], s88 offen offset:320
    buffer_load_ushort v166, v178, s[12:15], s88 offen offset:576
    buffer_load_ushort v167, v178, s[12:15], s88 offen offset:832
    s_waitcnt vmcnt(0)
    v_lshl_or_b32 v168, v161, 16, v160
    v_lshl_or_b32 v169, v163, 16, v162
    v_lshl_or_b32 v170, v165, 16, v164
    v_lshl_or_b32 v171, v167, 16, v166
    s_nop 1
    v_mfma_f32_16x16x32_bf16 v[104:107], v[168:171], v[152:155], v[104:107]
    s_nop 7
    buffer_load_ushort v160, v177, s[12:15], s88 offen offset:96
    buffer_load_ushort v161, v177, s[12:15], s88 offen offset:352
    buffer_load_ushort v162, v177, s[12:15], s88 offen offset:608
    buffer_load_ushort v163, v177, s[12:15], s88 offen offset:864
    buffer_load_ushort v164, v178, s[12:15], s88 offen offset:96
    buffer_load_ushort v165, v178, s[12:15], s88 offen offset:352
    buffer_load_ushort v166, v178, s[12:15], s88 offen offset:608
    buffer_load_ushort v167, v178, s[12:15], s88 offen offset:864
    s_waitcnt vmcnt(0)
    v_lshl_or_b32 v168, v161, 16, v160
    v_lshl_or_b32 v169, v163, 16, v162
    v_lshl_or_b32 v170, v165, 16, v164
    v_lshl_or_b32 v171, v167, 16, v166
    s_nop 1
    v_mfma_f32_16x16x32_bf16 v[108:111], v[168:171], v[152:155], v[108:111]
    s_nop 7
    buffer_load_ushort v160, v177, s[12:15], s88 offen offset:128
    buffer_load_ushort v161, v177, s[12:15], s88 offen offset:384
    buffer_load_ushort v162, v177, s[12:15], s88 offen offset:640
    buffer_load_ushort v163, v177, s[12:15], s88 offen offset:896
    buffer_load_ushort v164, v178, s[12:15], s88 offen offset:128
    buffer_load_ushort v165, v178, s[12:15], s88 offen offset:384
    buffer_load_ushort v166, v178, s[12:15], s88 offen offset:640
    buffer_load_ushort v167, v178, s[12:15], s88 offen offset:896
    s_waitcnt vmcnt(0)
    v_lshl_or_b32 v168, v161, 16, v160
    v_lshl_or_b32 v169, v163, 16, v162
    v_lshl_or_b32 v170, v165, 16, v164
    v_lshl_or_b32 v171, v167, 16, v166
    s_nop 1
    v_mfma_f32_16x16x32_bf16 v[112:115], v[168:171], v[152:155], v[112:115]
    s_nop 7
    buffer_load_ushort v160, v177, s[12:15], s88 offen offset:160
    buffer_load_ushort v161, v177, s[12:15], s88 offen offset:416
    buffer_load_ushort v162, v177, s[12:15], s88 offen offset:672
    buffer_load_ushort v163, v177, s[12:15], s88 offen offset:928
    buffer_load_ushort v164, v178, s[12:15], s88 offen offset:160
    buffer_load_ushort v165, v178, s[12:15], s88 offen offset:416
    buffer_load_ushort v166, v178, s[12:15], s88 offen offset:672
    buffer_load_ushort v167, v178, s[12:15], s88 offen offset:928
    s_waitcnt vmcnt(0)
    v_lshl_or_b32 v168, v161, 16, v160
    v_lshl_or_b32 v169, v163, 16, v162
    v_lshl_or_b32 v170, v165, 16, v164
    v_lshl_or_b32 v171, v167, 16, v166
    s_nop 1
    v_mfma_f32_16x16x32_bf16 v[116:119], v[168:171], v[152:155], v[116:119]
    s_nop 7
    buffer_load_ushort v160, v177, s[12:15], s88 offen offset:192
    buffer_load_ushort v161, v177, s[12:15], s88 offen offset:448
    buffer_load_ushort v162, v177, s[12:15], s88 offen offset:704
    buffer_load_ushort v163, v177, s[12:15], s88 offen offset:960
    buffer_load_ushort v164, v178, s[12:15], s88 offen offset:192
    buffer_load_ushort v165, v178, s[12:15], s88 offen offset:448
    buffer_load_ushort v166, v178, s[12:15], s88 offen offset:704
    buffer_load_ushort v167, v178, s[12:15], s88 offen offset:960
    s_waitcnt vmcnt(0)
    v_lshl_or_b32 v168, v161, 16, v160
    v_lshl_or_b32 v169, v163, 16, v162
    v_lshl_or_b32 v170, v165, 16, v164
    v_lshl_or_b32 v171, v167, 16, v166
    s_nop 1
    v_mfma_f32_16x16x32_bf16 v[120:123], v[168:171], v[152:155], v[120:123]
    s_nop 7
    buffer_load_ushort v160, v177, s[12:15], s88 offen offset:224
    buffer_load_ushort v161, v177, s[12:15], s88 offen offset:480
    buffer_load_ushort v162, v177, s[12:15], s88 offen offset:736
    buffer_load_ushort v163, v177, s[12:15], s88 offen offset:992
    buffer_load_ushort v164, v178, s[12:15], s88 offen offset:224
    buffer_load_ushort v165, v178, s[12:15], s88 offen offset:480
    buffer_load_ushort v166, v178, s[12:15], s88 offen offset:736
    buffer_load_ushort v167, v178, s[12:15], s88 offen offset:992
    s_waitcnt vmcnt(0)
    v_lshl_or_b32 v168, v161, 16, v160
    v_lshl_or_b32 v169, v163, 16, v162
    v_lshl_or_b32 v170, v165, 16, v164
    v_lshl_or_b32 v171, v167, 16, v166
    s_nop 1
    v_mfma_f32_16x16x32_bf16 v[124:127], v[168:171], v[152:155], v[124:127]
    s_nop 7
    s_add_u32 s89, s89, 1
    s_cmp_lt_u32 s89, 16
    s_cbranch_scc1 A_A_slow_pv1
    v_mov_b32_e32 v180, v250
    s_nop 1
    v_permlane32_swap_b32_e32 v250, v180
    v_add_f32_e32 v250, v250, v180
    v_mov_b32_e32 v180, v250
    s_nop 1
    v_permlane16_swap_b32_e32 v250, v180
    v_add_f32_e32 v250, v250, v180
    v_mov_b32_e32 v160, 0
    v_mov_b32_e32 v161, 0
    v_mov_b32_e32 v162, 0
    v_mov_b32_e32 v163, 0
    v_mov_b32_e32 v168, 0
    v_mov_b32_e32 v169, 0
    v_mov_b32_e32 v170, 0
    v_mov_b32_e32 v171, 0
    v_mov_b32_e32 v176, 0
    v_mov_b32_e32 v177, 0
    v_mov_b32_e32 v178, 0
    v_mov_b32_e32 v179, 0
    v_mov_b32_e32 v184, 0
    v_mov_b32_e32 v185, 0
    v_mov_b32_e32 v186, 0
    v_mov_b32_e32 v187, 0
    s_nop 15
    s_cmp_eq_u32 s87, 0
    s_cbranch_scc1 A_A_slow_ret0
    s_branch A_A_slow_ret1
A_B_start:
    s_mov_b32 m0, 32768
    s_add_u32 s37, s31, 0
    buffer_load_dwordx4 v32, s[16:19], s37 offen offset:0  lds
    buffer_load_dwordx4 v33, s[16:19], s37 offen offset:1024  lds
    buffer_load_dwordx4 v34, s[16:19], s37 offen offset:2048  lds
    buffer_load_dwordx4 v35, s[16:19], s37 offen offset:3072  lds
    s_mov_b32 m0, 36864
    s_add_u32 s37, s31, 131072
    buffer_load_dwordx4 v32, s[16:19], s37 offen offset:0  lds
    buffer_load_dwordx4 v33, s[16:19], s37 offen offset:1024  lds
    buffer_load_dwordx4 v34, s[16:19], s37 offen offset:2048  lds
    buffer_load_dwordx4 v35, s[16:19], s37 offen offset:3072  lds
    s_mov_b32 m0, 40960
    s_add_u32 s37, s31, 262144
    buffer_load_dwordx4 v32, s[16:19], s37 offen offset:0  lds
    buffer_load_dwordx4 v33, s[16:19], s37 offen offset:1024  lds
    buffer_load_dwordx4 v34, s[16:19], s37 offen offset:2048  lds
    buffer_load_dwordx4 v35, s[16:19], s37 offen offset:3072  lds
    s_mov_b32 m0, 45056
    s_add_u32 s37, s31, 393216
    buffer_load_dwordx4 v32, s[16:19], s37 offen offset:0  lds
    buffer_load_dwordx4 v33, s[16:19], s37 offen offset:1024  lds
    buffer_load_dwordx4 v34, s[16:19], s37 offen offset:2048  lds
    buffer_load_dwordx4 v35, s[16:19], s37 offen offset:3072  lds
    s_add_u32 m0, s70, 0
    s_mov_b32 s7, 0
    buffer_load_dwordx4 v144, s[24:27], s7 offen  lds
    s_add_u32 m0, s70, 1024
    s_mov_b32 s7, 5120
    buffer_load_dwordx4 v145, s[24:27], s7 offen  lds
    s_add_u32 m0, s70, 2048
    s_mov_b32 s7, 10240
    buffer_load_dwordx4 v146, s[24:27], s7 offen  lds
    s_add_u32 m0, s70, 3072
    s_mov_b32 s7, 15360
    buffer_load_dwordx4 v147, s[24:27], s7 offen  lds
    v_lshrrev_b32_e32 v5, 1, v0
    s_mul_i32 s7, s4, 40
    v_add_u32_e32 v5, s7, v5
    v_lshlrev_b32_e32 v5, 13, v5
    v_and_b32_e32 v11, 1, v0
    v_lshl_add_u32 v5, v11, 7, v5
    v_add_u32_e32 v11, 262144, v5
    v_cmp_gt_u32_e32 vcc, 16, v0
    v_mov_b32_e32 v12, 0x40000000
    s_nop 0
    v_cndmask_b32_e32 v11, v12, v11, vcc
    buffer_load_dword v47, v5, s[16:19], 0 offen
    buffer_load_dword v48, v11, s[16:19], 0 offen
    s_getpc_b64 s[96:97]
A_pc_here:
    s_sub_u32 s96, s96, A_pc_here-A_code_start
    s_subb_u32 s97, s97, 0
    s_lshr_b32 s7, s2, 3
    s_mul_i32 s7, s7, 3072
    v_lshlrev_b32_e32 v5, 7, v0
    v_add_u32_e32 v5, s7, v5
    v_min_u32_e32 v5, A_end-A_code_start-4, v5
    v_and_b32_e32 v5, 0xfffffffc, v5
    global_load_dword v42, v5, s[96:97]
    s_lshl_b32 s7, s4, 5
    s_add_u32 s7, s7, s86
    s_lshl_b32 s71, s7, 17
    s_add_u32 s8, s54, s71
    s_addc_u32 s9, s55, 0
    s_mov_b32 s10, 524288
    s_mov_b32 s11, 0x20000
    s_add_u32 s12, s56, s71
    s_addc_u32 s13, s57, 0
    s_mov_b32 s14, 524288
    s_mov_b32 s15, 0x20000
    s_mul_i32 s71, s86, 163840
    s_add_u32 s82, s82, s71
    s_addc_u32 s83, s83, 0
    s_lshl_b32 s71, s5, 4
    s_add_u32 s71, s71, s4
    s_lshl_b32 s71, s71, 3
    s_add_u32 s71, s71, s6
    s_mul_i32 s71, s71, 143360
    s_add_u32 s20, s68, s71
    s_addc_u32 s21, s69, 0
    s_mov_b32 s22, 143360
    s_mov_b32 s23, 0x20000
    s_lshl_b32 s38, s28, 12
    s_mov_b32 s42, 53248
    s_mov_b32 s43, 4294860800
    s_mov_b32 s41, 0x3e0293ee
    s_mov_b32 s35, 0
    s_mov_b32 s32, 0
    s_mov_b32 s29, 49152
    s_mov_b32 s30, 32768
    s_cmp_eq_u32 s6, 0
    s_cbranch_scc0 A_noinit
    s_lshl_b32 s60, s5, 4
    s_add_u32 s60, s60, s4
    s_lshl_b32 s61, s60, 8
    s_add_u32 s61, s61, 36700160
    s_add_u32 s96, s68, s61
    s_addc_u32 s97, s69, 0
    s_mov_b32 s98, 256
    s_mov_b32 s99, 0x20000
    v_mov_b32_e32 v44, 0
    v_lshlrev_b32_e32 v45, 2, v0
    buffer_store_dword v44, v45, s[96:99], 0 offen sc0 sc1
    s_waitcnt vmcnt(0)
    s_mov_b32 s96, s90
    s_mov_b32 s97, s91
    s_lshl_b32 s61, s60, 2
    v_mov_b32_e32 v45, s61
    v_mov_b32_e32 v44, 1
    v_cmp_eq_u32_e32 vcc, 0, v0
    v_mov_b32_e32 v46, 1073741824
    s_nop 0
    v_cndmask_b32_e32 v45, v46, v45, vcc
    buffer_atomic_add v44, v45, s[96:99], 0 offen sc1
A_noinit:
    v_add_u32_e32 v5, 0, v4
    v_xor_b32_e32 v5, v5, v3
    v_lshlrev_b32_e32 v5, 4, v5
    v_lshl_add_u32 v224, v3, 8, v5
    v_add_u32_e32 v5, 4, v4
    v_xor_b32_e32 v5, v5, v3
    v_lshlrev_b32_e32 v5, 4, v5
    v_lshl_add_u32 v225, v3, 8, v5
    v_add_u32_e32 v5, 8, v4
    v_xor_b32_e32 v5, v5, v3
    v_lshlrev_b32_e32 v5, 4, v5
    v_lshl_add_u32 v226, v3, 8, v5
    v_add_u32_e32 v5, 12, v4
    v_xor_b32_e32 v5, v5, v3
    v_lshlrev_b32_e32 v5, 4, v5
    v_lshl_add_u32 v227, v3, 8, v5
    v_lshrrev_b32_e32 v6, 2, v3
    v_and_b32_e32 v7, 3, v0
    v_lshl_add_u32 v9, v4, 2, v6
    v_and_b32_e32 v8, 7, v9
    v_lshlrev_b32_e32 v9, 8, v9
    v_lshl_add_u32 v9, v7, 3, v9
    v_xor_b32_e32 v11, 0, v8
    v_lshl_add_u32 v228, v11, 5, v9
    v_xor_b32_e32 v11, 1, v8
    v_lshl_add_u32 v229, v11, 5, v9
    v_xor_b32_e32 v11, 2, v8
    v_lshl_add_u32 v230, v11, 5, v9
    v_xor_b32_e32 v11, 3, v8
    v_lshl_add_u32 v231, v11, 5, v9
    v_xor_b32_e32 v11, 4, v8
    v_lshl_add_u32 v232, v11, 5, v9
    v_xor_b32_e32 v11, 5, v8
    v_lshl_add_u32 v233, v11, 5, v9
    v_xor_b32_e32 v11, 6, v8
    v_lshl_add_u32 v234, v11, 5, v9
    v_xor_b32_e32 v11, 7, v8
    v_lshl_add_u32 v235, v11, 5, v9
    v_lshrrev_b32_e32 v5, 1, v4
    v_add_u32_e32 v5, 0, v5
    v_xor_b32_e32 v5, v5, v3
    v_lshlrev_b32_e32 v5, 4, v5
    v_lshl_add_u32 v5, v3, 8, v5
    v_and_b32_e32 v11, 1, v4
    v_lshl_add_u32 v5, v11, 3, v5
    v_add_u32_e32 v128, s70, v5
    v_add_u32_e32 v136, 106496, v128
    v_lshrrev_b32_e32 v5, 1, v4
    v_add_u32_e32 v5, 2, v5
    v_xor_b32_e32 v5, v5, v3
    v_lshlrev_b32_e32 v5, 4, v5
    v_lshl_add_u32 v5, v3, 8, v5
    v_and_b32_e32 v11, 1, v4
    v_lshl_add_u32 v5, v11, 3, v5
    v_add_u32_e32 v129, s70, v5
    v_add_u32_e32 v137, 106496, v129
    v_lshrrev_b32_e32 v5, 1, v4
    v_add_u32_e32 v5, 4, v5
    v_xor_b32_e32 v5, v5, v3
    v_lshlrev_b32_e32 v5, 4, v5
    v_lshl_add_u32 v5, v3, 8, v5
    v_and_b32_e32 v11, 1, v4
    v_lshl_add_u32 v5, v11, 3, v5
    v_add_u32_e32 v130, s70, v5
    v_add_u32_e32 v138, 106496, v130
    v_lshrrev_b32_e32 v5, 1, v4
    v_add_u32_e32 v5, 6, v5
    v_xor_b32_e32 v5, v5, v3
    v_lshlrev_b32_e32 v5, 4, v5
    v_lshl_add_u32 v5, v3, 8, v5
    v_and_b32_e32 v11, 1, v4
    v_lshl_add_u32 v5, v11, 3, v5
    v_add_u32_e32 v131, s70, v5
    v_add_u32_e32 v139, 106496, v131
    v_lshrrev_b32_e32 v5, 1, v4
    v_add_u32_e32 v5, 8, v5
    v_xor_b32_e32 v5, v5, v3
    v_lshlrev_b32_e32 v5, 4, v5
    v_lshl_add_u32 v5, v3, 8, v5
    v_and_b32_e32 v11, 1, v4
    v_lshl_add_u32 v5, v11, 3, v5
    v_add_u32_e32 v132, s70, v5
    v_add_u32_e32 v140, 106496, v132
    v_lshrrev_b32_e32 v5, 1, v4
    v_add_u32_e32 v5, 10, v5
    v_xor_b32_e32 v5, v5, v3
    v_lshlrev_b32_e32 v5, 4, v5
    v_lshl_add_u32 v5, v3, 8, v5
    v_and_b32_e32 v11, 1, v4
    v_lshl_add_u32 v5, v11, 3, v5
    v_add_u32_e32 v133, s70, v5
    v_add_u32_e32 v141, 106496, v133
    v_lshrrev_b32_e32 v5, 1, v4
    v_add_u32_e32 v5, 12, v5
    v_xor_b32_e32 v5, v5, v3
    v_lshlrev_b32_e32 v5, 4, v5
    v_lshl_add_u32 v5, v3, 8, v5
    v_and_b32_e32 v11, 1, v4
    v_lshl_add_u32 v5, v11, 3, v5
    v_add_u32_e32 v134, s70, v5
    v_add_u32_e32 v142, 106496, v134
    v_lshrrev_b32_e32 v5, 1, v4
    v_add_u32_e32 v5, 14, v5
    v_xor_b32_e32 v5, v5, v3
    v_lshlrev_b32_e32 v5, 4, v5
    v_lshl_add_u32 v5, v3, 8, v5
    v_and_b32_e32 v11, 1, v4
    v_lshl_add_u32 v5, v11, 3, v5
    v_add_u32_e32 v135, s70, v5
    v_add_u32_e32 v143, 106496, v135
    v_add_u32_e32 v5, 0, v4
    v_xor_b32_e32 v5, v5, v3
    v_lshlrev_b32_e32 v5, 4, v5
    v_lshl_add_u32 v5, v4, 8, v5
    v_add_u32_e32 v236, s38, v5
    v_add_u32_e32 v5, 4, v4
    v_xor_b32_e32 v5, v5, v3
    v_lshlrev_b32_e32 v5, 4, v5
    v_lshl_add_u32 v5, v4, 8, v5
    v_add_u32_e32 v237, s38, v5
    v_add_u32_e32 v5, 8, v4
    v_xor_b32_e32 v5, v5, v3
    v_lshlrev_b32_e32 v5, 4, v5
    v_lshl_add_u32 v5, v4, 8, v5
    v_add_u32_e32 v238, s38, v5
    v_add_u32_e32 v5, 12, v4
    v_xor_b32_e32 v5, v5, v3
    v_lshlrev_b32_e32 v5, 4, v5
    v_lshl_add_u32 v5, v4, 8, v5
    v_add_u32_e32 v239, s38, v5
    v_add_u32_e32 v5, 0, v4
    v_lshlrev_b32_e32 v5, 1, v5
    v_xor_b32_e32 v5, v5, v3
    v_lshlrev_b32_e32 v12, 4, v5
    v_lshl_add_u32 v12, v4, 8, v12
    v_add_u32_e32 v240, s38, v12
    v_add_u32_e32 v5, 4, v4
    v_lshlrev_b32_e32 v5, 1, v5
    v_xor_b32_e32 v5, v5, v3
    v_lshlrev_b32_e32 v12, 4, v5
    v_lshl_add_u32 v12, v4, 8, v12
    v_add_u32_e32 v241, s38, v12
    v_mov_b32_e32 v242, 0x3f803f80
    v_mov_b32_e32 v243, 0x3f803f80
    v_mov_b32_e32 v244, 0x3f803f80
    v_mov_b32_e32 v245, 0x3f803f80
    s_mul_i32 s7, s4, 40960
    v_lshlrev_b32_e32 v40, 7, v0
    v_add_u32_e32 v40, s7, v40
    s_mov_b32 s92, s82
    s_mov_b32 s93, s83
    s_mov_b32 s94, 0
    s_mov_b32 s95, 0x20000
    s_waitcnt vmcnt(3)
    ds_read_b64 a[0:1], v128 offset:0
    ds_read_b64 a[2:3], v129 offset:0
    ds_read_b64 a[8:9], v130 offset:0
    ds_read_b64 a[10:11], v131 offset:0
    ds_read_b64 a[16:17], v132 offset:0
    ds_read_b64 a[18:19], v133 offset:0
    ds_read_b64 a[24:25], v134 offset:0
    ds_read_b64 a[26:27], v135 offset:0
    s_barrier
    ds_read_b64_tr_b16 a[160:161], v228 offset:32768
    ds_read_b64_tr_b16 a[162:163], v228 offset:36864
    ds_read_b64_tr_b16 a[164:165], v229 offset:32768
    ds_read_b64_tr_b16 a[166:167], v229 offset:36864
    ds_read_b64_tr_b16 a[168:169], v230 offset:32768
    ds_read_b64_tr_b16 a[170:171], v230 offset:36864
    s_waitcnt lgkmcnt(0)
    v_mfma_f32_16x16x32_bf16 v[0:3], a[160:163], a[0:3], 0
    s_mov_b32 m0, 159744
    s_add_u32 s37, s31, 524288
    buffer_load_dwordx4 v32, s[16:19], s37 offen offset:0  lds
    buffer_load_dwordx4 v33, s[16:19], s37 offen offset:1024  lds
    buffer_load_dwordx4 v34, s[16:19], s37 offen offset:2048  lds
    buffer_load_dwordx4 v35, s[16:19], s37 offen offset:3072  lds
    s_mov_b32 m0, 86016
    ds_read_b64_tr_b16 a[172:173], v231 offset:32768
    ds_read_b64_tr_b16 a[174:175], v231 offset:36864
    ds_read_b64_tr_b16 a[176:177], v232 offset:32768
    ds_read_b64_tr_b16 a[178:179], v232 offset:36864
    ds_read_b64_tr_b16 a[180:181], v233 offset:32768
    ds_read_b64_tr_b16 a[182:183], v233 offset:36864
    ds_read_b64_tr_b16 a[184:185], v234 offset:32768
    ds_read_b64_tr_b16 a[186:187], v234 offset:36864
    v_mfma_f32_16x16x32_bf16 v[4:7], a[164:167], a[0:3], 0
    s_add_u32 s37, s31, 655360
    buffer_load_dwordx4 v32, s[16:19], s37 offen offset:0  lds
    buffer_load_dwordx4 v33, s[16:19], s37 offen offset:1024  lds
    buffer_load_dwordx4 v34, s[16:19], s37 offen offset:2048  lds
    buffer_load_dwordx4 v35, s[16:19], s37 offen offset:3072  lds
    s_mov_b32 m0, 90112
    s_add_u32 s37, s31, 786432
    ds_read_b64_tr_b16 a[188:189], v235 offset:32768
    ds_read_b64_tr_b16 a[190:191], v235 offset:36864
    v_mfma_f32_16x16x32_bf16 v[8:11], a[168:171], a[0:3], 0
    buffer_load_dwordx4 v32, s[16:19], s37 offen offset:0  lds
    buffer_load_dwordx4 v33, s[16:19], s37 offen offset:1024  lds
    buffer_load_dwordx4 v34, s[16:19], s37 offen offset:2048  lds
    buffer_load_dwordx4 v35, s[16:19], s37 offen offset:3072  lds
    s_mov_b32 m0, 94208
    s_add_u32 s37, s31, 917504
    buffer_load_dwordx4 v32, s[16:19], s37 offen offset:0  lds
    ds_read_b64_tr_b16 a[160:161], v228 offset:40960
    ds_read_b64_tr_b16 a[162:163], v228 offset:45056
    s_waitcnt lgkmcnt(10)
    v_mfma_f32_16x16x32_bf16 v[12:15], a[172:175], a[0:3], 0
    buffer_load_dwordx4 v33, s[16:19], s37 offen offset:1024  lds
    buffer_load_dwordx4 v34, s[16:19], s37 offen offset:2048  lds
    buffer_load_dwordx4 v35, s[16:19], s37 offen offset:3072  lds
    s_mov_b32 m0, 98304
    s_add_u32 s37, s31, 1048576
    buffer_load_dwordx4 v32, s[16:19], s37 offen offset:0  lds
    buffer_load_dwordx4 v33, s[16:19], s37 offen offset:1024  lds
    ds_read_b64_tr_b16 a[164:165], v229 offset:40960
    ds_read_b64_tr_b16 a[166:167], v229 offset:45056
    s_waitcnt lgkmcnt(4)
    v_mfma_f32_16x16x32_bf16 v[16:19], a[176:179], a[0:3], 0
    buffer_load_dwordx4 v34, s[16:19], s37 offen offset:2048  lds
    buffer_load_dwordx4 v35, s[16:19], s37 offen offset:3072  lds
    s_mov_b32 m0, 102400
    s_add_u32 s37, s31, 1179648
    buffer_load_dwordx4 v32, s[16:19], s37 offen offset:0  lds
    buffer_load_dwordx4 v33, s[16:19], s37 offen offset:1024  lds
    buffer_load_dwordx4 v34, s[16:19], s37 offen offset:2048  lds
    ds_read_b64_tr_b16 a[168:169], v230 offset:40960
    ds_read_b64_tr_b16 a[170:171], v230 offset:45056
    v_mfma_f32_16x16x32_bf16 v[20:23], a[180:183], a[0:3], 0
    buffer_load_dwordx4 v35, s[16:19], s37 offen offset:3072  lds
    s_add_u32 m0, s70, 53248
    s_mov_b32 s7, 256
    buffer_load_dwordx4 v144, s[24:27], s7 offen  lds
    s_add_u32 m0, s70, 54272
    s_mov_b32 s7, 5376
    buffer_load_dwordx4 v145, s[24:27], s7 offen  lds
    ds_read_b64_tr_b16 a[172:173], v231 offset:40960
    ds_read_b64_tr_b16 a[174:175], v231 offset:45056
    v_mfma_f32_16x16x32_bf16 v[24:27], a[184:187], a[0:3], 0
    s_add_u32 m0, s70, 55296
    s_mov_b32 s7, 10496
    buffer_load_dwordx4 v146, s[24:27], s7 offen  lds
    s_add_u32 m0, s70, 56320
    s_mov_b32 s7, 15616
    buffer_load_dwordx4 v147, s[24:27], s7 offen  lds
    s_mov_b32 m0, 139264
    ds_read_b64_tr_b16 a[176:177], v232 offset:40960
    ds_read_b64_tr_b16 a[178:179], v232 offset:45056
    v_mfma_f32_16x16x32_bf16 v[28:31], a[188:191], a[0:3], 0
    s_add_u32 s37, s31, 1310720
    buffer_load_dwordx4 v32, s[16:19], s37 offen offset:0  lds
    buffer_load_dwordx4 v33, s[16:19], s37 offen offset:1024  lds
    buffer_load_dwordx4 v34, s[16:19], s37 offen offset:2048  lds
    buffer_load_dwordx4 v35, s[16:19], s37 offen offset:3072  lds
    s_mov_b32 m0, 143360
    s_add_u32 s37, s31, 1441792
    ds_read_b64_tr_b16 a[180:181], v233 offset:40960
    ds_read_b64_tr_b16 a[182:183], v233 offset:45056
    s_waitcnt lgkmcnt(4)
    v_mfma_f32_16x16x32_bf16 v[0:3], a[160:163], a[8:11], v[0:3]
    buffer_load_dwordx4 v32, s[16:19], s37 offen offset:0  lds
    buffer_load_dwordx4 v33, s[16:19], s37 offen offset:1024  lds
    buffer_load_dwordx4 v34, s[16:19], s37 offen offset:2048  lds
    buffer_load_dwordx4 v35, s[16:19], s37 offen offset:3072  lds
    s_mov_b32 m0, 147456
    s_add_u32 s37, s31, 1572864
    buffer_load_dwordx4 v32, s[16:19], s37 offen offset:0  lds
    ds_read_b64_tr_b16 a[184:185], v234 offset:40960
    ds_read_b64_tr_b16 a[186:187], v234 offset:45056
    v_mfma_f32_16x16x32_bf16 v[4:7], a[164:167], a[8:11], v[4:7]
    buffer_load_dwordx4 v33, s[16:19], s37 offen offset:1024  lds
    buffer_load_dwordx4 v34, s[16:19], s37 offen offset:2048  lds
    buffer_load_dwordx4 v35, s[16:19], s37 offen offset:3072  lds
    s_mov_b32 m0, 151552
    s_add_u32 s37, s31, 1703936
    buffer_load_dwordx4 v32, s[16:19], s37 offen offset:0  lds
    buffer_load_dwordx4 v33, s[16:19], s37 offen offset:1024  lds
    ds_read_b64_tr_b16 a[188:189], v235 offset:40960
    ds_read_b64_tr_b16 a[190:191], v235 offset:45056
    v_mfma_f32_16x16x32_bf16 v[8:11], a[168:171], a[8:11], v[8:11]
    buffer_load_dwordx4 v34, s[16:19], s37 offen offset:2048  lds
    buffer_load_dwordx4 v35, s[16:19], s37 offen offset:3072  lds
    s_add_u32 m0, s70, 106496
    s_mov_b32 s7, 512
    buffer_load_dwordx4 v144, s[24:27], s7 offen  lds
    s_add_u32 m0, s70, 107520
    s_mov_b32 s7, 5632
    v_mfma_f32_16x16x32_bf16 v[12:15], a[172:175], a[8:11], v[12:15]
    buffer_load_dwordx4 v145, s[24:27], s7 offen  lds
    s_add_u32 m0, s70, 108544
    s_mov_b32 s7, 10752
    buffer_load_dwordx4 v146, s[24:27], s7 offen  lds
    s_add_u32 m0, s70, 109568
    s_mov_b32 s7, 15872
    buffer_load_dwordx4 v147, s[24:27], s7 offen  lds
    s_waitcnt lgkmcnt(0)
    v_mfma_f32_16x16x32_bf16 v[16:19], a[176:179], a[8:11], v[16:19]
    s_waitcnt vmcnt(24)
    s_barrier
    s_mov_b32 s50, s32
    s_add_u32 s34, s32, s38
    s_add_u32 s32, s32, s42
    s_cmp_eq_u32 s32, 159744
    s_cselect_b32 s33, s43, s42
    s_cselect_b32 s32, 0, s32
    s_sub_u32 s39, 159744, s32
    v_add_u32_e32 v228, s33, v228
    v_add_u32_e32 v254, s39, v228
    ds_read_b64_tr_b16 a[160:161], v254 offset:0
    ds_read_b64_tr_b16 a[162:163], v228 offset:32768
    v_add_u32_e32 v229, s33, v229
    v_add_u32_e32 v254, s39, v229
    ds_read_b64_tr_b16 a[164:165], v254 offset:0
    ds_read_b64_tr_b16 a[166:167], v229 offset:32768
    v_add_u32_e32 v230, s33, v230
    v_add_u32_e32 v254, s39, v230
    ds_read_b64_tr_b16 a[168:169], v254 offset:0
    ds_read_b64_tr_b16 a[170:171], v230 offset:32768
    v_mfma_f32_16x16x32_bf16 v[20:23], a[180:183], a[8:11], v[20:23]
    v_add_u32_e32 v231, s33, v231
    v_add_u32_e32 v254, s39, v231
    ds_read_b64_tr_b16 a[172:173], v254 offset:0
    ds_read_b64_tr_b16 a[174:175], v231 offset:32768
    v_mfma_f32_16x16x32_bf16 v[24:27], a[184:187], a[8:11], v[24:27]
    v_add_u32_e32 v232, s33, v232
    v_add_u32_e32 v254, s39, v232
    ds_read_b64_tr_b16 a[176:177], v254 offset:0
    ds_read_b64_tr_b16 a[178:179], v232 offset:32768
    v_mfma_f32_16x16x32_bf16 v[28:31], a[188:191], a[8:11], v[28:31]
    v_add_u32_e32 v233, s33, v233
    v_add_u32_e32 v254, s39, v233
    ds_read_b64_tr_b16 a[180:181], v254 offset:0
    ds_read_b64_tr_b16 a[182:183], v233 offset:32768
    s_waitcnt lgkmcnt(4)
    v_mfma_f32_16x16x32_bf16 v[0:3], a[160:163], a[16:19], v[0:3]
    s_waitcnt vmcnt(20)
    ds_read_b64 a[32:33], v128 offset:53248
    ds_read_b64 a[34:35], v129 offset:53248
    ds_read_b64 a[40:41], v130 offset:53248
    ds_read_b64 a[42:43], v131 offset:53248
    ds_read_b64 a[48:49], v132 offset:53248
    ds_read_b64 a[50:51], v133 offset:53248
    ds_read_b64 a[56:57], v134 offset:53248
    ds_read_b64 a[58:59], v135 offset:53248
    s_add_u32 m0, s50, 32768
    s_add_u32 s37, s31, 1966080
    buffer_load_dwordx4 v32, s[16:19], s37 offen offset:0  lds
    v_add_u32_e32 v234, s33, v234
    v_add_u32_e32 v254, s39, v234
    ds_read_b64_tr_b16 a[184:185], v254 offset:0
    ds_read_b64_tr_b16 a[186:187], v234 offset:32768
    v_mfma_f32_16x16x32_bf16 v[4:7], a[164:167], a[16:19], v[4:7]
    buffer_load_dwordx4 v33, s[16:19], s37 offen offset:1024  lds
    buffer_load_dwordx4 v34, s[16:19], s37 offen offset:2048  lds
    v_add_u32_e32 v235, s33, v235
    v_add_u32_e32 v254, s39, v235
    ds_read_b64_tr_b16 a[188:189], v254 offset:0
    ds_read_b64_tr_b16 a[190:191], v235 offset:32768
    s_waitcnt lgkmcnt(15)
    v_mfma_f32_16x16x32_bf16 v[8:11], a[168:171], a[16:19], v[8:11]
    buffer_load_dwordx4 v35, s[16:19], s37 offen offset:3072  lds
    s_add_u32 m0, s50, 36864
    ds_read_b64_tr_b16 a[160:161], v228 offset:36864
    ds_read_b64_tr_b16 a[162:163], v228 offset:40960
    s_waitcnt lgkmcnt(15)
    v_mfma_f32_16x16x32_bf16 v[12:15], a[172:175], a[16:19], v[12:15]
    s_add_u32 s37, s31, 2097152
    buffer_load_dwordx4 v32, s[16:19], s37 offen offset:0  lds
    ds_read_b64_tr_b16 a[164:165], v229 offset:36864
    ds_read_b64_tr_b16 a[166:167], v229 offset:40960
    s_waitcnt lgkmcnt(4)
    v_mfma_f32_16x16x32_bf16 v[16:19], a[176:179], a[16:19], v[16:19]
    buffer_load_dwordx4 v33, s[16:19], s37 offen offset:1024  lds
    buffer_load_dwordx4 v34, s[16:19], s37 offen offset:2048  lds
    ds_read_b64_tr_b16 a[168:169], v230 offset:36864
    ds_read_b64_tr_b16 a[170:171], v230 offset:40960
    v_mfma_f32_16x16x32_bf16 v[20:23], a[180:183], a[16:19], v[20:23]
    buffer_load_dwordx4 v35, s[16:19], s37 offen offset:3072  lds
    s_add_u32 m0, s50, 40960
    ds_read_b64_tr_b16 a[172:173], v231 offset:36864
    ds_read_b64_tr_b16 a[174:175], v231 offset:40960
    v_mfma_f32_16x16x32_bf16 v[24:27], a[184:187], a[16:19], v[24:27]
    s_add_u32 s37, s31, 2228224
    buffer_load_dwordx4 v32, s[16:19], s37 offen offset:0  lds
    ds_read_b64_tr_b16 a[176:177], v232 offset:36864
    ds_read_b64_tr_b16 a[178:179], v232 offset:40960
    v_mfma_f32_16x16x32_bf16 v[28:31], a[188:191], a[16:19], v[28:31]
    buffer_load_dwordx4 v33, s[16:19], s37 offen offset:1024  lds
    buffer_load_dwordx4 v34, s[16:19], s37 offen offset:2048  lds
    ds_read_b64_tr_b16 a[180:181], v233 offset:36864
    ds_read_b64_tr_b16 a[182:183], v233 offset:40960
    s_waitcnt lgkmcnt(4)
    v_mfma_f32_16x16x32_bf16 v[0:3], a[160:163], a[24:27], v[0:3]
    buffer_load_dwordx4 v35, s[16:19], s37 offen offset:3072  lds
    s_add_u32 m0, s50, 45056
    ds_read_b64_tr_b16 a[184:185], v234 offset:36864
    ds_read_b64_tr_b16 a[186:187], v234 offset:40960
    v_mfma_f32_16x16x32_bf16 v[4:7], a[164:167], a[24:27], v[4:7]
    s_add_u32 s37, s31, 2359296
    buffer_load_dwordx4 v32, s[16:19], s37 offen offset:0  lds
    ds_read_b64_tr_b16 a[188:189], v235 offset:36864
    ds_read_b64_tr_b16 a[190:191], v235 offset:40960
    v_mfma_f32_16x16x32_bf16 v[8:11], a[168:171], a[24:27], v[8:11]
    buffer_load_dwordx4 v33, s[16:19], s37 offen offset:1024  lds
    buffer_load_dwordx4 v34, s[16:19], s37 offen offset:2048  lds
    buffer_load_dwordx4 v35, s[16:19], s37 offen offset:3072  lds
    ds_read_b64_tr_b16 a[160:161], v228 offset:45056
    ds_read_b64_tr_b16 a[162:163], v228 offset:49152
    v_mfma_f32_16x16x32_bf16 v[12:15], a[172:175], a[24:27], v[12:15]
    s_add_u32 m0, s50, 49152
    s_add_u32 s37, s31, 2490368
    ds_read_b64_tr_b16 a[164:165], v229 offset:45056
    ds_read_b64_tr_b16 a[166:167], v229 offset:49152
    s_waitcnt lgkmcnt(4)
    v_mfma_f32_16x16x32_bf16 v[16:19], a[176:179], a[24:27], v[16:19]
    buffer_load_dwordx4 v32, s[16:19], s37 offen offset:0  lds
    buffer_load_dwordx4 v33, s[16:19], s37 offen offset:1024  lds
    ds_read_b64_tr_b16 a[168:169], v230 offset:45056
    ds_read_b64_tr_b16 a[170:171], v230 offset:49152
    v_mfma_f32_16x16x32_bf16 v[20:23], a[180:183], a[24:27], v[20:23]
    buffer_load_dwordx4 v34, s[16:19], s37 offen offset:2048  lds
    buffer_load_dwordx4 v35, s[16:19], s37 offen offset:3072  lds
    ds_read_b64_tr_b16 a[172:173], v231 offset:45056
    ds_read_b64_tr_b16 a[174:175], v231 offset:49152
    v_mfma_f32_16x16x32_bf16 v[24:27], a[184:187], a[24:27], v[24:27]
    s_add_u32 m0, s70, 0
    s_mov_b32 s7, 768
    ds_read_b64_tr_b16 a[176:177], v232 offset:45056
    ds_read_b64_tr_b16 a[178:179], v232 offset:49152
    v_mfma_f32_16x16x32_bf16 v[28:31], a[188:191], a[24:27], v[28:31]
    buffer_load_dwordx4 v144, s[24:27], s7 offen  lds
    s_add_u32 m0, s70, 1024
    ds_read_b64_tr_b16 a[180:181], v233 offset:45056
    ds_read_b64_tr_b16 a[182:183], v233 offset:49152
    s_waitcnt lgkmcnt(4)
    v_mfma_f32_16x16x32_bf16 v[0:3], a[160:163], a[32:35], v[0:3]
    s_mov_b32 s7, 5888
    buffer_load_dwordx4 v145, s[24:27], s7 offen  lds
    ds_read_b64_tr_b16 a[184:185], v234 offset:45056
    ds_read_b64_tr_b16 a[186:187], v234 offset:49152
    v_mfma_f32_16x16x32_bf16 v[4:7], a[164:167], a[32:35], v[4:7]
    s_add_u32 m0, s70, 2048
    s_mov_b32 s7, 11008
    ds_read_b64_tr_b16 a[188:189], v235 offset:45056
    ds_read_b64_tr_b16 a[190:191], v235 offset:49152
    v_mfma_f32_16x16x32_bf16 v[8:11], a[168:171], a[32:35], v[8:11]
    buffer_load_dwordx4 v146, s[24:27], s7 offen  lds
    s_add_u32 m0, s70, 3072
    v_mfma_f32_16x16x32_bf16 v[12:15], a[172:175], a[32:35], v[12:15]
    s_mov_b32 s7, 16128
    buffer_load_dwordx4 v147, s[24:27], s7 offen  lds
    s_waitcnt lgkmcnt(0)
    v_mfma_f32_16x16x32_bf16 v[16:19], a[176:179], a[32:35], v[16:19]
    v_add_u32_e32 v224, s33, v224
    v_add_u32_e32 v225, s33, v225
    v_add_u32_e32 v226, s33, v226
    v_add_u32_e32 v227, s33, v227
    s_waitcnt vmcnt(28)
    s_barrier
    s_mov_b32 s50, s32
    s_add_u32 s34, s32, s38
    s_add_u32 s32, s32, s42
    s_cmp_eq_u32 s32, 159744
    s_cselect_b32 s33, s43, s42
    s_cselect_b32 s32, 0, s32
    v_add_u32_e32 v228, s33, v228
    ds_read_b64_tr_b16 a[160:161], v228 offset:32768
    ds_read_b64_tr_b16 a[162:163], v228 offset:36864
    v_add_u32_e32 v229, s33, v229
    ds_read_b64_tr_b16 a[164:165], v229 offset:32768
    ds_read_b64_tr_b16 a[166:167], v229 offset:36864
    v_add_u32_e32 v230, s33, v230
    ds_read_b64_tr_b16 a[168:169], v230 offset:32768
    ds_read_b64_tr_b16 a[170:171], v230 offset:36864
    v_mfma_f32_16x16x32_bf16 v[20:23], a[180:183], a[32:35], v[20:23]
    v_add_u32_e32 v231, s33, v231
    ds_read_b64_tr_b16 a[172:173], v231 offset:32768
    ds_read_b64_tr_b16 a[174:175], v231 offset:36864
    v_mfma_f32_16x16x32_bf16 v[24:27], a[184:187], a[32:35], v[24:27]
    v_add_u32_e32 v232, s33, v232
    ds_read_b64_tr_b16 a[176:177], v232 offset:32768
    ds_read_b64_tr_b16 a[178:179], v232 offset:36864
    v_mfma_f32_16x16x32_bf16 v[28:31], a[188:191], a[32:35], v[28:31]
    v_add_u32_e32 v233, s33, v233
    ds_read_b64_tr_b16 a[180:181], v233 offset:32768
    ds_read_b64_tr_b16 a[182:183], v233 offset:36864
    s_waitcnt lgkmcnt(4)
    v_mfma_f32_16x16x32_bf16 v[0:3], a[160:163], a[40:43], v[0:3]
    s_waitcnt vmcnt(24)
    ds_read_b64 a[64:65], v136 offset:0
    ds_read_b64 a[66:67], v137 offset:0
    ds_read_b64 a[72:73], v138 offset:0
    ds_read_b64 a[74:75], v139 offset:0
    ds_read_b64 a[80:81], v140 offset:0
    ds_read_b64 a[82:83], v141 offset:0
    ds_read_b64 a[88:89], v142 offset:0
    ds_read_b64 a[90:91], v143 offset:0
    s_mov_b32 m0, 159744
    s_add_u32 s37, s31, 1835008
    buffer_load_dwordx4 v32, s[16:19], s37 offen offset:0  lds
    buffer_load_dwordx4 v33, s[16:19], s37 offen offset:1024  lds
    v_add_u32_e32 v234, s33, v234
    ds_read_b64_tr_b16 a[184:185], v234 offset:32768
    ds_read_b64_tr_b16 a[186:187], v234 offset:36864
    v_mfma_f32_16x16x32_bf16 v[4:7], a[164:167], a[40:43], v[4:7]
    buffer_load_dwordx4 v34, s[16:19], s37 offen offset:2048  lds
    buffer_load_dwordx4 v35, s[16:19], s37 offen offset:3072  lds
    s_add_u32 m0, s50, 32768
    s_add_u32 s37, s31, 2621440
    v_add_u32_e32 v235, s33, v235
    ds_read_b64_tr_b16 a[188:189], v235 offset:32768
    ds_read_b64_tr_b16 a[190:191], v235 offset:36864
    s_waitcnt lgkmcnt(15)
    v_mfma_f32_16x16x32_bf16 v[8:11], a[168:171], a[40:43], v[8:11]
    buffer_load_dwordx4 v32, s[16:19], s37 offen offset:0  lds
    buffer_load_dwordx4 v33, s[16:19], s37 offen offset:1024  lds
    buffer_load_dwordx4 v34, s[16:19], s37 offen offset:2048  lds
    ds_read_b64_tr_b16 a[160:161], v228 offset:40960
    ds_read_b64_tr_b16 a[162:163], v228 offset:45056
    s_waitcnt lgkmcnt(15)
    v_mfma_f32_16x16x32_bf16 v[12:15], a[172:175], a[40:43], v[12:15]
    buffer_load_dwordx4 v35, s[16:19], s37 offen offset:3072  lds
    s_add_u32 m0, s50, 36864
    s_add_u32 s37, s31, 2752512
    buffer_load_dwordx4 v32, s[16:19], s37 offen offset:0  lds
    ds_read_b64_tr_b16 a[164:165], v229 offset:40960
    ds_read_b64_tr_b16 a[166:167], v229 offset:45056
    s_waitcnt lgkmcnt(4)
    v_mfma_f32_16x16x32_bf16 v[16:19], a[176:179], a[40:43], v[16:19]
    buffer_load_dwordx4 v33, s[16:19], s37 offen offset:1024  lds
    buffer_load_dwordx4 v34, s[16:19], s37 offen offset:2048  lds
    buffer_load_dwordx4 v35, s[16:19], s37 offen offset:3072  lds
    ds_read_b64_tr_b16 a[168:169], v230 offset:40960
    ds_read_b64_tr_b16 a[170:171], v230 offset:45056
    v_mfma_f32_16x16x32_bf16 v[20:23], a[180:183], a[40:43], v[20:23]
    s_add_u32 m0, s50, 40960
    s_add_u32 s37, s31, 2883584
    buffer_load_dwordx4 v32, s[16:19], s37 offen offset:0  lds
    buffer_load_dwordx4 v33, s[16:19], s37 offen offset:1024  lds
    ds_read_b64_tr_b16 a[172:173], v231 offset:40960
    ds_read_b64_tr_b16 a[174:175], v231 offset:45056
    v_mfma_f32_16x16x32_bf16 v[24:27], a[184:187], a[40:43], v[24:27]
    buffer_load_dwordx4 v34, s[16:19], s37 offen offset:2048  lds
    buffer_load_dwordx4 v35, s[16:19], s37 offen offset:3072  lds
    s_add_u32 m0, s50, 45056
    s_add_u32 s37, s31, 3014656
    ds_read_b64_tr_b16 a[176:177], v232 offset:40960
    ds_read_b64_tr_b16 a[178:179], v232 offset:45056
    v_mfma_f32_16x16x32_bf16 v[28:31], a[188:191], a[40:43], v[28:31]
    buffer_load_dwordx4 v32, s[16:19], s37 offen offset:0  lds
    buffer_load_dwordx4 v33, s[16:19], s37 offen offset:1024  lds
    buffer_load_dwordx4 v34, s[16:19], s37 offen offset:2048  lds
    ds_read_b64_tr_b16 a[180:181], v233 offset:40960
    ds_read_b64_tr_b16 a[182:183], v233 offset:45056
    s_waitcnt lgkmcnt(4)
    v_mfma_f32_16x16x32_bf16 v[0:3], a[160:163], a[48:51], v[0:3]
    buffer_load_dwordx4 v35, s[16:19], s37 offen offset:3072  lds
    s_add_u32 m0, s70, 106496
    s_mov_b32 s7, 1024
    ds_read_b64_tr_b16 a[184:185], v234 offset:40960
    ds_read_b64_tr_b16 a[186:187], v234 offset:45056
    v_mfma_f32_16x16x32_bf16 v[4:7], a[164:167], a[48:51], v[4:7]
    buffer_load_dwordx4 v144, s[24:27], s7 offen  lds
    s_add_u32 m0, s70, 107520
    s_mov_b32 s7, 6144
    ds_read_b64_tr_b16 a[188:189], v235 offset:40960
    ds_read_b64_tr_b16 a[190:191], v235 offset:45056
    v_mfma_f32_16x16x32_bf16 v[8:11], a[168:171], a[48:51], v[8:11]
    buffer_load_dwordx4 v145, s[24:27], s7 offen  lds
    s_add_u32 m0, s70, 108544
    s_mov_b32 s7, 11264
    buffer_load_dwordx4 v146, s[24:27], s7 offen  lds
    v_mfma_f32_16x16x32_bf16 v[12:15], a[172:175], a[48:51], v[12:15]
    s_add_u32 m0, s70, 109568
    s_mov_b32 s7, 16384
    buffer_load_dwordx4 v147, s[24:27], s7 offen  lds
    s_waitcnt lgkmcnt(0)
    v_mfma_f32_16x16x32_bf16 v[16:19], a[176:179], a[48:51], v[16:19]
    v_add_u32_e32 v224, s33, v224
    v_add_u32_e32 v225, s33, v225
    v_add_u32_e32 v226, s33, v226
    v_add_u32_e32 v227, s33, v227
    s_waitcnt vmcnt(20)
    s_barrier
    s_mov_b32 s50, s32
    s_add_u32 s34, s32, s38
    s_add_u32 s32, s32, s42
    s_cmp_eq_u32 s32, 159744
    s_cselect_b32 s33, s43, s42
    s_cselect_b32 s32, 0, s32
    s_sub_u32 s39, 159744, s32
    v_add_u32_e32 v228, s33, v228
    v_add_u32_e32 v254, s39, v228
    ds_read_b64_tr_b16 a[160:161], v254 offset:0
    ds_read_b64_tr_b16 a[162:163], v228 offset:32768
    v_add_u32_e32 v229, s33, v229
    v_add_u32_e32 v254, s39, v229
    ds_read_b64_tr_b16 a[164:165], v254 offset:0
    ds_read_b64_tr_b16 a[166:167], v229 offset:32768
    v_add_u32_e32 v230, s33, v230
    v_add_u32_e32 v254, s39, v230
    ds_read_b64_tr_b16 a[168:169], v254 offset:0
    ds_read_b64_tr_b16 a[170:171], v230 offset:32768
    v_mfma_f32_16x16x32_bf16 v[20:23], a[180:183], a[48:51], v[20:23]
    v_add_u32_e32 v231, s33, v231
    v_add_u32_e32 v254, s39, v231
    ds_read_b64_tr_b16 a[172:173], v254 offset:0
    ds_read_b64_tr_b16 a[174:175], v231 offset:32768
    v_mfma_f32_16x16x32_bf16 v[24:27], a[184:187], a[48:51], v[24:27]
    v_add_u32_e32 v232, s33, v232
    v_add_u32_e32 v254, s39, v232
    ds_read_b64_tr_b16 a[176:177], v254 offset:0
    ds_read_b64_tr_b16 a[178:179], v232 offset:32768
    v_mfma_f32_16x16x32_bf16 v[28:31], a[188:191], a[48:51], v[28:31]
    v_add_u32_e32 v233, s33, v233
    v_add_u32_e32 v254, s39, v233
    ds_read_b64_tr_b16 a[180:181], v254 offset:0
    ds_read_b64_tr_b16 a[182:183], v233 offset:32768
    s_waitcnt lgkmcnt(4)
    v_mfma_f32_16x16x32_bf16 v[0:3], a[160:163], a[56:59], v[0:3]
    s_add_u32 m0, s50, 32768
    s_add_u32 s37, s31, 3276800
    v_add_u32_e32 v234, s33, v234
    v_add_u32_e32 v254, s39, v234
    ds_read_b64_tr_b16 a[184:185], v254 offset:0
    ds_read_b64_tr_b16 a[186:187], v234 offset:32768
    v_mfma_f32_16x16x32_bf16 v[4:7], a[164:167], a[56:59], v[4:7]
    buffer_load_dwordx4 v32, s[16:19], s37 offen offset:0  lds
    v_add_u32_e32 v235, s33, v235
    v_add_u32_e32 v254, s39, v235
    ds_read_b64_tr_b16 a[188:189], v254 offset:0
    ds_read_b64_tr_b16 a[190:191], v235 offset:32768
    v_mfma_f32_16x16x32_bf16 v[8:11], a[168:171], a[56:59], v[8:11]
    buffer_load_dwordx4 v33, s[16:19], s37 offen offset:1024  lds
    buffer_load_dwordx4 v34, s[16:19], s37 offen offset:2048  lds
    ds_read_b64_tr_b16 a[160:161], v228 offset:36864
    ds_read_b64_tr_b16 a[162:163], v228 offset:40960
    v_mfma_f32_16x16x32_bf16 v[12:15], a[172:175], a[56:59], v[12:15]
    buffer_load_dwordx4 v35, s[16:19], s37 offen offset:3072  lds
    ds_read_b64_tr_b16 a[164:165], v229 offset:36864
    ds_read_b64_tr_b16 a[166:167], v229 offset:40960
    s_waitcnt lgkmcnt(4)
    v_mfma_f32_16x16x32_bf16 v[16:19], a[176:179], a[56:59], v[16:19]
    s_add_u32 m0, s50, 36864
    s_add_u32 s37, s31, 3407872
    ds_read_b64_tr_b16 a[168:169], v230 offset:36864
    ds_read_b64_tr_b16 a[170:171], v230 offset:40960
    v_mfma_f32_16x16x32_bf16 v[20:23], a[180:183], a[56:59], v[20:23]
    buffer_load_dwordx4 v32, s[16:19], s37 offen offset:0  lds
    ds_read_b64_tr_b16 a[172:173], v231 offset:36864
    ds_read_b64_tr_b16 a[174:175], v231 offset:40960
    v_mfma_f32_16x16x32_bf16 v[24:27], a[184:187], a[56:59], v[24:27]
    buffer_load_dwordx4 v33, s[16:19], s37 offen offset:1024  lds
    buffer_load_dwordx4 v34, s[16:19], s37 offen offset:2048  lds
    ds_read_b64_tr_b16 a[176:177], v232 offset:36864
    ds_read_b64_tr_b16 a[178:179], v232 offset:40960
    v_mfma_f32_16x16x32_bf16 v[28:31], a[188:191], a[56:59], v[28:31]
    buffer_load_dwordx4 v35, s[16:19], s37 offen offset:3072  lds
    ds_read_b64_tr_b16 a[180:181], v233 offset:36864
    ds_read_b64_tr_b16 a[182:183], v233 offset:40960
    s_waitcnt lgkmcnt(4)
    v_mfma_f32_16x16x32_bf16 v[0:3], a[160:163], a[64:67], v[0:3]
    ds_read_b64 a[96:97], v128 offset:0
    ds_read_b64 a[98:99], v129 offset:0
    ds_read_b64 a[104:105], v130 offset:0
    ds_read_b64 a[106:107], v131 offset:0
    ds_read_b64 a[112:113], v132 offset:0
    ds_read_b64 a[114:115], v133 offset:0
    ds_read_b64 a[120:121], v134 offset:0
    ds_read_b64 a[122:123], v135 offset:0
    s_add_u32 m0, s50, 40960
    s_add_u32 s37, s31, 3538944
    ds_read_b64_tr_b16 a[184:185], v234 offset:36864
    ds_read_b64_tr_b16 a[186:187], v234 offset:40960
    v_mfma_f32_16x16x32_bf16 v[4:7], a[164:167], a[64:67], v[4:7]
    buffer_load_dwordx4 v32, s[16:19], s37 offen offset:0  lds
    ds_read_b64_tr_b16 a[188:189], v235 offset:36864
    ds_read_b64_tr_b16 a[190:191], v235 offset:40960
    s_waitcnt lgkmcnt(15)
    v_mfma_f32_16x16x32_bf16 v[8:11], a[168:171], a[64:67], v[8:11]
    buffer_load_dwordx4 v33, s[16:19], s37 offen offset:1024  lds
    buffer_load_dwordx4 v34, s[16:19], s37 offen offset:2048  lds
    ds_read_b64_tr_b16 a[160:161], v228 offset:45056
    ds_read_b64_tr_b16 a[162:163], v228 offset:49152
    s_waitcnt lgkmcnt(15)
    v_mfma_f32_16x16x32_bf16 v[12:15], a[172:175], a[64:67], v[12:15]
    buffer_load_dwordx4 v35, s[16:19], s37 offen offset:3072  lds
    ds_read_b64_tr_b16 a[164:165], v229 offset:45056
    ds_read_b64_tr_b16 a[166:167], v229 offset:49152
    s_waitcnt lgkmcnt(4)
    v_mfma_f32_16x16x32_bf16 v[16:19], a[176:179], a[64:67], v[16:19]
    s_add_u32 m0, s50, 45056
    s_add_u32 s37, s31, 3670016
    ds_read_b64_tr_b16 a[168:169], v230 offset:45056
    ds_read_b64_tr_b16 a[170:171], v230 offset:49152
    v_mfma_f32_16x16x32_bf16 v[20:23], a[180:183], a[64:67], v[20:23]
    buffer_load_dwordx4 v32, s[16:19], s37 offen offset:0  lds
    ds_read_b64_tr_b16 a[172:173], v231 offset:45056
    ds_read_b64_tr_b16 a[174:175], v231 offset:49152
    v_mfma_f32_16x16x32_bf16 v[24:27], a[184:187], a[64:67], v[24:27]
    buffer_load_dwordx4 v33, s[16:19], s37 offen offset:1024  lds
    buffer_load_dwordx4 v34, s[16:19], s37 offen offset:2048  lds
    ds_read_b64_tr_b16 a[176:177], v232 offset:45056
    ds_read_b64_tr_b16 a[178:179], v232 offset:49152
    v_mfma_f32_16x16x32_bf16 v[28:31], a[188:191], a[64:67], v[28:31]
    buffer_load_dwordx4 v35, s[16:19], s37 offen offset:3072  lds
    ds_read_b64_tr_b16 a[180:181], v233 offset:45056
    ds_read_b64_tr_b16 a[182:183], v233 offset:49152
    s_waitcnt lgkmcnt(4)
    v_mfma_f32_16x16x32_bf16 v[0:3], a[160:163], a[72:75], v[0:3]
    s_add_u32 m0, s50, 49152
    s_add_u32 s37, s31, 3801088
    ds_read_b64_tr_b16 a[184:185], v234 offset:45056
    ds_read_b64_tr_b16 a[186:187], v234 offset:49152
    v_mfma_f32_16x16x32_bf16 v[4:7], a[164:167], a[72:75], v[4:7]
    buffer_load_dwordx4 v32, s[16:19], s37 offen offset:0  lds
    ds_read_b64_tr_b16 a[188:189], v235 offset:45056
    ds_read_b64_tr_b16 a[190:191], v235 offset:49152
    v_mfma_f32_16x16x32_bf16 v[8:11], a[168:171], a[72:75], v[8:11]
    buffer_load_dwordx4 v33, s[16:19], s37 offen offset:1024  lds
    buffer_load_dwordx4 v34, s[16:19], s37 offen offset:2048  lds
    v_mfma_f32_16x16x32_bf16 v[12:15], a[172:175], a[72:75], v[12:15]
    buffer_load_dwordx4 v35, s[16:19], s37 offen offset:3072  lds
    s_waitcnt lgkmcnt(0)
    v_mfma_f32_16x16x32_bf16 v[16:19], a[176:179], a[72:75], v[16:19]
    v_add_u32_e32 v224, s33, v224
    v_add_u32_e32 v225, s33, v225
    v_add_u32_e32 v226, s33, v226
    v_add_u32_e32 v227, s33, v227
    s_waitcnt vmcnt(24)
    s_barrier
    s_mov_b32 s50, s32
    s_add_u32 s34, s32, s38
    s_add_u32 s32, s32, s42
    s_cmp_eq_u32 s32, 159744
    s_cselect_b32 s33, s43, s42
    s_cselect_b32 s32, 0, s32
    v_add_u32_e32 v228, s33, v228
    ds_read_b64_tr_b16 a[160:161], v228 offset:32768
    ds_read_b64_tr_b16 a[162:163], v228 offset:36864
    v_add_u32_e32 v229, s33, v229
    ds_read_b64_tr_b16 a[164:165], v229 offset:32768
    ds_read_b64_tr_b16 a[166:167], v229 offset:36864
    v_add_u32_e32 v230, s33, v230
    ds_read_b64_tr_b16 a[168:169], v230 offset:32768
    ds_read_b64_tr_b16 a[170:171], v230 offset:36864
    v_mfma_f32_16x16x32_bf16 v[20:23], a[180:183], a[72:75], v[20:23]
    v_add_u32_e32 v231, s33, v231
    ds_read_b64_tr_b16 a[172:173], v231 offset:32768
    ds_read_b64_tr_b16 a[174:175], v231 offset:36864
    v_mfma_f32_16x16x32_bf16 v[24:27], a[184:187], a[72:75], v[24:27]
    v_add_u32_e32 v232, s33, v232
    ds_read_b64_tr_b16 a[176:177], v232 offset:32768
    ds_read_b64_tr_b16 a[178:179], v232 offset:36864
    v_mfma_f32_16x16x32_bf16 v[28:31], a[188:191], a[72:75], v[28:31]
    v_add_u32_e32 v233, s33, v233
    ds_read_b64_tr_b16 a[180:181], v233 offset:32768
    ds_read_b64_tr_b16 a[182:183], v233 offset:36864
    s_waitcnt lgkmcnt(4)
    v_mfma_f32_16x16x32_bf16 v[0:3], a[160:163], a[80:83], v[0:3]
    s_mov_b32 m0, 159744
    s_add_u32 s37, s31, 3145728
    buffer_load_dwordx4 v32, s[16:19], s37 offen offset:0  lds
    buffer_load_dwordx4 v33, s[16:19], s37 offen offset:1024  lds
    v_add_u32_e32 v234, s33, v234
    ds_read_b64_tr_b16 a[184:185], v234 offset:32768
    ds_read_b64_tr_b16 a[186:187], v234 offset:36864
    v_mfma_f32_16x16x32_bf16 v[4:7], a[164:167], a[80:83], v[4:7]
    buffer_load_dwordx4 v34, s[16:19], s37 offen offset:2048  lds
    buffer_load_dwordx4 v35, s[16:19], s37 offen offset:3072  lds
    s_add_u32 m0, s50, 32768
    v_add_u32_e32 v235, s33, v235
    ds_read_b64_tr_b16 a[188:189], v235 offset:32768
    ds_read_b64_tr_b16 a[190:191], v235 offset:36864
    v_mfma_f32_16x16x32_bf16 v[8:11], a[168:171], a[80:83], v[8:11]
    s_add_u32 s37, s31, 3932160
    buffer_load_dwordx4 v32, s[16:19], s37 offen offset:0  lds
    buffer_load_dwordx4 v33, s[16:19], s37 offen offset:1024  lds
    ds_read_b64_tr_b16 a[160:161], v228 offset:40960
    ds_read_b64_tr_b16 a[162:163], v228 offset:45056
    v_mfma_f32_16x16x32_bf16 v[12:15], a[172:175], a[80:83], v[12:15]
    buffer_load_dwordx4 v34, s[16:19], s37 offen offset:2048  lds
    buffer_load_dwordx4 v35, s[16:19], s37 offen offset:3072  lds
    s_add_u32 m0, s50, 36864
    ds_read_b64_tr_b16 a[164:165], v229 offset:40960
    ds_read_b64_tr_b16 a[166:167], v229 offset:45056
    s_waitcnt lgkmcnt(4)
    v_mfma_f32_16x16x32_bf16 v[16:19], a[176:179], a[80:83], v[16:19]
    s_waitcnt vmcnt(28)
    ds_read_b64 a[128:129], v136 offset:0
    ds_read_b64 a[130:131], v137 offset:0
    ds_read_b64 a[136:137], v138 offset:0
    ds_read_b64 a[138:139], v139 offset:0
    ds_read_b64 a[144:145], v140 offset:0
    ds_read_b64 a[146:147], v141 offset:0
    ds_read_b64 a[152:153], v142 offset:0
    ds_read_b64 a[154:155], v143 offset:0
    s_add_u32 s37, s31, 4063232
    buffer_load_dwordx4 v32, s[16:19], s37 offen offset:0  lds
    buffer_load_dwordx4 v33, s[16:19], s37 offen offset:1024  lds
    ds_read_b64_tr_b16 a[168:169], v230 offset:40960
    ds_read_b64_tr_b16 a[170:171], v230 offset:45056
    v_mfma_f32_16x16x32_bf16 v[20:23], a[180:183], a[80:83], v[20:23]
    buffer_load_dwordx4 v34, s[16:19], s37 offen offset:2048  lds
    buffer_load_dwordx4 v35, s[16:19], s37 offen offset:3072  lds
    s_add_u32 m0, s50, 40960
    ds_read_b64_tr_b16 a[172:173], v231 offset:40960
    ds_read_b64_tr_b16 a[174:175], v231 offset:45056
    s_waitcnt lgkmcnt(15)
    v_mfma_f32_16x16x32_bf16 v[24:27], a[184:187], a[80:83], v[24:27]
    s_add_u32 s37, s31, 4194304
    buffer_load_dwordx4 v32, s[16:19], s37 offen offset:0  lds
    buffer_load_dwordx4 v33, s[16:19], s37 offen offset:1024  lds
    ds_read_b64_tr_b16 a[176:177], v232 offset:40960
    ds_read_b64_tr_b16 a[178:179], v232 offset:45056
    s_waitcnt lgkmcnt(15)
    v_mfma_f32_16x16x32_bf16 v[28:31], a[188:191], a[80:83], v[28:31]
    buffer_load_dwordx4 v34, s[16:19], s37 offen offset:2048  lds
    buffer_load_dwordx4 v35, s[16:19], s37 offen offset:3072  lds
    s_add_u32 m0, s50, 45056
    ds_read_b64_tr_b16 a[180:181], v233 offset:40960
    ds_read_b64_tr_b16 a[182:183], v233 offset:45056
    s_waitcnt lgkmcnt(4)
    v_mfma_f32_16x16x32_bf16 v[0:3], a[160:163], a[88:91], v[0:3]
    s_add_u32 s37, s31, 4325376
    buffer_load_dwordx4 v32, s[16:19], s37 offen offset:0  lds
    buffer_load_dwordx4 v33, s[16:19], s37 offen offset:1024  lds
    ds_read_b64_tr_b16 a[184:185], v234 offset:40960
    ds_read_b64_tr_b16 a[186:187], v234 offset:45056
    v_mfma_f32_16x16x32_bf16 v[4:7], a[164:167], a[88:91], v[4:7]
    buffer_load_dwordx4 v34, s[16:19], s37 offen offset:2048  lds
    buffer_load_dwordx4 v35, s[16:19], s37 offen offset:3072  lds
    s_add_u32 s36, s38, 53248
    ds_read_b64_tr_b16 a[188:189], v235 offset:40960
    ds_read_b64_tr_b16 a[190:191], v235 offset:45056
    v_mfma_f32_16x16x32_bf16 v[8:11], a[168:171], a[88:91], v[8:11]
    s_mov_b32 s49, 0
    s_add_u32 m0, s36, 0
    s_nop 0
    buffer_load_dwordx4 v236, s[8:11], s49 offen offset:0 nt lds
    v_mfma_f32_16x16x32_bf16 v[12:15], a[172:175], a[88:91], v[12:15]
    buffer_load_dwordx4 v237, s[8:11], s49 offen offset:1024 nt lds
    buffer_load_dwordx4 v238, s[8:11], s49 offen offset:2048 nt lds
    buffer_load_dwordx4 v239, s[8:11], s49 offen offset:3072 nt lds
    s_waitcnt lgkmcnt(0)
    v_mfma_f32_16x16x32_bf16 v[16:19], a[176:179], a[88:91], v[16:19]
    v_add_u32_e32 v224, s33, v224
    v_add_u32_e32 v225, s33, v225
    v_add_u32_e32 v226, s33, v226
    v_add_u32_e32 v227, s33, v227
    s_waitcnt vmcnt(20)
    s_barrier
    s_mov_b32 s50, s32
    s_add_u32 s34, s32, s38
    s_add_u32 s32, s32, s42
    s_cmp_eq_u32 s32, 159744
    s_cselect_b32 s33, s43, s42
    s_cselect_b32 s32, 0, s32
    s_sub_u32 s39, 159744, s32
    v_add_u32_e32 v228, s33, v228
    v_add_u32_e32 v254, s39, v228
    ds_read_b64_tr_b16 a[160:161], v254 offset:0
    ds_read_b64_tr_b16 a[162:163], v228 offset:32768
    v_add_u32_e32 v229, s33, v229
    v_add_u32_e32 v254, s39, v229
    ds_read_b64_tr_b16 a[164:165], v254 offset:0
    ds_read_b64_tr_b16 a[166:167], v229 offset:32768
    v_add_u32_e32 v230, s33, v230
    v_add_u32_e32 v254, s39, v230
    ds_read_b64_tr_b16 a[168:169], v254 offset:0
    ds_read_b64_tr_b16 a[170:171], v230 offset:32768
    v_mfma_f32_16x16x32_bf16 v[20:23], a[180:183], a[88:91], v[20:23]
    v_add_u32_e32 v231, s33, v231
    v_add_u32_e32 v254, s39, v231
    ds_read_b64_tr_b16 a[172:173], v254 offset:0
    ds_read_b64_tr_b16 a[174:175], v231 offset:32768
    v_mfma_f32_16x16x32_bf16 v[24:27], a[184:187], a[88:91], v[24:27]
    v_add_u32_e32 v232, s33, v232
    v_add_u32_e32 v254, s39, v232
    ds_read_b64_tr_b16 a[176:177], v254 offset:0
    ds_read_b64_tr_b16 a[178:179], v232 offset:32768
    v_mfma_f32_16x16x32_bf16 v[28:31], a[188:191], a[88:91], v[28:31]
    v_add_u32_e32 v233, s33, v233
    v_add_u32_e32 v254, s39, v233
    ds_read_b64_tr_b16 a[180:181], v254 offset:0
    ds_read_b64_tr_b16 a[182:183], v233 offset:32768
    s_waitcnt lgkmcnt(4)
    v_mfma_f32_16x16x32_bf16 v[0:3], a[160:163], a[96:99], v[0:3]
    s_add_u32 m0, s50, 32768
    s_add_u32 s37, s31, 4587520
    v_add_u32_e32 v234, s33, v234
    v_add_u32_e32 v254, s39, v234
    ds_read_b64_tr_b16 a[184:185], v254 offset:0
    ds_read_b64_tr_b16 a[186:187], v234 offset:32768
    v_mfma_f32_16x16x32_bf16 v[4:7], a[164:167], a[96:99], v[4:7]
    s_mov_b32 s96, s90
    s_mov_b32 s97, s91
    s_mov_b32 s98, 256
    s_mov_b32 s99, 0x20000
    s_lshl_b32 s61, s5, 4
    s_add_u32 s61, s61, s4
    s_lshl_b32 s61, s61, 2
    v_mov_b32_e32 v114, s61
    buffer_load_dword v115, v114, s[96:99], 0 offen sc1
    buffer_load_dwordx4 v32, s[16:19], s37 offen offset:0  lds
    v_add_u32_e32 v235, s33, v235
    v_add_u32_e32 v254, s39, v235
    ds_read_b64_tr_b16 a[188:189], v254 offset:0
    ds_read_b64_tr_b16 a[190:191], v235 offset:32768
    v_mfma_f32_16x16x32_bf16 v[8:11], a[168:171], a[96:99], v[8:11]
    buffer_load_dwordx4 v33, s[16:19], s37 offen offset:1024  lds
    buffer_load_dwordx4 v34, s[16:19], s37 offen offset:2048  lds
    ds_read_b64_tr_b16 a[160:161], v228 offset:36864
    ds_read_b64_tr_b16 a[162:163], v228 offset:40960
    v_mfma_f32_16x16x32_bf16 v[12:15], a[172:175], a[96:99], v[12:15]
    buffer_load_dwordx4 v35, s[16:19], s37 offen offset:3072  lds
    ds_read_b64_tr_b16 a[164:165], v229 offset:36864
    ds_read_b64_tr_b16 a[166:167], v229 offset:40960
    s_waitcnt lgkmcnt(4)
    v_mfma_f32_16x16x32_bf16 v[16:19], a[176:179], a[96:99], v[16:19]
    s_add_u32 m0, s50, 36864
    s_add_u32 s37, s31, 4718592
    ds_read_b64_tr_b16 a[168:169], v230 offset:36864
    ds_read_b64_tr_b16 a[170:171], v230 offset:40960
    v_mfma_f32_16x16x32_bf16 v[20:23], a[180:183], a[96:99], v[20:23]
    buffer_load_dwordx4 v32, s[16:19], s37 offen offset:0  lds
    ds_read_b64_tr_b16 a[172:173], v231 offset:36864
    ds_read_b64_tr_b16 a[174:175], v231 offset:40960
    v_mfma_f32_16x16x32_bf16 v[24:27], a[184:187], a[96:99], v[24:27]
    buffer_load_dwordx4 v33, s[16:19], s37 offen offset:1024  lds
    buffer_load_dwordx4 v34, s[16:19], s37 offen offset:2048  lds
    ds_read_b64_tr_b16 a[176:177], v232 offset:36864
    ds_read_b64_tr_b16 a[178:179], v232 offset:40960
    v_mfma_f32_16x16x32_bf16 v[28:31], a[188:191], a[96:99], v[28:31]
    buffer_load_dwordx4 v35, s[16:19], s37 offen offset:3072  lds
    ds_read_b64_tr_b16 a[180:181], v233 offset:36864
    ds_read_b64_tr_b16 a[182:183], v233 offset:40960
    s_waitcnt lgkmcnt(4)
    v_mfma_f32_16x16x32_bf16 v[0:3], a[160:163], a[104:107], v[0:3]
    s_add_u32 m0, s50, 40960
    s_add_u32 s37, s31, 4849664
    ds_read_b64_tr_b16 a[184:185], v234 offset:36864
    ds_read_b64_tr_b16 a[186:187], v234 offset:40960
    v_mfma_f32_16x16x32_bf16 v[4:7], a[164:167], a[104:107], v[4:7]
    buffer_load_dwordx4 v32, s[16:19], s37 offen offset:0  lds
    ds_read_b64_tr_b16 a[188:189], v235 offset:36864
    ds_read_b64_tr_b16 a[190:191], v235 offset:40960
    v_mfma_f32_16x16x32_bf16 v[8:11], a[168:171], a[104:107], v[8:11]
    buffer_load_dwordx4 v33, s[16:19], s37 offen offset:1024  lds
    buffer_load_dwordx4 v34, s[16:19], s37 offen offset:2048  lds
    ds_read_b64_tr_b16 a[160:161], v228 offset:45056
    ds_read_b64_tr_b16 a[162:163], v228 offset:49152
    v_mfma_f32_16x16x32_bf16 v[12:15], a[172:175], a[104:107], v[12:15]
    buffer_load_dwordx4 v35, s[16:19], s37 offen offset:3072  lds
    ds_read_b64_tr_b16 a[164:165], v229 offset:45056
    ds_read_b64_tr_b16 a[166:167], v229 offset:49152
    s_waitcnt lgkmcnt(4)
    v_mfma_f32_16x16x32_bf16 v[16:19], a[176:179], a[104:107], v[16:19]
    s_add_u32 m0, s50, 45056
    s_add_u32 s37, s31, 4980736
    ds_read_b64_tr_b16 a[168:169], v230 offset:45056
    ds_read_b64_tr_b16 a[170:171], v230 offset:49152
    v_mfma_f32_16x16x32_bf16 v[20:23], a[180:183], a[104:107], v[20:23]
    buffer_load_dwordx4 v32, s[16:19], s37 offen offset:0  lds
    ds_read_b64_tr_b16 a[172:173], v231 offset:45056
    ds_read_b64_tr_b16 a[174:175], v231 offset:49152
    v_mfma_f32_16x16x32_bf16 v[24:27], a[184:187], a[104:107], v[24:27]
    buffer_load_dwordx4 v33, s[16:19], s37 offen offset:1024  lds
    buffer_load_dwordx4 v34, s[16:19], s37 offen offset:2048  lds
    ds_read_b64_tr_b16 a[176:177], v232 offset:45056
    ds_read_b64_tr_b16 a[178:179], v232 offset:49152
    v_mfma_f32_16x16x32_bf16 v[28:31], a[188:191], a[104:107], v[28:31]
    buffer_load_dwordx4 v35, s[16:19], s37 offen offset:3072  lds
    ds_read_b64_tr_b16 a[180:181], v233 offset:45056
    ds_read_b64_tr_b16 a[182:183], v233 offset:49152
    s_waitcnt lgkmcnt(4)
    v_mfma_f32_16x16x32_bf16 v[0:3], a[160:163], a[112:115], v[0:3]
    s_add_u32 m0, s50, 49152
    s_add_u32 s37, s31, 5111808
    ds_read_b64_tr_b16 a[184:185], v234 offset:45056
    ds_read_b64_tr_b16 a[186:187], v234 offset:49152
    v_mfma_f32_16x16x32_bf16 v[4:7], a[164:167], a[112:115], v[4:7]
    buffer_load_dwordx4 v32, s[16:19], s37 offen offset:0  lds
    ds_read_b64_tr_b16 a[188:189], v235 offset:45056
    ds_read_b64_tr_b16 a[190:191], v235 offset:49152
    v_mfma_f32_16x16x32_bf16 v[8:11], a[168:171], a[112:115], v[8:11]
    buffer_load_dwordx4 v33, s[16:19], s37 offen offset:1024  lds
    buffer_load_dwordx4 v34, s[16:19], s37 offen offset:2048  lds
    v_mfma_f32_16x16x32_bf16 v[12:15], a[172:175], a[112:115], v[12:15]
    buffer_load_dwordx4 v35, s[16:19], s37 offen offset:3072  lds
    s_waitcnt lgkmcnt(0)
    v_mfma_f32_16x16x32_bf16 v[16:19], a[176:179], a[112:115], v[16:19]
    v_add_u32_e32 v224, s33, v224
    v_add_u32_e32 v225, s33, v225
    v_add_u32_e32 v226, s33, v226
    v_add_u32_e32 v227, s33, v227
    s_waitcnt vmcnt(25)
    s_barrier
    s_mov_b32 s50, s32
    s_add_u32 s34, s32, s38
    s_add_u32 s32, s32, s42
    s_cmp_eq_u32 s32, 159744
    s_cselect_b32 s33, s43, s42
    s_cselect_b32 s32, 0, s32
    v_add_u32_e32 v228, s33, v228
    ds_read_b64_tr_b16 a[160:161], v228 offset:32768
    ds_read_b64_tr_b16 a[162:163], v228 offset:36864
    v_add_u32_e32 v229, s33, v229
    ds_read_b64_tr_b16 a[164:165], v229 offset:32768
    ds_read_b64_tr_b16 a[166:167], v229 offset:36864
    v_add_u32_e32 v230, s33, v230
    ds_read_b64_tr_b16 a[168:169], v230 offset:32768
    ds_read_b64_tr_b16 a[170:171], v230 offset:36864
    v_mfma_f32_16x16x32_bf16 v[20:23], a[180:183], a[112:115], v[20:23]
    v_add_u32_e32 v231, s33, v231
    ds_read_b64_tr_b16 a[172:173], v231 offset:32768
    ds_read_b64_tr_b16 a[174:175], v231 offset:36864
    v_mfma_f32_16x16x32_bf16 v[24:27], a[184:187], a[112:115], v[24:27]
    v_add_u32_e32 v232, s33, v232
    ds_read_b64_tr_b16 a[176:177], v232 offset:32768
    ds_read_b64_tr_b16 a[178:179], v232 offset:36864
    v_mfma_f32_16x16x32_bf16 v[28:31], a[188:191], a[112:115], v[28:31]
    v_add_u32_e32 v233, s33, v233
    ds_read_b64_tr_b16 a[180:181], v233 offset:32768
    ds_read_b64_tr_b16 a[182:183], v233 offset:36864
    s_waitcnt lgkmcnt(4)
    v_mfma_f32_16x16x32_bf16 v[0:3], a[160:163], a[120:123], v[0:3]
    s_mov_b32 m0, 159744
    s_add_u32 s37, s31, 4456448
    buffer_load_dwordx4 v32, s[16:19], s37 offen offset:0  lds
    buffer_load_dwordx4 v33, s[16:19], s37 offen offset:1024  lds
    v_add_u32_e32 v234, s33, v234
    ds_read_b64_tr_b16 a[184:185], v234 offset:32768
    ds_read_b64_tr_b16 a[186:187], v234 offset:36864
    v_mfma_f32_16x16x32_bf16 v[4:7], a[164:167], a[120:123], v[4:7]
    buffer_load_dwordx4 v34, s[16:19], s37 offen offset:2048  lds
    buffer_load_dwordx4 v35, s[16:19], s37 offen offset:3072  lds
    s_add_u32 s36, s38, 106496
    s_mov_b32 s49, 16384
    v_add_u32_e32 v235, s33, v235
    ds_read_b64_tr_b16 a[188:189], v235 offset:32768
    ds_read_b64_tr_b16 a[190:191], v235 offset:36864
    v_mfma_f32_16x16x32_bf16 v[8:11], a[168:171], a[120:123], v[8:11]
    s_add_u32 m0, s36, 0
    s_nop 0
    buffer_load_dwordx4 v236, s[8:11], s49 offen offset:0 nt lds
    buffer_load_dwordx4 v237, s[8:11], s49 offen offset:1024 nt lds
    ds_read_b64_tr_b16 a[160:161], v228 offset:40960
    ds_read_b64_tr_b16 a[162:163], v228 offset:45056
    v_mfma_f32_16x16x32_bf16 v[12:15], a[172:175], a[120:123], v[12:15]
    buffer_load_dwordx4 v238, s[8:11], s49 offen offset:2048 nt lds
    buffer_load_dwordx4 v239, s[8:11], s49 offen offset:3072 nt lds
    s_add_u32 s36, s38, 106496
    s_mov_b32 s49, 0
    ds_read_b64_tr_b16 a[164:165], v229 offset:40960
    ds_read_b64_tr_b16 a[166:167], v229 offset:45056
    s_waitcnt lgkmcnt(4)
    v_mfma_f32_16x16x32_bf16 v[16:19], a[176:179], a[120:123], v[16:19]
    s_add_u32 m0, s36, 16384
    s_nop 0
    buffer_load_dwordx4 v240, s[12:15], s49 offen offset:0 nt lds
    buffer_load_dwordx4 v241, s[12:15], s49 offen offset:1024 nt lds
    buffer_load_dwordx4 v240, s[12:15], s49 offen offset:2048 nt lds
    ds_read_b64_tr_b16 a[168:169], v230 offset:40960
    ds_read_b64_tr_b16 a[170:171], v230 offset:45056
    v_mfma_f32_16x16x32_bf16 v[20:23], a[180:183], a[120:123], v[20:23]
    buffer_load_dwordx4 v241, s[12:15], s49 offen offset:3072 nt lds
    s_add_u32 m0, s50, 32768
    s_add_u32 s37, s46, 0
    ds_read_b64_tr_b16 a[172:173], v231 offset:40960
    ds_read_b64_tr_b16 a[174:175], v231 offset:45056
    v_mfma_f32_16x16x32_bf16 v[24:27], a[184:187], a[120:123], v[24:27]
    buffer_load_dwordx4 v32, s[16:19], s37 offen offset:0  lds
    buffer_load_dwordx4 v33, s[16:19], s37 offen offset:1024  lds
    buffer_load_dwordx4 v34, s[16:19], s37 offen offset:2048  lds
    buffer_load_dwordx4 v35, s[16:19], s37 offen offset:3072  lds
    ds_read_b64_tr_b16 a[176:177], v232 offset:40960
    ds_read_b64_tr_b16 a[178:179], v232 offset:45056
    v_mfma_f32_16x16x32_bf16 v[28:31], a[188:191], a[120:123], v[28:31]
    s_add_u32 m0, s50, 36864
    s_add_u32 s37, s46, 131072
    buffer_load_dwordx4 v32, s[16:19], s37 offen offset:0  lds
    buffer_load_dwordx4 v33, s[16:19], s37 offen offset:1024  lds
    ds_read_b64_tr_b16 a[180:181], v233 offset:40960
    ds_read_b64_tr_b16 a[182:183], v233 offset:45056
    s_waitcnt lgkmcnt(4)
    v_mfma_f32_16x16x32_bf16 v[0:3], a[160:163], a[128:131], v[0:3]
    buffer_load_dwordx4 v34, s[16:19], s37 offen offset:2048  lds
    buffer_load_dwordx4 v35, s[16:19], s37 offen offset:3072  lds
    s_add_u32 m0, s50, 40960
    ds_read_b64_tr_b16 a[184:185], v234 offset:40960
    ds_read_b64_tr_b16 a[186:187], v234 offset:45056
    v_mfma_f32_16x16x32_bf16 v[4:7], a[164:167], a[128:131], v[4:7]
    s_add_u32 s37, s46, 262144
    buffer_load_dwordx4 v32, s[16:19], s37 offen offset:0  lds
    buffer_load_dwordx4 v33, s[16:19], s37 offen offset:1024  lds
    buffer_load_dwordx4 v34, s[16:19], s37 offen offset:2048  lds
    ds_read_b64_tr_b16 a[188:189], v235 offset:40960
    ds_read_b64_tr_b16 a[190:191], v235 offset:45056
    v_mfma_f32_16x16x32_bf16 v[8:11], a[168:171], a[128:131], v[8:11]
    buffer_load_dwordx4 v35, s[16:19], s37 offen offset:3072  lds
    s_add_u32 m0, s50, 45056
    s_add_u32 s37, s46, 393216
    buffer_load_dwordx4 v32, s[16:19], s37 offen offset:0  lds
    v_mfma_f32_16x16x32_bf16 v[12:15], a[172:175], a[128:131], v[12:15]
    buffer_load_dwordx4 v33, s[16:19], s37 offen offset:1024  lds
    buffer_load_dwordx4 v34, s[16:19], s37 offen offset:2048  lds
    buffer_load_dwordx4 v35, s[16:19], s37 offen offset:3072  lds
    s_waitcnt lgkmcnt(0)
    v_mfma_f32_16x16x32_bf16 v[16:19], a[176:179], a[128:131], v[16:19]
    v_add_u32_e32 v224, s33, v224
    v_add_u32_e32 v225, s33, v225
    v_add_u32_e32 v226, s33, v226
    v_add_u32_e32 v227, s33, v227
    s_waitcnt vmcnt(24)
    s_barrier
    s_mov_b32 s50, s32
    s_add_u32 s34, s32, s38
    s_add_u32 s32, s32, s42
    s_cmp_eq_u32 s32, 159744
    s_cselect_b32 s33, s43, s42
    s_cselect_b32 s32, 0, s32
    s_sub_u32 s39, 159744, s32
    v_add_u32_e32 v228, s33, v228
    v_add_u32_e32 v254, s39, v228
    ds_read_b64_tr_b16 a[160:161], v254 offset:0
    ds_read_b64_tr_b16 a[162:163], v228 offset:32768
    ds_read_b64_tr_b16 a[164:165], v228 offset:36864
    ds_read_b64_tr_b16 a[166:167], v228 offset:40960
    ds_read_b64_tr_b16 a[168:169], v228 offset:45056
    ds_read_b64_tr_b16 a[170:171], v228 offset:49152
    v_mfma_f32_16x16x32_bf16 v[20:23], a[180:183], a[128:131], v[20:23]
    v_add_u32_e32 v229, s33, v229
    v_add_u32_e32 v254, s39, v229
    ds_read_b64_tr_b16 a[172:173], v254 offset:0
    ds_read_b64_tr_b16 a[174:175], v229 offset:32768
    v_mfma_f32_16x16x32_bf16 v[24:27], a[184:187], a[128:131], v[24:27]
    ds_read_b64_tr_b16 a[176:177], v229 offset:36864
    ds_read_b64_tr_b16 a[178:179], v229 offset:40960
    v_mfma_f32_16x16x32_bf16 v[28:31], a[188:191], a[128:131], v[28:31]
    ds_read_b64_tr_b16 a[180:181], v229 offset:45056
    ds_read_b64_tr_b16 a[182:183], v229 offset:49152
    s_waitcnt lgkmcnt(4)
    v_mfma_f32_16x16x32_bf16 v[0:3], a[160:163], a[136:139], v[0:3]
    s_add_u32 s36, s38, 0
    s_mov_b32 s49, 32768
    v_add_u32_e32 v230, s33, v230
    v_add_u32_e32 v254, s39, v230
    ds_read_b64_tr_b16 a[184:185], v254 offset:0
    ds_read_b64_tr_b16 a[186:187], v230 offset:32768
    v_mfma_f32_16x16x32_bf16 v[0:3], a[164:167], a[144:147], v[0:3]
    s_add_u32 m0, s36, 0
    ds_read_b64_tr_b16 a[188:189], v230 offset:36864
    ds_read_b64_tr_b16 a[190:191], v230 offset:40960
    v_mfma_f32_16x16x32_bf16 v[0:3], a[168:171], a[152:155], v[0:3]
    buffer_load_dwordx4 v236, s[8:11], s49 offen offset:0 nt lds
    ds_read_b64_tr_b16 a[160:161], v230 offset:45056
    ds_read_b64_tr_b16 a[162:163], v230 offset:49152
    v_mfma_f32_16x16x32_bf16 v[4:7], a[172:175], a[136:139], v[4:7]
    buffer_load_dwordx4 v237, s[8:11], s49 offen offset:1024 nt lds
    buffer_load_dwordx4 v238, s[8:11], s49 offen offset:2048 nt lds
    v_add_u32_e32 v231, s33, v231
    v_add_u32_e32 v254, s39, v231
    ds_read_b64_tr_b16 a[164:165], v254 offset:0
    ds_read_b64_tr_b16 a[166:167], v231 offset:32768
    s_waitcnt lgkmcnt(4)
    v_mfma_f32_16x16x32_bf16 v[4:7], a[176:179], a[144:147], v[4:7]
    buffer_load_dwordx4 v239, s[8:11], s49 offen offset:3072 nt lds
    ds_read_b64_tr_b16 a[168:169], v231 offset:36864
    ds_read_b64_tr_b16 a[170:171], v231 offset:40960
    v_mfma_f32_16x16x32_bf16 v[4:7], a[180:183], a[152:155], v[4:7]
    s_add_u32 s36, s38, 0
    ds_read_b64_tr_b16 a[172:173], v231 offset:45056
    ds_read_b64_tr_b16 a[174:175], v231 offset:49152
    v_mfma_f32_16x16x32_bf16 v[8:11], a[184:187], a[136:139], v[8:11]
    s_mov_b32 s49, 16384
    v_add_u32_e32 v232, s33, v232
    v_add_u32_e32 v254, s39, v232
    ds_read_b64_tr_b16 a[176:177], v254 offset:0
    ds_read_b64_tr_b16 a[178:179], v232 offset:32768
    v_mfma_f32_16x16x32_bf16 v[8:11], a[188:191], a[144:147], v[8:11]
    s_add_u32 m0, s36, 16384
    s_nop 0
    buffer_load_dwordx4 v240, s[12:15], s49 offen offset:0 nt lds
    ds_read_b64_tr_b16 a[180:181], v232 offset:36864
    ds_read_b64_tr_b16 a[182:183], v232 offset:40960
    s_waitcnt lgkmcnt(4)
    v_mfma_f32_16x16x32_bf16 v[8:11], a[160:163], a[152:155], v[8:11]
    buffer_load_dwordx4 v241, s[12:15], s49 offen offset:1024 nt lds
    ds_read_b64_tr_b16 a[184:185], v232 offset:45056
    ds_read_b64_tr_b16 a[186:187], v232 offset:49152
    v_mfma_f32_16x16x32_bf16 v[12:15], a[164:167], a[136:139], v[12:15]
    buffer_load_dwordx4 v240, s[12:15], s49 offen offset:2048 nt lds
    v_add_u32_e32 v233, s33, v233
    v_add_u32_e32 v254, s39, v233
    ds_read_b64_tr_b16 a[188:189], v254 offset:0
    ds_read_b64_tr_b16 a[190:191], v233 offset:32768
    v_mfma_f32_16x16x32_bf16 v[12:15], a[168:171], a[144:147], v[12:15]
    buffer_load_dwordx4 v241, s[12:15], s49 offen offset:3072 nt lds
    s_add_u32 m0, s50, 32768
    ds_read_b64_tr_b16 a[160:161], v233 offset:36864
    ds_read_b64_tr_b16 a[162:163], v233 offset:40960
    v_mfma_f32_16x16x32_bf16 v[12:15], a[172:175], a[152:155], v[12:15]
    s_add_u32 s37, s46, 655360
    ds_read_b64_tr_b16 a[164:165], v233 offset:45056
    ds_read_b64_tr_b16 a[166:167], v233 offset:49152
    v_mul_f32_e32 v0, s41, v0
    v_mul_f32_e32 v1, s41, v1
    v_mul_f32_e32 v2, s41, v2
    s_waitcnt lgkmcnt(4)
    v_mfma_f32_16x16x32_bf16 v[16:19], a[176:179], a[136:139], v[16:19]
    buffer_load_dwordx4 v32, s[16:19], s37 offen offset:0  lds
    v_add_u32_e32 v234, s33, v234
    v_add_u32_e32 v254, s39, v234
    ds_read_b64_tr_b16 a[168:169], v254 offset:0
    ds_read_b64_tr_b16 a[170:171], v234 offset:32768
    v_mfma_f32_16x16x32_bf16 v[16:19], a[180:183], a[144:147], v[16:19]
    buffer_load_dwordx4 v33, s[16:19], s37 offen offset:1024  lds
    ds_read_b64_tr_b16 a[172:173], v234 offset:36864
    ds_read_b64_tr_b16 a[174:175], v234 offset:40960
    v_mfma_f32_16x16x32_bf16 v[16:19], a[184:187], a[152:155], v[16:19]
    buffer_load_dwordx4 v34, s[16:19], s37 offen offset:2048  lds
    buffer_load_dwordx4 v35, s[16:19], s37 offen offset:3072  lds
    ds_read_b64_tr_b16 a[176:177], v234 offset:45056
    ds_read_b64_tr_b16 a[178:179], v234 offset:49152
    v_mfma_f32_16x16x32_bf16 v[20:23], a[188:191], a[136:139], v[20:23]
    s_add_u32 m0, s50, 36864
    v_add_u32_e32 v235, s33, v235
    v_add_u32_e32 v254, s39, v235
    ds_read_b64_tr_b16 a[180:181], v254 offset:0
    ds_read_b64_tr_b16 a[182:183], v235 offset:32768
    v_mul_f32_e32 v3, s41, v3
    s_waitcnt lgkmcnt(4)
    v_mfma_f32_16x16x32_bf16 v[20:23], a[160:163], a[144:147], v[20:23]
    s_add_u32 s37, s46, 786432
    ds_read_b64_tr_b16 a[184:185], v235 offset:36864
    ds_read_b64_tr_b16 a[186:187], v235 offset:40960
    v_mul_f32_e32 v4, s41, v4
    v_mul_f32_e32 v5, s41, v5
    v_mfma_f32_16x16x32_bf16 v[20:23], a[164:167], a[152:155], v[20:23]
    buffer_load_dwordx4 v32, s[16:19], s37 offen offset:0  lds
    ds_read_b64_tr_b16 a[188:189], v235 offset:45056
    ds_read_b64_tr_b16 a[190:191], v235 offset:49152
    v_mfma_f32_16x16x32_bf16 v[24:27], a[168:171], a[136:139], v[24:27]
    buffer_load_dwordx4 v33, s[16:19], s37 offen offset:1024  lds
    buffer_load_dwordx4 v34, s[16:19], s37 offen offset:2048  lds
    v_add_u32_e32 v224, s33, v224
    ds_read_b128 a[160:163], v224 offset:0
    v_mfma_f32_16x16x32_bf16 v[24:27], a[172:175], a[144:147], v[24:27]
    buffer_load_dwordx4 v35, s[16:19], s37 offen offset:3072  lds
    v_add_u32_e32 v225, s33, v225
    ds_read_b128 a[164:167], v225 offset:0
    s_waitcnt lgkmcnt(2)
    v_mfma_f32_16x16x32_bf16 v[24:27], a[176:179], a[152:155], v[24:27]
    s_add_u32 m0, s50, 40960
    v_add_u32_e32 v226, s33, v226
    ds_read_b128 a[168:171], v226 offset:0
    v_mul_f32_e32 v6, s41, v6
    v_mul_f32_e32 v7, s41, v7
    v_mfma_f32_16x16x32_bf16 v[28:31], a[180:183], a[136:139], v[28:31]
    s_add_u32 s37, s46, 917504
    buffer_load_dwordx4 v32, s[16:19], s37 offen offset:0  lds
    v_add_u32_e32 v227, s33, v227
    ds_read_b128 a[172:175], v227 offset:0
    v_mfma_f32_16x16x32_bf16 v[28:31], a[184:187], a[144:147], v[28:31]
    buffer_load_dwordx4 v33, s[16:19], s37 offen offset:1024  lds
    ds_read_b128 a[176:179], v224 offset:4096
    v_mfma_f32_16x16x32_bf16 v[28:31], a[188:191], a[152:155], v[28:31]
    buffer_load_dwordx4 v34, s[16:19], s37 offen offset:2048  lds
    ds_read_b128 a[180:183], v225 offset:4096
    v_cvt_pk_bf16_f32 v192, v0, v1
    v_cvt_pk_bf16_f32 v193, v2, v3
    v_cvt_pk_bf16_f32 v194, v4, v5
    v_cvt_pk_bf16_f32 v195, v6, v7
    s_nop 0
    v_permlane32_swap_b32_e32 v192, v194
    v_permlane32_swap_b32_e32 v193, v195
    s_nop 0
    v_permlane16_swap_b32_e32 v192, v194
    v_permlane16_swap_b32_e32 v193, v195
    v_mul_f32_e32 v8, s41, v8
    v_mul_f32_e32 v9, s41, v9
    v_mul_f32_e32 v10, s41, v10
    v_mul_f32_e32 v11, s41, v11
    v_mul_f32_e32 v12, s41, v12
    v_mul_f32_e32 v13, s41, v13
    v_mul_f32_e32 v14, s41, v14
    v_mul_f32_e32 v15, s41, v15
    v_cvt_pk_bf16_f32 v196, v8, v9
    v_cvt_pk_bf16_f32 v197, v10, v11
    v_cvt_pk_bf16_f32 v198, v12, v13
    v_cvt_pk_bf16_f32 v199, v14, v15
    s_nop 0
    v_permlane32_swap_b32_e32 v196, v198
    v_permlane32_swap_b32_e32 v197, v199
    s_nop 0
    v_permlane16_swap_b32_e32 v196, v198
    v_permlane16_swap_b32_e32 v197, v199
    v_mul_f32_e32 v16, s41, v16
    v_mul_f32_e32 v17, s41, v17
    v_mul_f32_e32 v18, s41, v18
    v_mul_f32_e32 v19, s41, v19
    v_mul_f32_e32 v20, s41, v20
    v_mul_f32_e32 v21, s41, v21
    v_mul_f32_e32 v22, s41, v22
    v_mul_f32_e32 v23, s41, v23
    v_cvt_pk_bf16_f32 v200, v16, v17
    v_cvt_pk_bf16_f32 v201, v18, v19
    v_cvt_pk_bf16_f32 v202, v20, v21
    v_cvt_pk_bf16_f32 v203, v22, v23
    s_nop 0
    v_permlane32_swap_b32_e32 v200, v202
    v_permlane32_swap_b32_e32 v201, v203
    s_nop 0
    v_permlane16_swap_b32_e32 v200, v202
    v_permlane16_swap_b32_e32 v201, v203
    v_mul_f32_e32 v24, s41, v24
    v_mul_f32_e32 v25, s41, v25
    v_mul_f32_e32 v26, s41, v26
    v_mul_f32_e32 v27, s41, v27
    v_mul_f32_e32 v28, s41, v28
    v_mul_f32_e32 v29, s41, v29
    v_mul_f32_e32 v30, s41, v30
    v_mul_f32_e32 v31, s41, v31
    v_cvt_pk_bf16_f32 v204, v24, v25
    v_cvt_pk_bf16_f32 v205, v26, v27
    v_cvt_pk_bf16_f32 v206, v28, v29
    v_cvt_pk_bf16_f32 v207, v30, v31
    s_nop 0
    v_permlane32_swap_b32_e32 v204, v206
    v_permlane32_swap_b32_e32 v205, v207
    s_nop 0
    v_permlane16_swap_b32_e32 v204, v206
    v_permlane16_swap_b32_e32 v205, v207
    s_waitcnt lgkmcnt(2)
    v_mfma_f32_16x16x32_bf16 v[128:131], a[160:163], v[192:195], 0
    buffer_load_dwordx4 v35, s[16:19], s37 offen offset:3072  lds
    ds_read_b128 a[184:187], v226 offset:4096
    v_mfma_f32_16x16x32_bf16 v[128:131], a[164:167], v[196:199], v[128:131]
    s_add_u32 m0, s50, 45056
    s_add_u32 s37, s46, 1048576
    ds_read_b128 a[188:191], v227 offset:4096
    v_mfma_f32_16x16x32_bf16 v[128:131], a[168:171], v[200:203], v[128:131]
    buffer_load_dwordx4 v32, s[16:19], s37 offen offset:0  lds
    ds_read_b128 a[160:163], v224 offset:8192
    v_mfma_f32_16x16x32_bf16 v[128:131], a[172:175], v[204:207], v[128:131]
    buffer_load_dwordx4 v33, s[16:19], s37 offen offset:1024  lds
    ds_read_b128 a[164:167], v225 offset:8192
    s_waitcnt lgkmcnt(2)
    v_mfma_f32_16x16x32_bf16 v[132:135], a[176:179], v[192:195], 0
    buffer_load_dwordx4 v34, s[16:19], s37 offen offset:2048  lds
    buffer_load_dwordx4 v35, s[16:19], s37 offen offset:3072  lds
    ds_read_b128 a[168:171], v226 offset:8192
    v_mfma_f32_16x16x32_bf16 v[132:135], a[180:183], v[196:199], v[132:135]
    s_add_u32 m0, s50, 49152
    ds_read_b128 a[172:175], v227 offset:8192
    v_mfma_f32_16x16x32_bf16 v[132:135], a[184:187], v[200:203], v[132:135]
    s_mov_b32 s57, 0
    v_readfirstlane_b32 s56, v115
    s_nop 0
    s_lshr_b32 s56, s56, s57
    s_and_b32 s56, s56, 15
    s_cmp_ge_u32 s56, 1
    s_cbranch_scc1 A_chk_done2
    s_mov_b32 s57, 0
    s_mov_b32 s58, 0
A_poll3:
    buffer_load_dword v115, v114, s[96:99], 0 offen sc1
    s_waitcnt vmcnt(0)
    v_readfirstlane_b32 s56, v115
    s_add_u32 s58, s58, 1
    s_lshr_b32 s56, s56, s57
    s_and_b32 s56, s56, 15
    s_cmp_ge_u32 s56, 1
    s_cbranch_scc1 A_poll_done3
    s_sleep 4
    s_cmp_lt_u32 s58, 400000
    s_cbranch_scc1 A_poll3
A_poll_done3:
A_chk_done2:
    s_add_u32 s37, s46, 1179648
    ds_read_b128 a[176:179], v224 offset:12288
    v_mfma_f32_16x16x32_bf16 v[132:135], a[188:191], v[204:207], v[132:135]
    buffer_load_dwordx4 v32, s[16:19], s37 offen offset:0  lds
    ds_read_b128 a[180:183], v225 offset:12288
    s_waitcnt lgkmcnt(2)
    v_mfma_f32_16x16x32_bf16 v[136:139], a[160:163], v[192:195], 0
    buffer_load_dwordx4 v33, s[16:19], s37 offen offset:1024  lds
    buffer_load_dwordx4 v34, s[16:19], s37 offen offset:2048  lds
    ds_read_b128 a[184:187], v226 offset:12288
    v_mfma_f32_16x16x32_bf16 v[136:139], a[164:167], v[196:199], v[136:139]
    buffer_load_dwordx4 v35, s[16:19], s37 offen offset:3072  lds
    ds_read_b128 a[188:191], v227 offset:12288
    v_mfma_f32_16x16x32_bf16 v[136:139], a[168:171], v[200:203], v[136:139]
    s_mov_b32 s31, s46
    v_mfma_f32_16x16x32_bf16 v[136:139], a[172:175], v[204:207], v[136:139]
    s_add_u32 s46, s46, 256
    s_waitcnt lgkmcnt(0)
    v_mfma_f32_16x16x32_bf16 v[140:143], a[176:179], v[192:195], 0
    s_waitcnt vmcnt(28)
    s_barrier
    s_mov_b32 s50, s32
    s_add_u32 s34, s32, s38
    s_add_u32 s32, s32, s42
    s_cmp_eq_u32 s32, 159744
    s_cselect_b32 s33, s43, s42
    s_cselect_b32 s32, 0, s32
    v_add_u32_e32 v224, s33, v224
    ds_read_b128 a[160:163], v224 offset:0
    v_add_u32_e32 v225, s33, v225
    ds_read_b128 a[164:167], v225 offset:0
    v_add_u32_e32 v226, s33, v226
    ds_read_b128 a[168:171], v226 offset:0
    v_mfma_f32_16x16x32_bf16 v[140:143], a[180:183], v[196:199], v[140:143]
    v_mfma_f32_16x16x32_bf16 v[140:143], a[184:187], v[200:203], v[140:143]
    v_mfma_f32_16x16x32_bf16 v[140:143], a[188:191], v[204:207], v[140:143]
A_B_head:
    s_waitcnt lgkmcnt(0)
    v_mfma_f32_16x16x32_bf16 v[160:163], a[160:163], v[192:195], 0
    s_mov_b32 m0, 159744
    s_add_u32 s37, s31, 524288
    v_add_u32_e32 v227, s33, v227
    ds_read_b128 a[172:175], v227 offset:0
    ds_read_b128 a[176:179], v224 offset:4096
    ds_read_b128 a[180:183], v225 offset:4096
    ds_read_b128 a[184:187], v226 offset:4096
    v_mfma_f32_16x16x32_bf16 v[160:163], a[164:167], v[196:199], v[160:163]
    buffer_load_dwordx4 v32, s[16:19], s37 offen offset:0  lds
    ds_read_b128 a[188:191], v227 offset:4096
    v_mfma_f32_16x16x32_bf16 v[160:163], a[168:171], v[200:203], v[160:163]
    buffer_load_dwordx4 v33, s[16:19], s37 offen offset:1024  lds
    ds_read_b128 a[160:163], v224 offset:8192
    s_waitcnt lgkmcnt(5)
    v_mfma_f32_16x16x32_bf16 v[160:163], a[172:175], v[204:207], v[160:163]
    buffer_load_dwordx4 v34, s[16:19], s37 offen offset:2048  lds
    ds_read_b128 a[164:167], v225 offset:8192
    s_waitcnt lgkmcnt(2)
    v_mfma_f32_16x16x32_bf16 v[164:167], a[176:179], v[192:195], 0
    buffer_load_dwordx4 v35, s[16:19], s37 offen offset:3072  lds
    ds_read_b128 a[168:171], v226 offset:8192
    v_mfma_f32_16x16x32_bf16 v[164:167], a[180:183], v[196:199], v[164:167]
    s_add_u32 m0, s34, 0
    ds_read_b128 a[172:175], v227 offset:8192
    v_exp_f32_e32 v128, v128
    v_exp_f32_e32 v129, v129
    v_mfma_f32_16x16x32_bf16 v[164:167], a[184:187], v[200:203], v[164:167]
    buffer_load_dwordx4 v236, s[8:11], s29 offen offset:0 nt lds
    ds_read_b128 a[176:179], v224 offset:12288
    v_mfma_f32_16x16x32_bf16 v[164:167], a[188:191], v[204:207], v[164:167]
    buffer_load_dwordx4 v237, s[8:11], s29 offen offset:1024 nt lds
    ds_read_b128 a[180:183], v225 offset:12288
    s_waitcnt lgkmcnt(2)
    v_mfma_f32_16x16x32_bf16 v[168:171], a[160:163], v[192:195], 0
    buffer_load_dwordx4 v238, s[8:11], s29 offen offset:2048 nt lds
    ds_read_b128 a[184:187], v226 offset:12288
    v_mfma_f32_16x16x32_bf16 v[168:171], a[164:167], v[196:199], v[168:171]
    buffer_load_dwordx4 v239, s[8:11], s29 offen offset:3072 nt lds
    ds_read_b128 a[188:191], v227 offset:12288
    v_mfma_f32_16x16x32_bf16 v[168:171], a[168:171], v[200:203], v[168:171]
    s_add_u32 s29, s29, 16384
    v_add_u32_e32 v228, s33, v228
    ds_read_b64_tr_b16 a[160:161], v228 offset:32768
    ds_read_b64_tr_b16 a[162:163], v228 offset:36864
    v_exp_f32_e32 v130, v130
    v_mfma_f32_16x16x32_bf16 v[168:171], a[172:175], v[204:207], v[168:171]
    s_add_u32 m0, s34, 16384
    v_add_u32_e32 v229, s33, v229
    ds_read_b64_tr_b16 a[164:165], v229 offset:32768
    ds_read_b64_tr_b16 a[166:167], v229 offset:36864
    v_exp_f32_e32 v131, v131
    s_waitcnt lgkmcnt(4)
    v_mfma_f32_16x16x32_bf16 v[172:175], a[176:179], v[192:195], 0
    buffer_load_dwordx4 v240, s[12:15], s30 offen offset:0 nt lds
    v_add_u32_e32 v230, s33, v230
    ds_read_b64_tr_b16 a[168:169], v230 offset:32768
    ds_read_b64_tr_b16 a[170:171], v230 offset:36864
    v_mfma_f32_16x16x32_bf16 v[172:175], a[180:183], v[196:199], v[172:175]
    buffer_load_dwordx4 v241, s[12:15], s30 offen offset:1024 nt lds
    v_add_u32_e32 v231, s33, v231
    ds_read_b64_tr_b16 a[172:173], v231 offset:32768
    ds_read_b64_tr_b16 a[174:175], v231 offset:36864
    v_mfma_f32_16x16x32_bf16 v[172:175], a[184:187], v[200:203], v[172:175]
    buffer_load_dwordx4 v240, s[12:15], s30 offen offset:2048 nt lds
    v_add_u32_e32 v232, s33, v232
    ds_read_b64_tr_b16 a[176:177], v232 offset:32768
    ds_read_b64_tr_b16 a[178:179], v232 offset:36864
    v_mfma_f32_16x16x32_bf16 v[172:175], a[188:191], v[204:207], v[172:175]
    buffer_load_dwordx4 v241, s[12:15], s30 offen offset:3072 nt lds
    v_add_u32_e32 v233, s33, v233
    ds_read_b64_tr_b16 a[180:181], v233 offset:32768
    ds_read_b64_tr_b16 a[182:183], v233 offset:36864
    s_waitcnt lgkmcnt(4)
    v_mfma_f32_16x16x32_bf16 v[0:3], a[160:163], a[0:3], 0
    s_add_u32 s30, s30, 16384
    v_add_u32_e32 v234, s33, v234
    ds_read_b64_tr_b16 a[184:185], v234 offset:32768
    ds_read_b64_tr_b16 a[186:187], v234 offset:36864
    v_cvt_pk_bf16_f32 v128, v128, v129
    v_mfma_f32_16x16x32_bf16 v[4:7], a[164:167], a[0:3], 0
    v_add_u32_e32 v235, s33, v235
    ds_read_b64_tr_b16 a[188:189], v235 offset:32768
    ds_read_b64_tr_b16 a[190:191], v235 offset:36864
    v_exp_f32_e32 v132, v132
    v_mfma_f32_16x16x32_bf16 v[8:11], a[168:171], a[0:3], 0
    ds_read_b64_tr_b16 a[160:161], v228 offset:40960
    ds_read_b64_tr_b16 a[162:163], v228 offset:45056
    v_exp_f32_e32 v133, v133
    v_cvt_pk_bf16_f32 v129, v130, v131
    v_mfma_f32_16x16x32_bf16 v[12:15], a[172:175], a[0:3], 0
    ds_read_b64_tr_b16 a[164:165], v229 offset:40960
    ds_read_b64_tr_b16 a[166:167], v229 offset:45056
    v_exp_f32_e32 v134, v134
    v_exp_f32_e32 v135, v135
    s_waitcnt lgkmcnt(4)
    v_mfma_f32_16x16x32_bf16 v[16:19], a[176:179], a[0:3], 0
    ds_read_b64_tr_b16 a[168:169], v230 offset:40960
    ds_read_b64_tr_b16 a[170:171], v230 offset:45056
    v_cvt_pk_bf16_f32 v130, v132, v133
    v_cvt_pk_bf16_f32 v131, v134, v135
    v_mfma_f32_16x16x32_bf16 v[20:23], a[180:183], a[0:3], 0
    ds_read_b64_tr_b16 a[172:173], v231 offset:40960
    ds_read_b64_tr_b16 a[174:175], v231 offset:45056
    v_exp_f32_e32 v136, v136
    v_exp_f32_e32 v137, v137
    v_mfma_f32_16x16x32_bf16 v[24:27], a[184:187], a[0:3], 0
    ds_read_b64_tr_b16 a[176:177], v232 offset:40960
    ds_read_b64_tr_b16 a[178:179], v232 offset:45056
    v_mfma_f32_16x16x32_bf16 v[246:249], v[242:245], v[128:131], 0
    v_exp_f32_e32 v138, v138
    v_mfma_f32_16x16x32_bf16 v[28:31], a[188:191], a[0:3], 0
    ds_read_b64_tr_b16 a[180:181], v233 offset:40960
    ds_read_b64_tr_b16 a[182:183], v233 offset:45056
    v_exp_f32_e32 v139, v139
    v_cvt_pk_bf16_f32 v136, v136, v137
    s_waitcnt lgkmcnt(4)
    v_mfma_f32_16x16x32_bf16 v[0:3], a[160:163], a[8:11], v[0:3]
    ds_read_b64_tr_b16 a[184:185], v234 offset:40960
    ds_read_b64_tr_b16 a[186:187], v234 offset:45056
    v_exp_f32_e32 v140, v140
    v_mfma_f32_16x16x32_bf16 v[4:7], a[164:167], a[8:11], v[4:7]
    ds_read_b64_tr_b16 a[188:189], v235 offset:40960
    ds_read_b64_tr_b16 a[190:191], v235 offset:45056
    v_exp_f32_e32 v141, v141
    v_cvt_pk_bf16_f32 v137, v138, v139
    v_mfma_f32_16x16x32_bf16 v[8:11], a[168:171], a[8:11], v[8:11]
    ds_read_b64_tr_b16 a[160:161], v228 offset:16384
    ds_read_b64_tr_b16 a[162:163], v228 offset:20480
    v_exp_f32_e32 v142, v142
    v_mfma_f32_16x16x32_bf16 v[12:15], a[172:175], a[8:11], v[12:15]
    ds_read_b64_tr_b16 a[164:165], v229 offset:16384
    ds_read_b64_tr_b16 a[166:167], v229 offset:20480
    s_waitcnt lgkmcnt(4)
    v_mfma_f32_16x16x32_bf16 v[16:19], a[176:179], a[8:11], v[16:19]
    ds_read_b64_tr_b16 a[168:169], v230 offset:16384
    ds_read_b64_tr_b16 a[170:171], v230 offset:20480
    v_mfma_f32_16x16x32_bf16 v[20:23], a[180:183], a[8:11], v[20:23]
    ds_read_b64_tr_b16 a[172:173], v231 offset:16384
    ds_read_b64_tr_b16 a[174:175], v231 offset:20480
    v_mfma_f32_16x16x32_bf16 v[24:27], a[184:187], a[8:11], v[24:27]
    ds_read_b64_tr_b16 a[176:177], v232 offset:16384
    ds_read_b64_tr_b16 a[178:179], v232 offset:20480
    v_mfma_f32_16x16x32_bf16 v[28:31], a[188:191], a[8:11], v[28:31]
    s_cmp_eq_u32 s35, 3
    s_cselect_b32 s94, 655360, 0
    s_mov_b32 s36, 0
    buffer_load_dword v41, v40, s[92:95], s36 offen
    ds_read_b64_tr_b16 a[180:181], v233 offset:16384
    ds_read_b64_tr_b16 a[182:183], v233 offset:20480
    s_waitcnt lgkmcnt(4)
    v_mfma_f32_16x16x32_bf16 v[64:67], a[160:163], v[128:131], 0
    s_add_u32 m0, s50, 32768
    s_add_u32 s37, s31, 1310720
    ds_read_b64_tr_b16 a[184:185], v234 offset:16384
    ds_read_b64_tr_b16 a[186:187], v234 offset:20480
    v_mfma_f32_16x16x32_bf16 v[68:71], a[164:167], v[128:131], 0
    buffer_load_dwordx4 v32, s[16:19], s37 offen offset:0  lds
    buffer_load_dwordx4 v33, s[16:19], s37 offen offset:1024  lds
    ds_read_b64_tr_b16 a[188:189], v235 offset:16384
    ds_read_b64_tr_b16 a[190:191], v235 offset:20480
    v_mfma_f32_16x16x32_bf16 v[72:75], a[168:171], v[128:131], 0
    buffer_load_dwordx4 v34, s[16:19], s37 offen offset:2048  lds
    buffer_load_dwordx4 v35, s[16:19], s37 offen offset:3072  lds
    ds_read_b64_tr_b16 a[160:161], v228 offset:24576
    ds_read_b64_tr_b16 a[162:163], v228 offset:28672
    v_mfma_f32_16x16x32_bf16 v[76:79], a[172:175], v[128:131], 0
    s_add_u32 m0, s50, 36864
    s_add_u32 s37, s31, 1441792
    ds_read_b64_tr_b16 a[164:165], v229 offset:24576
    ds_read_b64_tr_b16 a[166:167], v229 offset:28672
    s_waitcnt lgkmcnt(4)
    v_mfma_f32_16x16x32_bf16 v[80:83], a[176:179], v[128:131], 0
    buffer_load_dwordx4 v32, s[16:19], s37 offen offset:0  lds
    buffer_load_dwordx4 v33, s[16:19], s37 offen offset:1024  lds
    ds_read_b64_tr_b16 a[168:169], v230 offset:24576
    ds_read_b64_tr_b16 a[170:171], v230 offset:28672
    v_mfma_f32_16x16x32_bf16 v[84:87], a[180:183], v[128:131], 0
    buffer_load_dwordx4 v34, s[16:19], s37 offen offset:2048  lds
    buffer_load_dwordx4 v35, s[16:19], s37 offen offset:3072  lds
    ds_read_b64_tr_b16 a[172:173], v231 offset:24576
    ds_read_b64_tr_b16 a[174:175], v231 offset:28672
    v_mfma_f32_16x16x32_bf16 v[88:91], a[184:187], v[128:131], 0
    s_add_u32 m0, s50, 40960
    s_add_u32 s37, s31, 1572864
    ds_read_b64_tr_b16 a[176:177], v232 offset:24576
    ds_read_b64_tr_b16 a[178:179], v232 offset:28672
    v_mfma_f32_16x16x32_bf16 v[92:95], a[188:191], v[128:131], 0
    buffer_load_dwordx4 v32, s[16:19], s37 offen offset:0  lds
    buffer_load_dwordx4 v33, s[16:19], s37 offen offset:1024  lds
    ds_read_b64_tr_b16 a[180:181], v233 offset:24576
    ds_read_b64_tr_b16 a[182:183], v233 offset:28672
    v_exp_f32_e32 v143, v143
    v_cvt_pk_bf16_f32 v138, v140, v141
    v_cvt_pk_bf16_f32 v139, v142, v143
    s_waitcnt lgkmcnt(4)
    s_nop 0
    v_mfma_f32_16x16x32_bf16 v[64:67], a[160:163], v[136:139], v[64:67]
    buffer_load_dwordx4 v34, s[16:19], s37 offen offset:2048  lds
    buffer_load_dwordx4 v35, s[16:19], s37 offen offset:3072  lds
    ds_read_b64_tr_b16 a[184:185], v234 offset:24576
    ds_read_b64_tr_b16 a[186:187], v234 offset:28672
    v_mfma_f32_16x16x32_bf16 v[68:71], a[164:167], v[136:139], v[68:71]
    s_add_u32 m0, s50, 45056
    s_add_u32 s37, s31, 1703936
    ds_read_b64_tr_b16 a[188:189], v235 offset:24576
    ds_read_b64_tr_b16 a[190:191], v235 offset:28672
    v_exp_f32_e32 v160, v160
    v_mfma_f32_16x16x32_bf16 v[72:75], a[168:171], v[136:139], v[72:75]
    buffer_load_dwordx4 v32, s[16:19], s37 offen offset:0  lds
    buffer_load_dwordx4 v33, s[16:19], s37 offen offset:1024  lds
    v_mfma_f32_16x16x32_bf16 v[76:79], a[172:175], v[136:139], v[76:79]
    buffer_load_dwordx4 v34, s[16:19], s37 offen offset:2048  lds
    buffer_load_dwordx4 v35, s[16:19], s37 offen offset:3072  lds
    s_waitcnt lgkmcnt(0)
    v_mfma_f32_16x16x32_bf16 v[80:83], a[176:179], v[136:139], v[80:83]
    s_waitcnt vmcnt(25)
    s_barrier
    s_mov_b32 s50, s32
    s_add_u32 s34, s32, s38
    s_add_u32 s32, s32, s42
    s_cmp_eq_u32 s32, 159744
    s_cselect_b32 s33, s43, s42
    s_cselect_b32 s32, 0, s32
    s_sub_u32 s39, 159744, s32
    v_add_u32_e32 v224, s33, v224
    ds_read_b128 a[160:163], v224 offset:0
    v_add_u32_e32 v225, s33, v225
    ds_read_b128 a[164:167], v225 offset:0
    v_add_u32_e32 v226, s33, v226
    ds_read_b128 a[168:171], v226 offset:0
    v_mfma_f32_16x16x32_bf16 v[84:87], a[180:183], v[136:139], v[84:87]
    v_add_u32_e32 v227, s33, v227
    ds_read_b128 a[172:175], v227 offset:0
    v_mfma_f32_16x16x32_bf16 v[246:249], v[242:245], v[136:139], v[246:249]
    v_exp_f32_e32 v161, v161
    v_mfma_f32_16x16x32_bf16 v[88:91], a[184:187], v[136:139], v[88:91]
    ds_read_b128 a[176:179], v224 offset:4096
    v_exp_f32_e32 v162, v162
    v_exp_f32_e32 v163, v163
    v_cvt_pk_bf16_f32 v160, v160, v161
    v_mfma_f32_16x16x32_bf16 v[92:95], a[188:191], v[136:139], v[92:95]
    ds_read_b128 a[180:183], v225 offset:4096
    v_exp_f32_e32 v164, v164
    v_exp_f32_e32 v165, v165
    v_cvt_pk_bf16_f32 v161, v162, v163
    s_waitcnt lgkmcnt(2)
    v_mfma_f32_16x16x32_bf16 v[128:131], a[160:163], v[192:195], 0
    s_add_u32 m0, s34, 0
    ds_read_b128 a[184:187], v226 offset:4096
    v_exp_f32_e32 v166, v166
    v_mfma_f32_16x16x32_bf16 v[128:131], a[164:167], v[196:199], v[128:131]
    buffer_load_dwordx4 v236, s[8:11], s29 offen offset:0 nt lds
    ds_read_b128 a[188:191], v227 offset:4096
    v_mfma_f32_16x16x32_bf16 v[128:131], a[168:171], v[200:203], v[128:131]
    buffer_load_dwordx4 v237, s[8:11], s29 offen offset:1024 nt lds
    ds_read_b128 a[160:163], v224 offset:8192
    v_mfma_f32_16x16x32_bf16 v[128:131], a[172:175], v[204:207], v[128:131]
    ds_read_b128 a[164:167], v225 offset:8192
    v_exp_f32_e32 v167, v167
    v_cvt_pk_bf16_f32 v162, v164, v165
    v_cvt_pk_bf16_f32 v163, v166, v167
    s_waitcnt lgkmcnt(2)
    v_mfma_f32_16x16x32_bf16 v[132:135], a[176:179], v[192:195], 0
    buffer_load_dwordx4 v238, s[8:11], s29 offen offset:2048 nt lds
    ds_read_b128 a[168:171], v226 offset:8192
    v_mfma_f32_16x16x32_bf16 v[132:135], a[180:183], v[196:199], v[132:135]
    buffer_load_dwordx4 v239, s[8:11], s29 offen offset:3072 nt lds
    ds_read_b128 a[172:175], v227 offset:8192
    v_mfma_f32_16x16x32_bf16 v[132:135], a[184:187], v[200:203], v[132:135]
    ds_read_b128 a[176:179], v224 offset:12288
    v_exp_f32_e32 v168, v168
    v_exp_f32_e32 v169, v169
    v_mfma_f32_16x16x32_bf16 v[132:135], a[188:191], v[204:207], v[132:135]
    s_add_u32 s29, s29, 16384
    ds_read_b128 a[180:183], v225 offset:12288
    v_mfma_f32_16x16x32_bf16 v[246:249], v[242:245], v[160:163], v[246:249]
    v_exp_f32_e32 v170, v170
    s_waitcnt lgkmcnt(2)
    v_mfma_f32_16x16x32_bf16 v[136:139], a[160:163], v[192:195], 0
    s_add_u32 m0, s34, 16384
    ds_read_b128 a[184:187], v226 offset:12288
    v_mfma_f32_16x16x32_bf16 v[136:139], a[164:167], v[196:199], v[136:139]
    buffer_load_dwordx4 v240, s[12:15], s30 offen offset:0 nt lds
    ds_read_b128 a[188:191], v227 offset:12288
    v_mfma_f32_16x16x32_bf16 v[136:139], a[168:171], v[200:203], v[136:139]
    v_add_u32_e32 v228, s33, v228
    v_add_u32_e32 v254, s39, v228
    ds_read_b64_tr_b16 a[160:161], v254 offset:0
    ds_read_b64_tr_b16 a[162:163], v228 offset:32768
    v_exp_f32_e32 v171, v171
    v_mfma_f32_16x16x32_bf16 v[136:139], a[172:175], v[204:207], v[136:139]
    buffer_load_dwordx4 v241, s[12:15], s30 offen offset:1024 nt lds
    v_add_u32_e32 v229, s33, v229
    v_add_u32_e32 v254, s39, v229
    ds_read_b64_tr_b16 a[164:165], v254 offset:0
    ds_read_b64_tr_b16 a[166:167], v229 offset:32768
    s_waitcnt lgkmcnt(4)
    v_mfma_f32_16x16x32_bf16 v[140:143], a[176:179], v[192:195], 0
    buffer_load_dwordx4 v240, s[12:15], s30 offen offset:2048 nt lds
    v_add_u32_e32 v230, s33, v230
    v_add_u32_e32 v254, s39, v230
    ds_read_b64_tr_b16 a[168:169], v254 offset:0
    ds_read_b64_tr_b16 a[170:171], v230 offset:32768
    v_mfma_f32_16x16x32_bf16 v[140:143], a[180:183], v[196:199], v[140:143]
    v_add_u32_e32 v231, s33, v231
    v_add_u32_e32 v254, s39, v231
    ds_read_b64_tr_b16 a[172:173], v254 offset:0
    ds_read_b64_tr_b16 a[174:175], v231 offset:32768
    v_cvt_pk_bf16_f32 v168, v168, v169
    v_mfma_f32_16x16x32_bf16 v[140:143], a[184:187], v[200:203], v[140:143]
    buffer_load_dwordx4 v241, s[12:15], s30 offen offset:3072 nt lds
    v_add_u32_e32 v232, s33, v232
    v_add_u32_e32 v254, s39, v232
    ds_read_b64_tr_b16 a[176:177], v254 offset:0
    ds_read_b64_tr_b16 a[178:179], v232 offset:32768
    v_mfma_f32_16x16x32_bf16 v[140:143], a[188:191], v[204:207], v[140:143]
    s_add_u32 s30, s30, 16384
    v_add_u32_e32 v233, s33, v233
    v_add_u32_e32 v254, s39, v233
    ds_read_b64_tr_b16 a[180:181], v254 offset:0
    ds_read_b64_tr_b16 a[182:183], v233 offset:32768
    s_waitcnt lgkmcnt(4)
    v_mfma_f32_16x16x32_bf16 v[0:3], a[160:163], a[16:19], v[0:3]
    v_add_u32_e32 v234, s33, v234
    v_add_u32_e32 v254, s39, v234
    ds_read_b64_tr_b16 a[184:185], v254 offset:0
    ds_read_b64_tr_b16 a[186:187], v234 offset:32768
    v_mfma_f32_16x16x32_bf16 v[4:7], a[164:167], a[16:19], v[4:7]
    v_add_u32_e32 v235, s33, v235
    v_add_u32_e32 v254, s39, v235
    ds_read_b64_tr_b16 a[188:189], v254 offset:0
    ds_read_b64_tr_b16 a[190:191], v235 offset:32768
    v_exp_f32_e32 v172, v172
    v_mfma_f32_16x16x32_bf16 v[8:11], a[168:171], a[16:19], v[8:11]
    ds_read_b64_tr_b16 a[160:161], v228 offset:36864
    ds_read_b64_tr_b16 a[162:163], v228 offset:40960
    v_exp_f32_e32 v173, v173
    v_cvt_pk_bf16_f32 v169, v170, v171
    v_mfma_f32_16x16x32_bf16 v[12:15], a[172:175], a[16:19], v[12:15]
    ds_read_b64_tr_b16 a[164:165], v229 offset:36864
    ds_read_b64_tr_b16 a[166:167], v229 offset:40960
    v_exp_f32_e32 v174, v174
    s_waitcnt lgkmcnt(4)
    v_mfma_f32_16x16x32_bf16 v[16:19], a[176:179], a[16:19], v[16:19]
    ds_read_b64_tr_b16 a[168:169], v230 offset:36864
    ds_read_b64_tr_b16 a[170:171], v230 offset:40960
    v_mfma_f32_16x16x32_bf16 v[20:23], a[180:183], a[16:19], v[20:23]
    ds_read_b64_tr_b16 a[172:173], v231 offset:36864
    ds_read_b64_tr_b16 a[174:175], v231 offset:40960
    v_mfma_f32_16x16x32_bf16 v[24:27], a[184:187], a[16:19], v[24:27]
    ds_read_b64_tr_b16 a[176:177], v232 offset:36864
    ds_read_b64_tr_b16 a[178:179], v232 offset:40960
    v_mfma_f32_16x16x32_bf16 v[28:31], a[188:191], a[16:19], v[28:31]
    ds_read_b64_tr_b16 a[180:181], v233 offset:36864
    ds_read_b64_tr_b16 a[182:183], v233 offset:40960
    s_waitcnt lgkmcnt(4)
    v_mfma_f32_16x16x32_bf16 v[0:3], a[160:163], a[24:27], v[0:3]
    ds_read_b64_tr_b16 a[184:185], v234 offset:36864
    ds_read_b64_tr_b16 a[186:187], v234 offset:40960
    v_mfma_f32_16x16x32_bf16 v[4:7], a[164:167], a[24:27], v[4:7]
    ds_read_b64_tr_b16 a[188:189], v235 offset:36864
    ds_read_b64_tr_b16 a[190:191], v235 offset:40960
    v_mfma_f32_16x16x32_bf16 v[8:11], a[168:171], a[24:27], v[8:11]
    ds_read_b64_tr_b16 a[160:161], v228 offset:45056
    ds_read_b64_tr_b16 a[162:163], v228 offset:49152
    v_mfma_f32_16x16x32_bf16 v[12:15], a[172:175], a[24:27], v[12:15]
    ds_read_b64_tr_b16 a[164:165], v229 offset:45056
    ds_read_b64_tr_b16 a[166:167], v229 offset:49152
    s_waitcnt lgkmcnt(4)
    v_mfma_f32_16x16x32_bf16 v[16:19], a[176:179], a[24:27], v[16:19]
    ds_read_b64_tr_b16 a[168:169], v230 offset:45056
    ds_read_b64_tr_b16 a[170:171], v230 offset:49152
    v_mfma_f32_16x16x32_bf16 v[20:23], a[180:183], a[24:27], v[20:23]
    ds_read_b64_tr_b16 a[172:173], v231 offset:45056
    ds_read_b64_tr_b16 a[174:175], v231 offset:49152
    v_mfma_f32_16x16x32_bf16 v[24:27], a[184:187], a[24:27], v[24:27]
    ds_read_b64_tr_b16 a[176:177], v232 offset:45056
    ds_read_b64_tr_b16 a[178:179], v232 offset:49152
    v_mfma_f32_16x16x32_bf16 v[28:31], a[188:191], a[24:27], v[28:31]
    ds_read_b64_tr_b16 a[180:181], v233 offset:45056
    ds_read_b64_tr_b16 a[182:183], v233 offset:49152
    s_waitcnt lgkmcnt(4)
    v_mfma_f32_16x16x32_bf16 v[0:3], a[160:163], a[32:35], v[0:3]
    ds_read_b64_tr_b16 a[184:185], v234 offset:45056
    ds_read_b64_tr_b16 a[186:187], v234 offset:49152
    v_mfma_f32_16x16x32_bf16 v[4:7], a[164:167], a[32:35], v[4:7]
    ds_read_b64_tr_b16 a[188:189], v235 offset:45056
    ds_read_b64_tr_b16 a[190:191], v235 offset:49152
    v_mfma_f32_16x16x32_bf16 v[8:11], a[168:171], a[32:35], v[8:11]
    ds_read_b64_tr_b16 a[160:161], v228 offset:16384
    ds_read_b64_tr_b16 a[162:163], v228 offset:20480
    v_mfma_f32_16x16x32_bf16 v[12:15], a[172:175], a[32:35], v[12:15]
    ds_read_b64_tr_b16 a[164:165], v229 offset:16384
    ds_read_b64_tr_b16 a[166:167], v229 offset:20480
    s_waitcnt lgkmcnt(4)
    v_mfma_f32_16x16x32_bf16 v[16:19], a[176:179], a[32:35], v[16:19]
    s_mov_b32 s36, 8192
    buffer_load_dword v41, v40, s[92:95], s36 offen
    ds_read_b64_tr_b16 a[168:169], v230 offset:16384
    ds_read_b64_tr_b16 a[170:171], v230 offset:20480
    v_mfma_f32_16x16x32_bf16 v[20:23], a[180:183], a[32:35], v[20:23]
    s_add_u32 m0, s50, 32768
    s_add_u32 s37, s31, 1966080
    ds_read_b64_tr_b16 a[172:173], v231 offset:16384
    ds_read_b64_tr_b16 a[174:175], v231 offset:20480
    v_mfma_f32_16x16x32_bf16 v[24:27], a[184:187], a[32:35], v[24:27]
    buffer_load_dwordx4 v32, s[16:19], s37 offen offset:0  lds
    buffer_load_dwordx4 v33, s[16:19], s37 offen offset:1024  lds
    ds_read_b64_tr_b16 a[176:177], v232 offset:16384
    ds_read_b64_tr_b16 a[178:179], v232 offset:20480
    v_mfma_f32_16x16x32_bf16 v[28:31], a[188:191], a[32:35], v[28:31]
    buffer_load_dwordx4 v34, s[16:19], s37 offen offset:2048  lds
    buffer_load_dwordx4 v35, s[16:19], s37 offen offset:3072  lds
    ds_read_b64_tr_b16 a[180:181], v233 offset:16384
    ds_read_b64_tr_b16 a[182:183], v233 offset:20480
    s_waitcnt lgkmcnt(4)
    v_mfma_f32_16x16x32_bf16 v[64:67], a[160:163], v[160:163], v[64:67]
    s_add_u32 m0, s50, 36864
    s_add_u32 s37, s31, 2097152
    ds_read_b64_tr_b16 a[184:185], v234 offset:16384
    ds_read_b64_tr_b16 a[186:187], v234 offset:20480
    v_mfma_f32_16x16x32_bf16 v[68:71], a[164:167], v[160:163], v[68:71]
    buffer_load_dwordx4 v32, s[16:19], s37 offen offset:0  lds
    buffer_load_dwordx4 v33, s[16:19], s37 offen offset:1024  lds
    ds_read_b64_tr_b16 a[188:189], v235 offset:16384
    ds_read_b64_tr_b16 a[190:191], v235 offset:20480
    v_mfma_f32_16x16x32_bf16 v[72:75], a[168:171], v[160:163], v[72:75]
    buffer_load_dwordx4 v34, s[16:19], s37 offen offset:2048  lds
    buffer_load_dwordx4 v35, s[16:19], s37 offen offset:3072  lds
    ds_read_b64_tr_b16 a[160:161], v228 offset:24576
    ds_read_b64_tr_b16 a[162:163], v228 offset:28672
    v_mfma_f32_16x16x32_bf16 v[76:79], a[172:175], v[160:163], v[76:79]
    s_add_u32 m0, s50, 40960
    s_add_u32 s37, s31, 2228224
    ds_read_b64_tr_b16 a[164:165], v229 offset:24576
    ds_read_b64_tr_b16 a[166:167], v229 offset:28672
    s_waitcnt lgkmcnt(4)
    v_mfma_f32_16x16x32_bf16 v[80:83], a[176:179], v[160:163], v[80:83]
    buffer_load_dwordx4 v32, s[16:19], s37 offen offset:0  lds
    buffer_load_dwordx4 v33, s[16:19], s37 offen offset:1024  lds
    ds_read_b64_tr_b16 a[168:169], v230 offset:24576
    ds_read_b64_tr_b16 a[170:171], v230 offset:28672
    v_mfma_f32_16x16x32_bf16 v[84:87], a[180:183], v[160:163], v[84:87]
    buffer_load_dwordx4 v34, s[16:19], s37 offen offset:2048  lds
    buffer_load_dwordx4 v35, s[16:19], s37 offen offset:3072  lds
    ds_read_b64_tr_b16 a[172:173], v231 offset:24576
    ds_read_b64_tr_b16 a[174:175], v231 offset:28672
    v_mfma_f32_16x16x32_bf16 v[88:91], a[184:187], v[160:163], v[88:91]
    s_add_u32 m0, s50, 45056
    s_add_u32 s37, s31, 2359296
    ds_read_b64_tr_b16 a[176:177], v232 offset:24576
    ds_read_b64_tr_b16 a[178:179], v232 offset:28672
    v_mfma_f32_16x16x32_bf16 v[92:95], a[188:191], v[160:163], v[92:95]
    buffer_load_dwordx4 v32, s[16:19], s37 offen offset:0  lds
    buffer_load_dwordx4 v33, s[16:19], s37 offen offset:1024  lds
    ds_read_b64_tr_b16 a[180:181], v233 offset:24576
    ds_read_b64_tr_b16 a[182:183], v233 offset:28672
    v_exp_f32_e32 v175, v175
    v_cvt_pk_bf16_f32 v170, v172, v173
    v_cvt_pk_bf16_f32 v171, v174, v175
    s_waitcnt lgkmcnt(4)
    s_nop 0
    v_mfma_f32_16x16x32_bf16 v[64:67], a[160:163], v[168:171], v[64:67]
    buffer_load_dwordx4 v34, s[16:19], s37 offen offset:2048  lds
    buffer_load_dwordx4 v35, s[16:19], s37 offen offset:3072  lds
    ds_read_b64_tr_b16 a[184:185], v234 offset:24576
    ds_read_b64_tr_b16 a[186:187], v234 offset:28672
    v_mfma_f32_16x16x32_bf16 v[68:71], a[164:167], v[168:171], v[68:71]
    s_add_u32 m0, s50, 49152
    s_add_u32 s37, s31, 2490368
    ds_read_b64_tr_b16 a[188:189], v235 offset:24576
    ds_read_b64_tr_b16 a[190:191], v235 offset:28672
    v_exp_f32_e32 v128, v128
    v_mfma_f32_16x16x32_bf16 v[72:75], a[168:171], v[168:171], v[72:75]
    buffer_load_dwordx4 v32, s[16:19], s37 offen offset:0  lds
    buffer_load_dwordx4 v33, s[16:19], s37 offen offset:1024  lds
    v_mfma_f32_16x16x32_bf16 v[76:79], a[172:175], v[168:171], v[76:79]
    buffer_load_dwordx4 v34, s[16:19], s37 offen offset:2048  lds
    buffer_load_dwordx4 v35, s[16:19], s37 offen offset:3072  lds
    s_waitcnt lgkmcnt(0)
    v_mfma_f32_16x16x32_bf16 v[80:83], a[176:179], v[168:171], v[80:83]
    s_waitcnt vmcnt(29)
    s_barrier
    s_mov_b32 s50, s32
    s_add_u32 s34, s32, s38
    s_add_u32 s32, s32, s42
    s_cmp_eq_u32 s32, 159744
    s_cselect_b32 s33, s43, s42
    s_cselect_b32 s32, 0, s32
    v_add_u32_e32 v224, s33, v224
    ds_read_b128 a[160:163], v224 offset:0
    v_add_u32_e32 v225, s33, v225
    ds_read_b128 a[164:167], v225 offset:0
    v_add_u32_e32 v226, s33, v226
    ds_read_b128 a[168:171], v226 offset:0
    v_mfma_f32_16x16x32_bf16 v[84:87], a[180:183], v[168:171], v[84:87]
    v_add_u32_e32 v227, s33, v227
    ds_read_b128 a[172:175], v227 offset:0
    v_mfma_f32_16x16x32_bf16 v[246:249], v[242:245], v[168:171], v[246:249]
    v_exp_f32_e32 v129, v129
    v_mfma_f32_16x16x32_bf16 v[88:91], a[184:187], v[168:171], v[88:91]
    ds_read_b128 a[176:179], v224 offset:4096
    v_exp_f32_e32 v130, v130
    v_exp_f32_e32 v131, v131
    v_cvt_pk_bf16_f32 v128, v128, v129
    v_mfma_f32_16x16x32_bf16 v[92:95], a[188:191], v[168:171], v[92:95]
    ds_read_b128 a[180:183], v225 offset:4096
    v_exp_f32_e32 v132, v132
    v_exp_f32_e32 v133, v133
    v_cvt_pk_bf16_f32 v129, v130, v131
    s_waitcnt lgkmcnt(2)
    v_mfma_f32_16x16x32_bf16 v[160:163], a[160:163], v[192:195], 0
    s_mov_b32 m0, 159744
    s_add_u32 s37, s31, 1835008
    ds_read_b128 a[184:187], v226 offset:4096
    v_exp_f32_e32 v134, v134
    v_mfma_f32_16x16x32_bf16 v[160:163], a[164:167], v[196:199], v[160:163]
    buffer_load_dwordx4 v32, s[16:19], s37 offen offset:0  lds
    ds_read_b128 a[188:191], v227 offset:4096
    v_mfma_f32_16x16x32_bf16 v[160:163], a[168:171], v[200:203], v[160:163]
    buffer_load_dwordx4 v33, s[16:19], s37 offen offset:1024  lds
    ds_read_b128 a[160:163], v224 offset:8192
    v_mfma_f32_16x16x32_bf16 v[160:163], a[172:175], v[204:207], v[160:163]
    buffer_load_dwordx4 v34, s[16:19], s37 offen offset:2048  lds
    ds_read_b128 a[164:167], v225 offset:8192
    s_waitcnt lgkmcnt(2)
    v_mfma_f32_16x16x32_bf16 v[164:167], a[176:179], v[192:195], 0
    buffer_load_dwordx4 v35, s[16:19], s37 offen offset:3072  lds
    ds_read_b128 a[168:171], v226 offset:8192
    v_mfma_f32_16x16x32_bf16 v[164:167], a[180:183], v[196:199], v[164:167]
    s_add_u32 m0, s34, 0
    ds_read_b128 a[172:175], v227 offset:8192
    v_exp_f32_e32 v135, v135
    v_cvt_pk_bf16_f32 v130, v132, v133
    v_cvt_pk_bf16_f32 v131, v134, v135
    v_mfma_f32_16x16x32_bf16 v[164:167], a[184:187], v[200:203], v[164:167]
    buffer_load_dwordx4 v236, s[8:11], s29 offen offset:0 nt lds
    ds_read_b128 a[176:179], v224 offset:12288
    v_mfma_f32_16x16x32_bf16 v[164:167], a[188:191], v[204:207], v[164:167]
    buffer_load_dwordx4 v237, s[8:11], s29 offen offset:1024 nt lds
    ds_read_b128 a[180:183], v225 offset:12288
    s_waitcnt lgkmcnt(2)
    v_mfma_f32_16x16x32_bf16 v[168:171], a[160:163], v[192:195], 0
    buffer_load_dwordx4 v238, s[8:11], s29 offen offset:2048 nt lds
    ds_read_b128 a[184:187], v226 offset:12288
    v_mfma_f32_16x16x32_bf16 v[168:171], a[164:167], v[196:199], v[168:171]
    buffer_load_dwordx4 v239, s[8:11], s29 offen offset:3072 nt lds
    ds_read_b128 a[188:191], v227 offset:12288
    v_mfma_f32_16x16x32_bf16 v[168:171], a[168:171], v[200:203], v[168:171]
    s_add_u32 s29, s29, 16384
    v_add_u32_e32 v228, s33, v228
    ds_read_b64_tr_b16 a[160:161], v228 offset:32768
    ds_read_b64_tr_b16 a[162:163], v228 offset:36864
    v_exp_f32_e32 v136, v136
    v_mfma_f32_16x16x32_bf16 v[168:171], a[172:175], v[204:207], v[168:171]
    s_add_u32 m0, s34, 16384
    v_add_u32_e32 v229, s33, v229
    ds_read_b64_tr_b16 a[164:165], v229 offset:32768
    ds_read_b64_tr_b16 a[166:167], v229 offset:36864
    v_exp_f32_e32 v137, v137
    s_waitcnt lgkmcnt(4)
    v_mfma_f32_16x16x32_bf16 v[172:175], a[176:179], v[192:195], 0
    buffer_load_dwordx4 v240, s[12:15], s30 offen offset:0 nt lds
    v_add_u32_e32 v230, s33, v230
    ds_read_b64_tr_b16 a[168:169], v230 offset:32768
    ds_read_b64_tr_b16 a[170:171], v230 offset:36864
    v_mfma_f32_16x16x32_bf16 v[172:175], a[180:183], v[196:199], v[172:175]
    buffer_load_dwordx4 v241, s[12:15], s30 offen offset:1024 nt lds
    v_add_u32_e32 v231, s33, v231
    ds_read_b64_tr_b16 a[172:173], v231 offset:32768
    ds_read_b64_tr_b16 a[174:175], v231 offset:36864
    v_mfma_f32_16x16x32_bf16 v[172:175], a[184:187], v[200:203], v[172:175]
    buffer_load_dwordx4 v240, s[12:15], s30 offen offset:2048 nt lds
    v_add_u32_e32 v232, s33, v232
    ds_read_b64_tr_b16 a[176:177], v232 offset:32768
    ds_read_b64_tr_b16 a[178:179], v232 offset:36864
    v_mfma_f32_16x16x32_bf16 v[172:175], a[188:191], v[204:207], v[172:175]
    buffer_load_dwordx4 v241, s[12:15], s30 offen offset:3072 nt lds
    v_add_u32_e32 v233, s33, v233
    ds_read_b64_tr_b16 a[180:181], v233 offset:32768
    ds_read_b64_tr_b16 a[182:183], v233 offset:36864
    s_waitcnt lgkmcnt(4)
    v_mfma_f32_16x16x32_bf16 v[0:3], a[160:163], a[40:43], v[0:3]
    s_add_u32 s30, s30, 16384
    v_add_u32_e32 v234, s33, v234
    ds_read_b64_tr_b16 a[184:185], v234 offset:32768
    ds_read_b64_tr_b16 a[186:187], v234 offset:36864
    v_mfma_f32_16x16x32_bf16 v[4:7], a[164:167], a[40:43], v[4:7]
    v_add_u32_e32 v235, s33, v235
    ds_read_b64_tr_b16 a[188:189], v235 offset:32768
    v_mfma_f32_16x16x32_bf16 v[246:249], v[242:245], v[128:131], v[246:249]
    ds_read_b64_tr_b16 a[190:191], v235 offset:36864
    v_mfma_f32_16x16x32_bf16 v[8:11], a[168:171], a[40:43], v[8:11]
    ds_read_b64_tr_b16 a[160:161], v228 offset:40960
    ds_read_b64_tr_b16 a[162:163], v228 offset:45056
    v_exp_f32_e32 v138, v138
    v_exp_f32_e32 v139, v139
    v_mfma_f32_16x16x32_bf16 v[12:15], a[172:175], a[40:43], v[12:15]
    ds_read_b64_tr_b16 a[164:165], v229 offset:40960
    ds_read_b64_tr_b16 a[166:167], v229 offset:45056
    v_cvt_pk_bf16_f32 v136, v136, v137
    v_exp_f32_e32 v140, v140
    s_waitcnt lgkmcnt(4)
    v_mfma_f32_16x16x32_bf16 v[16:19], a[176:179], a[40:43], v[16:19]
    ds_read_b64_tr_b16 a[168:169], v230 offset:40960
    ds_read_b64_tr_b16 a[170:171], v230 offset:45056
    v_exp_f32_e32 v141, v141
    v_cvt_pk_bf16_f32 v137, v138, v139
    v_mfma_f32_16x16x32_bf16 v[20:23], a[180:183], a[40:43], v[20:23]
    ds_read_b64_tr_b16 a[172:173], v231 offset:40960
    ds_read_b64_tr_b16 a[174:175], v231 offset:45056
    v_exp_f32_e32 v142, v142
    v_mfma_f32_16x16x32_bf16 v[24:27], a[184:187], a[40:43], v[24:27]
    ds_read_b64_tr_b16 a[176:177], v232 offset:40960
    ds_read_b64_tr_b16 a[178:179], v232 offset:45056
    v_mfma_f32_16x16x32_bf16 v[28:31], a[188:191], a[40:43], v[28:31]
    ds_read_b64_tr_b16 a[180:181], v233 offset:40960
    ds_read_b64_tr_b16 a[182:183], v233 offset:45056
    s_waitcnt lgkmcnt(4)
    v_mfma_f32_16x16x32_bf16 v[0:3], a[160:163], a[48:51], v[0:3]
    ds_read_b64_tr_b16 a[184:185], v234 offset:40960
    ds_read_b64_tr_b16 a[186:187], v234 offset:45056
    v_mfma_f32_16x16x32_bf16 v[4:7], a[164:167], a[48:51], v[4:7]
    ds_read_b64_tr_b16 a[188:189], v235 offset:40960
    ds_read_b64_tr_b16 a[190:191], v235 offset:45056
    v_mfma_f32_16x16x32_bf16 v[8:11], a[168:171], a[48:51], v[8:11]
    ds_read_b64_tr_b16 a[160:161], v228 offset:16384
    ds_read_b64_tr_b16 a[162:163], v228 offset:20480
    v_mfma_f32_16x16x32_bf16 v[12:15], a[172:175], a[48:51], v[12:15]
    ds_read_b64_tr_b16 a[164:165], v229 offset:16384
    ds_read_b64_tr_b16 a[166:167], v229 offset:20480
    s_waitcnt lgkmcnt(4)
    v_mfma_f32_16x16x32_bf16 v[16:19], a[176:179], a[48:51], v[16:19]
    ds_read_b64_tr_b16 a[168:169], v230 offset:16384
    ds_read_b64_tr_b16 a[170:171], v230 offset:20480
    v_mfma_f32_16x16x32_bf16 v[20:23], a[180:183], a[48:51], v[20:23]
    ds_read_b64_tr_b16 a[172:173], v231 offset:16384
    ds_read_b64_tr_b16 a[174:175], v231 offset:20480
    v_mfma_f32_16x16x32_bf16 v[24:27], a[184:187], a[48:51], v[24:27]
    ds_read_b64_tr_b16 a[176:177], v232 offset:16384
    ds_read_b64_tr_b16 a[178:179], v232 offset:20480
    v_mfma_f32_16x16x32_bf16 v[28:31], a[188:191], a[48:51], v[28:31]
    s_mov_b32 s36, 16384
    buffer_load_dword v41, v40, s[92:95], s36 offen
    ds_read_b64_tr_b16 a[180:181], v233 offset:16384
    ds_read_b64_tr_b16 a[182:183], v233 offset:20480
    s_waitcnt lgkmcnt(4)
    v_mfma_f32_16x16x32_bf16 v[64:67], a[160:163], v[128:131], v[64:67]
    s_add_u32 m0, s50, 32768
    s_add_u32 s37, s31, 2621440
    ds_read_b64_tr_b16 a[184:185], v234 offset:16384
    ds_read_b64_tr_b16 a[186:187], v234 offset:20480
    v_mfma_f32_16x16x32_bf16 v[68:71], a[164:167], v[128:131], v[68:71]
    buffer_load_dwordx4 v32, s[16:19], s37 offen offset:0  lds
    buffer_load_dwordx4 v33, s[16:19], s37 offen offset:1024  lds
    ds_read_b64_tr_b16 a[188:189], v235 offset:16384
    ds_read_b64_tr_b16 a[190:191], v235 offset:20480
    v_mfma_f32_16x16x32_bf16 v[72:75], a[168:171], v[128:131], v[72:75]
    buffer_load_dwordx4 v34, s[16:19], s37 offen offset:2048  lds
    buffer_load_dwordx4 v35, s[16:19], s37 offen offset:3072  lds
    ds_read_b64_tr_b16 a[160:161], v228 offset:24576
    ds_read_b64_tr_b16 a[162:163], v228 offset:28672
    v_mfma_f32_16x16x32_bf16 v[76:79], a[172:175], v[128:131], v[76:79]
    s_add_u32 m0, s50, 36864
    s_add_u32 s37, s31, 2752512
    ds_read_b64_tr_b16 a[164:165], v229 offset:24576
    ds_read_b64_tr_b16 a[166:167], v229 offset:28672
    s_waitcnt lgkmcnt(4)
    v_mfma_f32_16x16x32_bf16 v[80:83], a[176:179], v[128:131], v[80:83]
    buffer_load_dwordx4 v32, s[16:19], s37 offen offset:0  lds
    buffer_load_dwordx4 v33, s[16:19], s37 offen offset:1024  lds
    ds_read_b64_tr_b16 a[168:169], v230 offset:24576
    ds_read_b64_tr_b16 a[170:171], v230 offset:28672
    v_mfma_f32_16x16x32_bf16 v[84:87], a[180:183], v[128:131], v[84:87]
    buffer_load_dwordx4 v34, s[16:19], s37 offen offset:2048  lds
    buffer_load_dwordx4 v35, s[16:19], s37 offen offset:3072  lds
    ds_read_b64_tr_b16 a[172:173], v231 offset:24576
    ds_read_b64_tr_b16 a[174:175], v231 offset:28672
    v_mfma_f32_16x16x32_bf16 v[88:91], a[184:187], v[128:131], v[88:91]
    s_add_u32 m0, s50, 40960
    s_add_u32 s37, s31, 2883584
    ds_read_b64_tr_b16 a[176:177], v232 offset:24576
    ds_read_b64_tr_b16 a[178:179], v232 offset:28672
    v_mfma_f32_16x16x32_bf16 v[92:95], a[188:191], v[128:131], v[92:95]
    buffer_load_dwordx4 v32, s[16:19], s37 offen offset:0  lds
    buffer_load_dwordx4 v33, s[16:19], s37 offen offset:1024  lds
    ds_read_b64_tr_b16 a[180:181], v233 offset:24576
    ds_read_b64_tr_b16 a[182:183], v233 offset:28672
    v_exp_f32_e32 v143, v143
    v_cvt_pk_bf16_f32 v138, v140, v141
    v_cvt_pk_bf16_f32 v139, v142, v143
    s_waitcnt lgkmcnt(4)
    s_nop 0
    v_mfma_f32_16x16x32_bf16 v[64:67], a[160:163], v[136:139], v[64:67]
    buffer_load_dwordx4 v34, s[16:19], s37 offen offset:2048  lds
    buffer_load_dwordx4 v35, s[16:19], s37 offen offset:3072  lds
    ds_read_b64_tr_b16 a[184:185], v234 offset:24576
    ds_read_b64_tr_b16 a[186:187], v234 offset:28672
    v_mfma_f32_16x16x32_bf16 v[68:71], a[164:167], v[136:139], v[68:71]
    s_add_u32 m0, s50, 45056
    s_add_u32 s37, s31, 3014656
    ds_read_b64_tr_b16 a[188:189], v235 offset:24576
    ds_read_b64_tr_b16 a[190:191], v235 offset:28672
    v_exp_f32_e32 v160, v160
    v_mfma_f32_16x16x32_bf16 v[72:75], a[168:171], v[136:139], v[72:75]
    buffer_load_dwordx4 v32, s[16:19], s37 offen offset:0  lds
    buffer_load_dwordx4 v33, s[16:19], s37 offen offset:1024  lds
    v_mfma_f32_16x16x32_bf16 v[76:79], a[172:175], v[136:139], v[76:79]
    buffer_load_dwordx4 v34, s[16:19], s37 offen offset:2048  lds
    buffer_load_dwordx4 v35, s[16:19], s37 offen offset:3072  lds
    s_waitcnt lgkmcnt(0)
    v_mfma_f32_16x16x32_bf16 v[80:83], a[176:179], v[136:139], v[80:83]
    s_waitcnt vmcnt(25)
    s_barrier
    s_mov_b32 s50, s32
    s_add_u32 s34, s32, s38
    s_add_u32 s32, s32, s42
    s_cmp_eq_u32 s32, 159744
    s_cselect_b32 s33, s43, s42
    s_cselect_b32 s32, 0, s32
    s_sub_u32 s39, 159744, s32
    v_add_u32_e32 v224, s33, v224
    ds_read_b128 a[160:163], v224 offset:0
    v_add_u32_e32 v225, s33, v225
    ds_read_b128 a[164:167], v225 offset:0
    v_add_u32_e32 v226, s33, v226
    ds_read_b128 a[168:171], v226 offset:0
    v_mfma_f32_16x16x32_bf16 v[84:87], a[180:183], v[136:139], v[84:87]
    v_add_u32_e32 v227, s33, v227
    ds_read_b128 a[172:175], v227 offset:0
    v_mfma_f32_16x16x32_bf16 v[246:249], v[242:245], v[136:139], v[246:249]
    v_exp_f32_e32 v161, v161
    v_mfma_f32_16x16x32_bf16 v[88:91], a[184:187], v[136:139], v[88:91]
    ds_read_b128 a[176:179], v224 offset:4096
    v_exp_f32_e32 v162, v162
    v_exp_f32_e32 v163, v163
    v_cvt_pk_bf16_f32 v160, v160, v161
    v_mfma_f32_16x16x32_bf16 v[92:95], a[188:191], v[136:139], v[92:95]
    ds_read_b128 a[180:183], v225 offset:4096
    v_exp_f32_e32 v164, v164
    v_exp_f32_e32 v165, v165
    v_cvt_pk_bf16_f32 v161, v162, v163
    s_waitcnt lgkmcnt(2)
    v_mfma_f32_16x16x32_bf16 v[128:131], a[160:163], v[192:195], 0
    s_add_u32 m0, s34, 0
    ds_read_b128 a[184:187], v226 offset:4096
    v_exp_f32_e32 v166, v166
    v_mfma_f32_16x16x32_bf16 v[128:131], a[164:167], v[196:199], v[128:131]
    buffer_load_dwordx4 v236, s[8:11], s29 offen offset:0 nt lds
    ds_read_b128 a[188:191], v227 offset:4096
    v_mfma_f32_16x16x32_bf16 v[128:131], a[168:171], v[200:203], v[128:131]
    buffer_load_dwordx4 v237, s[8:11], s29 offen offset:1024 nt lds
    ds_read_b128 a[160:163], v224 offset:8192
    v_mfma_f32_16x16x32_bf16 v[128:131], a[172:175], v[204:207], v[128:131]
    ds_read_b128 a[164:167], v225 offset:8192
    v_exp_f32_e32 v167, v167
    v_cvt_pk_bf16_f32 v162, v164, v165
    v_cvt_pk_bf16_f32 v163, v166, v167
    s_waitcnt lgkmcnt(2)
    v_mfma_f32_16x16x32_bf16 v[132:135], a[176:179], v[192:195], 0
    buffer_load_dwordx4 v238, s[8:11], s29 offen offset:2048 nt lds
    ds_read_b128 a[168:171], v226 offset:8192
    v_mfma_f32_16x16x32_bf16 v[132:135], a[180:183], v[196:199], v[132:135]
    buffer_load_dwordx4 v239, s[8:11], s29 offen offset:3072 nt lds
    ds_read_b128 a[172:175], v227 offset:8192
    v_mfma_f32_16x16x32_bf16 v[132:135], a[184:187], v[200:203], v[132:135]
    ds_read_b128 a[176:179], v224 offset:12288
    v_exp_f32_e32 v168, v168
    v_exp_f32_e32 v169, v169
    v_mfma_f32_16x16x32_bf16 v[132:135], a[188:191], v[204:207], v[132:135]
    s_add_u32 s29, s29, 16384
    ds_read_b128 a[180:183], v225 offset:12288
    v_mfma_f32_16x16x32_bf16 v[246:249], v[242:245], v[160:163], v[246:249]
    v_exp_f32_e32 v170, v170
    s_waitcnt lgkmcnt(2)
    v_mfma_f32_16x16x32_bf16 v[136:139], a[160:163], v[192:195], 0
    s_add_u32 m0, s34, 16384
    ds_read_b128 a[184:187], v226 offset:12288
    v_mfma_f32_16x16x32_bf16 v[136:139], a[164:167], v[196:199], v[136:139]
    buffer_load_dwordx4 v240, s[12:15], s30 offen offset:0 nt lds
    ds_read_b128 a[188:191], v227 offset:12288
    v_mfma_f32_16x16x32_bf16 v[136:139], a[168:171], v[200:203], v[136:139]
    v_add_u32_e32 v228, s33, v228
    v_add_u32_e32 v254, s39, v228
    ds_read_b64_tr_b16 a[160:161], v254 offset:0
    ds_read_b64_tr_b16 a[162:163], v228 offset:32768
    v_exp_f32_e32 v171, v171
    v_mfma_f32_16x16x32_bf16 v[136:139], a[172:175], v[204:207], v[136:139]
    buffer_load_dwordx4 v241, s[12:15], s30 offen offset:1024 nt lds
    v_add_u32_e32 v229, s33, v229
    v_add_u32_e32 v254, s39, v229
    ds_read_b64_tr_b16 a[164:165], v254 offset:0
    ds_read_b64_tr_b16 a[166:167], v229 offset:32768
    s_waitcnt lgkmcnt(4)
    v_mfma_f32_16x16x32_bf16 v[140:143], a[176:179], v[192:195], 0
    buffer_load_dwordx4 v240, s[12:15], s30 offen offset:2048 nt lds
    v_add_u32_e32 v230, s33, v230
    v_add_u32_e32 v254, s39, v230
    ds_read_b64_tr_b16 a[168:169], v254 offset:0
    ds_read_b64_tr_b16 a[170:171], v230 offset:32768
    v_mfma_f32_16x16x32_bf16 v[140:143], a[180:183], v[196:199], v[140:143]
    v_add_u32_e32 v231, s33, v231
    v_add_u32_e32 v254, s39, v231
    ds_read_b64_tr_b16 a[172:173], v254 offset:0
    ds_read_b64_tr_b16 a[174:175], v231 offset:32768
    v_cvt_pk_bf16_f32 v168, v168, v169
    v_mfma_f32_16x16x32_bf16 v[140:143], a[184:187], v[200:203], v[140:143]
    buffer_load_dwordx4 v241, s[12:15], s30 offen offset:3072 nt lds
    v_add_u32_e32 v232, s33, v232
    v_add_u32_e32 v254, s39, v232
    ds_read_b64_tr_b16 a[176:177], v254 offset:0
    ds_read_b64_tr_b16 a[178:179], v232 offset:32768
    v_mfma_f32_16x16x32_bf16 v[140:143], a[188:191], v[204:207], v[140:143]
    s_add_u32 s30, s30, 16384
    v_add_u32_e32 v233, s33, v233
    v_add_u32_e32 v254, s39, v233
    ds_read_b64_tr_b16 a[180:181], v254 offset:0
    ds_read_b64_tr_b16 a[182:183], v233 offset:32768
    s_waitcnt lgkmcnt(4)
    v_mfma_f32_16x16x32_bf16 v[0:3], a[160:163], a[56:59], v[0:3]
    v_add_u32_e32 v234, s33, v234
    v_add_u32_e32 v254, s39, v234
    ds_read_b64_tr_b16 a[184:185], v254 offset:0
    ds_read_b64_tr_b16 a[186:187], v234 offset:32768
    v_mfma_f32_16x16x32_bf16 v[4:7], a[164:167], a[56:59], v[4:7]
    v_add_u32_e32 v235, s33, v235
    v_add_u32_e32 v254, s39, v235
    ds_read_b64_tr_b16 a[188:189], v254 offset:0
    ds_read_b64_tr_b16 a[190:191], v235 offset:32768
    v_exp_f32_e32 v172, v172
    v_mfma_f32_16x16x32_bf16 v[8:11], a[168:171], a[56:59], v[8:11]
    ds_read_b64_tr_b16 a[160:161], v228 offset:36864
    ds_read_b64_tr_b16 a[162:163], v228 offset:40960
    v_exp_f32_e32 v173, v173
    v_cvt_pk_bf16_f32 v169, v170, v171
    v_mfma_f32_16x16x32_bf16 v[12:15], a[172:175], a[56:59], v[12:15]
    ds_read_b64_tr_b16 a[164:165], v229 offset:36864
    ds_read_b64_tr_b16 a[166:167], v229 offset:40960
    v_exp_f32_e32 v174, v174
    s_waitcnt lgkmcnt(4)
    v_mfma_f32_16x16x32_bf16 v[16:19], a[176:179], a[56:59], v[16:19]
    ds_read_b64_tr_b16 a[168:169], v230 offset:36864
    ds_read_b64_tr_b16 a[170:171], v230 offset:40960
    v_mfma_f32_16x16x32_bf16 v[20:23], a[180:183], a[56:59], v[20:23]
    ds_read_b64_tr_b16 a[172:173], v231 offset:36864
    ds_read_b64_tr_b16 a[174:175], v231 offset:40960
    v_mfma_f32_16x16x32_bf16 v[24:27], a[184:187], a[56:59], v[24:27]
    ds_read_b64_tr_b16 a[176:177], v232 offset:36864
    ds_read_b64_tr_b16 a[178:179], v232 offset:40960
    v_mfma_f32_16x16x32_bf16 v[28:31], a[188:191], a[56:59], v[28:31]
    ds_read_b64_tr_b16 a[180:181], v233 offset:36864
    ds_read_b64_tr_b16 a[182:183], v233 offset:40960
    s_waitcnt lgkmcnt(4)
    v_mfma_f32_16x16x32_bf16 v[0:3], a[160:163], a[64:67], v[0:3]
    ds_read_b64_tr_b16 a[184:185], v234 offset:36864
    ds_read_b64_tr_b16 a[186:187], v234 offset:40960
    v_mfma_f32_16x16x32_bf16 v[4:7], a[164:167], a[64:67], v[4:7]
    ds_read_b64_tr_b16 a[188:189], v235 offset:36864
    ds_read_b64_tr_b16 a[190:191], v235 offset:40960
    v_mfma_f32_16x16x32_bf16 v[8:11], a[168:171], a[64:67], v[8:11]
    ds_read_b64_tr_b16 a[160:161], v228 offset:45056
    ds_read_b64_tr_b16 a[162:163], v228 offset:49152
    v_mfma_f32_16x16x32_bf16 v[12:15], a[172:175], a[64:67], v[12:15]
    ds_read_b64_tr_b16 a[164:165], v229 offset:45056
    ds_read_b64_tr_b16 a[166:167], v229 offset:49152
    s_waitcnt lgkmcnt(4)
    v_mfma_f32_16x16x32_bf16 v[16:19], a[176:179], a[64:67], v[16:19]
    ds_read_b64_tr_b16 a[168:169], v230 offset:45056
    ds_read_b64_tr_b16 a[170:171], v230 offset:49152
    v_mfma_f32_16x16x32_bf16 v[20:23], a[180:183], a[64:67], v[20:23]
    ds_read_b64_tr_b16 a[172:173], v231 offset:45056
    ds_read_b64_tr_b16 a[174:175], v231 offset:49152
    v_mfma_f32_16x16x32_bf16 v[24:27], a[184:187], a[64:67], v[24:27]
    ds_read_b64_tr_b16 a[176:177], v232 offset:45056
    ds_read_b64_tr_b16 a[178:179], v232 offset:49152
    v_mfma_f32_16x16x32_bf16 v[28:31], a[188:191], a[64:67], v[28:31]
    ds_read_b64_tr_b16 a[180:181], v233 offset:45056
    ds_read_b64_tr_b16 a[182:183], v233 offset:49152
    s_waitcnt lgkmcnt(4)
    v_mfma_f32_16x16x32_bf16 v[0:3], a[160:163], a[72:75], v[0:3]
    ds_read_b64_tr_b16 a[184:185], v234 offset:45056
    ds_read_b64_tr_b16 a[186:187], v234 offset:49152
    v_mfma_f32_16x16x32_bf16 v[4:7], a[164:167], a[72:75], v[4:7]
    ds_read_b64_tr_b16 a[188:189], v235 offset:45056
    ds_read_b64_tr_b16 a[190:191], v235 offset:49152
    v_mfma_f32_16x16x32_bf16 v[8:11], a[168:171], a[72:75], v[8:11]
    ds_read_b64_tr_b16 a[160:161], v228 offset:16384
    ds_read_b64_tr_b16 a[162:163], v228 offset:20480
    v_mfma_f32_16x16x32_bf16 v[12:15], a[172:175], a[72:75], v[12:15]
    ds_read_b64_tr_b16 a[164:165], v229 offset:16384
    ds_read_b64_tr_b16 a[166:167], v229 offset:20480
    s_waitcnt lgkmcnt(4)
    v_mfma_f32_16x16x32_bf16 v[16:19], a[176:179], a[72:75], v[16:19]
    s_mov_b32 s36, 24576
    buffer_load_dword v41, v40, s[92:95], s36 offen
    ds_read_b64_tr_b16 a[168:169], v230 offset:16384
    ds_read_b64_tr_b16 a[170:171], v230 offset:20480
    v_mfma_f32_16x16x32_bf16 v[20:23], a[180:183], a[72:75], v[20:23]
    s_add_u32 m0, s50, 32768
    s_add_u32 s37, s31, 3276800
    ds_read_b64_tr_b16 a[172:173], v231 offset:16384
    ds_read_b64_tr_b16 a[174:175], v231 offset:20480
    v_mfma_f32_16x16x32_bf16 v[24:27], a[184:187], a[72:75], v[24:27]
    buffer_load_dwordx4 v32, s[16:19], s37 offen offset:0  lds
    buffer_load_dwordx4 v33, s[16:19], s37 offen offset:1024  lds
    ds_read_b64_tr_b16 a[176:177], v232 offset:16384
    ds_read_b64_tr_b16 a[178:179], v232 offset:20480
    v_mfma_f32_16x16x32_bf16 v[28:31], a[188:191], a[72:75], v[28:31]
    buffer_load_dwordx4 v34, s[16:19], s37 offen offset:2048  lds
    buffer_load_dwordx4 v35, s[16:19], s37 offen offset:3072  lds
    ds_read_b64_tr_b16 a[180:181], v233 offset:16384
    ds_read_b64_tr_b16 a[182:183], v233 offset:20480
    s_waitcnt lgkmcnt(4)
    v_mfma_f32_16x16x32_bf16 v[64:67], a[160:163], v[160:163], v[64:67]
    s_add_u32 m0, s50, 36864
    s_add_u32 s37, s31, 3407872
    ds_read_b64_tr_b16 a[184:185], v234 offset:16384
    ds_read_b64_tr_b16 a[186:187], v234 offset:20480
    v_mfma_f32_16x16x32_bf16 v[68:71], a[164:167], v[160:163], v[68:71]
    buffer_load_dwordx4 v32, s[16:19], s37 offen offset:0  lds
    buffer_load_dwordx4 v33, s[16:19], s37 offen offset:1024  lds
    ds_read_b64_tr_b16 a[188:189], v235 offset:16384
    ds_read_b64_tr_b16 a[190:191], v235 offset:20480
    v_mfma_f32_16x16x32_bf16 v[72:75], a[168:171], v[160:163], v[72:75]
    buffer_load_dwordx4 v34, s[16:19], s37 offen offset:2048  lds
    buffer_load_dwordx4 v35, s[16:19], s37 offen offset:3072  lds
    ds_read_b64_tr_b16 a[160:161], v228 offset:24576
    ds_read_b64_tr_b16 a[162:163], v228 offset:28672
    v_mfma_f32_16x16x32_bf16 v[76:79], a[172:175], v[160:163], v[76:79]
    s_add_u32 m0, s50, 40960
    s_add_u32 s37, s31, 3538944
    ds_read_b64_tr_b16 a[164:165], v229 offset:24576
    ds_read_b64_tr_b16 a[166:167], v229 offset:28672
    s_waitcnt lgkmcnt(4)
    v_mfma_f32_16x16x32_bf16 v[80:83], a[176:179], v[160:163], v[80:83]
    buffer_load_dwordx4 v32, s[16:19], s37 offen offset:0  lds
    buffer_load_dwordx4 v33, s[16:19], s37 offen offset:1024  lds
    ds_read_b64_tr_b16 a[168:169], v230 offset:24576
    ds_read_b64_tr_b16 a[170:171], v230 offset:28672
    v_mfma_f32_16x16x32_bf16 v[84:87], a[180:183], v[160:163], v[84:87]
    buffer_load_dwordx4 v34, s[16:19], s37 offen offset:2048  lds
    buffer_load_dwordx4 v35, s[16:19], s37 offen offset:3072  lds
    ds_read_b64_tr_b16 a[172:173], v231 offset:24576
    ds_read_b64_tr_b16 a[174:175], v231 offset:28672
    v_mfma_f32_16x16x32_bf16 v[88:91], a[184:187], v[160:163], v[88:91]
    s_add_u32 m0, s50, 45056
    s_add_u32 s37, s31, 3670016
    ds_read_b64_tr_b16 a[176:177], v232 offset:24576
    ds_read_b64_tr_b16 a[178:179], v232 offset:28672
    v_mfma_f32_16x16x32_bf16 v[92:95], a[188:191], v[160:163], v[92:95]
    buffer_load_dwordx4 v32, s[16:19], s37 offen offset:0  lds
    buffer_load_dwordx4 v33, s[16:19], s37 offen offset:1024  lds
    ds_read_b64_tr_b16 a[180:181], v233 offset:24576
    ds_read_b64_tr_b16 a[182:183], v233 offset:28672
    v_exp_f32_e32 v175, v175
    v_cvt_pk_bf16_f32 v170, v172, v173
    v_cvt_pk_bf16_f32 v171, v174, v175
    s_waitcnt lgkmcnt(4)
    s_nop 0
    v_mfma_f32_16x16x32_bf16 v[64:67], a[160:163], v[168:171], v[64:67]
    buffer_load_dwordx4 v34, s[16:19], s37 offen offset:2048  lds
    buffer_load_dwordx4 v35, s[16:19], s37 offen offset:3072  lds
    ds_read_b64_tr_b16 a[184:185], v234 offset:24576
    ds_read_b64_tr_b16 a[186:187], v234 offset:28672
    v_mfma_f32_16x16x32_bf16 v[68:71], a[164:167], v[168:171], v[68:71]
    s_add_u32 m0, s50, 49152
    s_add_u32 s37, s31, 3801088
    ds_read_b64_tr_b16 a[188:189], v235 offset:24576
    ds_read_b64_tr_b16 a[190:191], v235 offset:28672
    v_exp_f32_e32 v128, v128
    v_mfma_f32_16x16x32_bf16 v[72:75], a[168:171], v[168:171], v[72:75]
    buffer_load_dwordx4 v32, s[16:19], s37 offen offset:0  lds
    buffer_load_dwordx4 v33, s[16:19], s37 offen offset:1024  lds
    v_mfma_f32_16x16x32_bf16 v[76:79], a[172:175], v[168:171], v[76:79]
    buffer_load_dwordx4 v34, s[16:19], s37 offen offset:2048  lds
    buffer_load_dwordx4 v35, s[16:19], s37 offen offset:3072  lds
    s_waitcnt lgkmcnt(0)
    v_mfma_f32_16x16x32_bf16 v[80:83], a[176:179], v[168:171], v[80:83]
    s_waitcnt vmcnt(29)
    s_barrier
    s_mov_b32 s50, s32
    s_add_u32 s34, s32, s38
    s_add_u32 s32, s32, s42
    s_cmp_eq_u32 s32, 159744
    s_cselect_b32 s33, s43, s42
    s_cselect_b32 s32, 0, s32
    v_add_u32_e32 v224, s33, v224
    ds_read_b128 a[160:163], v224 offset:0
    v_add_u32_e32 v225, s33, v225
    ds_read_b128 a[164:167], v225 offset:0
    v_add_u32_e32 v226, s33, v226
    ds_read_b128 a[168:171], v226 offset:0
    v_mfma_f32_16x16x32_bf16 v[84:87], a[180:183], v[168:171], v[84:87]
    v_add_u32_e32 v227, s33, v227
    ds_read_b128 a[172:175], v227 offset:0
    v_mfma_f32_16x16x32_bf16 v[246:249], v[242:245], v[168:171], v[246:249]
    v_exp_f32_e32 v129, v129
    v_mfma_f32_16x16x32_bf16 v[88:91], a[184:187], v[168:171], v[88:91]
    ds_read_b128 a[176:179], v224 offset:4096
    v_exp_f32_e32 v130, v130
    v_exp_f32_e32 v131, v131
    v_cvt_pk_bf16_f32 v128, v128, v129
    v_mfma_f32_16x16x32_bf16 v[92:95], a[188:191], v[168:171], v[92:95]
    ds_read_b128 a[180:183], v225 offset:4096
    v_exp_f32_e32 v132, v132
    v_exp_f32_e32 v133, v133
    v_cvt_pk_bf16_f32 v129, v130, v131
    s_waitcnt lgkmcnt(2)
    v_mfma_f32_16x16x32_bf16 v[160:163], a[160:163], v[192:195], 0
    s_mov_b32 m0, 159744
    s_add_u32 s37, s31, 3145728
    ds_read_b128 a[184:187], v226 offset:4096
    v_exp_f32_e32 v134, v134
    v_mfma_f32_16x16x32_bf16 v[160:163], a[164:167], v[196:199], v[160:163]
    buffer_load_dwordx4 v32, s[16:19], s37 offen offset:0  lds
    ds_read_b128 a[188:191], v227 offset:4096
    v_mfma_f32_16x16x32_bf16 v[160:163], a[168:171], v[200:203], v[160:163]
    buffer_load_dwordx4 v33, s[16:19], s37 offen offset:1024  lds
    ds_read_b128 a[160:163], v224 offset:8192
    v_mfma_f32_16x16x32_bf16 v[160:163], a[172:175], v[204:207], v[160:163]
    buffer_load_dwordx4 v34, s[16:19], s37 offen offset:2048  lds
    ds_read_b128 a[164:167], v225 offset:8192
    s_waitcnt lgkmcnt(2)
    v_mfma_f32_16x16x32_bf16 v[164:167], a[176:179], v[192:195], 0
    buffer_load_dwordx4 v35, s[16:19], s37 offen offset:3072  lds
    ds_read_b128 a[168:171], v226 offset:8192
    v_mfma_f32_16x16x32_bf16 v[164:167], a[180:183], v[196:199], v[164:167]
    s_add_u32 m0, s34, 0
    ds_read_b128 a[172:175], v227 offset:8192
    v_exp_f32_e32 v135, v135
    v_cvt_pk_bf16_f32 v130, v132, v133
    v_cvt_pk_bf16_f32 v131, v134, v135
    v_mfma_f32_16x16x32_bf16 v[164:167], a[184:187], v[200:203], v[164:167]
    buffer_load_dwordx4 v236, s[8:11], s29 offen offset:0 nt lds
    ds_read_b128 a[176:179], v224 offset:12288
    v_mfma_f32_16x16x32_bf16 v[164:167], a[188:191], v[204:207], v[164:167]
    buffer_load_dwordx4 v237, s[8:11], s29 offen offset:1024 nt lds
    ds_read_b128 a[180:183], v225 offset:12288
    s_waitcnt lgkmcnt(2)
    v_mfma_f32_16x16x32_bf16 v[168:171], a[160:163], v[192:195], 0
    buffer_load_dwordx4 v238, s[8:11], s29 offen offset:2048 nt lds
    ds_read_b128 a[184:187], v226 offset:12288
    v_mfma_f32_16x16x32_bf16 v[168:171], a[164:167], v[196:199], v[168:171]
    buffer_load_dwordx4 v239, s[8:11], s29 offen offset:3072 nt lds
    ds_read_b128 a[188:191], v227 offset:12288
    v_mfma_f32_16x16x32_bf16 v[168:171], a[168:171], v[200:203], v[168:171]
    s_add_u32 s29, s29, 16384
    v_add_u32_e32 v228, s33, v228
    ds_read_b64_tr_b16 a[160:161], v228 offset:32768
    ds_read_b64_tr_b16 a[162:163], v228 offset:36864
    v_exp_f32_e32 v136, v136
    v_mfma_f32_16x16x32_bf16 v[168:171], a[172:175], v[204:207], v[168:171]
    s_add_u32 m0, s34, 16384
    v_add_u32_e32 v229, s33, v229
    ds_read_b64_tr_b16 a[164:165], v229 offset:32768
    ds_read_b64_tr_b16 a[166:167], v229 offset:36864
    v_exp_f32_e32 v137, v137
    s_waitcnt lgkmcnt(4)
    v_mfma_f32_16x16x32_bf16 v[172:175], a[176:179], v[192:195], 0
    buffer_load_dwordx4 v240, s[12:15], s30 offen offset:0 nt lds
    v_add_u32_e32 v230, s33, v230
    ds_read_b64_tr_b16 a[168:169], v230 offset:32768
    ds_read_b64_tr_b16 a[170:171], v230 offset:36864
    v_mfma_f32_16x16x32_bf16 v[172:175], a[180:183], v[196:199], v[172:175]
    buffer_load_dwordx4 v241, s[12:15], s30 offen offset:1024 nt lds
    v_add_u32_e32 v231, s33, v231
    ds_read_b64_tr_b16 a[172:173], v231 offset:32768
    ds_read_b64_tr_b16 a[174:175], v231 offset:36864
    v_mfma_f32_16x16x32_bf16 v[172:175], a[184:187], v[200:203], v[172:175]
    buffer_load_dwordx4 v240, s[12:15], s30 offen offset:2048 nt lds
    v_add_u32_e32 v232, s33, v232
    ds_read_b64_tr_b16 a[176:177], v232 offset:32768
    ds_read_b64_tr_b16 a[178:179], v232 offset:36864
    v_mfma_f32_16x16x32_bf16 v[172:175], a[188:191], v[204:207], v[172:175]
    buffer_load_dwordx4 v241, s[12:15], s30 offen offset:3072 nt lds
    v_add_u32_e32 v233, s33, v233
    ds_read_b64_tr_b16 a[180:181], v233 offset:32768
    ds_read_b64_tr_b16 a[182:183], v233 offset:36864
    s_waitcnt lgkmcnt(4)
    v_mfma_f32_16x16x32_bf16 v[0:3], a[160:163], a[80:83], v[0:3]
    s_add_u32 s30, s30, 16384
    v_add_u32_e32 v234, s33, v234
    ds_read_b64_tr_b16 a[184:185], v234 offset:32768
    ds_read_b64_tr_b16 a[186:187], v234 offset:36864
    v_mfma_f32_16x16x32_bf16 v[4:7], a[164:167], a[80:83], v[4:7]
    v_add_u32_e32 v235, s33, v235
    ds_read_b64_tr_b16 a[188:189], v235 offset:32768
    v_mfma_f32_16x16x32_bf16 v[246:249], v[242:245], v[128:131], v[246:249]
    ds_read_b64_tr_b16 a[190:191], v235 offset:36864
    v_mfma_f32_16x16x32_bf16 v[8:11], a[168:171], a[80:83], v[8:11]
    ds_read_b64_tr_b16 a[160:161], v228 offset:40960
    ds_read_b64_tr_b16 a[162:163], v228 offset:45056
    v_exp_f32_e32 v138, v138
    v_exp_f32_e32 v139, v139
    v_mfma_f32_16x16x32_bf16 v[12:15], a[172:175], a[80:83], v[12:15]
    ds_read_b64_tr_b16 a[164:165], v229 offset:40960
    ds_read_b64_tr_b16 a[166:167], v229 offset:45056
    v_cvt_pk_bf16_f32 v136, v136, v137
    v_exp_f32_e32 v140, v140
    s_waitcnt lgkmcnt(4)
    v_mfma_f32_16x16x32_bf16 v[16:19], a[176:179], a[80:83], v[16:19]
    ds_read_b64_tr_b16 a[168:169], v230 offset:40960
    ds_read_b64_tr_b16 a[170:171], v230 offset:45056
    v_exp_f32_e32 v141, v141
    v_cvt_pk_bf16_f32 v137, v138, v139
    v_mfma_f32_16x16x32_bf16 v[20:23], a[180:183], a[80:83], v[20:23]
    ds_read_b64_tr_b16 a[172:173], v231 offset:40960
    ds_read_b64_tr_b16 a[174:175], v231 offset:45056
    v_exp_f32_e32 v142, v142
    v_mfma_f32_16x16x32_bf16 v[24:27], a[184:187], a[80:83], v[24:27]
    ds_read_b64_tr_b16 a[176:177], v232 offset:40960
    ds_read_b64_tr_b16 a[178:179], v232 offset:45056
    v_mfma_f32_16x16x32_bf16 v[28:31], a[188:191], a[80:83], v[28:31]
    ds_read_b64_tr_b16 a[180:181], v233 offset:40960
    ds_read_b64_tr_b16 a[182:183], v233 offset:45056
    s_waitcnt lgkmcnt(4)
    v_mfma_f32_16x16x32_bf16 v[0:3], a[160:163], a[88:91], v[0:3]
    ds_read_b64_tr_b16 a[184:185], v234 offset:40960
    ds_read_b64_tr_b16 a[186:187], v234 offset:45056
    v_mfma_f32_16x16x32_bf16 v[4:7], a[164:167], a[88:91], v[4:7]
    ds_read_b64_tr_b16 a[188:189], v235 offset:40960
    ds_read_b64_tr_b16 a[190:191], v235 offset:45056
    v_mfma_f32_16x16x32_bf16 v[8:11], a[168:171], a[88:91], v[8:11]
    ds_read_b64_tr_b16 a[160:161], v228 offset:16384
    ds_read_b64_tr_b16 a[162:163], v228 offset:20480
    v_mfma_f32_16x16x32_bf16 v[12:15], a[172:175], a[88:91], v[12:15]
    ds_read_b64_tr_b16 a[164:165], v229 offset:16384
    ds_read_b64_tr_b16 a[166:167], v229 offset:20480
    s_waitcnt lgkmcnt(4)
    v_mfma_f32_16x16x32_bf16 v[16:19], a[176:179], a[88:91], v[16:19]
    ds_read_b64_tr_b16 a[168:169], v230 offset:16384
    ds_read_b64_tr_b16 a[170:171], v230 offset:20480
    v_mfma_f32_16x16x32_bf16 v[20:23], a[180:183], a[88:91], v[20:23]
    ds_read_b64_tr_b16 a[172:173], v231 offset:16384
    ds_read_b64_tr_b16 a[174:175], v231 offset:20480
    v_mfma_f32_16x16x32_bf16 v[24:27], a[184:187], a[88:91], v[24:27]
    ds_read_b64_tr_b16 a[176:177], v232 offset:16384
    ds_read_b64_tr_b16 a[178:179], v232 offset:20480
    v_mfma_f32_16x16x32_bf16 v[28:31], a[188:191], a[88:91], v[28:31]
    s_mov_b32 s36, 32768
    buffer_load_dword v41, v40, s[92:95], s36 offen
    ds_read_b64_tr_b16 a[180:181], v233 offset:16384
    ds_read_b64_tr_b16 a[182:183], v233 offset:20480
    s_waitcnt lgkmcnt(4)
    v_mfma_f32_16x16x32_bf16 v[64:67], a[160:163], v[128:131], v[64:67]
    s_add_u32 m0, s50, 32768
    s_add_u32 s37, s31, 3932160
    ds_read_b64_tr_b16 a[184:185], v234 offset:16384
    ds_read_b64_tr_b16 a[186:187], v234 offset:20480
    v_mfma_f32_16x16x32_bf16 v[68:71], a[164:167], v[128:131], v[68:71]
    buffer_load_dwordx4 v32, s[16:19], s37 offen offset:0  lds
    buffer_load_dwordx4 v33, s[16:19], s37 offen offset:1024  lds
    ds_read_b64_tr_b16 a[188:189], v235 offset:16384
    ds_read_b64_tr_b16 a[190:191], v235 offset:20480
    v_mfma_f32_16x16x32_bf16 v[72:75], a[168:171], v[128:131], v[72:75]
    buffer_load_dwordx4 v34, s[16:19], s37 offen offset:2048  lds
    buffer_load_dwordx4 v35, s[16:19], s37 offen offset:3072  lds
    ds_read_b64_tr_b16 a[160:161], v228 offset:24576
    ds_read_b64_tr_b16 a[162:163], v228 offset:28672
    v_mfma_f32_16x16x32_bf16 v[76:79], a[172:175], v[128:131], v[76:79]
    s_add_u32 m0, s50, 36864
    s_add_u32 s37, s31, 4063232
    ds_read_b64_tr_b16 a[164:165], v229 offset:24576
    ds_read_b64_tr_b16 a[166:167], v229 offset:28672
    s_waitcnt lgkmcnt(4)
    v_mfma_f32_16x16x32_bf16 v[80:83], a[176:179], v[128:131], v[80:83]
    buffer_load_dwordx4 v32, s[16:19], s37 offen offset:0  lds
    buffer_load_dwordx4 v33, s[16:19], s37 offen offset:1024  lds
    ds_read_b64_tr_b16 a[168:169], v230 offset:24576
    ds_read_b64_tr_b16 a[170:171], v230 offset:28672
    v_mfma_f32_16x16x32_bf16 v[84:87], a[180:183], v[128:131], v[84:87]
    buffer_load_dwordx4 v34, s[16:19], s37 offen offset:2048  lds
    buffer_load_dwordx4 v35, s[16:19], s37 offen offset:3072  lds
    ds_read_b64_tr_b16 a[172:173], v231 offset:24576
    ds_read_b64_tr_b16 a[174:175], v231 offset:28672
    v_mfma_f32_16x16x32_bf16 v[88:91], a[184:187], v[128:131], v[88:91]
    s_add_u32 m0, s50, 40960
    s_add_u32 s37, s31, 4194304
    ds_read_b64_tr_b16 a[176:177], v232 offset:24576
    ds_read_b64_tr_b16 a[178:179], v232 offset:28672
    v_mfma_f32_16x16x32_bf16 v[92:95], a[188:191], v[128:131], v[92:95]
    buffer_load_dwordx4 v32, s[16:19], s37 offen offset:0  lds
    buffer_load_dwordx4 v33, s[16:19], s37 offen offset:1024  lds
    ds_read_b64_tr_b16 a[180:181], v233 offset:24576
    ds_read_b64_tr_b16 a[182:183], v233 offset:28672
    v_exp_f32_e32 v143, v143
    v_cvt_pk_bf16_f32 v138, v140, v141
    v_cvt_pk_bf16_f32 v139, v142, v143
    s_waitcnt lgkmcnt(4)
    s_nop 0
    v_mfma_f32_16x16x32_bf16 v[64:67], a[160:163], v[136:139], v[64:67]
    buffer_load_dwordx4 v34, s[16:19], s37 offen offset:2048  lds
    buffer_load_dwordx4 v35, s[16:19], s37 offen offset:3072  lds
    ds_read_b64_tr_b16 a[184:185], v234 offset:24576
    ds_read_b64_tr_b16 a[186:187], v234 offset:28672
    v_mfma_f32_16x16x32_bf16 v[68:71], a[164:167], v[136:139], v[68:71]
    s_add_u32 m0, s50, 45056
    s_add_u32 s37, s31, 4325376
    ds_read_b64_tr_b16 a[188:189], v235 offset:24576
    ds_read_b64_tr_b16 a[190:191], v235 offset:28672
    v_exp_f32_e32 v160, v160
    v_mfma_f32_16x16x32_bf16 v[72:75], a[168:171], v[136:139], v[72:75]
    buffer_load_dwordx4 v32, s[16:19], s37 offen offset:0  lds
    buffer_load_dwordx4 v33, s[16:19], s37 offen offset:1024  lds
    v_mfma_f32_16x16x32_bf16 v[76:79], a[172:175], v[136:139], v[76:79]
    buffer_load_dwordx4 v34, s[16:19], s37 offen offset:2048  lds
    buffer_load_dwordx4 v35, s[16:19], s37 offen offset:3072  lds
    s_waitcnt lgkmcnt(0)
    v_mfma_f32_16x16x32_bf16 v[80:83], a[176:179], v[136:139], v[80:83]
    s_waitcnt vmcnt(25)
    s_barrier
    s_mov_b32 s50, s32
    s_add_u32 s34, s32, s38
    s_add_u32 s32, s32, s42
    s_cmp_eq_u32 s32, 159744
    s_cselect_b32 s33, s43, s42
    s_cselect_b32 s32, 0, s32
    s_sub_u32 s39, 159744, s32
    v_add_u32_e32 v224, s33, v224
    ds_read_b128 a[160:163], v224 offset:0
    v_add_u32_e32 v225, s33, v225
    ds_read_b128 a[164:167], v225 offset:0
    v_add_u32_e32 v226, s33, v226
    ds_read_b128 a[168:171], v226 offset:0
    v_mfma_f32_16x16x32_bf16 v[84:87], a[180:183], v[136:139], v[84:87]
    v_add_u32_e32 v227, s33, v227
    ds_read_b128 a[172:175], v227 offset:0
    v_mfma_f32_16x16x32_bf16 v[246:249], v[242:245], v[136:139], v[246:249]
    v_exp_f32_e32 v161, v161
    v_mfma_f32_16x16x32_bf16 v[88:91], a[184:187], v[136:139], v[88:91]
    ds_read_b128 a[176:179], v224 offset:4096
    v_exp_f32_e32 v162, v162
    v_exp_f32_e32 v163, v163
    v_cvt_pk_bf16_f32 v160, v160, v161
    v_mfma_f32_16x16x32_bf16 v[92:95], a[188:191], v[136:139], v[92:95]
    ds_read_b128 a[180:183], v225 offset:4096
    v_exp_f32_e32 v164, v164
    v_exp_f32_e32 v165, v165
    v_cvt_pk_bf16_f32 v161, v162, v163
    s_waitcnt lgkmcnt(2)
    v_mfma_f32_16x16x32_bf16 v[128:131], a[160:163], v[192:195], 0
    s_add_u32 m0, s34, 0
    ds_read_b128 a[184:187], v226 offset:4096
    v_exp_f32_e32 v166, v166
    v_mfma_f32_16x16x32_bf16 v[128:131], a[164:167], v[196:199], v[128:131]
    buffer_load_dwordx4 v236, s[8:11], s29 offen offset:0 nt lds
    ds_read_b128 a[188:191], v227 offset:4096
    v_mfma_f32_16x16x32_bf16 v[128:131], a[168:171], v[200:203], v[128:131]
    buffer_load_dwordx4 v237, s[8:11], s29 offen offset:1024 nt lds
    ds_read_b128 a[160:163], v224 offset:8192
    v_mfma_f32_16x16x32_bf16 v[128:131], a[172:175], v[204:207], v[128:131]
    ds_read_b128 a[164:167], v225 offset:8192
    v_exp_f32_e32 v167, v167
    v_cvt_pk_bf16_f32 v162, v164, v165
    v_cvt_pk_bf16_f32 v163, v166, v167
    s_waitcnt lgkmcnt(2)
    v_mfma_f32_16x16x32_bf16 v[132:135], a[176:179], v[192:195], 0
    buffer_load_dwordx4 v238, s[8:11], s29 offen offset:2048 nt lds
    ds_read_b128 a[168:171], v226 offset:8192
    v_mfma_f32_16x16x32_bf16 v[132:135], a[180:183], v[196:199], v[132:135]
    buffer_load_dwordx4 v239, s[8:11], s29 offen offset:3072 nt lds
    ds_read_b128 a[172:175], v227 offset:8192
    v_mfma_f32_16x16x32_bf16 v[132:135], a[184:187], v[200:203], v[132:135]
    ds_read_b128 a[176:179], v224 offset:12288
    v_exp_f32_e32 v168, v168
    v_exp_f32_e32 v169, v169
    v_mfma_f32_16x16x32_bf16 v[132:135], a[188:191], v[204:207], v[132:135]
    s_add_u32 s29, s29, 16384
    ds_read_b128 a[180:183], v225 offset:12288
    v_mfma_f32_16x16x32_bf16 v[246:249], v[242:245], v[160:163], v[246:249]
    v_exp_f32_e32 v170, v170
    s_waitcnt lgkmcnt(2)
    v_mfma_f32_16x16x32_bf16 v[136:139], a[160:163], v[192:195], 0
    s_add_u32 m0, s34, 16384
    ds_read_b128 a[184:187], v226 offset:12288
    v_mfma_f32_16x16x32_bf16 v[136:139], a[164:167], v[196:199], v[136:139]
    buffer_load_dwordx4 v240, s[12:15], s30 offen offset:0 nt lds
    ds_read_b128 a[188:191], v227 offset:12288
    v_mfma_f32_16x16x32_bf16 v[136:139], a[168:171], v[200:203], v[136:139]
    v_add_u32_e32 v228, s33, v228
    v_add_u32_e32 v254, s39, v228
    ds_read_b64_tr_b16 a[160:161], v254 offset:0
    ds_read_b64_tr_b16 a[162:163], v228 offset:32768
    v_exp_f32_e32 v171, v171
    v_mfma_f32_16x16x32_bf16 v[136:139], a[172:175], v[204:207], v[136:139]
    buffer_load_dwordx4 v241, s[12:15], s30 offen offset:1024 nt lds
    v_add_u32_e32 v229, s33, v229
    v_add_u32_e32 v254, s39, v229
    ds_read_b64_tr_b16 a[164:165], v254 offset:0
    ds_read_b64_tr_b16 a[166:167], v229 offset:32768
    s_waitcnt lgkmcnt(4)
    v_mfma_f32_16x16x32_bf16 v[140:143], a[176:179], v[192:195], 0
    buffer_load_dwordx4 v240, s[12:15], s30 offen offset:2048 nt lds
    v_add_u32_e32 v230, s33, v230
    v_add_u32_e32 v254, s39, v230
    ds_read_b64_tr_b16 a[168:169], v254 offset:0
    ds_read_b64_tr_b16 a[170:171], v230 offset:32768
    v_mfma_f32_16x16x32_bf16 v[140:143], a[180:183], v[196:199], v[140:143]
    v_add_u32_e32 v231, s33, v231
    v_add_u32_e32 v254, s39, v231
    ds_read_b64_tr_b16 a[172:173], v254 offset:0
    ds_read_b64_tr_b16 a[174:175], v231 offset:32768
    v_cvt_pk_bf16_f32 v168, v168, v169
    v_mfma_f32_16x16x32_bf16 v[140:143], a[184:187], v[200:203], v[140:143]
    buffer_load_dwordx4 v241, s[12:15], s30 offen offset:3072 nt lds
    v_add_u32_e32 v232, s33, v232
    v_add_u32_e32 v254, s39, v232
    ds_read_b64_tr_b16 a[176:177], v254 offset:0
    ds_read_b64_tr_b16 a[178:179], v232 offset:32768
    v_mfma_f32_16x16x32_bf16 v[140:143], a[188:191], v[204:207], v[140:143]
    s_add_u32 s30, s30, 16384
    v_add_u32_e32 v233, s33, v233
    v_add_u32_e32 v254, s39, v233
    ds_read_b64_tr_b16 a[180:181], v254 offset:0
    ds_read_b64_tr_b16 a[182:183], v233 offset:32768
    s_waitcnt lgkmcnt(4)
    v_mfma_f32_16x16x32_bf16 v[0:3], a[160:163], a[96:99], v[0:3]
    v_add_u32_e32 v234, s33, v234
    v_add_u32_e32 v254, s39, v234
    ds_read_b64_tr_b16 a[184:185], v254 offset:0
    ds_read_b64_tr_b16 a[186:187], v234 offset:32768
    v_mfma_f32_16x16x32_bf16 v[4:7], a[164:167], a[96:99], v[4:7]
    v_add_u32_e32 v235, s33, v235
    v_add_u32_e32 v254, s39, v235
    ds_read_b64_tr_b16 a[188:189], v254 offset:0
    ds_read_b64_tr_b16 a[190:191], v235 offset:32768
    v_exp_f32_e32 v172, v172
    v_mfma_f32_16x16x32_bf16 v[8:11], a[168:171], a[96:99], v[8:11]
    ds_read_b64_tr_b16 a[160:161], v228 offset:36864
    ds_read_b64_tr_b16 a[162:163], v228 offset:40960
    v_exp_f32_e32 v173, v173
    v_cvt_pk_bf16_f32 v169, v170, v171
    v_mfma_f32_16x16x32_bf16 v[12:15], a[172:175], a[96:99], v[12:15]
    ds_read_b64_tr_b16 a[164:165], v229 offset:36864
    ds_read_b64_tr_b16 a[166:167], v229 offset:40960
    v_exp_f32_e32 v174, v174
    s_waitcnt lgkmcnt(4)
    v_mfma_f32_16x16x32_bf16 v[16:19], a[176:179], a[96:99], v[16:19]
    ds_read_b64_tr_b16 a[168:169], v230 offset:36864
    ds_read_b64_tr_b16 a[170:171], v230 offset:40960
    v_mfma_f32_16x16x32_bf16 v[20:23], a[180:183], a[96:99], v[20:23]
    ds_read_b64_tr_b16 a[172:173], v231 offset:36864
    ds_read_b64_tr_b16 a[174:175], v231 offset:40960
    v_mfma_f32_16x16x32_bf16 v[24:27], a[184:187], a[96:99], v[24:27]
    ds_read_b64_tr_b16 a[176:177], v232 offset:36864
    ds_read_b64_tr_b16 a[178:179], v232 offset:40960
    v_mfma_f32_16x16x32_bf16 v[28:31], a[188:191], a[96:99], v[28:31]
    ds_read_b64_tr_b16 a[180:181], v233 offset:36864
    ds_read_b64_tr_b16 a[182:183], v233 offset:40960
    s_waitcnt lgkmcnt(4)
    v_mfma_f32_16x16x32_bf16 v[0:3], a[160:163], a[104:107], v[0:3]
    ds_read_b64_tr_b16 a[184:185], v234 offset:36864
    ds_read_b64_tr_b16 a[186:187], v234 offset:40960
    v_mfma_f32_16x16x32_bf16 v[4:7], a[164:167], a[104:107], v[4:7]
    ds_read_b64_tr_b16 a[188:189], v235 offset:36864
    ds_read_b64_tr_b16 a[190:191], v235 offset:40960
    v_mfma_f32_16x16x32_bf16 v[8:11], a[168:171], a[104:107], v[8:11]
    ds_read_b64_tr_b16 a[160:161], v228 offset:45056
    ds_read_b64_tr_b16 a[162:163], v228 offset:49152
    v_mfma_f32_16x16x32_bf16 v[12:15], a[172:175], a[104:107], v[12:15]
    ds_read_b64_tr_b16 a[164:165], v229 offset:45056
    ds_read_b64_tr_b16 a[166:167], v229 offset:49152
    s_waitcnt lgkmcnt(4)
    v_mfma_f32_16x16x32_bf16 v[16:19], a[176:179], a[104:107], v[16:19]
    ds_read_b64_tr_b16 a[168:169], v230 offset:45056
    ds_read_b64_tr_b16 a[170:171], v230 offset:49152
    v_mfma_f32_16x16x32_bf16 v[20:23], a[180:183], a[104:107], v[20:23]
    ds_read_b64_tr_b16 a[172:173], v231 offset:45056
    ds_read_b64_tr_b16 a[174:175], v231 offset:49152
    v_mfma_f32_16x16x32_bf16 v[24:27], a[184:187], a[104:107], v[24:27]
    ds_read_b64_tr_b16 a[176:177], v232 offset:45056
    ds_read_b64_tr_b16 a[178:179], v232 offset:49152
    v_mfma_f32_16x16x32_bf16 v[28:31], a[188:191], a[104:107], v[28:31]
    ds_read_b64_tr_b16 a[180:181], v233 offset:45056
    ds_read_b64_tr_b16 a[182:183], v233 offset:49152
    s_waitcnt lgkmcnt(4)
    v_mfma_f32_16x16x32_bf16 v[0:3], a[160:163], a[112:115], v[0:3]
    ds_read_b64_tr_b16 a[184:185], v234 offset:45056
    ds_read_b64_tr_b16 a[186:187], v234 offset:49152
    v_mfma_f32_16x16x32_bf16 v[4:7], a[164:167], a[112:115], v[4:7]
    ds_read_b64_tr_b16 a[188:189], v235 offset:45056
    ds_read_b64_tr_b16 a[190:191], v235 offset:49152
    v_mfma_f32_16x16x32_bf16 v[8:11], a[168:171], a[112:115], v[8:11]
    ds_read_b64_tr_b16 a[160:161], v228 offset:16384
    ds_read_b64_tr_b16 a[162:163], v228 offset:20480
    v_mfma_f32_16x16x32_bf16 v[12:15], a[172:175], a[112:115], v[12:15]
    ds_read_b64_tr_b16 a[164:165], v229 offset:16384
    ds_read_b64_tr_b16 a[166:167], v229 offset:20480
    s_waitcnt lgkmcnt(4)
    v_mfma_f32_16x16x32_bf16 v[16:19], a[176:179], a[112:115], v[16:19]
    s_add_u32 s36, s50, 32768
    s_cmp_eq_u32 s35, 3
    s_cselect_b32 m0, 159744, s36
    s_add_u32 s37, s31, 4587520
    ds_read_b64_tr_b16 a[168:169], v230 offset:16384
    ds_read_b64_tr_b16 a[170:171], v230 offset:20480
    v_mfma_f32_16x16x32_bf16 v[20:23], a[180:183], a[112:115], v[20:23]
    buffer_load_dwordx4 v32, s[16:19], s37 offen offset:0  lds
    buffer_load_dwordx4 v33, s[16:19], s37 offen offset:1024  lds
    ds_read_b64_tr_b16 a[172:173], v231 offset:16384
    ds_read_b64_tr_b16 a[174:175], v231 offset:20480
    v_mfma_f32_16x16x32_bf16 v[24:27], a[184:187], a[112:115], v[24:27]
    buffer_load_dwordx4 v34, s[16:19], s37 offen offset:2048  lds
    buffer_load_dwordx4 v35, s[16:19], s37 offen offset:3072  lds
    ds_read_b64_tr_b16 a[176:177], v232 offset:16384
    ds_read_b64_tr_b16 a[178:179], v232 offset:20480
    v_mfma_f32_16x16x32_bf16 v[28:31], a[188:191], a[112:115], v[28:31]
    s_add_u32 s36, s50, 36864
    s_cmp_eq_u32 s35, 3
    s_cselect_b32 m0, 159744, s36
    s_add_u32 s37, s31, 4718592
    ds_read_b64_tr_b16 a[180:181], v233 offset:16384
    ds_read_b64_tr_b16 a[182:183], v233 offset:20480
    s_waitcnt lgkmcnt(4)
    v_mfma_f32_16x16x32_bf16 v[64:67], a[160:163], v[160:163], v[64:67]
    buffer_load_dwordx4 v32, s[16:19], s37 offen offset:0  lds
    buffer_load_dwordx4 v33, s[16:19], s37 offen offset:1024  lds
    ds_read_b64_tr_b16 a[184:185], v234 offset:16384
    ds_read_b64_tr_b16 a[186:187], v234 offset:20480
    v_mfma_f32_16x16x32_bf16 v[68:71], a[164:167], v[160:163], v[68:71]
    buffer_load_dwordx4 v34, s[16:19], s37 offen offset:2048  lds
    buffer_load_dwordx4 v35, s[16:19], s37 offen offset:3072  lds
    ds_read_b64_tr_b16 a[188:189], v235 offset:16384
    ds_read_b64_tr_b16 a[190:191], v235 offset:20480
    v_mfma_f32_16x16x32_bf16 v[72:75], a[168:171], v[160:163], v[72:75]
    s_add_u32 s36, s50, 40960
    s_cmp_eq_u32 s35, 3
    s_cselect_b32 m0, 159744, s36
    s_add_u32 s37, s31, 4849664
    ds_read_b64_tr_b16 a[160:161], v228 offset:24576
    ds_read_b64_tr_b16 a[162:163], v228 offset:28672
    v_mfma_f32_16x16x32_bf16 v[76:79], a[172:175], v[160:163], v[76:79]
    buffer_load_dwordx4 v32, s[16:19], s37 offen offset:0  lds
    ds_read_b64_tr_b16 a[164:165], v229 offset:24576
    ds_read_b64_tr_b16 a[166:167], v229 offset:28672
    s_waitcnt lgkmcnt(4)
    v_mfma_f32_16x16x32_bf16 v[80:83], a[176:179], v[160:163], v[80:83]
    buffer_load_dwordx4 v33, s[16:19], s37 offen offset:1024  lds
    buffer_load_dwordx4 v34, s[16:19], s37 offen offset:2048  lds
    ds_read_b64_tr_b16 a[168:169], v230 offset:24576
    ds_read_b64_tr_b16 a[170:171], v230 offset:28672
    v_mfma_f32_16x16x32_bf16 v[84:87], a[180:183], v[160:163], v[84:87]
    buffer_load_dwordx4 v35, s[16:19], s37 offen offset:3072  lds
    s_add_u32 s36, s50, 45056
    s_cmp_eq_u32 s35, 3
    s_cselect_b32 m0, 159744, s36
    ds_read_b64_tr_b16 a[172:173], v231 offset:24576
    ds_read_b64_tr_b16 a[174:175], v231 offset:28672
    v_mfma_f32_16x16x32_bf16 v[88:91], a[184:187], v[160:163], v[88:91]
    s_add_u32 s37, s31, 4980736
    buffer_load_dwordx4 v32, s[16:19], s37 offen offset:0  lds
    ds_read_b64_tr_b16 a[176:177], v232 offset:24576
    ds_read_b64_tr_b16 a[178:179], v232 offset:28672
    v_mfma_f32_16x16x32_bf16 v[92:95], a[188:191], v[160:163], v[92:95]
    buffer_load_dwordx4 v33, s[16:19], s37 offen offset:1024  lds
    buffer_load_dwordx4 v34, s[16:19], s37 offen offset:2048  lds
    ds_read_b64_tr_b16 a[180:181], v233 offset:24576
    ds_read_b64_tr_b16 a[182:183], v233 offset:28672
    v_exp_f32_e32 v175, v175
    v_cvt_pk_bf16_f32 v170, v172, v173
    v_cvt_pk_bf16_f32 v171, v174, v175
    s_waitcnt lgkmcnt(4)
    s_nop 0
    v_mfma_f32_16x16x32_bf16 v[64:67], a[160:163], v[168:171], v[64:67]
    buffer_load_dwordx4 v35, s[16:19], s37 offen offset:3072  lds
    s_add_u32 s36, s50, 49152
    s_cmp_eq_u32 s35, 3
    s_cselect_b32 m0, 159744, s36
    ds_read_b64_tr_b16 a[184:185], v234 offset:24576
    ds_read_b64_tr_b16 a[186:187], v234 offset:28672
    v_mfma_f32_16x16x32_bf16 v[68:71], a[164:167], v[168:171], v[68:71]
    s_add_u32 s37, s31, 5111808
    buffer_load_dwordx4 v32, s[16:19], s37 offen offset:0  lds
    ds_read_b64_tr_b16 a[188:189], v235 offset:24576
    ds_read_b64_tr_b16 a[190:191], v235 offset:28672
    v_mfma_f32_16x16x32_bf16 v[72:75], a[168:171], v[168:171], v[72:75]
    buffer_load_dwordx4 v33, s[16:19], s37 offen offset:1024  lds
    buffer_load_dwordx4 v34, s[16:19], s37 offen offset:2048  lds
    v_mfma_f32_16x16x32_bf16 v[76:79], a[172:175], v[168:171], v[76:79]
    buffer_load_dwordx4 v35, s[16:19], s37 offen offset:3072  lds
    s_waitcnt lgkmcnt(0)
    v_mfma_f32_16x16x32_bf16 v[80:83], a[176:179], v[168:171], v[80:83]
    s_waitcnt vmcnt(28)
    s_barrier
    s_mov_b32 s50, s32
    s_add_u32 s34, s32, s38
    s_add_u32 s32, s32, s42
    s_cmp_eq_u32 s32, 159744
    s_cselect_b32 s33, s43, s42
    s_cselect_b32 s32, 0, s32
    v_add_u32_e32 v224, s33, v224
    ds_read_b128 a[160:163], v224 offset:0
    v_add_u32_e32 v225, s33, v225
    ds_read_b128 a[164:167], v225 offset:0
    v_add_u32_e32 v226, s33, v226
    ds_read_b128 a[168:171], v226 offset:0
    v_mfma_f32_16x16x32_bf16 v[84:87], a[180:183], v[168:171], v[84:87]
    v_exp_f32_e32 v128, v128
    v_mfma_f32_16x16x32_bf16 v[246:249], v[242:245], v[168:171], v[246:249]
    v_exp_f32_e32 v129, v129
    v_mfma_f32_16x16x32_bf16 v[88:91], a[184:187], v[168:171], v[88:91]
    v_exp_f32_e32 v130, v130
    v_exp_f32_e32 v131, v131
    v_cvt_pk_bf16_f32 v128, v128, v129
    v_mfma_f32_16x16x32_bf16 v[92:95], a[188:191], v[168:171], v[92:95]
    v_exp_f32_e32 v132, v132
    v_exp_f32_e32 v133, v133
    v_cvt_pk_bf16_f32 v129, v130, v131
    s_cmp_eq_u32 s35, 3
    s_cbranch_scc1 A_B_last
    s_waitcnt lgkmcnt(0)
    v_mfma_f32_16x16x32_bf16 v[160:163], a[160:163], v[192:195], 0
    s_mov_b32 m0, 159744
    s_add_u32 s37, s31, 4456448
    v_add_u32_e32 v227, s33, v227
    ds_read_b128 a[172:175], v227 offset:0
    ds_read_b128 a[176:179], v224 offset:4096
    ds_read_b128 a[180:183], v225 offset:4096
    ds_read_b128 a[184:187], v226 offset:4096
    v_mfma_f32_16x16x32_bf16 v[160:163], a[164:167], v[196:199], v[160:163]
    buffer_load_dwordx4 v32, s[16:19], s37 offen offset:0  lds
    ds_read_b128 a[188:191], v227 offset:4096
    v_mfma_f32_16x16x32_bf16 v[160:163], a[168:171], v[200:203], v[160:163]
    buffer_load_dwordx4 v33, s[16:19], s37 offen offset:1024  lds
    ds_read_b128 a[160:163], v224 offset:8192
    s_waitcnt lgkmcnt(5)
    v_mfma_f32_16x16x32_bf16 v[160:163], a[172:175], v[204:207], v[160:163]
    buffer_load_dwordx4 v34, s[16:19], s37 offen offset:2048  lds
    ds_read_b128 a[164:167], v225 offset:8192
    s_waitcnt lgkmcnt(2)
    v_mfma_f32_16x16x32_bf16 v[164:167], a[176:179], v[192:195], 0
    buffer_load_dwordx4 v35, s[16:19], s37 offen offset:3072  lds
    ds_read_b128 a[168:171], v226 offset:8192
    v_mfma_f32_16x16x32_bf16 v[164:167], a[180:183], v[196:199], v[164:167]
    s_add_u32 m0, s34, 0
    ds_read_b128 a[172:175], v227 offset:8192
    v_exp_f32_e32 v134, v134
    v_exp_f32_e32 v135, v135
    v_mfma_f32_16x16x32_bf16 v[164:167], a[184:187], v[200:203], v[164:167]
    buffer_load_dwordx4 v236, s[8:11], s29 offen offset:0 nt lds
    ds_read_b128 a[176:179], v224 offset:12288
    v_mfma_f32_16x16x32_bf16 v[164:167], a[188:191], v[204:207], v[164:167]
    buffer_load_dwordx4 v237, s[8:11], s29 offen offset:1024 nt lds
    ds_read_b128 a[180:183], v225 offset:12288
    s_waitcnt lgkmcnt(2)
    v_mfma_f32_16x16x32_bf16 v[168:171], a[160:163], v[192:195], 0
    buffer_load_dwordx4 v238, s[8:11], s29 offen offset:2048 nt lds
    ds_read_b128 a[184:187], v226 offset:12288
    v_mfma_f32_16x16x32_bf16 v[168:171], a[164:167], v[196:199], v[168:171]
    buffer_load_dwordx4 v239, s[8:11], s29 offen offset:3072 nt lds
    ds_read_b128 a[188:191], v227 offset:12288
    v_mfma_f32_16x16x32_bf16 v[168:171], a[168:171], v[200:203], v[168:171]
    s_add_u32 s29, s29, 16384
    v_add_u32_e32 v228, s33, v228
    ds_read_b64_tr_b16 a[160:161], v228 offset:32768
    ds_read_b64_tr_b16 a[162:163], v228 offset:36864
    v_cvt_pk_bf16_f32 v130, v132, v133
    v_cvt_pk_bf16_f32 v131, v134, v135
    v_mfma_f32_16x16x32_bf16 v[168:171], a[172:175], v[204:207], v[168:171]
    s_add_u32 m0, s34, 16384
    v_add_u32_e32 v229, s33, v229
    ds_read_b64_tr_b16 a[164:165], v229 offset:32768
    ds_read_b64_tr_b16 a[166:167], v229 offset:36864
    v_exp_f32_e32 v136, v136
    s_waitcnt lgkmcnt(4)
    v_mfma_f32_16x16x32_bf16 v[172:175], a[176:179], v[192:195], 0
    buffer_load_dwordx4 v240, s[12:15], s30 offen offset:0 nt lds
    v_add_u32_e32 v230, s33, v230
    ds_read_b64_tr_b16 a[168:169], v230 offset:32768
    ds_read_b64_tr_b16 a[170:171], v230 offset:36864
    v_mfma_f32_16x16x32_bf16 v[172:175], a[180:183], v[196:199], v[172:175]
    buffer_load_dwordx4 v241, s[12:15], s30 offen offset:1024 nt lds
    v_add_u32_e32 v231, s33, v231
    ds_read_b64_tr_b16 a[172:173], v231 offset:32768
    ds_read_b64_tr_b16 a[174:175], v231 offset:36864
    v_mfma_f32_16x16x32_bf16 v[172:175], a[184:187], v[200:203], v[172:175]
    buffer_load_dwordx4 v240, s[12:15], s30 offen offset:2048 nt lds
    v_add_u32_e32 v232, s33, v232
    ds_read_b64_tr_b16 a[176:177], v232 offset:32768
    ds_read_b64_tr_b16 a[178:179], v232 offset:36864
    v_mfma_f32_16x16x32_bf16 v[172:175], a[188:191], v[204:207], v[172:175]
    buffer_load_dwordx4 v241, s[12:15], s30 offen offset:3072 nt lds
    v_add_u32_e32 v233, s33, v233
    ds_read_b64_tr_b16 a[180:181], v233 offset:32768
    ds_read_b64_tr_b16 a[182:183], v233 offset:36864
    s_waitcnt lgkmcnt(4)
    v_mfma_f32_16x16x32_bf16 v[0:3], a[160:163], a[120:123], v[0:3]
    s_add_u32 s30, s30, 16384
    v_add_u32_e32 v234, s33, v234
    ds_read_b64_tr_b16 a[184:185], v234 offset:32768
    ds_read_b64_tr_b16 a[186:187], v234 offset:36864
    v_mfma_f32_16x16x32_bf16 v[4:7], a[164:167], a[120:123], v[4:7]
    v_add_u32_e32 v235, s33, v235
    ds_read_b64_tr_b16 a[188:189], v235 offset:32768
    ds_read_b64_tr_b16 a[190:191], v235 offset:36864
    v_exp_f32_e32 v137, v137
    v_mfma_f32_16x16x32_bf16 v[8:11], a[168:171], a[120:123], v[8:11]
    ds_read_b64_tr_b16 a[160:161], v228 offset:40960
    ds_read_b64_tr_b16 a[162:163], v228 offset:45056
    v_mfma_f32_16x16x32_bf16 v[246:249], v[242:245], v[128:131], v[246:249]
    v_exp_f32_e32 v138, v138
    v_mfma_f32_16x16x32_bf16 v[12:15], a[172:175], a[120:123], v[12:15]
    ds_read_b64_tr_b16 a[164:165], v229 offset:40960
    ds_read_b64_tr_b16 a[166:167], v229 offset:45056
    v_exp_f32_e32 v139, v139
    v_cvt_pk_bf16_f32 v136, v136, v137
    s_waitcnt lgkmcnt(4)
    v_mfma_f32_16x16x32_bf16 v[16:19], a[176:179], a[120:123], v[16:19]
    ds_read_b64_tr_b16 a[168:169], v230 offset:40960
    ds_read_b64_tr_b16 a[170:171], v230 offset:45056
    v_exp_f32_e32 v140, v140
    v_mfma_f32_16x16x32_bf16 v[20:23], a[180:183], a[120:123], v[20:23]
    ds_read_b64_tr_b16 a[172:173], v231 offset:40960
    ds_read_b64_tr_b16 a[174:175], v231 offset:45056
    v_exp_f32_e32 v141, v141
    v_cvt_pk_bf16_f32 v137, v138, v139
    v_mfma_f32_16x16x32_bf16 v[24:27], a[184:187], a[120:123], v[24:27]
    ds_read_b64_tr_b16 a[176:177], v232 offset:40960
    ds_read_b64_tr_b16 a[178:179], v232 offset:45056
    v_exp_f32_e32 v142, v142
    v_mfma_f32_16x16x32_bf16 v[28:31], a[188:191], a[120:123], v[28:31]
    ds_read_b64_tr_b16 a[180:181], v233 offset:40960
    ds_read_b64_tr_b16 a[182:183], v233 offset:45056
    s_waitcnt lgkmcnt(4)
    v_mfma_f32_16x16x32_bf16 v[0:3], a[160:163], a[128:131], v[0:3]
    ds_read_b64_tr_b16 a[184:185], v234 offset:40960
    ds_read_b64_tr_b16 a[186:187], v234 offset:45056
    v_mfma_f32_16x16x32_bf16 v[4:7], a[164:167], a[128:131], v[4:7]
    ds_read_b64_tr_b16 a[188:189], v235 offset:40960
    ds_read_b64_tr_b16 a[190:191], v235 offset:45056
    v_mfma_f32_16x16x32_bf16 v[8:11], a[168:171], a[128:131], v[8:11]
    ds_read_b64_tr_b16 a[160:161], v228 offset:16384
    ds_read_b64_tr_b16 a[162:163], v228 offset:20480
    v_mfma_f32_16x16x32_bf16 v[12:15], a[172:175], a[128:131], v[12:15]
    ds_read_b64_tr_b16 a[164:165], v229 offset:16384
    ds_read_b64_tr_b16 a[166:167], v229 offset:20480
    s_waitcnt lgkmcnt(4)
    v_mfma_f32_16x16x32_bf16 v[16:19], a[176:179], a[128:131], v[16:19]
    ds_read_b64_tr_b16 a[168:169], v230 offset:16384
    ds_read_b64_tr_b16 a[170:171], v230 offset:20480
    v_mfma_f32_16x16x32_bf16 v[20:23], a[180:183], a[128:131], v[20:23]
    ds_read_b64_tr_b16 a[172:173], v231 offset:16384
    ds_read_b64_tr_b16 a[174:175], v231 offset:20480
    v_mfma_f32_16x16x32_bf16 v[24:27], a[184:187], a[128:131], v[24:27]
    ds_read_b64_tr_b16 a[176:177], v232 offset:16384
    ds_read_b64_tr_b16 a[178:179], v232 offset:20480
    v_mfma_f32_16x16x32_bf16 v[28:31], a[188:191], a[128:131], v[28:31]
    s_cmp_ge_u32 s35, 2
    s_cselect_b32 s18, 0, s18
    s_add_u32 m0, s50, 32768
    ds_read_b64_tr_b16 a[180:181], v233 offset:16384
    ds_read_b64_tr_b16 a[182:183], v233 offset:20480
    s_waitcnt lgkmcnt(4)
    v_mfma_f32_16x16x32_bf16 v[64:67], a[160:163], v[128:131], v[64:67]
    s_add_u32 s37, s46, 0
    buffer_load_dwordx4 v32, s[16:19], s37 offen offset:0  lds
    ds_read_b64_tr_b16 a[184:185], v234 offset:16384
    ds_read_b64_tr_b16 a[186:187], v234 offset:20480
    v_mfma_f32_16x16x32_bf16 v[68:71], a[164:167], v[128:131], v[68:71]
    buffer_load_dwordx4 v33, s[16:19], s37 offen offset:1024  lds
    buffer_load_dwordx4 v34, s[16:19], s37 offen offset:2048  lds
    ds_read_b64_tr_b16 a[188:189], v235 offset:16384
    ds_read_b64_tr_b16 a[190:191], v235 offset:20480
    v_mfma_f32_16x16x32_bf16 v[72:75], a[168:171], v[128:131], v[72:75]
    buffer_load_dwordx4 v35, s[16:19], s37 offen offset:3072  lds
    s_add_u32 m0, s50, 36864
    ds_read_b64_tr_b16 a[160:161], v228 offset:24576
    ds_read_b64_tr_b16 a[162:163], v228 offset:28672
    v_mfma_f32_16x16x32_bf16 v[76:79], a[172:175], v[128:131], v[76:79]
    s_add_u32 s37, s46, 131072
    buffer_load_dwordx4 v32, s[16:19], s37 offen offset:0  lds
    ds_read_b64_tr_b16 a[164:165], v229 offset:24576
    ds_read_b64_tr_b16 a[166:167], v229 offset:28672
    s_waitcnt lgkmcnt(4)
    v_mfma_f32_16x16x32_bf16 v[80:83], a[176:179], v[128:131], v[80:83]
    buffer_load_dwordx4 v33, s[16:19], s37 offen offset:1024  lds
    buffer_load_dwordx4 v34, s[16:19], s37 offen offset:2048  lds
    ds_read_b64_tr_b16 a[168:169], v230 offset:24576
    ds_read_b64_tr_b16 a[170:171], v230 offset:28672
    v_mfma_f32_16x16x32_bf16 v[84:87], a[180:183], v[128:131], v[84:87]
    buffer_load_dwordx4 v35, s[16:19], s37 offen offset:3072  lds
    s_add_u32 m0, s50, 40960
    ds_read_b64_tr_b16 a[172:173], v231 offset:24576
    ds_read_b64_tr_b16 a[174:175], v231 offset:28672
    v_mfma_f32_16x16x32_bf16 v[88:91], a[184:187], v[128:131], v[88:91]
    s_add_u32 s37, s46, 262144
    buffer_load_dwordx4 v32, s[16:19], s37 offen offset:0  lds
    ds_read_b64_tr_b16 a[176:177], v232 offset:24576
    ds_read_b64_tr_b16 a[178:179], v232 offset:28672
    v_mfma_f32_16x16x32_bf16 v[92:95], a[188:191], v[128:131], v[92:95]
    buffer_load_dwordx4 v33, s[16:19], s37 offen offset:1024  lds
    buffer_load_dwordx4 v34, s[16:19], s37 offen offset:2048  lds
    ds_read_b64_tr_b16 a[180:181], v233 offset:24576
    ds_read_b64_tr_b16 a[182:183], v233 offset:28672
    v_exp_f32_e32 v143, v143
    v_cvt_pk_bf16_f32 v138, v140, v141
    v_cvt_pk_bf16_f32 v139, v142, v143
    s_waitcnt lgkmcnt(4)
    s_nop 0
    v_mfma_f32_16x16x32_bf16 v[64:67], a[160:163], v[136:139], v[64:67]
    buffer_load_dwordx4 v35, s[16:19], s37 offen offset:3072  lds
    s_add_u32 m0, s50, 45056
    ds_read_b64_tr_b16 a[184:185], v234 offset:24576
    ds_read_b64_tr_b16 a[186:187], v234 offset:28672
    v_mfma_f32_16x16x32_bf16 v[68:71], a[164:167], v[136:139], v[68:71]
    s_add_u32 s37, s46, 393216
    buffer_load_dwordx4 v32, s[16:19], s37 offen offset:0  lds
    ds_read_b64_tr_b16 a[188:189], v235 offset:24576
    ds_read_b64_tr_b16 a[190:191], v235 offset:28672
    v_mfma_f32_16x16x32_bf16 v[72:75], a[168:171], v[136:139], v[72:75]
    buffer_load_dwordx4 v33, s[16:19], s37 offen offset:1024  lds
    buffer_load_dwordx4 v34, s[16:19], s37 offen offset:2048  lds
    v_mfma_f32_16x16x32_bf16 v[76:79], a[172:175], v[136:139], v[76:79]
    buffer_load_dwordx4 v35, s[16:19], s37 offen offset:3072  lds
    s_waitcnt lgkmcnt(0)
    v_mfma_f32_16x16x32_bf16 v[80:83], a[176:179], v[136:139], v[80:83]
    s_waitcnt vmcnt(24)
    s_barrier
    s_mov_b32 s50, s32
    s_add_u32 s34, s32, s38
    s_add_u32 s32, s32, s42
    s_cmp_eq_u32 s32, 159744
    s_cselect_b32 s33, s43, s42
    s_cselect_b32 s32, 0, s32
    s_sub_u32 s39, 159744, s32
    v_add_u32_e32 v228, s33, v228
    v_add_u32_e32 v254, s39, v228
    ds_read_b64_tr_b16 a[160:161], v254 offset:0
    ds_read_b64_tr_b16 a[162:163], v228 offset:32768
    ds_read_b64_tr_b16 a[164:165], v228 offset:36864
    ds_read_b64_tr_b16 a[166:167], v228 offset:40960
    ds_read_b64_tr_b16 a[168:169], v228 offset:45056
    ds_read_b64_tr_b16 a[170:171], v228 offset:49152
    v_mfma_f32_16x16x32_bf16 v[84:87], a[180:183], v[136:139], v[84:87]
    v_add_u32_e32 v229, s33, v229
    v_add_u32_e32 v254, s39, v229
    ds_read_b64_tr_b16 a[172:173], v254 offset:0
    ds_read_b64_tr_b16 a[174:175], v229 offset:32768
    v_exp_f32_e32 v160, v160
    v_mfma_f32_16x16x32_bf16 v[88:91], a[184:187], v[136:139], v[88:91]
    ds_read_b64_tr_b16 a[176:177], v229 offset:36864
    ds_read_b64_tr_b16 a[178:179], v229 offset:40960
    v_mfma_f32_16x16x32_bf16 v[246:249], v[242:245], v[136:139], v[246:249]
    v_exp_f32_e32 v161, v161
    v_mfma_f32_16x16x32_bf16 v[92:95], a[188:191], v[136:139], v[92:95]
    ds_read_b64_tr_b16 a[180:181], v229 offset:45056
    ds_read_b64_tr_b16 a[182:183], v229 offset:49152
    v_exp_f32_e32 v162, v162
    v_exp_f32_e32 v163, v163
    s_waitcnt lgkmcnt(4)
    v_mfma_f32_16x16x32_bf16 v[0:3], a[160:163], a[136:139], v[0:3]
    s_add_u32 m0, s34, 0
    v_add_u32_e32 v230, s33, v230
    v_add_u32_e32 v254, s39, v230
    ds_read_b64_tr_b16 a[184:185], v254 offset:0
    ds_read_b64_tr_b16 a[186:187], v230 offset:32768
    v_mfma_f32_16x16x32_bf16 v[0:3], a[164:167], a[144:147], v[0:3]
    buffer_load_dwordx4 v236, s[8:11], s29 offen offset:0 nt lds
    ds_read_b64_tr_b16 a[188:189], v230 offset:36864
    ds_read_b64_tr_b16 a[190:191], v230 offset:40960
    v_mfma_f32_16x16x32_bf16 v[0:3], a[168:171], a[152:155], v[0:3]
    buffer_load_dwordx4 v237, s[8:11], s29 offen offset:1024 nt lds
    ds_read_b64_tr_b16 a[160:161], v230 offset:45056
    ds_read_b64_tr_b16 a[162:163], v230 offset:49152
    v_mfma_f32_16x16x32_bf16 v[4:7], a[172:175], a[136:139], v[4:7]
    v_add_u32_e32 v231, s33, v231
    v_add_u32_e32 v254, s39, v231
    ds_read_b64_tr_b16 a[164:165], v254 offset:0
    ds_read_b64_tr_b16 a[166:167], v231 offset:32768
    v_cvt_pk_bf16_f32 v160, v160, v161
    s_waitcnt lgkmcnt(4)
    v_mfma_f32_16x16x32_bf16 v[4:7], a[176:179], a[144:147], v[4:7]
    buffer_load_dwordx4 v238, s[8:11], s29 offen offset:2048 nt lds
    ds_read_b64_tr_b16 a[168:169], v231 offset:36864
    ds_read_b64_tr_b16 a[170:171], v231 offset:40960
    v_mfma_f32_16x16x32_bf16 v[4:7], a[180:183], a[152:155], v[4:7]
    buffer_load_dwordx4 v239, s[8:11], s29 offen offset:3072 nt lds
    ds_read_b64_tr_b16 a[172:173], v231 offset:45056
    ds_read_b64_tr_b16 a[174:175], v231 offset:49152
    v_mfma_f32_16x16x32_bf16 v[8:11], a[184:187], a[136:139], v[8:11]
    v_add_u32_e32 v232, s33, v232
    v_add_u32_e32 v254, s39, v232
    ds_read_b64_tr_b16 a[176:177], v254 offset:0
    ds_read_b64_tr_b16 a[178:179], v232 offset:32768
    v_exp_f32_e32 v164, v164
    v_exp_f32_e32 v165, v165
    v_cvt_pk_bf16_f32 v161, v162, v163
    v_exp_f32_e32 v166, v166
    v_exp_f32_e32 v167, v167
    v_cvt_pk_bf16_f32 v162, v164, v165
    v_cvt_pk_bf16_f32 v163, v166, v167
    v_exp_f32_e32 v168, v168
    v_exp_f32_e32 v169, v169
    v_mfma_f32_16x16x32_bf16 v[246:249], v[242:245], v[160:163], v[246:249]
    v_exp_f32_e32 v170, v170
    v_exp_f32_e32 v171, v171
    v_cvt_pk_bf16_f32 v168, v168, v169
    v_exp_f32_e32 v172, v172
    v_exp_f32_e32 v173, v173
    v_cvt_pk_bf16_f32 v169, v170, v171
    v_exp_f32_e32 v174, v174
    v_exp_f32_e32 v175, v175
    v_cvt_pk_bf16_f32 v170, v172, v173
    v_cvt_pk_bf16_f32 v171, v174, v175
    s_nop 1
    v_mfma_f32_16x16x32_bf16 v[246:249], v[242:245], v[168:171], v[246:249]
    v_mfma_f32_16x16x32_bf16 v[8:11], a[188:191], a[144:147], v[8:11]
    s_add_u32 s29, s29, 16384
    ds_read_b64_tr_b16 a[180:181], v232 offset:36864
    ds_read_b64_tr_b16 a[182:183], v232 offset:40960
    s_mov_b64 s[44:45], -1
    s_nop 2
    v_cmp_le_f32_e32 vcc, 0x33800000, v246
    s_nop 0
    s_and_b64 s[44:45], s[44:45], vcc
    v_cmp_ge_f32_e32 vcc, 0x4b800000, v246
    s_nop 0
    s_and_b64 s[44:45], s[44:45], vcc
    s_cmp_eq_u64 s[44:45], -1
    s_cbranch_scc1 A_B_fast_ok0
    s_mov_b32 s87, 0
    s_branch A_B_slow
A_B_slow_ret0:
A_B_fast_ok0:
    v_rcp_f32_e32 v246, v246
    s_waitcnt lgkmcnt(4)
    v_mfma_f32_16x16x32_bf16 v[8:11], a[160:163], a[152:155], v[8:11]
    s_add_u32 m0, s34, 16384
    ds_read_b64_tr_b16 a[184:185], v232 offset:45056
    ds_read_b64_tr_b16 a[186:187], v232 offset:49152
    v_mfma_f32_16x16x32_bf16 v[12:15], a[164:167], a[136:139], v[12:15]
    buffer_load_dwordx4 v240, s[12:15], s30 offen offset:0 nt lds
    v_add_u32_e32 v233, s33, v233
    v_add_u32_e32 v254, s39, v233
    ds_read_b64_tr_b16 a[188:189], v254 offset:0
    ds_read_b64_tr_b16 a[190:191], v233 offset:32768
    v_mfma_f32_16x16x32_bf16 v[12:15], a[168:171], a[144:147], v[12:15]
    ds_read_b64_tr_b16 a[160:161], v233 offset:36864
    ds_read_b64_tr_b16 a[162:163], v233 offset:40960
    v_mul_f32_e32 v0, s41, v0
    v_mul_f32_e32 v1, s41, v1
    v_mul_f32_e32 v2, s41, v2
    v_mul_f32_e32 v3, s41, v3
    v_mfma_f32_16x16x32_bf16 v[12:15], a[172:175], a[152:155], v[12:15]
    buffer_load_dwordx4 v241, s[12:15], s30 offen offset:1024 nt lds
    ds_read_b64_tr_b16 a[164:165], v233 offset:45056
    ds_read_b64_tr_b16 a[166:167], v233 offset:49152
    s_waitcnt lgkmcnt(4)
    v_mfma_f32_16x16x32_bf16 v[16:19], a[176:179], a[136:139], v[16:19]
    buffer_load_dwordx4 v240, s[12:15], s30 offen offset:2048 nt lds
    v_add_u32_e32 v234, s33, v234
    v_add_u32_e32 v254, s39, v234
    ds_read_b64_tr_b16 a[168:169], v254 offset:0
    ds_read_b64_tr_b16 a[170:171], v234 offset:32768
    v_mfma_f32_16x16x32_bf16 v[16:19], a[180:183], a[144:147], v[16:19]
    ds_read_b64_tr_b16 a[172:173], v234 offset:36864
    ds_read_b64_tr_b16 a[174:175], v234 offset:40960
    v_mul_f32_e32 v4, s41, v4
    v_mul_f32_e32 v5, s41, v5
    v_mul_f32_e32 v6, s41, v6
    v_mul_f32_e32 v7, s41, v7
    v_mfma_f32_16x16x32_bf16 v[16:19], a[184:187], a[152:155], v[16:19]
    buffer_load_dwordx4 v241, s[12:15], s30 offen offset:3072 nt lds
    ds_read_b64_tr_b16 a[176:177], v234 offset:45056
    ds_read_b64_tr_b16 a[178:179], v234 offset:49152
    v_mfma_f32_16x16x32_bf16 v[20:23], a[188:191], a[136:139], v[20:23]
    s_add_u32 s30, s30, 16384
    v_add_u32_e32 v235, s33, v235
    v_add_u32_e32 v254, s39, v235
    ds_read_b64_tr_b16 a[180:181], v254 offset:0
    ds_read_b64_tr_b16 a[182:183], v235 offset:32768
    v_cvt_pk_bf16_f32 v192, v0, v1
    s_waitcnt lgkmcnt(4)
    v_mfma_f32_16x16x32_bf16 v[20:23], a[160:163], a[144:147], v[20:23]
    ds_read_b64_tr_b16 a[184:185], v235 offset:36864
    ds_read_b64_tr_b16 a[186:187], v235 offset:40960
    v_cvt_pk_bf16_f32 v193, v2, v3
    v_cvt_pk_bf16_f32 v194, v4, v5
    v_cvt_pk_bf16_f32 v195, v6, v7
    v_mfma_f32_16x16x32_bf16 v[20:23], a[164:167], a[152:155], v[20:23]
    ds_read_b64_tr_b16 a[188:189], v235 offset:45056
    ds_read_b64_tr_b16 a[190:191], v235 offset:49152
    v_permlane32_swap_b32_e32 v192, v194
    v_permlane32_swap_b32_e32 v193, v195
    s_nop 0
    v_permlane16_swap_b32_e32 v192, v194
    v_permlane16_swap_b32_e32 v193, v195
    v_mfma_f32_16x16x32_bf16 v[24:27], a[168:171], a[136:139], v[24:27]
    ds_read_b64_tr_b16 a[160:161], v228 offset:16384
    ds_read_b64_tr_b16 a[162:163], v228 offset:20480
    v_mul_f32_e32 v8, s41, v8
    v_mul_f32_e32 v9, s41, v9
    v_mul_f32_e32 v10, s41, v10
    v_mul_f32_e32 v11, s41, v11
    v_mfma_f32_16x16x32_bf16 v[24:27], a[172:175], a[144:147], v[24:27]
    ds_read_b64_tr_b16 a[164:165], v228 offset:24576
    ds_read_b64_tr_b16 a[166:167], v228 offset:28672
    v_mul_f32_e32 v12, s41, v12
    v_mul_f32_e32 v13, s41, v13
    v_mul_f32_e32 v14, s41, v14
    v_mul_f32_e32 v15, s41, v15
    s_waitcnt lgkmcnt(4)
    v_mfma_f32_16x16x32_bf16 v[24:27], a[176:179], a[152:155], v[24:27]
    ds_read_b64_tr_b16 a[168:169], v229 offset:16384
    ds_read_b64_tr_b16 a[170:171], v229 offset:20480
    v_cvt_pk_bf16_f32 v196, v8, v9
    v_cvt_pk_bf16_f32 v197, v10, v11
    v_cvt_pk_bf16_f32 v198, v12, v13
    v_mfma_f32_16x16x32_bf16 v[28:31], a[180:183], a[136:139], v[28:31]
    ds_read_b64_tr_b16 a[172:173], v229 offset:24576
    ds_read_b64_tr_b16 a[174:175], v229 offset:28672
    v_cvt_pk_bf16_f32 v199, v14, v15
    v_permlane32_swap_b32_e32 v196, v198
    s_nop 0
    v_permlane32_swap_b32_e32 v197, v199
    v_permlane16_swap_b32_e32 v196, v198
    v_mfma_f32_16x16x32_bf16 v[28:31], a[184:187], a[144:147], v[28:31]
    ds_read_b64_tr_b16 a[176:177], v230 offset:16384
    ds_read_b64_tr_b16 a[178:179], v230 offset:20480
    v_permlane16_swap_b32_e32 v197, v199
    v_mul_f32_e32 v16, s41, v16
    v_mfma_f32_16x16x32_bf16 v[28:31], a[188:191], a[152:155], v[28:31]
    ds_read_b64_tr_b16 a[180:181], v230 offset:24576
    ds_read_b64_tr_b16 a[182:183], v230 offset:28672
    v_mul_f32_e32 v17, s41, v17
    v_mul_f32_e32 v18, s41, v18
    v_mul_f32_e32 v19, s41, v19
    s_waitcnt lgkmcnt(4)
    v_mfma_f32_16x16x32_bf16 v[64:67], a[160:163], v[160:163], v[64:67]
    ds_read_b64_tr_b16 a[184:185], v231 offset:16384
    ds_read_b64_tr_b16 a[186:187], v231 offset:20480
    v_mul_f32_e32 v20, s41, v20
    v_mul_f32_e32 v21, s41, v21
    v_mfma_f32_16x16x32_bf16 v[64:67], a[164:167], v[168:171], v[64:67]
    ds_read_b64_tr_b16 a[188:189], v231 offset:24576
    ds_read_b64_tr_b16 a[190:191], v231 offset:28672
    v_mul_f32_e32 v22, s41, v22
    v_mul_f32_e32 v23, s41, v23
    v_cvt_pk_bf16_f32 v200, v16, v17
    v_mfma_f32_16x16x32_bf16 v[68:71], a[168:171], v[160:163], v[68:71]
    ds_read_b64_tr_b16 a[160:161], v232 offset:16384
    ds_read_b64_tr_b16 a[162:163], v232 offset:20480
    v_cvt_pk_bf16_f32 v201, v18, v19
    v_cvt_pk_bf16_f32 v202, v20, v21
    v_mfma_f32_16x16x32_bf16 v[68:71], a[172:175], v[168:171], v[68:71]
    ds_read_b64_tr_b16 a[164:165], v232 offset:24576
    ds_read_b64_tr_b16 a[166:167], v232 offset:28672
    v_cvt_pk_bf16_f32 v203, v22, v23
    v_permlane32_swap_b32_e32 v200, v202
    s_nop 0
    v_permlane32_swap_b32_e32 v201, v203
    s_waitcnt lgkmcnt(4)
    v_mfma_f32_16x16x32_bf16 v[72:75], a[176:179], v[160:163], v[72:75]
    ds_read_b64_tr_b16 a[168:169], v233 offset:16384
    ds_read_b64_tr_b16 a[170:171], v233 offset:20480
    v_permlane16_swap_b32_e32 v200, v202
    v_permlane16_swap_b32_e32 v201, v203
    v_mfma_f32_16x16x32_bf16 v[72:75], a[180:183], v[168:171], v[72:75]
    ds_read_b64_tr_b16 a[172:173], v233 offset:24576
    ds_read_b64_tr_b16 a[174:175], v233 offset:28672
    v_mul_f32_e32 v24, s41, v24
    v_mul_f32_e32 v25, s41, v25
    v_mul_f32_e32 v26, s41, v26
    v_mfma_f32_16x16x32_bf16 v[76:79], a[184:187], v[160:163], v[76:79]
    ds_read_b64_tr_b16 a[176:177], v234 offset:16384
    ds_read_b64_tr_b16 a[178:179], v234 offset:20480
    v_mul_f32_e32 v27, s41, v27
    v_mul_f32_e32 v28, s41, v28
    v_mfma_f32_16x16x32_bf16 v[76:79], a[188:191], v[168:171], v[76:79]
    ds_read_b64_tr_b16 a[180:181], v234 offset:24576
    ds_read_b64_tr_b16 a[182:183], v234 offset:28672
    v_mul_f32_e32 v29, s41, v29
    v_mul_f32_e32 v30, s41, v30
    v_mul_f32_e32 v31, s41, v31
    s_waitcnt lgkmcnt(4)
    v_mfma_f32_16x16x32_bf16 v[80:83], a[160:163], v[160:163], v[80:83]
    ds_read_b64_tr_b16 a[184:185], v235 offset:16384
    ds_read_b64_tr_b16 a[186:187], v235 offset:20480
    v_cvt_pk_bf16_f32 v204, v24, v25
    v_cvt_pk_bf16_f32 v205, v26, v27
    v_mfma_f32_16x16x32_bf16 v[80:83], a[164:167], v[168:171], v[80:83]
    ds_read_b64_tr_b16 a[188:189], v235 offset:24576
    ds_read_b64_tr_b16 a[190:191], v235 offset:28672
    v_cvt_pk_bf16_f32 v206, v28, v29
    v_cvt_pk_bf16_f32 v207, v30, v31
    v_mfma_f32_16x16x32_bf16 v[84:87], a[168:171], v[160:163], v[84:87]
    v_add_u32_e32 v224, s33, v224
    ds_read_b128 a[160:163], v224 offset:0
    v_mfma_f32_16x16x32_bf16 v[84:87], a[172:175], v[168:171], v[84:87]
    v_add_u32_e32 v225, s33, v225
    ds_read_b128 a[164:167], v225 offset:0
    s_waitcnt lgkmcnt(2)
    v_mfma_f32_16x16x32_bf16 v[88:91], a[176:179], v[160:163], v[88:91]
    s_add_u32 m0, s50, 32768
    s_add_u32 s37, s46, 655360
    v_add_u32_e32 v226, s33, v226
    ds_read_b128 a[168:171], v226 offset:0
    v_mfma_f32_16x16x32_bf16 v[88:91], a[180:183], v[168:171], v[88:91]
    buffer_load_dwordx4 v32, s[16:19], s37 offen offset:0  lds
    buffer_load_dwordx4 v33, s[16:19], s37 offen offset:1024  lds
    v_add_u32_e32 v227, s33, v227
    ds_read_b128 a[172:175], v227 offset:0
    v_mfma_f32_16x16x32_bf16 v[92:95], a[184:187], v[160:163], v[92:95]
    buffer_load_dwordx4 v34, s[16:19], s37 offen offset:2048  lds
    buffer_load_dwordx4 v35, s[16:19], s37 offen offset:3072  lds
    ds_read_b128 a[176:179], v224 offset:4096
    v_mfma_f32_16x16x32_bf16 v[92:95], a[188:191], v[168:171], v[92:95]
    s_add_u32 m0, s50, 36864
    s_add_u32 s37, s46, 786432
    ds_read_b128 a[180:183], v225 offset:4096
    v_permlane32_swap_b32_e32 v204, v206
    v_permlane32_swap_b32_e32 v205, v207
    s_nop 0
    v_permlane16_swap_b32_e32 v204, v206
    v_permlane16_swap_b32_e32 v205, v207
    s_waitcnt lgkmcnt(2)
    v_mfma_f32_16x16x32_bf16 v[128:131], a[160:163], v[192:195], 0
    buffer_load_dwordx4 v32, s[16:19], s37 offen offset:0  lds
    buffer_load_dwordx4 v33, s[16:19], s37 offen offset:1024  lds
    ds_read_b128 a[184:187], v226 offset:4096
    v_mfma_f32_16x16x32_bf16 v[128:131], a[164:167], v[196:199], v[128:131]
    buffer_load_dwordx4 v34, s[16:19], s37 offen offset:2048  lds
    buffer_load_dwordx4 v35, s[16:19], s37 offen offset:3072  lds
    ds_read_b128 a[188:191], v227 offset:4096
    v_mfma_f32_16x16x32_bf16 v[128:131], a[168:171], v[200:203], v[128:131]
    s_add_u32 m0, s50, 40960
    s_add_u32 s37, s46, 917504
    ds_read_b128 a[160:163], v224 offset:8192
    v_mul_f32_e32 v64, v246, v64
    v_mul_f32_e32 v65, v246, v65
    v_mul_f32_e32 v66, v246, v66
    v_mfma_f32_16x16x32_bf16 v[128:131], a[172:175], v[204:207], v[128:131]
    buffer_load_dwordx4 v32, s[16:19], s37 offen offset:0  lds
    buffer_load_dwordx4 v33, s[16:19], s37 offen offset:1024  lds
    ds_read_b128 a[164:167], v225 offset:8192
    s_waitcnt lgkmcnt(2)
    v_mfma_f32_16x16x32_bf16 v[132:135], a[176:179], v[192:195], 0
    buffer_load_dwordx4 v34, s[16:19], s37 offen offset:2048  lds
    buffer_load_dwordx4 v35, s[16:19], s37 offen offset:3072  lds
    ds_read_b128 a[168:171], v226 offset:8192
    v_mfma_f32_16x16x32_bf16 v[132:135], a[180:183], v[196:199], v[132:135]
    s_add_u32 m0, s50, 45056
    s_add_u32 s37, s46, 1048576
    ds_read_b128 a[172:175], v227 offset:8192
    v_mul_f32_e32 v67, v246, v67
    v_mul_f32_e32 v68, v246, v68
    v_mul_f32_e32 v69, v246, v69
    v_mfma_f32_16x16x32_bf16 v[132:135], a[184:187], v[200:203], v[132:135]
    buffer_load_dwordx4 v32, s[16:19], s37 offen offset:0  lds
    buffer_load_dwordx4 v33, s[16:19], s37 offen offset:1024  lds
    ds_read_b128 a[176:179], v224 offset:12288
    v_mfma_f32_16x16x32_bf16 v[132:135], a[188:191], v[204:207], v[132:135]
    buffer_load_dwordx4 v34, s[16:19], s37 offen offset:2048  lds
    buffer_load_dwordx4 v35, s[16:19], s37 offen offset:3072  lds
    ds_read_b128 a[180:183], v225 offset:12288
    s_waitcnt lgkmcnt(2)
    v_mfma_f32_16x16x32_bf16 v[136:139], a[160:163], v[192:195], 0
    s_add_u32 m0, s50, 49152
    s_add_u32 s37, s46, 1179648
    ds_read_b128 a[184:187], v226 offset:12288
    v_mul_f32_e32 v70, v246, v70
    v_mul_f32_e32 v71, v246, v71
    v_mfma_f32_16x16x32_bf16 v[136:139], a[164:167], v[196:199], v[136:139]
    buffer_load_dwordx4 v32, s[16:19], s37 offen offset:0  lds
    buffer_load_dwordx4 v33, s[16:19], s37 offen offset:1024  lds
    ds_read_b128 a[188:191], v227 offset:12288
    v_mfma_f32_16x16x32_bf16 v[136:139], a[168:171], v[200:203], v[136:139]
    buffer_load_dwordx4 v34, s[16:19], s37 offen offset:2048  lds
    buffer_load_dwordx4 v35, s[16:19], s37 offen offset:3072  lds
    v_mfma_f32_16x16x32_bf16 v[136:139], a[172:175], v[204:207], v[136:139]
    s_mov_b32 s31, s46
    s_add_u32 s46, s46, 256
    v_cvt_pk_bf16_f32 v64, v64, v65
    v_cvt_pk_bf16_f32 v65, v66, v67
    v_cvt_pk_bf16_f32 v66, v68, v69
    v_cvt_pk_bf16_f32 v67, v70, v71
    s_waitcnt lgkmcnt(0)
    v_mfma_f32_16x16x32_bf16 v[140:143], a[176:179], v[192:195], 0
    s_waitcnt vmcnt(28)
    s_barrier
    s_mov_b32 s50, s32
    s_add_u32 s34, s32, s38
    s_add_u32 s32, s32, s42
    s_cmp_eq_u32 s32, 159744
    s_cselect_b32 s33, s43, s42
    s_cselect_b32 s32, 0, s32
    v_add_u32_e32 v224, s33, v224
    ds_read_b128 a[160:163], v224 offset:0
    v_add_u32_e32 v225, s33, v225
    ds_read_b128 a[164:167], v225 offset:0
    v_add_u32_e32 v226, s33, v226
    ds_read_b128 a[168:171], v226 offset:0
    v_mfma_f32_16x16x32_bf16 v[140:143], a[180:183], v[196:199], v[140:143]
    v_mul_f32_e32 v72, v246, v72
    v_mul_f32_e32 v73, v246, v73
    v_mul_f32_e32 v74, v246, v74
    v_mul_f32_e32 v75, v246, v75
    v_mul_f32_e32 v76, v246, v76
    v_mul_f32_e32 v77, v246, v77
    v_mfma_f32_16x16x32_bf16 v[140:143], a[184:187], v[200:203], v[140:143]
    v_mul_f32_e32 v78, v246, v78
    v_mul_f32_e32 v79, v246, v79
    v_cvt_pk_bf16_f32 v72, v72, v73
    v_cvt_pk_bf16_f32 v73, v74, v75
    v_cvt_pk_bf16_f32 v74, v76, v77
    v_cvt_pk_bf16_f32 v75, v78, v79
    v_mfma_f32_16x16x32_bf16 v[140:143], a[188:191], v[204:207], v[140:143]
    v_mul_f32_e32 v80, v246, v80
    v_mul_f32_e32 v81, v246, v81
    v_mul_f32_e32 v82, v246, v82
    v_mul_f32_e32 v83, v246, v83
    v_mul_f32_e32 v84, v246, v84
    v_mul_f32_e32 v85, v246, v85
    v_mul_f32_e32 v86, v246, v86
    v_mul_f32_e32 v87, v246, v87
    v_cvt_pk_bf16_f32 v80, v80, v81
    v_cvt_pk_bf16_f32 v81, v82, v83
    v_cvt_pk_bf16_f32 v82, v84, v85
    v_cvt_pk_bf16_f32 v83, v86, v87
    v_mul_f32_e32 v88, v246, v88
    v_mul_f32_e32 v89, v246, v89
    v_mul_f32_e32 v90, v246, v90
    v_mul_f32_e32 v91, v246, v91
    v_mul_f32_e32 v92, v246, v92
    v_mul_f32_e32 v93, v246, v93
    v_mul_f32_e32 v94, v246, v94
    v_mul_f32_e32 v95, v246, v95
    v_cvt_pk_bf16_f32 v88, v88, v89
    v_cvt_pk_bf16_f32 v89, v90, v91
    v_cvt_pk_bf16_f32 v90, v92, v93
    v_cvt_pk_bf16_f32 v91, v94, v95
    s_cmp_eq_u32 s35, 0
    s_cbranch_scc1 A_B_st0
    s_cmp_eq_u32 s35, 1
    s_cbranch_scc1 A_B_st1
    v_accvgpr_write_b32 a0, v64
    v_accvgpr_write_b32 a1, v65
    v_accvgpr_write_b32 a2, v66
    v_accvgpr_write_b32 a3, v67
    v_accvgpr_write_b32 a4, v72
    v_accvgpr_write_b32 a5, v73
    v_accvgpr_write_b32 a6, v74
    v_accvgpr_write_b32 a7, v75
    v_accvgpr_write_b32 a8, v80
    v_accvgpr_write_b32 a9, v81
    v_accvgpr_write_b32 a10, v82
    v_accvgpr_write_b32 a11, v83
    v_accvgpr_write_b32 a12, v88
    v_accvgpr_write_b32 a13, v89
    v_accvgpr_write_b32 a14, v90
    v_accvgpr_write_b32 a15, v91
    s_branch A_B_st_done
A_B_st0:
    v_accvgpr_write_b32 a192, v64
    v_accvgpr_write_b32 a193, v65
    v_accvgpr_write_b32 a194, v66
    v_accvgpr_write_b32 a195, v67
    v_accvgpr_write_b32 a196, v72
    v_accvgpr_write_b32 a197, v73
    v_accvgpr_write_b32 a198, v74
    v_accvgpr_write_b32 a199, v75
    v_accvgpr_write_b32 a200, v80
    v_accvgpr_write_b32 a201, v81
    v_accvgpr_write_b32 a202, v82
    v_accvgpr_write_b32 a203, v83
    v_accvgpr_write_b32 a204, v88
    v_accvgpr_write_b32 a205, v89
    v_accvgpr_write_b32 a206, v90
    v_accvgpr_write_b32 a207, v91
    s_branch A_B_st_done
A_B_st1:
    v_accvgpr_write_b32 a224, v64
    v_accvgpr_write_b32 a225, v65
    v_accvgpr_write_b32 a226, v66
    v_accvgpr_write_b32 a227, v67
    v_accvgpr_write_b32 a228, v72
    v_accvgpr_write_b32 a229, v73
    v_accvgpr_write_b32 a230, v74
    v_accvgpr_write_b32 a231, v75
    v_accvgpr_write_b32 a232, v80
    v_accvgpr_write_b32 a233, v81
    v_accvgpr_write_b32 a234, v82
    v_accvgpr_write_b32 a235, v83
    v_accvgpr_write_b32 a236, v88
    v_accvgpr_write_b32 a237, v89
    v_accvgpr_write_b32 a238, v90
    v_accvgpr_write_b32 a239, v91
A_B_st_done:
    s_add_u32 s35, s35, 1
    s_branch A_B_head
A_B_last:
    s_waitcnt lgkmcnt(0)
    v_mfma_f32_16x16x32_bf16 v[160:163], a[160:163], v[192:195], 0
    v_mbcnt_lo_u32_b32 v0, -1, 0
    v_mbcnt_hi_u32_b32 v0, -1, v0
    v_and_b32_e32 v3, 15, v0
    v_lshrrev_b32_e32 v4, 4, v0
    s_mov_b32 s38, 0
    s_mov_b32 s7, 0
    v_mul_u32_u24_e32 v11, 1280, v4
    v_lshlrev_b32_e32 v5, 1, v4
    v_add_u32_e32 v5, 0, v5
    v_lshlrev_b32_e32 v5, 1, v5
    v_xor_b32_e32 v5, v5, v3
    v_lshlrev_b32_e32 v12, 4, v5
    v_add3_u32 v12, v12, v11, s7
    v_add_u32_e32 v236, 0, v12
    v_lshlrev_b32_e32 v5, 1, v4
    v_add_u32_e32 v5, 1, v5
    v_lshlrev_b32_e32 v5, 1, v5
    v_xor_b32_e32 v5, v5, v3
    v_lshlrev_b32_e32 v12, 4, v5
    v_add3_u32 v12, v12, v11, s7
    v_add_u32_e32 v237, 4096, v12
    v_lshlrev_b32_e32 v5, 1, v4
    v_add_u32_e32 v5, 0, v5
    v_lshlrev_b32_e32 v5, 1, v5
    v_xor_b32_e32 v5, v5, v3
    v_lshlrev_b32_e32 v12, 4, v5
    v_add3_u32 v12, v12, v11, s7
    v_add_u32_e32 v238, 8192, v12
    v_lshlrev_b32_e32 v5, 1, v4
    v_add_u32_e32 v5, 1, v5
    v_lshlrev_b32_e32 v5, 1, v5
    v_xor_b32_e32 v5, v5, v3
    v_lshlrev_b32_e32 v12, 4, v5
    v_add3_u32 v12, v12, v11, s7
    v_add_u32_e32 v239, 12288, v12
    s_mov_b32 s16, s82
    s_mov_b32 s17, s83
    s_mov_b32 s18, 655360
    s_mov_b32 s19, 0x20000
    s_mov_b32 s47, 0
    s_add_u32 s34, s38, 32768
    s_add_u32 m0, s34, 12288
    s_add_u32 s37, s47, 61440
    v_add_u32_e32 v227, s33, v227
    ds_read_b128 a[172:175], v227 offset:0
    ds_read_b128 a[176:179], v224 offset:4096
    ds_read_b128 a[180:183], v225 offset:4096
    ds_read_b128 a[184:187], v226 offset:4096
    v_mfma_f32_16x16x32_bf16 v[160:163], a[164:167], v[196:199], v[160:163]
    buffer_load_dwordx4 v236, s[16:19], s37 offen offset:0  lds
    buffer_load_dwordx4 v237, s[16:19], s37 offen offset:1024  lds
    ds_read_b128 a[188:191], v227 offset:4096
    v_mfma_f32_16x16x32_bf16 v[160:163], a[168:171], v[200:203], v[160:163]
    buffer_load_dwordx4 v238, s[16:19], s37 offen offset:2048  lds
    buffer_load_dwordx4 v239, s[16:19], s37 offen offset:3072  lds
    ds_read_b128 a[160:163], v224 offset:8192
    s_waitcnt lgkmcnt(5)
    v_mfma_f32_16x16x32_bf16 v[160:163], a[172:175], v[204:207], v[160:163]
    s_add_u32 m0, s34, 16384
    s_add_u32 s37, s47, 81920
    buffer_load_dwordx4 v236, s[16:19], s37 offen offset:0  lds
    ds_read_b128 a[164:167], v225 offset:8192
    s_waitcnt lgkmcnt(2)
    v_mfma_f32_16x16x32_bf16 v[164:167], a[176:179], v[192:195], 0
    buffer_load_dwordx4 v237, s[16:19], s37 offen offset:1024  lds
    buffer_load_dwordx4 v238, s[16:19], s37 offen offset:2048  lds
    ds_read_b128 a[168:171], v226 offset:8192
    v_mfma_f32_16x16x32_bf16 v[164:167], a[180:183], v[196:199], v[164:167]
    buffer_load_dwordx4 v239, s[16:19], s37 offen offset:3072  lds
    s_add_u32 m0, s34, 20480
    ds_read_b128 a[172:175], v227 offset:8192
    v_mfma_f32_16x16x32_bf16 v[164:167], a[184:187], v[200:203], v[164:167]
    s_add_u32 s37, s47, 102400
    buffer_load_dwordx4 v236, s[16:19], s37 offen offset:0  lds
    ds_read_b128 a[176:179], v224 offset:12288
    v_mfma_f32_16x16x32_bf16 v[164:167], a[188:191], v[204:207], v[164:167]
    buffer_load_dwordx4 v237, s[16:19], s37 offen offset:1024  lds
    buffer_load_dwordx4 v238, s[16:19], s37 offen offset:2048  lds
    buffer_load_dwordx4 v239, s[16:19], s37 offen offset:3072  lds
    ds_read_b128 a[180:183], v225 offset:12288
    s_waitcnt lgkmcnt(2)
    v_mfma_f32_16x16x32_bf16 v[168:171], a[160:163], v[192:195], 0
    s_add_u32 m0, s34, 24576
    s_add_u32 s37, s47, 122880
    ds_read_b128 a[184:187], v226 offset:12288
    v_exp_f32_e32 v134, v134
    v_mfma_f32_16x16x32_bf16 v[168:171], a[164:167], v[196:199], v[168:171]
    buffer_load_dwordx4 v236, s[16:19], s37 offen offset:0  lds
    buffer_load_dwordx4 v237, s[16:19], s37 offen offset:1024  lds
    ds_read_b128 a[188:191], v227 offset:12288
    v_mfma_f32_16x16x32_bf16 v[168:171], a[168:171], v[200:203], v[168:171]
    buffer_load_dwordx4 v238, s[16:19], s37 offen offset:2048  lds
    buffer_load_dwordx4 v239, s[16:19], s37 offen offset:3072  lds
    s_add_u32 m0, s34, 28672
    v_add_u32_e32 v228, s33, v228
    ds_read_b64_tr_b16 a[160:161], v228 offset:16384
    ds_read_b64_tr_b16 a[162:163], v228 offset:20480
    v_mfma_f32_16x16x32_bf16 v[168:171], a[172:175], v[204:207], v[168:171]
    s_add_u32 s37, s47, 143360
    buffer_load_dwordx4 v236, s[16:19], s37 offen offset:0  lds
    v_add_u32_e32 v229, s33, v229
    ds_read_b64_tr_b16 a[164:165], v229 offset:16384
    ds_read_b64_tr_b16 a[166:167], v229 offset:20480
    s_waitcnt lgkmcnt(4)
    v_mfma_f32_16x16x32_bf16 v[172:175], a[176:179], v[192:195], 0
    buffer_load_dwordx4 v237, s[16:19], s37 offen offset:1024  lds
    buffer_load_dwordx4 v238, s[16:19], s37 offen offset:2048  lds
    v_add_u32_e32 v230, s33, v230
    ds_read_b64_tr_b16 a[168:169], v230 offset:16384
    ds_read_b64_tr_b16 a[170:171], v230 offset:20480
    v_mfma_f32_16x16x32_bf16 v[172:175], a[180:183], v[196:199], v[172:175]
    buffer_load_dwordx4 v239, s[16:19], s37 offen offset:3072  lds
    s_add_u32 s47, s47, 163840
    v_add_u32_e32 v231, s33, v231
    ds_read_b64_tr_b16 a[172:173], v231 offset:16384
    ds_read_b64_tr_b16 a[174:175], v231 offset:20480
    v_mfma_f32_16x16x32_bf16 v[172:175], a[184:187], v[200:203], v[172:175]
    s_add_u32 s34, s38, 65536
    s_add_u32 m0, s34, 12288
    s_add_u32 s37, s47, 61440
    v_add_u32_e32 v232, s33, v232
    ds_read_b64_tr_b16 a[176:177], v232 offset:16384
    ds_read_b64_tr_b16 a[178:179], v232 offset:20480
    v_mfma_f32_16x16x32_bf16 v[172:175], a[188:191], v[204:207], v[172:175]
    buffer_load_dwordx4 v236, s[16:19], s37 offen offset:0  lds
    buffer_load_dwordx4 v237, s[16:19], s37 offen offset:1024  lds
    v_add_u32_e32 v233, s33, v233
    ds_read_b64_tr_b16 a[180:181], v233 offset:16384
    ds_read_b64_tr_b16 a[182:183], v233 offset:20480
    v_exp_f32_e32 v135, v135
    v_cvt_pk_bf16_f32 v130, v132, v133
    v_cvt_pk_bf16_f32 v131, v134, v135
    s_waitcnt lgkmcnt(4)
    s_nop 0
    v_mfma_f32_16x16x32_bf16 v[64:67], a[160:163], v[128:131], v[64:67]
    buffer_load_dwordx4 v238, s[16:19], s37 offen offset:2048  lds
    buffer_load_dwordx4 v239, s[16:19], s37 offen offset:3072  lds
    v_add_u32_e32 v234, s33, v234
    ds_read_b64_tr_b16 a[184:185], v234 offset:16384
    ds_read_b64_tr_b16 a[186:187], v234 offset:20480
    v_mfma_f32_16x16x32_bf16 v[68:71], a[164:167], v[128:131], v[68:71]
    s_add_u32 m0, s34, 16384
    s_add_u32 s37, s47, 81920
    buffer_load_dwordx4 v236, s[16:19], s37 offen offset:0  lds
    v_add_u32_e32 v235, s33, v235
    ds_read_b64_tr_b16 a[188:189], v235 offset:16384
    ds_read_b64_tr_b16 a[190:191], v235 offset:20480
    v_mfma_f32_16x16x32_bf16 v[72:75], a[168:171], v[128:131], v[72:75]
    buffer_load_dwordx4 v237, s[16:19], s37 offen offset:1024  lds
    buffer_load_dwordx4 v238, s[16:19], s37 offen offset:2048  lds
    ds_read_b64_tr_b16 a[160:161], v228 offset:24576
    ds_read_b64_tr_b16 a[162:163], v228 offset:28672
    v_mfma_f32_16x16x32_bf16 v[76:79], a[172:175], v[128:131], v[76:79]
    buffer_load_dwordx4 v239, s[16:19], s37 offen offset:3072  lds
    s_add_u32 m0, s34, 20480
    ds_read_b64_tr_b16 a[164:165], v229 offset:24576
    ds_read_b64_tr_b16 a[166:167], v229 offset:28672
    s_waitcnt lgkmcnt(4)
    v_mfma_f32_16x16x32_bf16 v[80:83], a[176:179], v[128:131], v[80:83]
    s_add_u32 s37, s47, 102400
    buffer_load_dwordx4 v236, s[16:19], s37 offen offset:0  lds
    ds_read_b64_tr_b16 a[168:169], v230 offset:24576
    ds_read_b64_tr_b16 a[170:171], v230 offset:28672
    v_mfma_f32_16x16x32_bf16 v[84:87], a[180:183], v[128:131], v[84:87]
    buffer_load_dwordx4 v237, s[16:19], s37 offen offset:1024  lds
    buffer_load_dwordx4 v238, s[16:19], s37 offen offset:2048  lds
    buffer_load_dwordx4 v239, s[16:19], s37 offen offset:3072  lds
    ds_read_b64_tr_b16 a[172:173], v231 offset:24576
    ds_read_b64_tr_b16 a[174:175], v231 offset:28672
    v_mfma_f32_16x16x32_bf16 v[88:91], a[184:187], v[128:131], v[88:91]
    s_add_u32 m0, s34, 24576
    s_add_u32 s37, s47, 122880
    ds_read_b64_tr_b16 a[176:177], v232 offset:24576
    ds_read_b64_tr_b16 a[178:179], v232 offset:28672
    v_exp_f32_e32 v136, v136
    v_mfma_f32_16x16x32_bf16 v[92:95], a[188:191], v[128:131], v[92:95]
    buffer_load_dwordx4 v236, s[16:19], s37 offen offset:0  lds
    buffer_load_dwordx4 v237, s[16:19], s37 offen offset:1024  lds
    ds_read_b64_tr_b16 a[180:181], v233 offset:24576
    ds_read_b64_tr_b16 a[182:183], v233 offset:28672
    v_exp_f32_e32 v137, v137
    v_mfma_f32_16x16x32_bf16 v[246:249], v[242:245], v[128:131], v[246:249]
    v_exp_f32_e32 v138, v138
    v_exp_f32_e32 v139, v139
    v_cvt_pk_bf16_f32 v136, v136, v137
    v_exp_f32_e32 v140, v140
    v_exp_f32_e32 v141, v141
    v_cvt_pk_bf16_f32 v137, v138, v139
    v_exp_f32_e32 v142, v142
    v_exp_f32_e32 v143, v143
    v_cvt_pk_bf16_f32 v138, v140, v141
    v_cvt_pk_bf16_f32 v139, v142, v143
    s_waitcnt lgkmcnt(4)
    s_nop 0
    v_mfma_f32_16x16x32_bf16 v[64:67], a[160:163], v[136:139], v[64:67]
    buffer_load_dwordx4 v238, s[16:19], s37 offen offset:2048  lds
    buffer_load_dwordx4 v239, s[16:19], s37 offen offset:3072  lds
    s_add_u32 m0, s34, 28672
    ds_read_b64_tr_b16 a[184:185], v234 offset:24576
    ds_read_b64_tr_b16 a[186:187], v234 offset:28672
    v_mfma_f32_16x16x32_bf16 v[68:71], a[164:167], v[136:139], v[68:71]
    s_add_u32 s37, s47, 143360
    buffer_load_dwordx4 v236, s[16:19], s37 offen offset:0  lds
    ds_read_b64_tr_b16 a[188:189], v235 offset:24576
    ds_read_b64_tr_b16 a[190:191], v235 offset:28672
    v_mfma_f32_16x16x32_bf16 v[72:75], a[168:171], v[136:139], v[72:75]
    buffer_load_dwordx4 v237, s[16:19], s37 offen offset:1024  lds
    buffer_load_dwordx4 v238, s[16:19], s37 offen offset:2048  lds
    v_mfma_f32_16x16x32_bf16 v[76:79], a[172:175], v[136:139], v[76:79]
    buffer_load_dwordx4 v239, s[16:19], s37 offen offset:3072  lds
    s_add_u32 s47, s47, 163840
    s_waitcnt lgkmcnt(0)
    v_mfma_f32_16x16x32_bf16 v[80:83], a[176:179], v[136:139], v[80:83]
    s_waitcnt vmcnt(40)
    s_barrier
    s_mov_b32 s50, s32
    s_add_u32 s34, s32, s38
    s_add_u32 s32, s32, s42
    s_cmp_eq_u32 s32, 159744
    s_cselect_b32 s33, s43, s42
    s_cselect_b32 s32, 0, s32
    v_add_u32_e32 v228, s33, v228
    ds_read_b64_tr_b16 a[160:161], v228 offset:16384
    ds_read_b64_tr_b16 a[162:163], v228 offset:20480
    ds_read_b64_tr_b16 a[164:165], v228 offset:24576
    ds_read_b64_tr_b16 a[166:167], v228 offset:28672
    v_add_u32_e32 v229, s33, v229
    ds_read_b64_tr_b16 a[168:169], v229 offset:16384
    ds_read_b64_tr_b16 a[170:171], v229 offset:20480
    v_mfma_f32_16x16x32_bf16 v[84:87], a[180:183], v[136:139], v[84:87]
    ds_read_b64_tr_b16 a[172:173], v229 offset:24576
    ds_read_b64_tr_b16 a[174:175], v229 offset:28672
    v_exp_f32_e32 v160, v160
    v_exp_f32_e32 v161, v161
    v_mfma_f32_16x16x32_bf16 v[88:91], a[184:187], v[136:139], v[88:91]
    v_add_u32_e32 v230, s33, v230
    ds_read_b64_tr_b16 a[176:177], v230 offset:16384
    v_mfma_f32_16x16x32_bf16 v[246:249], v[242:245], v[136:139], v[246:249]
    ds_read_b64_tr_b16 a[178:179], v230 offset:20480
    v_mfma_f32_16x16x32_bf16 v[92:95], a[188:191], v[136:139], v[92:95]
    ds_read_b64_tr_b16 a[180:181], v230 offset:24576
    ds_read_b64_tr_b16 a[182:183], v230 offset:28672
    v_exp_f32_e32 v162, v162
    v_exp_f32_e32 v163, v163
    v_cvt_pk_bf16_f32 v160, v160, v161
    v_exp_f32_e32 v164, v164
    v_exp_f32_e32 v165, v165
    v_cvt_pk_bf16_f32 v161, v162, v163
    v_exp_f32_e32 v166, v166
    v_exp_f32_e32 v167, v167
    v_cvt_pk_bf16_f32 v162, v164, v165
    v_cvt_pk_bf16_f32 v163, v166, v167
    v_exp_f32_e32 v168, v168
    v_exp_f32_e32 v169, v169
    v_mfma_f32_16x16x32_bf16 v[246:249], v[242:245], v[160:163], v[246:249]
    v_exp_f32_e32 v170, v170
    v_exp_f32_e32 v171, v171
    v_cvt_pk_bf16_f32 v168, v168, v169
    v_exp_f32_e32 v172, v172
    v_exp_f32_e32 v173, v173
    v_cvt_pk_bf16_f32 v169, v170, v171
    v_exp_f32_e32 v174, v174
    v_exp_f32_e32 v175, v175
    v_cvt_pk_bf16_f32 v170, v172, v173
    v_cvt_pk_bf16_f32 v171, v174, v175
    s_nop 1
    v_mfma_f32_16x16x32_bf16 v[246:249], v[242:245], v[168:171], v[246:249]
    s_waitcnt lgkmcnt(4)
    v_mfma_f32_16x16x32_bf16 v[64:67], a[160:163], v[160:163], v[64:67]
    v_mbcnt_lo_u32_b32 v0, -1, 0
    v_mbcnt_hi_u32_b32 v0, -1, v0
    v_and_b32_e32 v3, 15, v0
    v_lshrrev_b32_e32 v4, 4, v0
    s_lshl_b32 s7, s28, 11
    v_lshlrev_b32_e32 v11, 4, v0
    v_add_u32_e32 v224, s7, v11
    s_mov_b32 s40, 4294938624
    s_mov_b32 s51, 0
    v_lshrrev_b32_e32 v6, 2, v3
    v_and_b32_e32 v7, 3, v0
    v_lshl_add_u32 v9, v4, 2, v6
    v_lshlrev_b32_e32 v9, 8, v9
    v_lshl_add_u32 v9, v7, 3, v9
    v_and_b32_e32 v8, 1, v4
    v_lshl_add_u32 v8, v6, 1, v8
    v_xor_b32_e32 v11, 0, v8
    v_lshl_add_u32 v50, v11, 5, v9
    v_add_u32_e32 v225, 0x10000, v50
    v_xor_b32_e32 v11, 1, v8
    v_lshl_add_u32 v51, v11, 5, v9
    v_add_u32_e32 v226, 0x10000, v51
    v_xor_b32_e32 v11, 2, v8
    v_lshl_add_u32 v52, v11, 5, v9
    v_add_u32_e32 v227, 0x10000, v52
    v_xor_b32_e32 v11, 3, v8
    v_lshl_add_u32 v53, v11, 5, v9
    v_add_u32_e32 v240, 0x10000, v53
    v_xor_b32_e32 v11, 4, v8
    v_lshl_add_u32 v54, v11, 5, v9
    v_add_u32_e32 v241, 0x10000, v54
    v_xor_b32_e32 v11, 5, v8
    v_lshl_add_u32 v55, v11, 5, v9
    v_add_u32_e32 v242, 0x10000, v55
    v_xor_b32_e32 v11, 6, v8
    v_lshl_add_u32 v56, v11, 5, v9
    v_add_u32_e32 v243, 0x10000, v56
    v_xor_b32_e32 v11, 7, v8
    v_lshl_add_u32 v57, v11, 5, v9
    v_add_u32_e32 v244, 0x10000, v57
    s_mov_b32 s42, 32768
    s_mov_b32 s43, 4294836224
    s_add_u32 s34, s38, 98304
    s_add_u32 m0, s34, 12288
    s_add_u32 s37, s47, 61440
    buffer_load_dwordx4 v236, s[16:19], s37 offen offset:0  lds
    v_add_u32_e32 v231, s33, v231
    ds_read_b64_tr_b16 a[184:185], v231 offset:16384
    ds_read_b64_tr_b16 a[186:187], v231 offset:20480
    v_mfma_f32_16x16x32_bf16 v[64:67], a[164:167], v[168:171], v[64:67]
    buffer_load_dwordx4 v237, s[16:19], s37 offen offset:1024  lds
    buffer_load_dwordx4 v238, s[16:19], s37 offen offset:2048  lds
    buffer_load_dwordx4 v239, s[16:19], s37 offen offset:3072  lds
    ds_read_b64_tr_b16 a[188:189], v231 offset:24576
    ds_read_b64_tr_b16 a[190:191], v231 offset:28672
    s_mov_b64 s[44:45], -1
    v_cmp_le_f32_e32 vcc, 0x33800000, v246
    s_nop 0
    s_and_b64 s[44:45], s[44:45], vcc
    v_cmp_ge_f32_e32 vcc, 0x4b800000, v246
    s_nop 0
    s_and_b64 s[44:45], s[44:45], vcc
    s_cmp_eq_u64 s[44:45], -1
    s_cbranch_scc1 A_B_fast_ok1
    s_mov_b32 s87, 1
    s_branch A_B_slow
A_B_slow_ret1:
A_B_fast_ok1:
    v_rcp_f32_e32 v246, v246
    v_mfma_f32_16x16x32_bf16 v[68:71], a[168:171], v[160:163], v[68:71]
    s_add_u32 m0, s34, 16384
    s_add_u32 s37, s47, 81920
    buffer_load_dwordx4 v236, s[16:19], s37 offen offset:0  lds
    v_add_u32_e32 v232, s33, v232
    ds_read_b64_tr_b16 a[160:161], v232 offset:16384
    ds_read_b64_tr_b16 a[162:163], v232 offset:20480
    v_mfma_f32_16x16x32_bf16 v[68:71], a[172:175], v[168:171], v[68:71]
    buffer_load_dwordx4 v237, s[16:19], s37 offen offset:1024  lds
    buffer_load_dwordx4 v238, s[16:19], s37 offen offset:2048  lds
    buffer_load_dwordx4 v239, s[16:19], s37 offen offset:3072  lds
    ds_read_b64_tr_b16 a[164:165], v232 offset:24576
    ds_read_b64_tr_b16 a[166:167], v232 offset:28672
    s_waitcnt lgkmcnt(4)
    v_mfma_f32_16x16x32_bf16 v[72:75], a[176:179], v[160:163], v[72:75]
    s_add_u32 m0, s34, 20480
    s_add_u32 s37, s47, 102400
    buffer_load_dwordx4 v236, s[16:19], s37 offen offset:0  lds
    v_add_u32_e32 v233, s33, v233
    ds_read_b64_tr_b16 a[168:169], v233 offset:16384
    ds_read_b64_tr_b16 a[170:171], v233 offset:20480
    v_mfma_f32_16x16x32_bf16 v[72:75], a[180:183], v[168:171], v[72:75]
    buffer_load_dwordx4 v237, s[16:19], s37 offen offset:1024  lds
    buffer_load_dwordx4 v238, s[16:19], s37 offen offset:2048  lds
    buffer_load_dwordx4 v239, s[16:19], s37 offen offset:3072  lds
    s_add_u32 m0, s34, 24576
    ds_read_b64_tr_b16 a[172:173], v233 offset:24576
    ds_read_b64_tr_b16 a[174:175], v233 offset:28672
    v_mfma_f32_16x16x32_bf16 v[76:79], a[184:187], v[160:163], v[76:79]
    s_add_u32 s37, s47, 122880
    buffer_load_dwordx4 v236, s[16:19], s37 offen offset:0  lds
    buffer_load_dwordx4 v237, s[16:19], s37 offen offset:1024  lds
    v_add_u32_e32 v234, s33, v234
    ds_read_b64_tr_b16 a[176:177], v234 offset:16384
    ds_read_b64_tr_b16 a[178:179], v234 offset:20480
    v_mfma_f32_16x16x32_bf16 v[76:79], a[188:191], v[168:171], v[76:79]
    buffer_load_dwordx4 v238, s[16:19], s37 offen offset:2048  lds
    buffer_load_dwordx4 v239, s[16:19], s37 offen offset:3072  lds
    s_add_u32 m0, s34, 28672
    ds_read_b64_tr_b16 a[180:181], v234 offset:24576
    ds_read_b64_tr_b16 a[182:183], v234 offset:28672
    s_waitcnt lgkmcnt(4)
    v_mfma_f32_16x16x32_bf16 v[80:83], a[160:163], v[160:163], v[80:83]
    s_add_u32 s37, s47, 143360
    buffer_load_dwordx4 v236, s[16:19], s37 offen offset:0  lds
    buffer_load_dwordx4 v237, s[16:19], s37 offen offset:1024  lds
    v_add_u32_e32 v235, s33, v235
    ds_read_b64_tr_b16 a[184:185], v235 offset:16384
    ds_read_b64_tr_b16 a[186:187], v235 offset:20480
    v_mfma_f32_16x16x32_bf16 v[80:83], a[164:167], v[168:171], v[80:83]
    buffer_load_dwordx4 v238, s[16:19], s37 offen offset:2048  lds
    buffer_load_dwordx4 v239, s[16:19], s37 offen offset:3072  lds
    s_add_u32 s47, s47, 163840
    ds_read_b64_tr_b16 a[188:189], v235 offset:24576
    ds_read_b64_tr_b16 a[190:191], v235 offset:28672
    v_mfma_f32_16x16x32_bf16 v[84:87], a[168:171], v[160:163], v[84:87]
    v_mul_f32_e32 v64, v246, v64
    v_mul_f32_e32 v65, v246, v65
    v_mul_f32_e32 v66, v246, v66
    v_mul_f32_e32 v67, v246, v67
    v_mul_f32_e32 v68, v246, v68
    v_mul_f32_e32 v69, v246, v69
    v_mfma_f32_16x16x32_bf16 v[84:87], a[172:175], v[168:171], v[84:87]
    v_mul_f32_e32 v70, v246, v70
    v_mul_f32_e32 v71, v246, v71
    v_cvt_pk_bf16_f32 v64, v64, v65
    v_cvt_pk_bf16_f32 v65, v66, v67
    v_cvt_pk_bf16_f32 v66, v68, v69
    v_cvt_pk_bf16_f32 v67, v70, v71
    s_waitcnt lgkmcnt(0)
    v_mfma_f32_16x16x32_bf16 v[88:91], a[176:179], v[160:163], v[88:91]
    s_waitcnt vmcnt(40)
    s_barrier
    ds_read_b64_tr_b16 a[160:161], v50 offset:32768
    ds_read_b64_tr_b16 a[162:163], v50 offset:36864
    ds_read_b64_tr_b16 a[164:165], v50 offset:40960
    ds_read_b64_tr_b16 a[166:167], v50 offset:45056
    ds_read_b64_tr_b16 a[168:169], v50 offset:49152
    ds_read_b64_tr_b16 a[170:171], v50 offset:53248
    v_mfma_f32_16x16x32_bf16 v[88:91], a[180:183], v[168:171], v[88:91]
    v_mul_f32_e32 v72, v246, v72
    v_mul_f32_e32 v73, v246, v73
    v_mul_f32_e32 v74, v246, v74
    v_mul_f32_e32 v75, v246, v75
    v_mul_f32_e32 v76, v246, v76
    v_mul_f32_e32 v77, v246, v77
    v_mfma_f32_16x16x32_bf16 v[92:95], a[184:187], v[160:163], v[92:95]
    v_mul_f32_e32 v78, v246, v78
    v_mul_f32_e32 v79, v246, v79
    v_cvt_pk_bf16_f32 v72, v72, v73
    v_cvt_pk_bf16_f32 v73, v74, v75
    v_cvt_pk_bf16_f32 v74, v76, v77
    v_cvt_pk_bf16_f32 v75, v78, v79
    v_mfma_f32_16x16x32_bf16 v[92:95], a[188:191], v[168:171], v[92:95]
    v_mul_f32_e32 v80, v246, v80
    v_mul_f32_e32 v81, v246, v81
    v_mul_f32_e32 v82, v246, v82
    v_mul_f32_e32 v83, v246, v83
    v_mul_f32_e32 v84, v246, v84
    v_mul_f32_e32 v85, v246, v85
    v_mul_f32_e32 v86, v246, v86
    v_mul_f32_e32 v87, v246, v87
    v_cvt_pk_bf16_f32 v80, v80, v81
    v_cvt_pk_bf16_f32 v81, v82, v83
    v_cvt_pk_bf16_f32 v82, v84, v85
    v_cvt_pk_bf16_f32 v83, v86, v87
    v_mul_f32_e32 v88, v246, v88
    v_mul_f32_e32 v89, v246, v89
    v_mul_f32_e32 v90, v246, v90
    v_mul_f32_e32 v91, v246, v91
    v_mul_f32_e32 v92, v246, v92
    v_mul_f32_e32 v93, v246, v93
    v_mul_f32_e32 v94, v246, v94
    v_mul_f32_e32 v95, v246, v95
    v_cvt_pk_bf16_f32 v88, v88, v89
    v_cvt_pk_bf16_f32 v89, v90, v91
    v_cvt_pk_bf16_f32 v90, v92, v93
    v_cvt_pk_bf16_f32 v91, v94, v95
    v_accvgpr_write_b32 a32, v64
    v_accvgpr_write_b32 a33, v65
    v_accvgpr_write_b32 a34, v66
    v_accvgpr_write_b32 a35, v67
    v_accvgpr_write_b32 a36, v72
    v_accvgpr_write_b32 a37, v73
    v_accvgpr_write_b32 a38, v74
    v_accvgpr_write_b32 a39, v75
    v_accvgpr_write_b32 a40, v80
    v_accvgpr_write_b32 a41, v81
    v_accvgpr_write_b32 a42, v82
    v_accvgpr_write_b32 a43, v83
    v_accvgpr_write_b32 a44, v88
    v_accvgpr_write_b32 a45, v89
    v_accvgpr_write_b32 a46, v90
    v_accvgpr_write_b32 a47, v91
    v_mbcnt_lo_u32_b32 v0, -1, 0
    v_mbcnt_hi_u32_b32 v0, -1, v0
    v_and_b32_e32 v3, 15, v0
    v_lshrrev_b32_e32 v4, 4, v0
    s_lshl_b32 s60, s5, 4
    s_add_u32 s60, s60, s4
    s_mul_i32 s61, s60, 1146880
    s_add_u32 s8, s68, s61
    s_addc_u32 s9, s69, 0
    s_mov_b32 s10, 1146880
    s_mov_b32 s11, 0x20000
    s_mov_b32 s12, s100
    s_mov_b32 s13, s101
    s_mov_b32 s14, 4587520
    s_mov_b32 s15, 0x20000
    s_mov_b32 s96, s90
    s_mov_b32 s97, s91
    s_mov_b32 s98, 256
    s_mov_b32 s99, 0x20000
    s_lshl_b32 s61, s60, 2
    v_mov_b32_e32 v114, s61
    s_add_u32 s96, s68, 36700160
    s_addc_u32 s97, s69, 0
    s_mov_b32 s98, 8192
    s_lshl_b32 s62, s6, 2
    s_add_u32 s62, s62, s28
    s_lshr_b32 s63, s62, 1
    s_and_b32 s64, s62, 1
    s_cmp_ge_u32 s63, 7
    s_cselect_b32 s65, 1, 0
    s_mul_i32 s66, s65, 7
    s_sub_u32 s66, s63, s66
    s_lshl_b32 s67, s65, 1
    s_add_u32 s67, s67, s64
    s_mul_i32 s67, s67, 7
    s_add_u32 s67, s67, s66
    s_lshl_b32 s52, s67, 10
    s_mul_i32 s61, s4, 286720
    s_mul_i32 s67, s5, 1280
    s_add_u32 s61, s61, s67
    s_mul_i32 s67, s66, 40960
    s_add_u32 s61, s61, s67
    s_lshl_b32 s67, s65, 7
    s_add_u32 s61, s61, s67
    s_lshl_b32 s67, s64, 6
    s_add_u32 s53, s61, s67
    s_sub_u32 s52, s52, 57344
    s_sub_u32 s53, s53, 768
    s_cmp_lt_u32 s62, 28
    s_cselect_b32 s52, s52, 1073741824
    s_cselect_b32 s53, s53, 1073741824
    v_lshlrev_b32_e32 v110, 4, v0
    v_mul_u32_u24_e32 v111, 2560, v3
    v_lshl_add_u32 v111, v4, 4, v111
    s_lshl_b32 s61, s60, 8
    v_mov_b32_e32 v114, s61
    v_cmp_eq_u32_e32 vcc, 0, v0
    v_mov_b32_e32 v5, 1073741824
    s_nop 0
    v_cndmask_b32_e32 v113, v5, v114, vcc
A_B_ng:
    s_waitcnt lgkmcnt(0)
    v_mfma_f32_16x16x32_bf16 v[0:3], a[160:163], a[192:195], 0
    s_cmp_eq_u32 s51, 0
    s_cselect_b32 s22, 0, 143360
    s_sub_u32 s56, s51, 2
    s_lshl_b32 s56, s56, 2
    s_lshl_b32 s56, 1, s56
    s_cmp_ge_u32 s51, 2
    s_cselect_b32 s56, s56, 0
    v_mov_b32_e32 v112, s56
    buffer_atomic_add v112, v113, s[96:99], 0 offen sc1
    s_add_u32 m0, s38, 12288
    s_add_u32 s37, s47, 61440
    ds_read_b64_tr_b16 a[172:173], v50 offset:57344
    ds_read_b64_tr_b16 a[174:175], v50 offset:61440
    ds_read_b64_tr_b16 a[176:177], v51 offset:32768
    ds_read_b64_tr_b16 a[178:179], v51 offset:36864
    ds_read_b64_tr_b16 a[180:181], v51 offset:40960
    ds_read_b64_tr_b16 a[182:183], v51 offset:45056
    ds_read_b64_tr_b16 a[184:185], v51 offset:49152
    ds_read_b64_tr_b16 a[186:187], v51 offset:53248
    v_mfma_f32_16x16x32_bf16 v[0:3], a[164:167], a[196:199], v[0:3]
    buffer_load_dwordx4 v236, s[16:19], s37 offen offset:0  lds
    ds_read_b64_tr_b16 a[188:189], v51 offset:57344
    ds_read_b64_tr_b16 a[190:191], v51 offset:61440
    v_mfma_f32_16x16x32_bf16 v[0:3], a[168:171], a[200:203], v[0:3]
    buffer_load_dwordx4 v237, s[16:19], s37 offen offset:1024  lds
    ds_read_b64_tr_b16 a[160:161], v52 offset:32768
    ds_read_b64_tr_b16 a[162:163], v52 offset:36864
    s_waitcnt lgkmcnt(10)
    v_mfma_f32_16x16x32_bf16 v[0:3], a[172:175], a[204:207], v[0:3]
    buffer_load_dwordx4 v238, s[16:19], s37 offen offset:2048  lds
    ds_read_b64_tr_b16 a[164:165], v52 offset:40960
    ds_read_b64_tr_b16 a[166:167], v52 offset:45056
    s_waitcnt lgkmcnt(4)
    v_mfma_f32_16x16x32_bf16 v[4:7], a[176:179], a[192:195], 0
    buffer_load_dwordx4 v239, s[16:19], s37 offen offset:3072  lds
    ds_read_b64_tr_b16 a[168:169], v52 offset:49152
    ds_read_b64_tr_b16 a[170:171], v52 offset:53248
    v_mfma_f32_16x16x32_bf16 v[4:7], a[180:183], a[196:199], v[4:7]
    s_add_u32 m0, s38, 16384
    ds_read_b64_tr_b16 a[172:173], v52 offset:57344
    ds_read_b64_tr_b16 a[174:175], v52 offset:61440
    v_mfma_f32_16x16x32_bf16 v[4:7], a[184:187], a[200:203], v[4:7]
    s_add_u32 s37, s47, 81920
    ds_read_b64_tr_b16 a[176:177], v53 offset:32768
    ds_read_b64_tr_b16 a[178:179], v53 offset:36864
    v_mfma_f32_16x16x32_bf16 v[4:7], a[188:191], a[204:207], v[4:7]
    buffer_load_dwordx4 v236, s[16:19], s37 offen offset:0  lds
    ds_read_b64_tr_b16 a[180:181], v53 offset:40960
    ds_read_b64_tr_b16 a[182:183], v53 offset:45056
    s_waitcnt lgkmcnt(4)
    v_mfma_f32_16x16x32_bf16 v[8:11], a[160:163], a[192:195], 0
    buffer_load_dwordx4 v237, s[16:19], s37 offen offset:1024  lds
    ds_read_b64_tr_b16 a[184:185], v53 offset:49152
    ds_read_b64_tr_b16 a[186:187], v53 offset:53248
    v_mfma_f32_16x16x32_bf16 v[8:11], a[164:167], a[196:199], v[8:11]
    buffer_load_dwordx4 v238, s[16:19], s37 offen offset:2048  lds
    buffer_load_dwordx4 v239, s[16:19], s37 offen offset:3072  lds
    ds_read_b64_tr_b16 a[188:189], v53 offset:57344
    ds_read_b64_tr_b16 a[190:191], v53 offset:61440
    v_mfma_f32_16x16x32_bf16 v[8:11], a[168:171], a[200:203], v[8:11]
    s_add_u32 m0, s38, 20480
    ds_read_b64_tr_b16 a[160:161], v54 offset:32768
    ds_read_b64_tr_b16 a[162:163], v54 offset:36864
    v_mfma_f32_16x16x32_bf16 v[8:11], a[172:175], a[204:207], v[8:11]
    s_add_u32 s37, s47, 102400
    ds_read_b64_tr_b16 a[164:165], v54 offset:40960
    ds_read_b64_tr_b16 a[166:167], v54 offset:45056
    s_waitcnt lgkmcnt(4)
    v_mfma_f32_16x16x32_bf16 v[12:15], a[176:179], a[192:195], 0
    s_add_u32 s36, s40, 0
    buffer_store_dwordx4 v[128:131], v224, s[20:23], s36 offen sc0 sc1
    buffer_load_dwordx4 v236, s[16:19], s37 offen offset:0  lds
    ds_read_b64_tr_b16 a[168:169], v54 offset:49152
    ds_read_b64_tr_b16 a[170:171], v54 offset:53248
    v_mfma_f32_16x16x32_bf16 v[12:15], a[180:183], a[196:199], v[12:15]
    buffer_load_dwordx4 v237, s[16:19], s37 offen offset:1024  lds
    ds_read_b64_tr_b16 a[172:173], v54 offset:57344
    ds_read_b64_tr_b16 a[174:175], v54 offset:61440
    v_mfma_f32_16x16x32_bf16 v[12:15], a[184:187], a[200:203], v[12:15]
    buffer_load_dwordx4 v238, s[16:19], s37 offen offset:2048  lds
    ds_read_b64_tr_b16 a[176:177], v55 offset:32768
    ds_read_b64_tr_b16 a[178:179], v55 offset:36864
    v_mfma_f32_16x16x32_bf16 v[12:15], a[188:191], a[204:207], v[12:15]
    buffer_load_dwordx4 v239, s[16:19], s37 offen offset:3072  lds
    ds_read_b64_tr_b16 a[180:181], v55 offset:40960
    ds_read_b64_tr_b16 a[182:183], v55 offset:45056
    s_waitcnt lgkmcnt(4)
    v_mfma_f32_16x16x32_bf16 v[16:19], a[160:163], a[192:195], 0
    s_add_u32 m0, s38, 24576
    ds_read_b64_tr_b16 a[184:185], v55 offset:49152
    ds_read_b64_tr_b16 a[186:187], v55 offset:53248
    v_mfma_f32_16x16x32_bf16 v[16:19], a[164:167], a[196:199], v[16:19]
    s_add_u32 s37, s47, 122880
    ds_read_b64_tr_b16 a[188:189], v55 offset:57344
    ds_read_b64_tr_b16 a[190:191], v55 offset:61440
    v_mfma_f32_16x16x32_bf16 v[16:19], a[168:171], a[200:203], v[16:19]
    buffer_load_dwordx4 v236, s[16:19], s37 offen offset:0  lds
    buffer_load_dwordx4 v237, s[16:19], s37 offen offset:1024  lds
    ds_read_b64_tr_b16 a[160:161], v56 offset:32768
    ds_read_b64_tr_b16 a[162:163], v56 offset:36864
    v_mfma_f32_16x16x32_bf16 v[16:19], a[172:175], a[204:207], v[16:19]
    buffer_load_dwordx4 v238, s[16:19], s37 offen offset:2048  lds
    ds_read_b64_tr_b16 a[164:165], v56 offset:40960
    ds_read_b64_tr_b16 a[166:167], v56 offset:45056
    s_waitcnt lgkmcnt(4)
    v_mfma_f32_16x16x32_bf16 v[20:23], a[176:179], a[192:195], 0
    buffer_load_dwordx4 v239, s[16:19], s37 offen offset:3072  lds
    ds_read_b64_tr_b16 a[168:169], v56 offset:49152
    ds_read_b64_tr_b16 a[170:171], v56 offset:53248
    v_mfma_f32_16x16x32_bf16 v[20:23], a[180:183], a[196:199], v[20:23]
    s_add_u32 m0, s38, 28672
    ds_read_b64_tr_b16 a[172:173], v56 offset:57344
    ds_read_b64_tr_b16 a[174:175], v56 offset:61440
    v_mfma_f32_16x16x32_bf16 v[20:23], a[184:187], a[200:203], v[20:23]
    s_add_u32 s37, s47, 143360
    ds_read_b64_tr_b16 a[176:177], v57 offset:32768
    ds_read_b64_tr_b16 a[178:179], v57 offset:36864
    v_mfma_f32_16x16x32_bf16 v[20:23], a[188:191], a[204:207], v[20:23]
    buffer_load_dwordx4 v236, s[16:19], s37 offen offset:0  lds
    ds_read_b64_tr_b16 a[180:181], v57 offset:40960
    ds_read_b64_tr_b16 a[182:183], v57 offset:45056
    s_waitcnt lgkmcnt(4)
    v_mfma_f32_16x16x32_bf16 v[24:27], a[160:163], a[192:195], 0
    buffer_load_dwordx4 v237, s[16:19], s37 offen offset:1024  lds
    ds_read_b64_tr_b16 a[184:185], v57 offset:49152
    ds_read_b64_tr_b16 a[186:187], v57 offset:53248
    v_mfma_f32_16x16x32_bf16 v[24:27], a[164:167], a[196:199], v[24:27]
    buffer_load_dwordx4 v238, s[16:19], s37 offen offset:2048  lds
    ds_read_b64_tr_b16 a[188:189], v57 offset:57344
    ds_read_b64_tr_b16 a[190:191], v57 offset:61440
    v_mfma_f32_16x16x32_bf16 v[24:27], a[168:171], a[200:203], v[24:27]
    buffer_load_dwordx4 v239, s[16:19], s37 offen offset:3072  lds
    v_mfma_f32_16x16x32_bf16 v[24:27], a[172:175], a[204:207], v[24:27]
    s_add_u32 s47, s47, 4294476032
    s_waitcnt lgkmcnt(0)
    v_mfma_f32_16x16x32_bf16 v[28:31], a[176:179], a[192:195], 0
    s_waitcnt vmcnt(42)
    s_barrier
    ds_read_b64_tr_b16 a[160:161], v225 offset:0
    ds_read_b64_tr_b16 a[162:163], v225 offset:4096
    ds_read_b64_tr_b16 a[164:165], v226 offset:0
    ds_read_b64_tr_b16 a[166:167], v226 offset:4096
    ds_read_b64_tr_b16 a[168:169], v227 offset:0
    ds_read_b64_tr_b16 a[170:171], v227 offset:4096
    v_mfma_f32_16x16x32_bf16 v[28:31], a[180:183], a[196:199], v[28:31]
    ds_read_b64_tr_b16 a[172:173], v240 offset:0
    ds_read_b64_tr_b16 a[174:175], v240 offset:4096
    v_mfma_f32_16x16x32_bf16 v[28:31], a[184:187], a[200:203], v[28:31]
    ds_read_b64_tr_b16 a[176:177], v241 offset:0
    ds_read_b64_tr_b16 a[178:179], v241 offset:4096
    v_mfma_f32_16x16x32_bf16 v[28:31], a[188:191], a[204:207], v[28:31]
    ds_read_b64_tr_b16 a[180:181], v242 offset:0
    ds_read_b64_tr_b16 a[182:183], v242 offset:4096
    s_waitcnt lgkmcnt(4)
    v_mfma_f32_16x16x32_bf16 v[0:3], a[160:163], a[224:227], v[0:3]
    s_cmp_ge_u32 s51, 4
    s_cselect_b32 s18, 0, s18
    s_add_u32 m0, s38, 45056
    ds_read_b64_tr_b16 a[184:185], v243 offset:0
    ds_read_b64_tr_b16 a[186:187], v243 offset:4096
    v_mfma_f32_16x16x32_bf16 v[4:7], a[164:167], a[224:227], v[4:7]
    s_add_u32 s37, s47, 61440
    ds_read_b64_tr_b16 a[188:189], v244 offset:0
    ds_read_b64_tr_b16 a[190:191], v244 offset:4096
    v_mfma_f32_16x16x32_bf16 v[8:11], a[168:171], a[224:227], v[8:11]
    buffer_load_dwordx4 v236, s[16:19], s37 offen offset:0  lds
    ds_read_b64_tr_b16 a[160:161], v225 offset:8192
    ds_read_b64_tr_b16 a[162:163], v225 offset:12288
    v_mfma_f32_16x16x32_bf16 v[12:15], a[172:175], a[224:227], v[12:15]
    buffer_load_dwordx4 v237, s[16:19], s37 offen offset:1024  lds
    ds_read_b64_tr_b16 a[164:165], v226 offset:8192
    ds_read_b64_tr_b16 a[166:167], v226 offset:12288
    s_waitcnt lgkmcnt(4)
    v_mfma_f32_16x16x32_bf16 v[16:19], a[176:179], a[224:227], v[16:19]
    s_add_u32 s36, s40, 7168
    buffer_store_dwordx4 v[132:135], v224, s[20:23], s36 offen sc0 sc1
    buffer_load_dwordx4 v238, s[16:19], s37 offen offset:2048  lds
    ds_read_b64_tr_b16 a[168:169], v227 offset:8192
    ds_read_b64_tr_b16 a[170:171], v227 offset:12288
    v_mfma_f32_16x16x32_bf16 v[20:23], a[180:183], a[224:227], v[20:23]
    buffer_load_dwordx4 v239, s[16:19], s37 offen offset:3072  lds
    ds_read_b64_tr_b16 a[172:173], v240 offset:8192
    ds_read_b64_tr_b16 a[174:175], v240 offset:12288
    v_mfma_f32_16x16x32_bf16 v[24:27], a[184:187], a[224:227], v[24:27]
    s_cmp_lt_u32 s51, 3
    s_cbranch_scc1 A_sum_done4
    s_waitcnt vmcnt(42)
    v_lshlrev_b32_e32 v96, 16, v64
    v_and_b32_e32 v97, 0xffff0000, v64
    v_lshlrev_b32_e32 v98, 16, v65
    v_and_b32_e32 v99, 0xffff0000, v65
    v_lshlrev_b32_e32 v100, 16, v66
    v_and_b32_e32 v101, 0xffff0000, v66
    v_lshlrev_b32_e32 v102, 16, v67
    v_and_b32_e32 v103, 0xffff0000, v67
    v_lshlrev_b32_e32 v108, 16, v68
    v_and_b32_e32 v109, 0xffff0000, v68
    v_add_f32_e32 v96, v96, v108
    v_add_f32_e32 v97, v97, v109
    v_lshlrev_b32_e32 v108, 16, v69
    v_and_b32_e32 v109, 0xffff0000, v69
    v_add_f32_e32 v98, v98, v108
    v_add_f32_e32 v99, v99, v109
    v_lshlrev_b32_e32 v108, 16, v70
    v_and_b32_e32 v109, 0xffff0000, v70
    v_add_f32_e32 v100, v100, v108
    v_add_f32_e32 v101, v101, v109
    v_lshlrev_b32_e32 v108, 16, v71
    v_and_b32_e32 v109, 0xffff0000, v71
    v_add_f32_e32 v102, v102, v108
    v_add_f32_e32 v103, v103, v109
    v_lshlrev_b32_e32 v108, 16, v72
    v_and_b32_e32 v109, 0xffff0000, v72
    v_add_f32_e32 v96, v96, v108
    v_add_f32_e32 v97, v97, v109
    v_lshlrev_b32_e32 v108, 16, v73
    v_and_b32_e32 v109, 0xffff0000, v73
    v_add_f32_e32 v98, v98, v108
    v_add_f32_e32 v99, v99, v109
    v_lshlrev_b32_e32 v108, 16, v74
    v_and_b32_e32 v109, 0xffff0000, v74
    v_add_f32_e32 v100, v100, v108
    v_add_f32_e32 v101, v101, v109
    v_lshlrev_b32_e32 v108, 16, v75
    v_and_b32_e32 v109, 0xffff0000, v75
    v_add_f32_e32 v102, v102, v108
    v_add_f32_e32 v103, v103, v109
    v_lshlrev_b32_e32 v108, 16, v76
    v_and_b32_e32 v109, 0xffff0000, v76
    v_add_f32_e32 v96, v96, v108
    v_add_f32_e32 v97, v97, v109
    v_lshlrev_b32_e32 v108, 16, v77
    v_and_b32_e32 v109, 0xffff0000, v77
    v_add_f32_e32 v98, v98, v108
    v_add_f32_e32 v99, v99, v109
    v_lshlrev_b32_e32 v108, 16, v78
    v_and_b32_e32 v109, 0xffff0000, v78
    v_add_f32_e32 v100, v100, v108
    v_add_f32_e32 v101, v101, v109
    v_lshlrev_b32_e32 v108, 16, v79
    v_and_b32_e32 v109, 0xffff0000, v79
    v_add_f32_e32 v102, v102, v108
    v_add_f32_e32 v103, v103, v109
    v_lshlrev_b32_e32 v108, 16, v80
    v_and_b32_e32 v109, 0xffff0000, v80
    v_add_f32_e32 v96, v96, v108
    v_add_f32_e32 v97, v97, v109
    v_lshlrev_b32_e32 v108, 16, v81
    v_and_b32_e32 v109, 0xffff0000, v81
    v_add_f32_e32 v98, v98, v108
    v_add_f32_e32 v99, v99, v109
    v_lshlrev_b32_e32 v108, 16, v82
    v_and_b32_e32 v109, 0xffff0000, v82
    v_add_f32_e32 v100, v100, v108
    v_add_f32_e32 v101, v101, v109
    v_lshlrev_b32_e32 v108, 16, v83
    v_and_b32_e32 v109, 0xffff0000, v83
    v_add_f32_e32 v102, v102, v108
    v_add_f32_e32 v103, v103, v109
    v_lshlrev_b32_e32 v108, 16, v84
    v_and_b32_e32 v109, 0xffff0000, v84
    v_add_f32_e32 v96, v96, v108
    v_add_f32_e32 v97, v97, v109
    v_lshlrev_b32_e32 v108, 16, v85
    v_and_b32_e32 v109, 0xffff0000, v85
    v_add_f32_e32 v98, v98, v108
    v_add_f32_e32 v99, v99, v109
    v_lshlrev_b32_e32 v108, 16, v86
    v_and_b32_e32 v109, 0xffff0000, v86
    v_add_f32_e32 v100, v100, v108
    v_add_f32_e32 v101, v101, v109
    v_lshlrev_b32_e32 v108, 16, v87
    v_and_b32_e32 v109, 0xffff0000, v87
    v_add_f32_e32 v102, v102, v108
    v_add_f32_e32 v103, v103, v109
    v_lshlrev_b32_e32 v108, 16, v88
    v_and_b32_e32 v109, 0xffff0000, v88
    v_add_f32_e32 v96, v96, v108
    v_add_f32_e32 v97, v97, v109
    v_lshlrev_b32_e32 v108, 16, v89
    v_and_b32_e32 v109, 0xffff0000, v89
    v_add_f32_e32 v98, v98, v108
    v_add_f32_e32 v99, v99, v109
    v_lshlrev_b32_e32 v108, 16, v90
    v_and_b32_e32 v109, 0xffff0000, v90
    v_add_f32_e32 v100, v100, v108
    v_add_f32_e32 v101, v101, v109
    v_lshlrev_b32_e32 v108, 16, v91
    v_and_b32_e32 v109, 0xffff0000, v91
    v_add_f32_e32 v102, v102, v108
    v_add_f32_e32 v103, v103, v109
    s_waitcnt vmcnt(42)
    v_lshlrev_b32_e32 v108, 16, v92
    v_and_b32_e32 v109, 0xffff0000, v92
    v_add_f32_e32 v96, v96, v108
    v_add_f32_e32 v97, v97, v109
    v_lshlrev_b32_e32 v108, 16, v93
    v_and_b32_e32 v109, 0xffff0000, v93
    v_add_f32_e32 v98, v98, v108
    v_add_f32_e32 v99, v99, v109
    v_lshlrev_b32_e32 v108, 16, v94
    v_and_b32_e32 v109, 0xffff0000, v94
    v_add_f32_e32 v100, v100, v108
    v_add_f32_e32 v101, v101, v109
    v_lshlrev_b32_e32 v108, 16, v95
    v_and_b32_e32 v109, 0xffff0000, v95
    v_add_f32_e32 v102, v102, v108
    v_add_f32_e32 v103, v103, v109
    v_cvt_pk_bf16_f32 v104, v96, v97
    v_cvt_pk_bf16_f32 v105, v98, v99
    v_cvt_pk_bf16_f32 v106, v100, v101
    v_cvt_pk_bf16_f32 v107, v102, v103
    s_nop 0
    v_permlane32_swap_b32_e32 v104, v106
    v_permlane32_swap_b32_e32 v105, v107
    s_nop 0
    v_permlane16_swap_b32_e32 v104, v106
    v_permlane16_swap_b32_e32 v105, v107
    buffer_store_dwordx4 v[104:107], v111, s[12:15], s53 offen sc0 sc1
A_sum_done4:
    s_add_u32 m0, s38, 49152
    ds_read_b64_tr_b16 a[176:177], v241 offset:8192
    ds_read_b64_tr_b16 a[178:179], v241 offset:12288
    v_mfma_f32_16x16x32_bf16 v[28:31], a[188:191], a[224:227], v[28:31]
    s_add_u32 s37, s47, 81920
    buffer_load_dwordx4 v236, s[16:19], s37 offen offset:0  lds
    ds_read_b64_tr_b16 a[180:181], v242 offset:8192
    ds_read_b64_tr_b16 a[182:183], v242 offset:12288
    s_waitcnt lgkmcnt(4)
    v_mfma_f32_16x16x32_bf16 v[0:3], a[160:163], a[228:231], v[0:3]
    buffer_load_dwordx4 v237, s[16:19], s37 offen offset:1024  lds
    ds_read_b64_tr_b16 a[184:185], v243 offset:8192
    ds_read_b64_tr_b16 a[186:187], v243 offset:12288
    v_mfma_f32_16x16x32_bf16 v[4:7], a[164:167], a[228:231], v[4:7]
    buffer_load_dwordx4 v238, s[16:19], s37 offen offset:2048  lds
    ds_read_b64_tr_b16 a[188:189], v244 offset:8192
    ds_read_b64_tr_b16 a[190:191], v244 offset:12288
    v_mfma_f32_16x16x32_bf16 v[8:11], a[168:171], a[228:231], v[8:11]
    buffer_load_dwordx4 v239, s[16:19], s37 offen offset:3072  lds
    ds_read_b64_tr_b16 a[160:161], v225 offset:16384
    ds_read_b64_tr_b16 a[162:163], v225 offset:20480
    v_mfma_f32_16x16x32_bf16 v[12:15], a[172:175], a[228:231], v[12:15]
    s_add_u32 m0, s38, 53248
    ds_read_b64_tr_b16 a[164:165], v226 offset:16384
    ds_read_b64_tr_b16 a[166:167], v226 offset:20480
    s_waitcnt lgkmcnt(4)
    v_mfma_f32_16x16x32_bf16 v[16:19], a[176:179], a[228:231], v[16:19]
    s_add_u32 s37, s47, 102400
    ds_read_b64_tr_b16 a[168:169], v227 offset:16384
    ds_read_b64_tr_b16 a[170:171], v227 offset:20480
    v_mfma_f32_16x16x32_bf16 v[20:23], a[180:183], a[228:231], v[20:23]
    buffer_load_dwordx4 v236, s[16:19], s37 offen offset:0  lds
    ds_read_b64_tr_b16 a[172:173], v240 offset:16384
    ds_read_b64_tr_b16 a[174:175], v240 offset:20480
    v_mfma_f32_16x16x32_bf16 v[24:27], a[184:187], a[228:231], v[24:27]
    buffer_load_dwordx4 v237, s[16:19], s37 offen offset:1024  lds
    buffer_load_dwordx4 v238, s[16:19], s37 offen offset:2048  lds
    ds_read_b64_tr_b16 a[176:177], v241 offset:16384
    ds_read_b64_tr_b16 a[178:179], v241 offset:20480
    v_mfma_f32_16x16x32_bf16 v[28:31], a[188:191], a[228:231], v[28:31]
    buffer_load_dwordx4 v239, s[16:19], s37 offen offset:3072  lds
    ds_read_b64_tr_b16 a[180:181], v242 offset:16384
    ds_read_b64_tr_b16 a[182:183], v242 offset:20480
    s_waitcnt lgkmcnt(4)
    v_mfma_f32_16x16x32_bf16 v[0:3], a[160:163], a[232:235], v[0:3]
    s_add_u32 m0, s38, 57344
    ds_read_b64_tr_b16 a[184:185], v243 offset:16384
    ds_read_b64_tr_b16 a[186:187], v243 offset:20480
    v_mfma_f32_16x16x32_bf16 v[4:7], a[164:167], a[232:235], v[4:7]
    s_add_u32 s37, s47, 122880
    ds_read_b64_tr_b16 a[188:189], v244 offset:16384
    ds_read_b64_tr_b16 a[190:191], v244 offset:20480
    v_mfma_f32_16x16x32_bf16 v[8:11], a[168:171], a[232:235], v[8:11]
    buffer_load_dwordx4 v236, s[16:19], s37 offen offset:0  lds
    ds_read_b64_tr_b16 a[160:161], v225 offset:24576
    ds_read_b64_tr_b16 a[162:163], v225 offset:28672
    v_mfma_f32_16x16x32_bf16 v[12:15], a[172:175], a[232:235], v[12:15]
    buffer_load_dwordx4 v237, s[16:19], s37 offen offset:1024  lds
    ds_read_b64_tr_b16 a[164:165], v226 offset:24576
    ds_read_b64_tr_b16 a[166:167], v226 offset:28672
    s_waitcnt lgkmcnt(4)
    v_mfma_f32_16x16x32_bf16 v[16:19], a[176:179], a[232:235], v[16:19]
    buffer_load_dwordx4 v238, s[16:19], s37 offen offset:2048  lds
    ds_read_b64_tr_b16 a[168:169], v227 offset:24576
    ds_read_b64_tr_b16 a[170:171], v227 offset:28672
    v_mfma_f32_16x16x32_bf16 v[20:23], a[180:183], a[232:235], v[20:23]
    buffer_load_dwordx4 v239, s[16:19], s37 offen offset:3072  lds
    s_add_u32 m0, s38, 61440
    ds_read_b64_tr_b16 a[172:173], v240 offset:24576
    ds_read_b64_tr_b16 a[174:175], v240 offset:28672
    v_mfma_f32_16x16x32_bf16 v[24:27], a[184:187], a[232:235], v[24:27]
    s_add_u32 s37, s47, 143360
    ds_read_b64_tr_b16 a[176:177], v241 offset:24576
    ds_read_b64_tr_b16 a[178:179], v241 offset:28672
    v_mfma_f32_16x16x32_bf16 v[28:31], a[188:191], a[232:235], v[28:31]
    buffer_load_dwordx4 v236, s[16:19], s37 offen offset:0  lds
    ds_read_b64_tr_b16 a[180:181], v242 offset:24576
    ds_read_b64_tr_b16 a[182:183], v242 offset:28672
    s_waitcnt lgkmcnt(4)
    v_mfma_f32_16x16x32_bf16 v[0:3], a[160:163], a[236:239], v[0:3]
    buffer_load_dwordx4 v237, s[16:19], s37 offen offset:1024  lds
    ds_read_b64_tr_b16 a[184:185], v243 offset:24576
    ds_read_b64_tr_b16 a[186:187], v243 offset:28672
    v_mfma_f32_16x16x32_bf16 v[4:7], a[164:167], a[236:239], v[4:7]
    buffer_load_dwordx4 v238, s[16:19], s37 offen offset:2048  lds
    ds_read_b64_tr_b16 a[188:189], v244 offset:24576
    ds_read_b64_tr_b16 a[190:191], v244 offset:28672
    v_mfma_f32_16x16x32_bf16 v[8:11], a[168:171], a[236:239], v[8:11]
    buffer_load_dwordx4 v239, s[16:19], s37 offen offset:3072  lds
    v_mfma_f32_16x16x32_bf16 v[12:15], a[172:175], a[236:239], v[12:15]
    s_add_u32 s36, s40, 14336
    buffer_store_dwordx4 v[136:139], v224, s[20:23], s36 offen sc0 sc1
    s_add_u32 s47, s47, 163840
    s_waitcnt lgkmcnt(0)
    v_mfma_f32_16x16x32_bf16 v[16:19], a[176:179], a[236:239], v[16:19]
    s_waitcnt vmcnt(44)
    s_barrier
    ds_read_b64_tr_b16 a[160:161], v225 offset:32768
    ds_read_b64_tr_b16 a[162:163], v225 offset:36864
    ds_read_b64_tr_b16 a[164:165], v226 offset:32768
    ds_read_b64_tr_b16 a[166:167], v226 offset:36864
    ds_read_b64_tr_b16 a[168:169], v227 offset:32768
    ds_read_b64_tr_b16 a[170:171], v227 offset:36864
    v_mfma_f32_16x16x32_bf16 v[20:23], a[180:183], a[236:239], v[20:23]
    ds_read_b64_tr_b16 a[172:173], v240 offset:32768
    ds_read_b64_tr_b16 a[174:175], v240 offset:36864
    v_mfma_f32_16x16x32_bf16 v[24:27], a[184:187], a[236:239], v[24:27]
    ds_read_b64_tr_b16 a[176:177], v241 offset:32768
    ds_read_b64_tr_b16 a[178:179], v241 offset:36864
    v_mfma_f32_16x16x32_bf16 v[28:31], a[188:191], a[236:239], v[28:31]
    ds_read_b64_tr_b16 a[180:181], v242 offset:32768
    ds_read_b64_tr_b16 a[182:183], v242 offset:36864
    s_waitcnt lgkmcnt(4)
    v_mfma_f32_16x16x32_bf16 v[0:3], a[160:163], a[0:3], v[0:3]
    s_add_u32 m0, s38, 77824
    s_add_u32 s37, s47, 61440
    ds_read_b64_tr_b16 a[184:185], v243 offset:32768
    ds_read_b64_tr_b16 a[186:187], v243 offset:36864
    v_mfma_f32_16x16x32_bf16 v[4:7], a[164:167], a[0:3], v[4:7]
    buffer_load_dwordx4 v236, s[16:19], s37 offen offset:0  lds
    ds_read_b64_tr_b16 a[188:189], v244 offset:32768
    ds_read_b64_tr_b16 a[190:191], v244 offset:36864
    v_mfma_f32_16x16x32_bf16 v[8:11], a[168:171], a[0:3], v[8:11]
    buffer_load_dwordx4 v237, s[16:19], s37 offen offset:1024  lds
    ds_read_b64_tr_b16 a[160:161], v225 offset:40960
    ds_read_b64_tr_b16 a[162:163], v225 offset:45056
    v_mfma_f32_16x16x32_bf16 v[12:15], a[172:175], a[0:3], v[12:15]
    buffer_load_dwordx4 v238, s[16:19], s37 offen offset:2048  lds
    ds_read_b64_tr_b16 a[164:165], v226 offset:40960
    ds_read_b64_tr_b16 a[166:167], v226 offset:45056
    s_waitcnt lgkmcnt(4)
    v_mfma_f32_16x16x32_bf16 v[16:19], a[176:179], a[0:3], v[16:19]
    buffer_load_dwordx4 v239, s[16:19], s37 offen offset:3072  lds
    ds_read_b64_tr_b16 a[168:169], v227 offset:40960
    ds_read_b64_tr_b16 a[170:171], v227 offset:45056
    v_mfma_f32_16x16x32_bf16 v[20:23], a[180:183], a[0:3], v[20:23]
    s_add_u32 m0, s38, 81920
    ds_read_b64_tr_b16 a[172:173], v240 offset:40960
    ds_read_b64_tr_b16 a[174:175], v240 offset:45056
    v_mfma_f32_16x16x32_bf16 v[24:27], a[184:187], a[0:3], v[24:27]
    s_add_u32 s37, s47, 81920
    ds_read_b64_tr_b16 a[176:177], v241 offset:40960
    ds_read_b64_tr_b16 a[178:179], v241 offset:45056
    v_mfma_f32_16x16x32_bf16 v[28:31], a[188:191], a[0:3], v[28:31]
    buffer_load_dwordx4 v236, s[16:19], s37 offen offset:0  lds
    ds_read_b64_tr_b16 a[180:181], v242 offset:40960
    ds_read_b64_tr_b16 a[182:183], v242 offset:45056
    s_waitcnt lgkmcnt(4)
    v_mfma_f32_16x16x32_bf16 v[0:3], a[160:163], a[4:7], v[0:3]
    buffer_load_dword v115, v114, s[96:99], 0 offen sc1
    buffer_load_dwordx4 v237, s[16:19], s37 offen offset:1024  lds
    ds_read_b64_tr_b16 a[184:185], v243 offset:40960
    ds_read_b64_tr_b16 a[186:187], v243 offset:45056
    v_mfma_f32_16x16x32_bf16 v[4:7], a[164:167], a[4:7], v[4:7]
    buffer_load_dwordx4 v238, s[16:19], s37 offen offset:2048  lds
    buffer_load_dwordx4 v239, s[16:19], s37 offen offset:3072  lds
    ds_read_b64_tr_b16 a[188:189], v244 offset:40960
    ds_read_b64_tr_b16 a[190:191], v244 offset:45056
    v_mfma_f32_16x16x32_bf16 v[8:11], a[168:171], a[4:7], v[8:11]
    s_add_u32 m0, s38, 86016
    ds_read_b64_tr_b16 a[160:161], v225 offset:49152
    ds_read_b64_tr_b16 a[162:163], v225 offset:53248
    v_mfma_f32_16x16x32_bf16 v[12:15], a[172:175], a[4:7], v[12:15]
    s_add_u32 s37, s47, 102400
    ds_read_b64_tr_b16 a[164:165], v226 offset:49152
    ds_read_b64_tr_b16 a[166:167], v226 offset:53248
    s_waitcnt lgkmcnt(4)
    v_mfma_f32_16x16x32_bf16 v[16:19], a[176:179], a[4:7], v[16:19]
    buffer_load_dwordx4 v236, s[16:19], s37 offen offset:0  lds
    ds_read_b64_tr_b16 a[168:169], v227 offset:49152
    ds_read_b64_tr_b16 a[170:171], v227 offset:53248
    v_mfma_f32_16x16x32_bf16 v[20:23], a[180:183], a[4:7], v[20:23]
    buffer_load_dwordx4 v237, s[16:19], s37 offen offset:1024  lds
    ds_read_b64_tr_b16 a[172:173], v240 offset:49152
    ds_read_b64_tr_b16 a[174:175], v240 offset:53248
    v_mfma_f32_16x16x32_bf16 v[24:27], a[184:187], a[4:7], v[24:27]
    buffer_load_dwordx4 v238, s[16:19], s37 offen offset:2048  lds
    ds_read_b64_tr_b16 a[176:177], v241 offset:49152
    ds_read_b64_tr_b16 a[178:179], v241 offset:53248
    v_mfma_f32_16x16x32_bf16 v[28:31], a[188:191], a[4:7], v[28:31]
    buffer_load_dwordx4 v239, s[16:19], s37 offen offset:3072  lds
    ds_read_b64_tr_b16 a[180:181], v242 offset:49152
    ds_read_b64_tr_b16 a[182:183], v242 offset:53248
    s_waitcnt lgkmcnt(4)
    v_mfma_f32_16x16x32_bf16 v[0:3], a[160:163], a[8:11], v[0:3]
    s_add_u32 m0, s38, 90112
    ds_read_b64_tr_b16 a[184:185], v243 offset:49152
    ds_read_b64_tr_b16 a[186:187], v243 offset:53248
    v_mfma_f32_16x16x32_bf16 v[4:7], a[164:167], a[8:11], v[4:7]
    s_add_u32 s37, s47, 122880
    ds_read_b64_tr_b16 a[188:189], v244 offset:49152
    ds_read_b64_tr_b16 a[190:191], v244 offset:53248
    v_mfma_f32_16x16x32_bf16 v[8:11], a[168:171], a[8:11], v[8:11]
    buffer_load_dwordx4 v236, s[16:19], s37 offen offset:0  lds
    buffer_load_dwordx4 v237, s[16:19], s37 offen offset:1024  lds
    ds_read_b64_tr_b16 a[160:161], v225 offset:57344
    ds_read_b64_tr_b16 a[162:163], v225 offset:61440
    v_mfma_f32_16x16x32_bf16 v[12:15], a[172:175], a[8:11], v[12:15]
    buffer_load_dwordx4 v238, s[16:19], s37 offen offset:2048  lds
    ds_read_b64_tr_b16 a[164:165], v226 offset:57344
    ds_read_b64_tr_b16 a[166:167], v226 offset:61440
    s_waitcnt lgkmcnt(4)
    v_mfma_f32_16x16x32_bf16 v[16:19], a[176:179], a[8:11], v[16:19]
    s_add_u32 s36, s40, 21504
    buffer_store_dwordx4 v[140:143], v224, s[20:23], s36 offen sc0 sc1
    buffer_load_dwordx4 v239, s[16:19], s37 offen offset:3072  lds
    ds_read_b64_tr_b16 a[168:169], v227 offset:57344
    ds_read_b64_tr_b16 a[170:171], v227 offset:61440
    v_mfma_f32_16x16x32_bf16 v[20:23], a[180:183], a[8:11], v[20:23]
    s_add_u32 m0, s38, 94208
    ds_read_b64_tr_b16 a[172:173], v240 offset:57344
    ds_read_b64_tr_b16 a[174:175], v240 offset:61440
    v_mfma_f32_16x16x32_bf16 v[24:27], a[184:187], a[8:11], v[24:27]
    s_add_u32 s37, s47, 143360
    ds_read_b64_tr_b16 a[176:177], v241 offset:57344
    ds_read_b64_tr_b16 a[178:179], v241 offset:61440
    v_mfma_f32_16x16x32_bf16 v[28:31], a[188:191], a[8:11], v[28:31]
    buffer_load_dwordx4 v236, s[16:19], s37 offen offset:0  lds
    ds_read_b64_tr_b16 a[180:181], v242 offset:57344
    ds_read_b64_tr_b16 a[182:183], v242 offset:61440
    s_waitcnt lgkmcnt(4)
    v_mfma_f32_16x16x32_bf16 v[0:3], a[160:163], a[12:15], v[0:3]
    buffer_load_dwordx4 v237, s[16:19], s37 offen offset:1024  lds
    ds_read_b64_tr_b16 a[184:185], v243 offset:57344
    ds_read_b64_tr_b16 a[186:187], v243 offset:61440
    v_mfma_f32_16x16x32_bf16 v[4:7], a[164:167], a[12:15], v[4:7]
    buffer_load_dwordx4 v238, s[16:19], s37 offen offset:2048  lds
    ds_read_b64_tr_b16 a[188:189], v244 offset:57344
    ds_read_b64_tr_b16 a[190:191], v244 offset:61440
    v_mfma_f32_16x16x32_bf16 v[8:11], a[168:171], a[12:15], v[8:11]
    buffer_load_dwordx4 v239, s[16:19], s37 offen offset:3072  lds
    v_mfma_f32_16x16x32_bf16 v[12:15], a[172:175], a[12:15], v[12:15]
    s_waitcnt vmcnt(16)
    s_cmp_lt_u32 s51, 2
    s_cbranch_scc1 A_chk_done5
    s_sub_u32 s57, s51, 2
    s_lshl_b32 s57, s57, 2
    v_readfirstlane_b32 s56, v115
    s_nop 0
    s_lshr_b32 s56, s56, s57
    s_and_b32 s56, s56, 15
    s_cmp_ge_u32 s56, 8
    s_cbranch_scc1 A_chk_done5
    s_sub_u32 s57, s51, 2
    s_lshl_b32 s57, s57, 2
    s_mov_b32 s58, 0
A_poll6:
    buffer_load_dword v115, v114, s[96:99], 0 offen sc1
    s_waitcnt vmcnt(0)
    v_readfirstlane_b32 s56, v115
    s_add_u32 s58, s58, 1
    s_lshr_b32 s56, s56, s57
    s_and_b32 s56, s56, 15
    s_cmp_ge_u32 s56, 8
    s_cbranch_scc1 A_poll_done6
    s_sleep 4
    s_cmp_lt_u32 s58, 400000
    s_cbranch_scc1 A_poll6
A_poll_done6:
A_chk_done5:
    s_add_u32 s47, s47, 163840
    s_waitcnt lgkmcnt(0)
    v_mfma_f32_16x16x32_bf16 v[16:19], a[176:179], a[12:15], v[16:19]
    s_barrier
    ds_read_b64_tr_b16 a[160:161], v50 offset:0
    ds_read_b64_tr_b16 a[162:163], v50 offset:4096
    ds_read_b64_tr_b16 a[164:165], v50 offset:8192
    ds_read_b64_tr_b16 a[166:167], v50 offset:12288
    ds_read_b64_tr_b16 a[168:169], v50 offset:16384
    ds_read_b64_tr_b16 a[170:171], v50 offset:20480
    v_mfma_f32_16x16x32_bf16 v[20:23], a[180:183], a[12:15], v[20:23]
    ds_read_b64_tr_b16 a[172:173], v50 offset:24576
    ds_read_b64_tr_b16 a[174:175], v50 offset:28672
    v_mfma_f32_16x16x32_bf16 v[24:27], a[184:187], a[12:15], v[24:27]
    ds_read_b64_tr_b16 a[176:177], v51 offset:0
    ds_read_b64_tr_b16 a[178:179], v51 offset:4096
    v_mfma_f32_16x16x32_bf16 v[28:31], a[188:191], a[12:15], v[28:31]
    ds_read_b64_tr_b16 a[180:181], v51 offset:8192
    ds_read_b64_tr_b16 a[182:183], v51 offset:12288
    s_waitcnt lgkmcnt(4)
    v_mfma_f32_16x16x32_bf16 v[0:3], a[160:163], a[32:35], v[0:3]
    s_cmp_ge_u32 s51, 2
    s_cselect_b32 s54, s52, 1073741824
    s_add_u32 m0, s38, 110592
    s_add_u32 s37, s47, 61440
    ds_read_b64_tr_b16 a[184:185], v51 offset:16384
    ds_read_b64_tr_b16 a[186:187], v51 offset:20480
    v_mfma_f32_16x16x32_bf16 v[0:3], a[164:167], a[36:39], v[0:3]
    s_add_u32 s57, s54, 0
    buffer_load_dwordx4 v[64:67], v110, s[8:11], s57 offen sc1
    buffer_load_dwordx4 v236, s[16:19], s37 offen offset:0  lds
    ds_read_b64_tr_b16 a[188:189], v51 offset:24576
    ds_read_b64_tr_b16 a[190:191], v51 offset:28672
    v_mfma_f32_16x16x32_bf16 v[0:3], a[168:171], a[40:43], v[0:3]
    s_add_u32 s57, s54, 143360
    buffer_load_dwordx4 v[68:71], v110, s[8:11], s57 offen sc1
    buffer_load_dwordx4 v237, s[16:19], s37 offen offset:1024  lds
    ds_read_b64_tr_b16 a[160:161], v52 offset:0
    ds_read_b64_tr_b16 a[162:163], v52 offset:4096
    v_mfma_f32_16x16x32_bf16 v[0:3], a[172:175], a[44:47], v[0:3]
    s_add_u32 s57, s54, 286720
    buffer_load_dwordx4 v[72:75], v110, s[8:11], s57 offen sc1
    buffer_load_dwordx4 v238, s[16:19], s37 offen offset:2048  lds
    ds_read_b64_tr_b16 a[164:165], v52 offset:8192
    ds_read_b64_tr_b16 a[166:167], v52 offset:12288
    s_waitcnt lgkmcnt(4)
    v_mfma_f32_16x16x32_bf16 v[4:7], a[176:179], a[32:35], v[4:7]
    s_add_u32 s57, s54, 430080
    buffer_load_dwordx4 v[76:79], v110, s[8:11], s57 offen sc1
    buffer_load_dwordx4 v239, s[16:19], s37 offen offset:3072  lds
    ds_read_b64_tr_b16 a[168:169], v52 offset:16384
    ds_read_b64_tr_b16 a[170:171], v52 offset:20480
    v_mfma_f32_16x16x32_bf16 v[4:7], a[180:183], a[36:39], v[4:7]
    s_add_u32 s57, s54, 573440
    buffer_load_dwordx4 v[80:83], v110, s[8:11], s57 offen sc1
    s_add_u32 m0, s38, 114688
    ds_read_b64_tr_b16 a[172:173], v52 offset:24576
    ds_read_b64_tr_b16 a[174:175], v52 offset:28672
    v_mfma_f32_16x16x32_bf16 v[4:7], a[184:187], a[40:43], v[4:7]
    s_add_u32 s57, s54, 716800
    buffer_load_dwordx4 v[84:87], v110, s[8:11], s57 offen sc1
    s_add_u32 s37, s47, 81920
    ds_read_b64_tr_b16 a[176:177], v53 offset:0
    ds_read_b64_tr_b16 a[178:179], v53 offset:4096
    v_mfma_f32_16x16x32_bf16 v[4:7], a[188:191], a[44:47], v[4:7]
    s_add_u32 s57, s54, 860160
    buffer_load_dwordx4 v[88:91], v110, s[8:11], s57 offen sc1
    buffer_load_dwordx4 v236, s[16:19], s37 offen offset:0  lds
    ds_read_b64_tr_b16 a[180:181], v53 offset:8192
    ds_read_b64_tr_b16 a[182:183], v53 offset:12288
    s_waitcnt lgkmcnt(4)
    v_mfma_f32_16x16x32_bf16 v[8:11], a[160:163], a[32:35], v[8:11]
    s_add_u32 s57, s54, 1003520
    buffer_load_dwordx4 v[92:95], v110, s[8:11], s57 offen sc1
    buffer_load_dwordx4 v237, s[16:19], s37 offen offset:1024  lds
    ds_read_b64_tr_b16 a[184:185], v53 offset:16384
    ds_read_b64_tr_b16 a[186:187], v53 offset:20480
    v_mfma_f32_16x16x32_bf16 v[8:11], a[164:167], a[36:39], v[8:11]
    buffer_load_dwordx4 v238, s[16:19], s37 offen offset:2048  lds
    buffer_load_dwordx4 v239, s[16:19], s37 offen offset:3072  lds
    ds_read_b64_tr_b16 a[188:189], v53 offset:24576
    ds_read_b64_tr_b16 a[190:191], v53 offset:28672
    v_mfma_f32_16x16x32_bf16 v[8:11], a[168:171], a[40:43], v[8:11]
    s_add_u32 m0, s38, 118784
    ds_read_b64_tr_b16 a[160:161], v54 offset:0
    ds_read_b64_tr_b16 a[162:163], v54 offset:4096
    v_cvt_pk_bf16_f32 v128, v0, v1
    v_cvt_pk_bf16_f32 v129, v2, v3
    v_cvt_pk_bf16_f32 v130, v4, v5
    v_mfma_f32_16x16x32_bf16 v[8:11], a[172:175], a[44:47], v[8:11]
    s_add_u32 s37, s47, 102400
    ds_read_b64_tr_b16 a[164:165], v54 offset:8192
    ds_read_b64_tr_b16 a[166:167], v54 offset:12288
    v_cvt_pk_bf16_f32 v131, v6, v7
    s_waitcnt lgkmcnt(4)
    v_mfma_f32_16x16x32_bf16 v[12:15], a[176:179], a[32:35], v[12:15]
    s_add_u32 s40, s40, 28672
    buffer_load_dwordx4 v236, s[16:19], s37 offen offset:0  lds
    ds_read_b64_tr_b16 a[168:169], v54 offset:16384
    ds_read_b64_tr_b16 a[170:171], v54 offset:20480
    v_mfma_f32_16x16x32_bf16 v[12:15], a[180:183], a[36:39], v[12:15]
    buffer_load_dwordx4 v237, s[16:19], s37 offen offset:1024  lds
    ds_read_b64_tr_b16 a[172:173], v54 offset:24576
    ds_read_b64_tr_b16 a[174:175], v54 offset:28672
    v_mfma_f32_16x16x32_bf16 v[12:15], a[184:187], a[40:43], v[12:15]
    buffer_load_dwordx4 v238, s[16:19], s37 offen offset:2048  lds
    ds_read_b64_tr_b16 a[176:177], v55 offset:0
    ds_read_b64_tr_b16 a[178:179], v55 offset:4096
    v_mfma_f32_16x16x32_bf16 v[12:15], a[188:191], a[44:47], v[12:15]
    buffer_load_dwordx4 v239, s[16:19], s37 offen offset:3072  lds
    ds_read_b64_tr_b16 a[180:181], v55 offset:8192
    ds_read_b64_tr_b16 a[182:183], v55 offset:12288
    s_waitcnt lgkmcnt(4)
    v_mfma_f32_16x16x32_bf16 v[16:19], a[160:163], a[32:35], v[16:19]
    s_add_u32 m0, s38, 122880
    ds_read_b64_tr_b16 a[184:185], v55 offset:16384
    ds_read_b64_tr_b16 a[186:187], v55 offset:20480
    v_mfma_f32_16x16x32_bf16 v[16:19], a[164:167], a[36:39], v[16:19]
    s_add_u32 s37, s47, 122880
    ds_read_b64_tr_b16 a[188:189], v55 offset:24576
    ds_read_b64_tr_b16 a[190:191], v55 offset:28672
    v_cvt_pk_bf16_f32 v132, v8, v9
    v_cvt_pk_bf16_f32 v133, v10, v11
    v_cvt_pk_bf16_f32 v134, v12, v13
    v_mfma_f32_16x16x32_bf16 v[16:19], a[168:171], a[40:43], v[16:19]
    buffer_load_dwordx4 v236, s[16:19], s37 offen offset:0  lds
    buffer_load_dwordx4 v237, s[16:19], s37 offen offset:1024  lds
    ds_read_b64_tr_b16 a[160:161], v56 offset:0
    ds_read_b64_tr_b16 a[162:163], v56 offset:4096
    v_mfma_f32_16x16x32_bf16 v[16:19], a[172:175], a[44:47], v[16:19]
    buffer_load_dwordx4 v238, s[16:19], s37 offen offset:2048  lds
    ds_read_b64_tr_b16 a[164:165], v56 offset:8192
    ds_read_b64_tr_b16 a[166:167], v56 offset:12288
    s_waitcnt lgkmcnt(4)
    v_mfma_f32_16x16x32_bf16 v[20:23], a[176:179], a[32:35], v[20:23]
    buffer_load_dwordx4 v239, s[16:19], s37 offen offset:3072  lds
    ds_read_b64_tr_b16 a[168:169], v56 offset:16384
    ds_read_b64_tr_b16 a[170:171], v56 offset:20480
    v_mfma_f32_16x16x32_bf16 v[20:23], a[180:183], a[36:39], v[20:23]
    s_add_u32 m0, s38, 126976
    ds_read_b64_tr_b16 a[172:173], v56 offset:24576
    ds_read_b64_tr_b16 a[174:175], v56 offset:28672
    v_cvt_pk_bf16_f32 v135, v14, v15
    v_mfma_f32_16x16x32_bf16 v[20:23], a[184:187], a[40:43], v[20:23]
    s_add_u32 s37, s47, 143360
    ds_read_b64_tr_b16 a[176:177], v57 offset:0
    ds_read_b64_tr_b16 a[178:179], v57 offset:4096
    v_mfma_f32_16x16x32_bf16 v[20:23], a[188:191], a[44:47], v[20:23]
    buffer_load_dwordx4 v236, s[16:19], s37 offen offset:0  lds
    ds_read_b64_tr_b16 a[180:181], v57 offset:8192
    ds_read_b64_tr_b16 a[182:183], v57 offset:12288
    s_waitcnt lgkmcnt(4)
    v_mfma_f32_16x16x32_bf16 v[24:27], a[160:163], a[32:35], v[24:27]
    buffer_load_dwordx4 v237, s[16:19], s37 offen offset:1024  lds
    ds_read_b64_tr_b16 a[184:185], v57 offset:16384
    ds_read_b64_tr_b16 a[186:187], v57 offset:20480
    v_mfma_f32_16x16x32_bf16 v[24:27], a[164:167], a[36:39], v[24:27]
    buffer_load_dwordx4 v238, s[16:19], s37 offen offset:2048  lds
    ds_read_b64_tr_b16 a[188:189], v57 offset:24576
    ds_read_b64_tr_b16 a[190:191], v57 offset:28672
    v_mfma_f32_16x16x32_bf16 v[24:27], a[168:171], a[40:43], v[24:27]
    buffer_load_dwordx4 v239, s[16:19], s37 offen offset:3072  lds
    v_cvt_pk_bf16_f32 v136, v16, v17
    v_mfma_f32_16x16x32_bf16 v[24:27], a[172:175], a[44:47], v[24:27]
    s_add_u32 s52, s52, 28672
    s_add_u32 s53, s53, 256
    s_add_u32 s47, s47, 163840
    v_cvt_pk_bf16_f32 v137, v18, v19
    v_cvt_pk_bf16_f32 v138, v20, v21
    v_cvt_pk_bf16_f32 v139, v22, v23
    s_waitcnt lgkmcnt(0)
    v_mfma_f32_16x16x32_bf16 v[28:31], a[176:179], a[32:35], v[28:31]
    s_waitcnt vmcnt(33)
    s_barrier
    ds_read_b64_tr_b16 a[160:161], v50 offset:32768
    ds_read_b64_tr_b16 a[162:163], v50 offset:36864
    ds_read_b64_tr_b16 a[164:165], v50 offset:40960
    ds_read_b64_tr_b16 a[166:167], v50 offset:45056
    ds_read_b64_tr_b16 a[168:169], v50 offset:49152
    ds_read_b64_tr_b16 a[170:171], v50 offset:53248
    v_mfma_f32_16x16x32_bf16 v[28:31], a[180:183], a[36:39], v[28:31]
    v_mfma_f32_16x16x32_bf16 v[28:31], a[184:187], a[40:43], v[28:31]
    v_mfma_f32_16x16x32_bf16 v[28:31], a[188:191], a[44:47], v[28:31]
    v_cvt_pk_bf16_f32 v140, v24, v25
    v_cvt_pk_bf16_f32 v141, v26, v27
    s_nop 5
    v_cvt_pk_bf16_f32 v142, v28, v29
    v_cvt_pk_bf16_f32 v143, v30, v31
    s_add_u32 s51, s51, 1
    s_cmp_lt_u32 s51, 5
    s_cbranch_scc1 A_B_ng
    s_mov_b32 s22, 143360
    s_add_u32 s36, s40, 0
    buffer_store_dwordx4 v[128:131], v224, s[20:23], s36 offen sc0 sc1
    s_add_u32 s36, s40, 7168
    buffer_store_dwordx4 v[132:135], v224, s[20:23], s36 offen sc0 sc1
    s_add_u32 s36, s40, 14336
    buffer_store_dwordx4 v[136:139], v224, s[20:23], s36 offen sc0 sc1
    s_add_u32 s36, s40, 21504
    buffer_store_dwordx4 v[140:143], v224, s[20:23], s36 offen sc0 sc1
    s_waitcnt lgkmcnt(0)
    s_branch A_red
A_B_slow:
    s_nop 15
    s_nop 15
    v_mbcnt_lo_u32_b32 v182, -1, 0
    v_mbcnt_hi_u32_b32 v182, -1, v182
    v_and_b32_e32 v183, 15, v182
    v_lshrrev_b32_e32 v182, 4, v182
    v_lshlrev_b32_e32 v176, 8, v183
    v_lshl_add_u32 v176, v182, 4, v176
    v_lshlrev_b32_e32 v177, 10, v182
    v_lshl_add_u32 v177, v183, 1, v177
    v_add_u32_e32 v178, 0x1000, v177
    s_lshl_b32 s48, s35, 17
    v_mov_b32_e32 v179, 0xff800000
    s_mov_b32 s89, 0
A_B_slow_max0:
    s_lshl_b32 s88, s89, 12
    s_add_u32 s88, s88, s48
    buffer_load_dwordx4 v[128:131], v176, s[8:11], s88 offen offset:0
    buffer_load_dwordx4 v[132:135], v176, s[8:11], s88 offen offset:64
    buffer_load_dwordx4 v[136:139], v176, s[8:11], s88 offen offset:128
    buffer_load_dwordx4 v[140:143], v176, s[8:11], s88 offen offset:192
    s_waitcnt vmcnt(0)
    v_mfma_f32_16x16x32_bf16 v[144:147], v[128:131], v[192:195], 0
    v_mfma_f32_16x16x32_bf16 v[144:147], v[132:135], v[196:199], v[144:147]
    v_mfma_f32_16x16x32_bf16 v[144:147], v[136:139], v[200:203], v[144:147]
    v_mfma_f32_16x16x32_bf16 v[144:147], v[140:143], v[204:207], v[144:147]
    s_nop 15
    v_max3_f32 v179, v179, v144, v145
    v_max3_f32 v179, v179, v146, v147
    s_add_u32 s89, s89, 1
    s_cmp_lt_u32 s89, 32
    s_cbranch_scc1 A_B_slow_max0
    v_mov_b32_e32 v180, v179
    s_nop 1
    v_permlane32_swap_b32_e32 v179, v180
    v_max_f32_e32 v179, v179, v180
    v_mov_b32_e32 v180, v179
    s_nop 1
    v_permlane16_swap_b32_e32 v179, v180
    v_max_f32_e32 v179, v179, v180
    v_mov_b32_e32 v246, 0
    v_mov_b32_e32 v64, 0
    v_mov_b32_e32 v65, 0
    v_mov_b32_e32 v66, 0
    v_mov_b32_e32 v67, 0
    v_mov_b32_e32 v68, 0
    v_mov_b32_e32 v69, 0
    v_mov_b32_e32 v70, 0
    v_mov_b32_e32 v71, 0
    v_mov_b32_e32 v72, 0
    v_mov_b32_e32 v73, 0
    v_mov_b32_e32 v74, 0
    v_mov_b32_e32 v75, 0
    v_mov_b32_e32 v76, 0
    v_mov_b32_e32 v77, 0
    v_mov_b32_e32 v78, 0
    v_mov_b32_e32 v79, 0
    v_mov_b32_e32 v80, 0
    v_mov_b32_e32 v81, 0
    v_mov_b32_e32 v82, 0
    v_mov_b32_e32 v83, 0
    v_mov_b32_e32 v84, 0
    v_mov_b32_e32 v85, 0
    v_mov_b32_e32 v86, 0
    v_mov_b32_e32 v87, 0
    v_mov_b32_e32 v88, 0
    v_mov_b32_e32 v89, 0
    v_mov_b32_e32 v90, 0
    v_mov_b32_e32 v91, 0
    v_mov_b32_e32 v92, 0
    v_mov_b32_e32 v93, 0
    v_mov_b32_e32 v94, 0
    v_mov_b32_e32 v95, 0
    s_mov_b32 s89, 0
A_B_slow_pv0:
    s_lshl_b32 s88, s89, 13
    s_add_u32 s88, s88, s48
    buffer_load_dwordx4 v[128:131], v176, s[8:11], s88 offen offset:0
    buffer_load_dwordx4 v[132:135], v176, s[8:11], s88 offen offset:64
    buffer_load_dwordx4 v[136:139], v176, s[8:11], s88 offen offset:128
    buffer_load_dwordx4 v[140:143], v176, s[8:11], s88 offen offset:192
    s_waitcnt vmcnt(0)
    v_mfma_f32_16x16x32_bf16 v[144:147], v[128:131], v[192:195], 0
    v_mfma_f32_16x16x32_bf16 v[144:147], v[132:135], v[196:199], v[144:147]
    v_mfma_f32_16x16x32_bf16 v[144:147], v[136:139], v[200:203], v[144:147]
    v_mfma_f32_16x16x32_bf16 v[144:147], v[140:143], v[204:207], v[144:147]
    s_nop 15
    s_add_u32 s88, s88, 4096
    buffer_load_dwordx4 v[128:131], v176, s[8:11], s88 offen offset:0
    buffer_load_dwordx4 v[132:135], v176, s[8:11], s88 offen offset:64
    buffer_load_dwordx4 v[136:139], v176, s[8:11], s88 offen offset:128
    buffer_load_dwordx4 v[140:143], v176, s[8:11], s88 offen offset:192
    s_waitcnt vmcnt(0)
    v_mfma_f32_16x16x32_bf16 v[148:151], v[128:131], v[192:195], 0
    v_mfma_f32_16x16x32_bf16 v[148:151], v[132:135], v[196:199], v[148:151]
    v_mfma_f32_16x16x32_bf16 v[148:151], v[136:139], v[200:203], v[148:151]
    v_mfma_f32_16x16x32_bf16 v[148:151], v[140:143], v[204:207], v[148:151]
    s_nop 15
    s_sub_u32 s88, s88, 4096
    v_sub_f32_e32 v144, v144, v179
    v_sub_f32_e32 v145, v145, v179
    v_sub_f32_e32 v146, v146, v179
    v_sub_f32_e32 v147, v147, v179
    v_sub_f32_e32 v148, v148, v179
    v_sub_f32_e32 v149, v149, v179
    v_sub_f32_e32 v150, v150, v179
    v_sub_f32_e32 v151, v151, v179
    v_exp_f32_e32 v144, v144
    v_exp_f32_e32 v145, v145
    v_exp_f32_e32 v146, v146
    v_exp_f32_e32 v147, v147
    v_exp_f32_e32 v148, v148
    v_exp_f32_e32 v149, v149
    v_exp_f32_e32 v150, v150
    v_exp_f32_e32 v151, v151
    s_nop 0
    v_add_f32_e32 v246, v246, v144
    v_add_f32_e32 v246, v246, v145
    v_add_f32_e32 v246, v246, v146
    v_add_f32_e32 v246, v246, v147
    v_add_f32_e32 v246, v246, v148
    v_add_f32_e32 v246, v246, v149
    v_add_f32_e32 v246, v246, v150
    v_add_f32_e32 v246, v246, v151
    v_cvt_pk_bf16_f32 v152, v144, v145
    v_cvt_pk_bf16_f32 v153, v146, v147
    v_cvt_pk_bf16_f32 v154, v148, v149
    v_cvt_pk_bf16_f32 v155, v150, v151
    buffer_load_ushort v160, v177, s[12:15], s88 offen offset:0
    buffer_load_ushort v161, v177, s[12:15], s88 offen offset:256
    buffer_load_ushort v162, v177, s[12:15], s88 offen offset:512
    buffer_load_ushort v163, v177, s[12:15], s88 offen offset:768
    buffer_load_ushort v164, v178, s[12:15], s88 offen offset:0
    buffer_load_ushort v165, v178, s[12:15], s88 offen offset:256
    buffer_load_ushort v166, v178, s[12:15], s88 offen offset:512
    buffer_load_ushort v167, v178, s[12:15], s88 offen offset:768
    s_waitcnt vmcnt(0)
    v_lshl_or_b32 v168, v161, 16, v160
    v_lshl_or_b32 v169, v163, 16, v162
    v_lshl_or_b32 v170, v165, 16, v164
    v_lshl_or_b32 v171, v167, 16, v166
    s_nop 1
    v_mfma_f32_16x16x32_bf16 v[64:67], v[168:171], v[152:155], v[64:67]
    s_nop 7
    buffer_load_ushort v160, v177, s[12:15], s88 offen offset:32
    buffer_load_ushort v161, v177, s[12:15], s88 offen offset:288
    buffer_load_ushort v162, v177, s[12:15], s88 offen offset:544
    buffer_load_ushort v163, v177, s[12:15], s88 offen offset:800
    buffer_load_ushort v164, v178, s[12:15], s88 offen offset:32
    buffer_load_ushort v165, v178, s[12:15], s88 offen offset:288
    buffer_load_ushort v166, v178, s[12:15], s88 offen offset:544
    buffer_load_ushort v167, v178, s[12:15], s88 offen offset:800
    s_waitcnt vmcnt(0)
    v_lshl_or_b32 v168, v161, 16, v160
    v_lshl_or_b32 v169, v163, 16, v162
    v_lshl_or_b32 v170, v165, 16, v164
    v_lshl_or_b32 v171, v167, 16, v166
    s_nop 1
    v_mfma_f32_16x16x32_bf16 v[68:71], v[168:171], v[152:155], v[68:71]
    s_nop 7
    buffer_load_ushort v160, v177, s[12:15], s88 offen offset:64
    buffer_load_ushort v161, v177, s[12:15], s88 offen offset:320
    buffer_load_ushort v162, v177, s[12:15], s88 offen offset:576
    buffer_load_ushort v163, v177, s[12:15], s88 offen offset:832
    buffer_load_ushort v164, v178, s[12:15], s88 offen offset:64
    buffer_load_ushort v165, v178, s[12:15], s88 offen offset:320
    buffer_load_ushort v166, v178, s[12:15], s88 offen offset:576
    buffer_load_ushort v167, v178, s[12:15], s88 offen offset:832
    s_waitcnt vmcnt(0)
    v_lshl_or_b32 v168, v161, 16, v160
    v_lshl_or_b32 v169, v163, 16, v162
    v_lshl_or_b32 v170, v165, 16, v164
    v_lshl_or_b32 v171, v167, 16, v166
    s_nop 1
    v_mfma_f32_16x16x32_bf16 v[72:75], v[168:171], v[152:155], v[72:75]
    s_nop 7
    buffer_load_ushort v160, v177, s[12:15], s88 offen offset:96
    buffer_load_ushort v161, v177, s[12:15], s88 offen offset:352
    buffer_load_ushort v162, v177, s[12:15], s88 offen offset:608
    buffer_load_ushort v163, v177, s[12:15], s88 offen offset:864
    buffer_load_ushort v164, v178, s[12:15], s88 offen offset:96
    buffer_load_ushort v165, v178, s[12:15], s88 offen offset:352
    buffer_load_ushort v166, v178, s[12:15], s88 offen offset:608
    buffer_load_ushort v167, v178, s[12:15], s88 offen offset:864
    s_waitcnt vmcnt(0)
    v_lshl_or_b32 v168, v161, 16, v160
    v_lshl_or_b32 v169, v163, 16, v162
    v_lshl_or_b32 v170, v165, 16, v164
    v_lshl_or_b32 v171, v167, 16, v166
    s_nop 1
    v_mfma_f32_16x16x32_bf16 v[76:79], v[168:171], v[152:155], v[76:79]
    s_nop 7
    buffer_load_ushort v160, v177, s[12:15], s88 offen offset:128
    buffer_load_ushort v161, v177, s[12:15], s88 offen offset:384
    buffer_load_ushort v162, v177, s[12:15], s88 offen offset:640
    buffer_load_ushort v163, v177, s[12:15], s88 offen offset:896
    buffer_load_ushort v164, v178, s[12:15], s88 offen offset:128
    buffer_load_ushort v165, v178, s[12:15], s88 offen offset:384
    buffer_load_ushort v166, v178, s[12:15], s88 offen offset:640
    buffer_load_ushort v167, v178, s[12:15], s88 offen offset:896
    s_waitcnt vmcnt(0)
    v_lshl_or_b32 v168, v161, 16, v160
    v_lshl_or_b32 v169, v163, 16, v162
    v_lshl_or_b32 v170, v165, 16, v164
    v_lshl_or_b32 v171, v167, 16, v166
    s_nop 1
    v_mfma_f32_16x16x32_bf16 v[80:83], v[168:171], v[152:155], v[80:83]
    s_nop 7
    buffer_load_ushort v160, v177, s[12:15], s88 offen offset:160
    buffer_load_ushort v161, v177, s[12:15], s88 offen offset:416
    buffer_load_ushort v162, v177, s[12:15], s88 offen offset:672
    buffer_load_ushort v163, v177, s[12:15], s88 offen offset:928
    buffer_load_ushort v164, v178, s[12:15], s88 offen offset:160
    buffer_load_ushort v165, v178, s[12:15], s88 offen offset:416
    buffer_load_ushort v166, v178, s[12:15], s88 offen offset:672
    buffer_load_ushort v167, v178, s[12:15], s88 offen offset:928
    s_waitcnt vmcnt(0)
    v_lshl_or_b32 v168, v161, 16, v160
    v_lshl_or_b32 v169, v163, 16, v162
    v_lshl_or_b32 v170, v165, 16, v164
    v_lshl_or_b32 v171, v167, 16, v166
    s_nop 1
    v_mfma_f32_16x16x32_bf16 v[84:87], v[168:171], v[152:155], v[84:87]
    s_nop 7
    buffer_load_ushort v160, v177, s[12:15], s88 offen offset:192
    buffer_load_ushort v161, v177, s[12:15], s88 offen offset:448
    buffer_load_ushort v162, v177, s[12:15], s88 offen offset:704
    buffer_load_ushort v163, v177, s[12:15], s88 offen offset:960
    buffer_load_ushort v164, v178, s[12:15], s88 offen offset:192
    buffer_load_ushort v165, v178, s[12:15], s88 offen offset:448
    buffer_load_ushort v166, v178, s[12:15], s88 offen offset:704
    buffer_load_ushort v167, v178, s[12:15], s88 offen offset:960
    s_waitcnt vmcnt(0)
    v_lshl_or_b32 v168, v161, 16, v160
    v_lshl_or_b32 v169, v163, 16, v162
    v_lshl_or_b32 v170, v165, 16, v164
    v_lshl_or_b32 v171, v167, 16, v166
    s_nop 1
    v_mfma_f32_16x16x32_bf16 v[88:91], v[168:171], v[152:155], v[88:91]
    s_nop 7
    buffer_load_ushort v160, v177, s[12:15], s88 offen offset:224
    buffer_load_ushort v161, v177, s[12:15], s88 offen offset:480
    buffer_load_ushort v162, v177, s[12:15], s88 offen offset:736
    buffer_load_ushort v163, v177, s[12:15], s88 offen offset:992
    buffer_load_ushort v164, v178, s[12:15], s88 offen offset:224
    buffer_load_ushort v165, v178, s[12:15], s88 offen offset:480
    buffer_load_ushort v166, v178, s[12:15], s88 offen offset:736
    buffer_load_ushort v167, v178, s[12:15], s88 offen offset:992
    s_waitcnt vmcnt(0)
    v_lshl_or_b32 v168, v161, 16, v160
    v_lshl_or_b32 v169, v163, 16, v162
    v_lshl_or_b32 v170, v165, 16, v164
    v_lshl_or_b32 v171, v167, 16, v166
    s_nop 1
    v_mfma_f32_16x16x32_bf16 v[92:95], v[168:171], v[152:155], v[92:95]
    s_nop 7
    s_add_u32 s89, s89, 1
    s_cmp_lt_u32 s89, 16
    s_cbranch_scc1 A_B_slow_pv0
    v_mov_b32_e32 v180, v246
    s_nop 1
    v_permlane32_swap_b32_e32 v246, v180
    v_add_f32_e32 v246, v246, v180
    v_mov_b32_e32 v180, v246
    s_nop 1
    v_permlane16_swap_b32_e32 v246, v180
    v_add_f32_e32 v246, v246, v180
    v_mov_b32_e32 v160, 0
    v_mov_b32_e32 v161, 0
    v_mov_b32_e32 v162, 0
    v_mov_b32_e32 v163, 0
    v_mov_b32_e32 v168, 0
    v_mov_b32_e32 v169, 0
    v_mov_b32_e32 v170, 0
    v_mov_b32_e32 v171, 0
    s_nop 15
    s_cmp_eq_u32 s87, 0
    s_cbranch_scc1 A_B_slow_ret0
    s_branch A_B_slow_ret1
A_red:
    s_cmp_eq_u32 s28, 3
    s_cbranch_scc0 A_t0
    s_mov_b32 s56, 4096
    v_mov_b32_e32 v112, s56
    buffer_atomic_add v112, v113, s[96:99], 0 offen sc1
A_t0:
    s_cmp_eq_u32 s28, 3
    s_cbranch_scc1 A_t0b
    s_waitcnt vmcnt(8)
    v_lshlrev_b32_e32 v96, 16, v64
    v_and_b32_e32 v97, 0xffff0000, v64
    v_lshlrev_b32_e32 v98, 16, v65
    v_and_b32_e32 v99, 0xffff0000, v65
    v_lshlrev_b32_e32 v100, 16, v66
    v_and_b32_e32 v101, 0xffff0000, v66
    v_lshlrev_b32_e32 v102, 16, v67
    v_and_b32_e32 v103, 0xffff0000, v67
    v_lshlrev_b32_e32 v108, 16, v68
    v_and_b32_e32 v109, 0xffff0000, v68
    v_add_f32_e32 v96, v96, v108
    v_add_f32_e32 v97, v97, v109
    v_lshlrev_b32_e32 v108, 16, v69
    v_and_b32_e32 v109, 0xffff0000, v69
    v_add_f32_e32 v98, v98, v108
    v_add_f32_e32 v99, v99, v109
    v_lshlrev_b32_e32 v108, 16, v70
    v_and_b32_e32 v109, 0xffff0000, v70
    v_add_f32_e32 v100, v100, v108
    v_add_f32_e32 v101, v101, v109
    v_lshlrev_b32_e32 v108, 16, v71
    v_and_b32_e32 v109, 0xffff0000, v71
    v_add_f32_e32 v102, v102, v108
    v_add_f32_e32 v103, v103, v109
    v_lshlrev_b32_e32 v108, 16, v72
    v_and_b32_e32 v109, 0xffff0000, v72
    v_add_f32_e32 v96, v96, v108
    v_add_f32_e32 v97, v97, v109
    v_lshlrev_b32_e32 v108, 16, v73
    v_and_b32_e32 v109, 0xffff0000, v73
    v_add_f32_e32 v98, v98, v108
    v_add_f32_e32 v99, v99, v109
    v_lshlrev_b32_e32 v108, 16, v74
    v_and_b32_e32 v109, 0xffff0000, v74
    v_add_f32_e32 v100, v100, v108
    v_add_f32_e32 v101, v101, v109
    v_lshlrev_b32_e32 v108, 16, v75
    v_and_b32_e32 v109, 0xffff0000, v75
    v_add_f32_e32 v102, v102, v108
    v_add_f32_e32 v103, v103, v109
    v_lshlrev_b32_e32 v108, 16, v76
    v_and_b32_e32 v109, 0xffff0000, v76
    v_add_f32_e32 v96, v96, v108
    v_add_f32_e32 v97, v97, v109
    v_lshlrev_b32_e32 v108, 16, v77
    v_and_b32_e32 v109, 0xffff0000, v77
    v_add_f32_e32 v98, v98, v108
    v_add_f32_e32 v99, v99, v109
    v_lshlrev_b32_e32 v108, 16, v78
    v_and_b32_e32 v109, 0xffff0000, v78
    v_add_f32_e32 v100, v100, v108
    v_add_f32_e32 v101, v101, v109
    v_lshlrev_b32_e32 v108, 16, v79
    v_and_b32_e32 v109, 0xffff0000, v79
    v_add_f32_e32 v102, v102, v108
    v_add_f32_e32 v103, v103, v109
    v_lshlrev_b32_e32 v108, 16, v80
    v_and_b32_e32 v109, 0xffff0000, v80
    v_add_f32_e32 v96, v96, v108
    v_add_f32_e32 v97, v97, v109
    v_lshlrev_b32_e32 v108, 16, v81
    v_and_b32_e32 v109, 0xffff0000, v81
    v_add_f32_e32 v98, v98, v108
    v_add_f32_e32 v99, v99, v109
    v_lshlrev_b32_e32 v108, 16, v82
    v_and_b32_e32 v109, 0xffff0000, v82
    v_add_f32_e32 v100, v100, v108
    v_add_f32_e32 v101, v101, v109
    v_lshlrev_b32_e32 v108, 16, v83
    v_and_b32_e32 v109, 0xffff0000, v83
    v_add_f32_e32 v102, v102, v108
    v_add_f32_e32 v103, v103, v109
    v_lshlrev_b32_e32 v108, 16, v84
    v_and_b32_e32 v109, 0xffff0000, v84
    v_add_f32_e32 v96, v96, v108
    v_add_f32_e32 v97, v97, v109
    v_lshlrev_b32_e32 v108, 16, v85
    v_and_b32_e32 v109, 0xffff0000, v85
    v_add_f32_e32 v98, v98, v108
    v_add_f32_e32 v99, v99, v109
    v_lshlrev_b32_e32 v108, 16, v86
    v_and_b32_e32 v109, 0xffff0000, v86
    v_add_f32_e32 v100, v100, v108
    v_add_f32_e32 v101, v101, v109
    v_lshlrev_b32_e32 v108, 16, v87
    v_and_b32_e32 v109, 0xffff0000, v87
    v_add_f32_e32 v102, v102, v108
    v_add_f32_e32 v103, v103, v109
    v_lshlrev_b32_e32 v108, 16, v88
    v_and_b32_e32 v109, 0xffff0000, v88
    v_add_f32_e32 v96, v96, v108
    v_add_f32_e32 v97, v97, v109
    v_lshlrev_b32_e32 v108, 16, v89
    v_and_b32_e32 v109, 0xffff0000, v89
    v_add_f32_e32 v98, v98, v108
    v_add_f32_e32 v99, v99, v109
    v_lshlrev_b32_e32 v108, 16, v90
    v_and_b32_e32 v109, 0xffff0000, v90
    v_add_f32_e32 v100, v100, v108
    v_add_f32_e32 v101, v101, v109
    v_lshlrev_b32_e32 v108, 16, v91
    v_and_b32_e32 v109, 0xffff0000, v91
    v_add_f32_e32 v102, v102, v108
    v_add_f32_e32 v103, v103, v109
    v_lshlrev_b32_e32 v108, 16, v92
    v_and_b32_e32 v109, 0xffff0000, v92
    v_add_f32_e32 v96, v96, v108
    v_add_f32_e32 v97, v97, v109
    v_lshlrev_b32_e32 v108, 16, v93
    v_and_b32_e32 v109, 0xffff0000, v93
    v_add_f32_e32 v98, v98, v108
    v_add_f32_e32 v99, v99, v109
    v_lshlrev_b32_e32 v108, 16, v94
    v_and_b32_e32 v109, 0xffff0000, v94
    v_add_f32_e32 v100, v100, v108
    v_add_f32_e32 v101, v101, v109
    v_lshlrev_b32_e32 v108, 16, v95
    v_and_b32_e32 v109, 0xffff0000, v95
    v_add_f32_e32 v102, v102, v108
    v_add_f32_e32 v103, v103, v109
    v_cvt_pk_bf16_f32 v104, v96, v97
    v_cvt_pk_bf16_f32 v105, v98, v99
    v_cvt_pk_bf16_f32 v106, v100, v101
    v_cvt_pk_bf16_f32 v107, v102, v103
    s_nop 0
    v_permlane32_swap_b32_e32 v104, v106
    v_permlane32_swap_b32_e32 v105, v107
    s_nop 0
    v_permlane16_swap_b32_e32 v104, v106
    v_permlane16_swap_b32_e32 v105, v107
    buffer_store_dwordx4 v[104:107], v111, s[12:15], s53 offen sc0 sc1
    s_branch A_t0c
A_t0b:
    s_waitcnt vmcnt(5)
    v_lshlrev_b32_e32 v96, 16, v64
    v_and_b32_e32 v97, 0xffff0000, v64
    v_lshlrev_b32_e32 v98, 16, v65
    v_and_b32_e32 v99, 0xffff0000, v65
    v_lshlrev_b32_e32 v100, 16, v66
    v_and_b32_e32 v101, 0xffff0000, v66
    v_lshlrev_b32_e32 v102, 16, v67
    v_and_b32_e32 v103, 0xffff0000, v67
    v_lshlrev_b32_e32 v108, 16, v68
    v_and_b32_e32 v109, 0xffff0000, v68
    v_add_f32_e32 v96, v96, v108
    v_add_f32_e32 v97, v97, v109
    v_lshlrev_b32_e32 v108, 16, v69
    v_and_b32_e32 v109, 0xffff0000, v69
    v_add_f32_e32 v98, v98, v108
    v_add_f32_e32 v99, v99, v109
    v_lshlrev_b32_e32 v108, 16, v70
    v_and_b32_e32 v109, 0xffff0000, v70
    v_add_f32_e32 v100, v100, v108
    v_add_f32_e32 v101, v101, v109
    v_lshlrev_b32_e32 v108, 16, v71
    v_and_b32_e32 v109, 0xffff0000, v71
    v_add_f32_e32 v102, v102, v108
    v_add_f32_e32 v103, v103, v109
    v_lshlrev_b32_e32 v108, 16, v72
    v_and_b32_e32 v109, 0xffff0000, v72
    v_add_f32_e32 v96, v96, v108
    v_add_f32_e32 v97, v97, v109
    v_lshlrev_b32_e32 v108, 16, v73
    v_and_b32_e32 v109, 0xffff0000, v73
    v_add_f32_e32 v98, v98, v108
    v_add_f32_e32 v99, v99, v109
    v_lshlrev_b32_e32 v108, 16, v74
    v_and_b32_e32 v109, 0xffff0000, v74
    v_add_f32_e32 v100, v100, v108
    v_add_f32_e32 v101, v101, v109
    v_lshlrev_b32_e32 v108, 16, v75
    v_and_b32_e32 v109, 0xffff0000, v75
    v_add_f32_e32 v102, v102, v108
    v_add_f32_e32 v103, v103, v109
    v_lshlrev_b32_e32 v108, 16, v76
    v_and_b32_e32 v109, 0xffff0000, v76
    v_add_f32_e32 v96, v96, v108
    v_add_f32_e32 v97, v97, v109
    v_lshlrev_b32_e32 v108, 16, v77
    v_and_b32_e32 v109, 0xffff0000, v77
    v_add_f32_e32 v98, v98, v108
    v_add_f32_e32 v99, v99, v109
    v_lshlrev_b32_e32 v108, 16, v78
    v_and_b32_e32 v109, 0xffff0000, v78
    v_add_f32_e32 v100, v100, v108
    v_add_f32_e32 v101, v101, v109
    v_lshlrev_b32_e32 v108, 16, v79
    v_and_b32_e32 v109, 0xffff0000, v79
    v_add_f32_e32 v102, v102, v108
    v_add_f32_e32 v103, v103, v109
    v_lshlrev_b32_e32 v108, 16, v80
    v_and_b32_e32 v109, 0xffff0000, v80
    v_add_f32_e32 v96, v96, v108
    v_add_f32_e32 v97, v97, v109
    v_lshlrev_b32_e32 v108, 16, v81
    v_and_b32_e32 v109, 0xffff0000, v81
    v_add_f32_e32 v98, v98, v108
    v_add_f32_e32 v99, v99, v109
    v_lshlrev_b32_e32 v108, 16, v82
    v_and_b32_e32 v109, 0xffff0000, v82
    v_add_f32_e32 v100, v100, v108
    v_add_f32_e32 v101, v101, v109
    v_lshlrev_b32_e32 v108, 16, v83
    v_and_b32_e32 v109, 0xffff0000, v83
    v_add_f32_e32 v102, v102, v108
    v_add_f32_e32 v103, v103, v109
    v_lshlrev_b32_e32 v108, 16, v84
    v_and_b32_e32 v109, 0xffff0000, v84
    v_add_f32_e32 v96, v96, v108
    v_add_f32_e32 v97, v97, v109
    v_lshlrev_b32_e32 v108, 16, v85
    v_and_b32_e32 v109, 0xffff0000, v85
    v_add_f32_e32 v98, v98, v108
    v_add_f32_e32 v99, v99, v109
    v_lshlrev_b32_e32 v108, 16, v86
    v_and_b32_e32 v109, 0xffff0000, v86
    v_add_f32_e32 v100, v100, v108
    v_add_f32_e32 v101, v101, v109
    v_lshlrev_b32_e32 v108, 16, v87
    v_and_b32_e32 v109, 0xffff0000, v87
    v_add_f32_e32 v102, v102, v108
    v_add_f32_e32 v103, v103, v109
    v_lshlrev_b32_e32 v108, 16, v88
    v_and_b32_e32 v109, 0xffff0000, v88
    v_add_f32_e32 v96, v96, v108
    v_add_f32_e32 v97, v97, v109
    v_lshlrev_b32_e32 v108, 16, v89
    v_and_b32_e32 v109, 0xffff0000, v89
    v_add_f32_e32 v98, v98, v108
    v_add_f32_e32 v99, v99, v109
    v_lshlrev_b32_e32 v108, 16, v90
    v_and_b32_e32 v109, 0xffff0000, v90
    v_add_f32_e32 v100, v100, v108
    v_add_f32_e32 v101, v101, v109
    v_lshlrev_b32_e32 v108, 16, v91
    v_and_b32_e32 v109, 0xffff0000, v91
    v_add_f32_e32 v102, v102, v108
    v_add_f32_e32 v103, v103, v109
    v_lshlrev_b32_e32 v108, 16, v92
    v_and_b32_e32 v109, 0xffff0000, v92
    v_add_f32_e32 v96, v96, v108
    v_add_f32_e32 v97, v97, v109
    v_lshlrev_b32_e32 v108, 16, v93
    v_and_b32_e32 v109, 0xffff0000, v93
    v_add_f32_e32 v98, v98, v108
    v_add_f32_e32 v99, v99, v109
    v_lshlrev_b32_e32 v108, 16, v94
    v_and_b32_e32 v109, 0xffff0000, v94
    v_add_f32_e32 v100, v100, v108
    v_add_f32_e32 v101, v101, v109
    v_lshlrev_b32_e32 v108, 16, v95
    v_and_b32_e32 v109, 0xffff0000, v95
    v_add_f32_e32 v102, v102, v108
    v_add_f32_e32 v103, v103, v109
    v_cvt_pk_bf16_f32 v104, v96, v97
    v_cvt_pk_bf16_f32 v105, v98, v99
    v_cvt_pk_bf16_f32 v106, v100, v101
    v_cvt_pk_bf16_f32 v107, v102, v103
    s_nop 0
    v_permlane32_swap_b32_e32 v104, v106
    v_permlane32_swap_b32_e32 v105, v107
    s_nop 0
    v_permlane16_swap_b32_e32 v104, v106
    v_permlane16_swap_b32_e32 v105, v107
    buffer_store_dwordx4 v[104:107], v111, s[12:15], s53 offen sc0 sc1
A_t0c:
    s_cmp_eq_u32 s28, 3
    s_cbranch_scc0 A_t1
    s_mov_b32 s57, 12
    s_mov_b32 s58, 0
A_poll7:
    buffer_load_dword v115, v114, s[96:99], 0 offen sc1
    s_waitcnt vmcnt(0)
    v_readfirstlane_b32 s56, v115
    s_add_u32 s58, s58, 1
    s_lshr_b32 s56, s56, s57
    s_and_b32 s56, s56, 15
    s_cmp_ge_u32 s56, 8
    s_cbranch_scc1 A_poll_done7
    s_sleep 4
    s_cmp_lt_u32 s58, 400000
    s_cbranch_scc1 A_poll7
A_poll_done7:
A_t1:
    s_barrier
    s_add_u32 s53, s53, 256
    s_add_u32 s57, s52, 0
    buffer_load_dwordx4 v[64:67], v110, s[8:11], s57 offen sc1
    s_add_u32 s57, s52, 143360
    buffer_load_dwordx4 v[68:71], v110, s[8:11], s57 offen sc1
    s_add_u32 s57, s52, 286720
    buffer_load_dwordx4 v[72:75], v110, s[8:11], s57 offen sc1
    s_add_u32 s57, s52, 430080
    buffer_load_dwordx4 v[76:79], v110, s[8:11], s57 offen sc1
    s_add_u32 s57, s52, 573440
    buffer_load_dwordx4 v[80:83], v110, s[8:11], s57 offen sc1
    s_add_u32 s57, s52, 716800
    buffer_load_dwordx4 v[84:87], v110, s[8:11], s57 offen sc1
    s_add_u32 s57, s52, 860160
    buffer_load_dwordx4 v[88:91], v110, s[8:11], s57 offen sc1
    s_add_u32 s57, s52, 1003520
    buffer_load_dwordx4 v[92:95], v110, s[8:11], s57 offen sc1
    s_waitcnt vmcnt(8)
    s_barrier
    s_cmp_eq_u32 s28, 3
    s_cbranch_scc0 A_t2
    s_mov_b32 s56, 65536
    v_mov_b32_e32 v112, s56
    buffer_atomic_add v112, v113, s[96:99], 0 offen sc1
A_t2:
    s_waitcnt vmcnt(0)
    v_lshlrev_b32_e32 v96, 16, v64
    v_and_b32_e32 v97, 0xffff0000, v64
    v_lshlrev_b32_e32 v98, 16, v65
    v_and_b32_e32 v99, 0xffff0000, v65
    v_lshlrev_b32_e32 v100, 16, v66
    v_and_b32_e32 v101, 0xffff0000, v66
    v_lshlrev_b32_e32 v102, 16, v67
    v_and_b32_e32 v103, 0xffff0000, v67
    v_lshlrev_b32_e32 v108, 16, v68
    v_and_b32_e32 v109, 0xffff0000, v68
    v_add_f32_e32 v96, v96, v108
    v_add_f32_e32 v97, v97, v109
    v_lshlrev_b32_e32 v108, 16, v69
    v_and_b32_e32 v109, 0xffff0000, v69
    v_add_f32_e32 v98, v98, v108
    v_add_f32_e32 v99, v99, v109
    v_lshlrev_b32_e32 v108, 16, v70
    v_and_b32_e32 v109, 0xffff0000, v70
    v_add_f32_e32 v100, v100, v108
    v_add_f32_e32 v101, v101, v109
    v_lshlrev_b32_e32 v108, 16, v71
    v_and_b32_e32 v109, 0xffff0000, v71
    v_add_f32_e32 v102, v102, v108
    v_add_f32_e32 v103, v103, v109
    v_lshlrev_b32_e32 v108, 16, v72
    v_and_b32_e32 v109, 0xffff0000, v72
    v_add_f32_e32 v96, v96, v108
    v_add_f32_e32 v97, v97, v109
    v_lshlrev_b32_e32 v108, 16, v73
    v_and_b32_e32 v109, 0xffff0000, v73
    v_add_f32_e32 v98, v98, v108
    v_add_f32_e32 v99, v99, v109
    v_lshlrev_b32_e32 v108, 16, v74
    v_and_b32_e32 v109, 0xffff0000, v74
    v_add_f32_e32 v100, v100, v108
    v_add_f32_e32 v101, v101, v109
    v_lshlrev_b32_e32 v108, 16, v75
    v_and_b32_e32 v109, 0xffff0000, v75
    v_add_f32_e32 v102, v102, v108
    v_add_f32_e32 v103, v103, v109
    v_lshlrev_b32_e32 v108, 16, v76
    v_and_b32_e32 v109, 0xffff0000, v76
    v_add_f32_e32 v96, v96, v108
    v_add_f32_e32 v97, v97, v109
    v_lshlrev_b32_e32 v108, 16, v77
    v_and_b32_e32 v109, 0xffff0000, v77
    v_add_f32_e32 v98, v98, v108
    v_add_f32_e32 v99, v99, v109
    v_lshlrev_b32_e32 v108, 16, v78
    v_and_b32_e32 v109, 0xffff0000, v78
    v_add_f32_e32 v100, v100, v108
    v_add_f32_e32 v101, v101, v109
    v_lshlrev_b32_e32 v108, 16, v79
    v_and_b32_e32 v109, 0xffff0000, v79
    v_add_f32_e32 v102, v102, v108
    v_add_f32_e32 v103, v103, v109
    v_lshlrev_b32_e32 v108, 16, v80
    v_and_b32_e32 v109, 0xffff0000, v80
    v_add_f32_e32 v96, v96, v108
    v_add_f32_e32 v97, v97, v109
    v_lshlrev_b32_e32 v108, 16, v81
    v_and_b32_e32 v109, 0xffff0000, v81
    v_add_f32_e32 v98, v98, v108
    v_add_f32_e32 v99, v99, v109
    v_lshlrev_b32_e32 v108, 16, v82
    v_and_b32_e32 v109, 0xffff0000, v82
    v_add_f32_e32 v100, v100, v108
    v_add_f32_e32 v101, v101, v109
    v_lshlrev_b32_e32 v108, 16, v83
    v_and_b32_e32 v109, 0xffff0000, v83
    v_add_f32_e32 v102, v102, v108
    v_add_f32_e32 v103, v103, v109
    v_lshlrev_b32_e32 v108, 16, v84
    v_and_b32_e32 v109, 0xffff0000, v84
    v_add_f32_e32 v96, v96, v108
    v_add_f32_e32 v97, v97, v109
    v_lshlrev_b32_e32 v108, 16, v85
    v_and_b32_e32 v109, 0xffff0000, v85
    v_add_f32_e32 v98, v98, v108
    v_add_f32_e32 v99, v99, v109
    v_lshlrev_b32_e32 v108, 16, v86
    v_and_b32_e32 v109, 0xffff0000, v86
    v_add_f32_e32 v100, v100, v108
    v_add_f32_e32 v101, v101, v109
    v_lshlrev_b32_e32 v108, 16, v87
    v_and_b32_e32 v109, 0xffff0000, v87
    v_add_f32_e32 v102, v102, v108
    v_add_f32_e32 v103, v103, v109
    v_lshlrev_b32_e32 v108, 16, v88
    v_and_b32_e32 v109, 0xffff0000, v88
    v_add_f32_e32 v96, v96, v108
    v_add_f32_e32 v97, v97, v109
    v_lshlrev_b32_e32 v108, 16, v89
    v_and_b32_e32 v109, 0xffff0000, v89
    v_add_f32_e32 v98, v98, v108
    v_add_f32_e32 v99, v99, v109
    v_lshlrev_b32_e32 v108, 16, v90
    v_and_b32_e32 v109, 0xffff0000, v90
    v_add_f32_e32 v100, v100, v108
    v_add_f32_e32 v101, v101, v109
    v_lshlrev_b32_e32 v108, 16, v91
    v_and_b32_e32 v109, 0xffff0000, v91
    v_add_f32_e32 v102, v102, v108
    v_add_f32_e32 v103, v103, v109
    v_lshlrev_b32_e32 v108, 16, v92
    v_and_b32_e32 v109, 0xffff0000, v92
    v_add_f32_e32 v96, v96, v108
    v_add_f32_e32 v97, v97, v109
    v_lshlrev_b32_e32 v108, 16, v93
    v_and_b32_e32 v109, 0xffff0000, v93
    v_add_f32_e32 v98, v98, v108
    v_add_f32_e32 v99, v99, v109
    v_lshlrev_b32_e32 v108, 16, v94
    v_and_b32_e32 v109, 0xffff0000, v94
    v_add_f32_e32 v100, v100, v108
    v_add_f32_e32 v101, v101, v109
    v_lshlrev_b32_e32 v108, 16, v95
    v_and_b32_e32 v109, 0xffff0000, v95
    v_add_f32_e32 v102, v102, v108
    v_add_f32_e32 v103, v103, v109
    v_cvt_pk_bf16_f32 v104, v96, v97
    v_cvt_pk_bf16_f32 v105, v98, v99
    v_cvt_pk_bf16_f32 v106, v100, v101
    v_cvt_pk_bf16_f32 v107, v102, v103
    s_nop 0
    v_permlane32_swap_b32_e32 v104, v106
    v_permlane32_swap_b32_e32 v105, v107
    s_nop 0
    v_permlane16_swap_b32_e32 v104, v106
    v_permlane16_swap_b32_e32 v105, v107
    buffer_store_dwordx4 v[104:107], v111, s[12:15], s53 offen sc0 sc1
    s_cmp_eq_u32 s28, 3
    s_cbranch_scc0 A_t3
    s_mov_b32 s57, 16
    s_mov_b32 s58, 0
A_poll8:
    buffer_load_dword v115, v114, s[96:99], 0 offen sc1
    s_waitcnt vmcnt(0)
    v_readfirstlane_b32 s56, v115
    s_add_u32 s58, s58, 1
    s_lshr_b32 s56, s56, s57
    s_and_b32 s56, s56, 15
    s_cmp_ge_u32 s56, 8
    s_cbranch_scc1 A_poll_done8
    s_sleep 4
    s_cmp_lt_u32 s58, 400000
    s_cbranch_scc1 A_poll8
A_poll_done8:
A_t3:
    s_barrier
    s_add_u32 s52, s52, 28672
    s_add_u32 s53, s53, 256
    s_add_u32 s57, s52, 0
    buffer_load_dwordx4 v[64:67], v110, s[8:11], s57 offen sc1
    s_add_u32 s57, s52, 143360
    buffer_load_dwordx4 v[68:71], v110, s[8:11], s57 offen sc1
    s_add_u32 s57, s52, 286720
    buffer_load_dwordx4 v[72:75], v110, s[8:11], s57 offen sc1
    s_add_u32 s57, s52, 430080
    buffer_load_dwordx4 v[76:79], v110, s[8:11], s57 offen sc1
    s_add_u32 s57, s52, 573440
    buffer_load_dwordx4 v[80:83], v110, s[8:11], s57 offen sc1
    s_add_u32 s57, s52, 716800
    buffer_load_dwordx4 v[84:87], v110, s[8:11], s57 offen sc1
    s_add_u32 s57, s52, 860160
    buffer_load_dwordx4 v[88:91], v110, s[8:11], s57 offen sc1
    s_add_u32 s57, s52, 1003520
    buffer_load_dwordx4 v[92:95], v110, s[8:11], s57 offen sc1
    s_waitcnt vmcnt(0)
    v_lshlrev_b32_e32 v96, 16, v64
    v_and_b32_e32 v97, 0xffff0000, v64
    v_lshlrev_b32_e32 v98, 16, v65
    v_and_b32_e32 v99, 0xffff0000, v65
    v_lshlrev_b32_e32 v100, 16, v66
    v_and_b32_e32 v101, 0xffff0000, v66
    v_lshlrev_b32_e32 v102, 16, v67
    v_and_b32_e32 v103, 0xffff0000, v67
    v_lshlrev_b32_e32 v108, 16, v68
    v_and_b32_e32 v109, 0xffff0000, v68
    v_add_f32_e32 v96, v96, v108
    v_add_f32_e32 v97, v97, v109
    v_lshlrev_b32_e32 v108, 16, v69
    v_and_b32_e32 v109, 0xffff0000, v69
    v_add_f32_e32 v98, v98, v108
    v_add_f32_e32 v99, v99, v109
    v_lshlrev_b32_e32 v108, 16, v70
    v_and_b32_e32 v109, 0xffff0000, v70
    v_add_f32_e32 v100, v100, v108
    v_add_f32_e32 v101, v101, v109
    v_lshlrev_b32_e32 v108, 16, v71
    v_and_b32_e32 v109, 0xffff0000, v71
    v_add_f32_e32 v102, v102, v108
    v_add_f32_e32 v103, v103, v109
    v_lshlrev_b32_e32 v108, 16, v72
    v_and_b32_e32 v109, 0xffff0000, v72
    v_add_f32_e32 v96, v96, v108
    v_add_f32_e32 v97, v97, v109
    v_lshlrev_b32_e32 v108, 16, v73
    v_and_b32_e32 v109, 0xffff0000, v73
    v_add_f32_e32 v98, v98, v108
    v_add_f32_e32 v99, v99, v109
    v_lshlrev_b32_e32 v108, 16, v74
    v_and_b32_e32 v109, 0xffff0000, v74
    v_add_f32_e32 v100, v100, v108
    v_add_f32_e32 v101, v101, v109
    v_lshlrev_b32_e32 v108, 16, v75
    v_and_b32_e32 v109, 0xffff0000, v75
    v_add_f32_e32 v102, v102, v108
    v_add_f32_e32 v103, v103, v109
    v_lshlrev_b32_e32 v108, 16, v76
    v_and_b32_e32 v109, 0xffff0000, v76
    v_add_f32_e32 v96, v96, v108
    v_add_f32_e32 v97, v97, v109
    v_lshlrev_b32_e32 v108, 16, v77
    v_and_b32_e32 v109, 0xffff0000, v77
    v_add_f32_e32 v98, v98, v108
    v_add_f32_e32 v99, v99, v109
    v_lshlrev_b32_e32 v108, 16, v78
    v_and_b32_e32 v109, 0xffff0000, v78
    v_add_f32_e32 v100, v100, v108
    v_add_f32_e32 v101, v101, v109
    v_lshlrev_b32_e32 v108, 16, v79
    v_and_b32_e32 v109, 0xffff0000, v79
    v_add_f32_e32 v102, v102, v108
    v_add_f32_e32 v103, v103, v109
    v_lshlrev_b32_e32 v108, 16, v80
    v_and_b32_e32 v109, 0xffff0000, v80
    v_add_f32_e32 v96, v96, v108
    v_add_f32_e32 v97, v97, v109
    v_lshlrev_b32_e32 v108, 16, v81
    v_and_b32_e32 v109, 0xffff0000, v81
    v_add_f32_e32 v98, v98, v108
    v_add_f32_e32 v99, v99, v109
    v_lshlrev_b32_e32 v108, 16, v82
    v_and_b32_e32 v109, 0xffff0000, v82
    v_add_f32_e32 v100, v100, v108
    v_add_f32_e32 v101, v101, v109
    v_lshlrev_b32_e32 v108, 16, v83
    v_and_b32_e32 v109, 0xffff0000, v83
    v_add_f32_e32 v102, v102, v108
    v_add_f32_e32 v103, v103, v109
    v_lshlrev_b32_e32 v108, 16, v84
    v_and_b32_e32 v109, 0xffff0000, v84
    v_add_f32_e32 v96, v96, v108
    v_add_f32_e32 v97, v97, v109
    v_lshlrev_b32_e32 v108, 16, v85
    v_and_b32_e32 v109, 0xffff0000, v85
    v_add_f32_e32 v98, v98, v108
    v_add_f32_e32 v99, v99, v109
    v_lshlrev_b32_e32 v108, 16, v86
    v_and_b32_e32 v109, 0xffff0000, v86
    v_add_f32_e32 v100, v100, v108
    v_add_f32_e32 v101, v101, v109
    v_lshlrev_b32_e32 v108, 16, v87
    v_and_b32_e32 v109, 0xffff0000, v87
    v_add_f32_e32 v102, v102, v108
    v_add_f32_e32 v103, v103, v109
    v_lshlrev_b32_e32 v108, 16, v88
    v_and_b32_e32 v109, 0xffff0000, v88
    v_add_f32_e32 v96, v96, v108
    v_add_f32_e32 v97, v97, v109
    v_lshlrev_b32_e32 v108, 16, v89
    v_and_b32_e32 v109, 0xffff0000, v89
    v_add_f32_e32 v98, v98, v108
    v_add_f32_e32 v99, v99, v109
    v_lshlrev_b32_e32 v108, 16, v90
    v_and_b32_e32 v109, 0xffff0000, v90
    v_add_f32_e32 v100, v100, v108
    v_add_f32_e32 v101, v101, v109
    v_lshlrev_b32_e32 v108, 16, v91
    v_and_b32_e32 v109, 0xffff0000, v91
    v_add_f32_e32 v102, v102, v108
    v_add_f32_e32 v103, v103, v109
    v_lshlrev_b32_e32 v108, 16, v92
    v_and_b32_e32 v109, 0xffff0000, v92
    v_add_f32_e32 v96, v96, v108
    v_add_f32_e32 v97, v97, v109
    v_lshlrev_b32_e32 v108, 16, v93
    v_and_b32_e32 v109, 0xffff0000, v93
    v_add_f32_e32 v98, v98, v108
    v_add_f32_e32 v99, v99, v109
    v_lshlrev_b32_e32 v108, 16, v94
    v_and_b32_e32 v109, 0xffff0000, v94
    v_add_f32_e32 v100, v100, v108
    v_add_f32_e32 v101, v101, v109
    v_lshlrev_b32_e32 v108, 16, v95
    v_and_b32_e32 v109, 0xffff0000, v95
    v_add_f32_e32 v102, v102, v108
    v_add_f32_e32 v103, v103, v109
    v_cvt_pk_bf16_f32 v104, v96, v97
    v_cvt_pk_bf16_f32 v105, v98, v99
    v_cvt_pk_bf16_f32 v106, v100, v101
    v_cvt_pk_bf16_f32 v107, v102, v103
    s_nop 0
    v_permlane32_swap_b32_e32 v104, v106
    v_permlane32_swap_b32_e32 v105, v107
    s_nop 0
    v_permlane16_swap_b32_e32 v104, v106
    v_permlane16_swap_b32_e32 v105, v107
    buffer_store_dwordx4 v[104:107], v111, s[12:15], s53 offen sc0 sc1
    s_waitcnt vmcnt(0)
    s_endpgm
A_end:
    s_endpgm
.section .rodata,"a"
.p2align 6
.amdhsa_kernel concat_heads__gqa_block_cached__mha_block_cached__near_ridge_kernel
  .amdhsa_next_free_vgpr 512
  .amdhsa_next_free_sgpr 102
  .amdhsa_accum_offset 256
  .amdhsa_group_segment_fixed_size 0
  .amdhsa_kernarg_size 104
  .amdhsa_user_sgpr_count 2
  .amdhsa_user_sgpr_kernarg_segment_ptr 1
  .amdhsa_system_sgpr_workgroup_id_x 1
.end_amdhsa_kernel
```
